```python
import torch

def _softmax(x, axis=-1):
    return torch.softmax(x, dim=axis)

def _gelu(x):
    return torch.nn.functional.gelu(x, approximate='tanh')

def _silu(x):
    return torch.nn.functional.silu(x)

def _sigmoid(x):
    return torch.sigmoid(x)

def _layernorm(x, axis=-1, eps=1e-05):
    m = x.mean(dim=axis, keepdim=True)
    v = x.var(dim=axis, keepdim=True, unbiased=False)
    return (x - m) / torch.sqrt(v + eps)

def _scatter_add(tgt, idx, src, axis=0):
    return tgt.clone().index_add_(axis, idx, src)

def _segment_sum(src, seg, n):
    out = torch.zeros((n,) + src.shape[1:], dtype=src.dtype)
    return out.index_add_(0, seg, src)

def _pad(x, pw):
    flat = tuple((v for pair in reversed(pw) for v in pair))
    return torch.nn.functional.pad(x, flat)
kernel_name = 'gated_mix__memory_aug_recurrent_mem_tr__ssm_conv_h3__prompt'

def setup_inputs():

    _w = lambda a: (lambda t: t.to(torch.bfloat16) if t.is_floating_point() else t)(torch.as_tensor(a))

    def _A_setup():
        B, S, Dm = (1, 2048, 640)
        H, Dh = (32, 192)
        M, seg = (8, 32)
        seg = min(seg, S)
        S = S // seg * seg
        return {'x': _w((lambda *s: torch.randn(*s, dtype=torch.bfloat16) * 0.05)(B, S, Dm)), 'mem0': _w((lambda *s: torch.randn(*s, dtype=torch.bfloat16) * 0.4)(B, M, Dm)), 'Wq': _w((lambda *s: torch.randn(*s, dtype=torch.bfloat16) * 6.4)(Dm, H, Dh) * Dm ** (-0.5)), 'Wk': _w((lambda *s: torch.randn(*s, dtype=torch.bfloat16) * 6.4)(Dm, H, Dh) * Dm ** (-0.5)), 'Wv': _w((lambda *s: torch.randn(*s, dtype=torch.bfloat16) * 0.4)(Dm, H, Dh) * Dm ** (-0.5)), 'Wo': _w((lambda *s: torch.randn(*s, dtype=torch.bfloat16) * 0.4)(H, Dh, Dm) * (H * Dh) ** (-0.5)), 'seg_len': seg}
    _A_in = _A_setup()

    def _B_setup():
        B, S, D = (1, 2048, 640)
        ks = 4
        return {'q': _w((lambda *s: torch.randn(*s, dtype=torch.bfloat16) * 0.05)(B, S, D)), 'k': _w((lambda *s: torch.randn(*s, dtype=torch.bfloat16) * 0.4)(B, S, D)), 'v': _w((lambda *s: torch.randn(*s, dtype=torch.bfloat16) * 0.4)(B, S, D)), 'shift_k': _w((lambda *s: torch.randn(*s, dtype=torch.bfloat16) * 0.4)(D, ks) * 0.5), 'ssm_k': _w((lambda *s: torch.randn(*s, dtype=torch.bfloat16) * 0.4)(D, S) * (1.0 / S ** 0.5)), 'ssm_D': _w((lambda *s: torch.randn(*s, dtype=torch.bfloat16) * 0.4)(D))}
    _B_in = _B_setup()
    return {'A_x': _A_in['x'], 'A_mem0': _A_in['mem0'], 'A_Wq': _A_in['Wq'], 'A_Wk': _A_in['Wk'], 'A_Wv': _A_in['Wv'], 'A_Wo': _A_in['Wo'], 'A_seg_len': _A_in['seg_len'], 'B_q': _B_in['q'], 'B_k': _B_in['k'], 'B_v': _B_in['v'], 'B_shift_k': _B_in['shift_k'], 'B_ssm_k': _B_in['ssm_k'], 'B_ssm_D': _B_in['ssm_D'], 'gate_w': _w((lambda *s: torch.randn(*s, dtype=torch.bfloat16) * 0.05)(640) * 16.0)}

def reference(A_x, A_mem0, A_Wq, A_Wk, A_Wv, A_Wo, A_seg_len, B_q, B_k, B_v, B_shift_k, B_ssm_k, B_ssm_D, gate_w):

    def _A_ref(x, mem0, Wq, Wk, Wv, Wo, seg_len):
        B, S, Dm = x.shape
        H, Dh = (Wq.shape[1], Wq.shape[2])
        M = mem0.shape[1]
        scale = Dh ** (-0.5)
        n_seg = S // seg_len
        L = M + seg_len
        idx = torch.arange(L)
        mask = (idx[:, None] < M) | (idx[:, None] >= idx[None, :])
        mem = mem0
        outs = []
        for s in range(n_seg):
            xs = x[:, s * seg_len:(s + 1) * seg_len, :].clone()
            h = torch.concatenate([mem, xs], axis=1)
            q = torch.einsum('btd,dhe->bhte', h, Wq)
            k = torch.einsum('btd,dhe->bhte', h, Wk)
            v = torch.einsum('btd,dhe->bhte', h, Wv)
            scores = torch.einsum('bhqe,bhke->bhqk', q, k) * scale
            scores = torch.where(mask[None, None], scores, -1000000000.0)
            p = _softmax(scores, axis=-1)
            o = torch.einsum('bhqk,bhke->bhqe', p, v)
            o = torch.einsum('bhte,hed->btd', o, Wo)
            mem = o[:, :M, :].clone()
            outs.append(o[:, M:, :])
        return torch.concatenate(outs, axis=1)

    def _B_ref(q, k, v, shift_k, ssm_k, ssm_D):
        B, S, D = q.shape
        ks = shift_k.shape[-1]
        k_pad = _pad(k, ((0, 0), (ks - 1, 0), (0, 0)))
        k_shift = torch.zeros_like(k)
        for t in range(ks):
            k_shift = k_shift + k_pad[:, t:t + S, :] * shift_k[:, ks - 1 - t][None, None, :]
        kv = k_shift * v
        L = 2 * S
        kv_pad = _pad(kv, ((0, 0), (0, S), (0, 0)))
        kf_pad = _pad(ssm_k, ((0, 0), (0, S)))
        kv_f = (lambda x, axes=(-2, -1): torch.fft.rfft2(x.float(), dim=axes))(kv_pad[:, None, :, :], axes=(1, 2))
        kf_f = (lambda x, axes=(-2, -1): torch.fft.rfft2(x.float(), dim=axes))(kf_pad[:, None, :], axes=(1, 2))
        kf_f = (lambda x, *d: x.permute(*d))(kf_f, 1, 2, 0)
        y_f = kv_f * kf_f[None, :, :, :]
        y = (lambda x, s, axes=(-2, -1): torch.fft.irfft2(x, s=s, dim=axes).to(torch.bfloat16))(y_f, (1, L), axes=(1, 2))[:, 0, :S, :]
        y = y + kv * ssm_D[None, None, :]
        return q * y
    x = A_x
    g = _sigmoid((x * gate_w).sum(-1, keepdims=True))
    a = _A_ref(x, A_mem0, A_Wq, A_Wk, A_Wv, A_Wo, A_seg_len)
    b = _B_ref(x, B_k, B_v, B_shift_k, B_ssm_k, B_ssm_D)
    return g * a + (1 - g) * b
```

```asm
; @launch grid=(256,1,1) block=(256,1,1) lds=163840
.amdgcn_target "amdgcn-amd-amdhsa--gfx950"
.text
.globl gated_mix__memory_aug_recurrent_mem_tr__ssm_conv_h3__prompt_kernel
.p2align 8
.type gated_mix__memory_aug_recurrent_mem_tr__ssm_conv_h3__prompt_kernel,@function
gated_mix__memory_aug_recurrent_mem_tr__ssm_conv_h3__prompt_kernel:
  s_cmp_ge_u32 s2, 256
  s_cbranch_scc1 L_exit
  s_load_dwordx4 s[16:19], s[0:1], 120
  s_getreg_b32 s20, hwreg(HW_REG_XCC_ID, 0, 4)
  v_lshrrev_b32 v1, 6, v0
  s_nop 0
  v_readfirstlane_b32 s12, v1
  s_min_u32 s20, s20, 8
  s_waitcnt lgkmcnt(0)
  s_mov_b32 s8, s16
  s_mov_b32 s9, s17
  s_mov_b32 s10, 256
  s_mov_b32 s11, 0x20000
  s_mov_b32 s4, s18
  s_mov_b32 s5, s19
  s_mov_b32 s6, 268435456
  s_mov_b32 s7, 0x20000
  s_and_b32 s22, s20, 3
  s_lshl_b32 s22, s22, 6
  s_and_b32 s23, s20, 12
  s_add_u32 s22, s22, s23
  v_mov_b32 v1, 1
  v_mov_b32 v2, s22
  v_mov_b32 v3, 0
  s_cmp_lg_u32 s12, 0
  s_cbranch_scc1 L_tk0
  s_mov_b64 exec, 1
  buffer_atomic_add v1, v2, s[8:11], 0 offen sc0 sc1
  v_mov_b32 v4, 51905536
  buffer_load_dword v5, v4, s[4:7], 0 offen
  s_waitcnt vmcnt(0)
  ds_write_b32 v3, v1
  s_waitcnt lgkmcnt(0)
  s_mov_b64 exec, -1
L_tk0:
  s_barrier
  ds_read_b32 v1, v3
  s_waitcnt lgkmcnt(0)
  v_readfirstlane_b32 s21, v1
  s_barrier
  s_cmp_lt_u32 s20, 8
  s_cselect_b32 s22, 32, 0
  s_cmp_lt_u32 s21, s22
  s_cbranch_scc1 L_have_role
  v_and_b32 v2, 3, v0
  v_lshlrev_b32 v2, 6, v2
  v_and_b32 v1, 12, v0
  v_add_u32 v2, v2, v1
  s_mov_b32 s15, 0
L_sp_cnt:
  buffer_load_dword v1, v2, s[8:11], 0 offen sc1
  s_waitcnt vmcnt(0)
  v_readlane_b32 s90, v1, 0
  v_readlane_b32 s91, v1, 1
  v_readlane_b32 s92, v1, 2
  v_readlane_b32 s93, v1, 3
  v_readlane_b32 s94, v1, 4
  v_readlane_b32 s95, v1, 5
  v_readlane_b32 s96, v1, 6
  v_readlane_b32 s97, v1, 7
  v_readlane_b32 s98, v1, 8
  s_mov_b32 s99, s90
  s_add_u32 s99, s99, s91
  s_add_u32 s99, s99, s92
  s_add_u32 s99, s99, s93
  s_add_u32 s99, s99, s94
  s_add_u32 s99, s99, s95
  s_add_u32 s99, s99, s96
  s_add_u32 s99, s99, s97
  s_add_u32 s99, s99, s98
  s_cmp_ge_u32 s99, 256
  s_cbranch_scc1 L_sp_cnt_ok
  s_sleep 4
  s_add_u32 s15, s15, 1
  s_cmp_lt_u32 s15, 0x40000
  s_cbranch_scc1 L_sp_cnt
  s_branch L_fail
L_sp_cnt_ok:
  s_min_u32 s90, s90, 32
  s_min_u32 s91, s91, 32
  s_min_u32 s92, s92, 32
  s_min_u32 s93, s93, 32
  s_min_u32 s94, s94, 32
  s_min_u32 s95, s95, 32
  s_min_u32 s96, s96, 32
  s_min_u32 s97, s97, 32
  v_mov_b32 v1, 1
  v_mov_b32 v2, 176
  v_mov_b32 v3, 0
  s_cmp_lg_u32 s12, 0
  s_cbranch_scc1 L_tk1
  s_mov_b64 exec, 1
  buffer_atomic_add v1, v2, s[8:11], 0 offen sc0 sc1
  s_waitcnt vmcnt(0)
  ds_write_b32 v3, v1
  s_waitcnt lgkmcnt(0)
  s_mov_b64 exec, -1
L_tk1:
  s_barrier
  ds_read_b32 v1, v3
  s_waitcnt lgkmcnt(0)
  v_readfirstlane_b32 s21, v1
  s_barrier
  s_sub_u32 s22, 32, s90
  s_mov_b32 s20, 0
  s_add_u32 s23, s21, s90
  s_cmp_lt_u32 s21, s22
  s_cbranch_scc1 L_took
  s_sub_u32 s21, s21, s22
  s_sub_u32 s22, 32, s91
  s_mov_b32 s20, 1
  s_add_u32 s23, s21, s91
  s_cmp_lt_u32 s21, s22
  s_cbranch_scc1 L_took
  s_sub_u32 s21, s21, s22
  s_sub_u32 s22, 32, s92
  s_mov_b32 s20, 2
  s_add_u32 s23, s21, s92
  s_cmp_lt_u32 s21, s22
  s_cbranch_scc1 L_took
  s_sub_u32 s21, s21, s22
  s_sub_u32 s22, 32, s93
  s_mov_b32 s20, 3
  s_add_u32 s23, s21, s93
  s_cmp_lt_u32 s21, s22
  s_cbranch_scc1 L_took
  s_sub_u32 s21, s21, s22
  s_sub_u32 s22, 32, s94
  s_mov_b32 s20, 4
  s_add_u32 s23, s21, s94
  s_cmp_lt_u32 s21, s22
  s_cbranch_scc1 L_took
  s_sub_u32 s21, s21, s22
  s_sub_u32 s22, 32, s95
  s_mov_b32 s20, 5
  s_add_u32 s23, s21, s95
  s_cmp_lt_u32 s21, s22
  s_cbranch_scc1 L_took
  s_sub_u32 s21, s21, s22
  s_sub_u32 s22, 32, s96
  s_mov_b32 s20, 6
  s_add_u32 s23, s21, s96
  s_cmp_lt_u32 s21, s22
  s_cbranch_scc1 L_took
  s_sub_u32 s21, s21, s22
  s_sub_u32 s22, 32, s97
  s_mov_b32 s20, 7
  s_add_u32 s23, s21, s97
  s_cmp_lt_u32 s21, s22
  s_cbranch_scc1 L_took
  s_sub_u32 s21, s21, s22
  s_branch L_exit
L_took:
  s_mov_b32 s21, s23
L_have_role:
  s_cmp_ge_u32 s20, 4
  s_cbranch_scc1 L_worker
  s_cmp_lt_u32 s21, 8
  s_cbranch_scc1 L_role_aux
  s_mul_i32 s13, s20, 24
  s_add_u32 s13, s13, s21
  s_sub_u32 s13, s13, 8
  s_load_dwordx2 s[24:25], s[0:1], 8
  s_load_dwordx8 s[28:35], s[0:1], 16
  v_and_b32 v90, 63, v0
  v_and_b32 v91, 15, v0
  v_bfe_u32 v92, v0, 4, 2
  s_mul_i32 s43, s13, 2731
  s_lshr_b32 s43, s43, 16
  s_mul_i32 s74, s43, 24
  s_sub_u32 s40, s13, s74
  s_mul_i32 s41, s13, 0x5556
  s_lshr_b32 s41, s41, 16
  s_mul_i32 s75, s41, 3
  s_sub_u32 s42, s13, s75
  s_lshl_b32 s79, s40, 1
  s_and_b32 s74, s12, 1
  s_add_u32 s79, s79, s74
  s_lshl_b32 s72, s41, 7
  s_lshl_b32 s74, s42, 2
  s_add_u32 s73, s72, s74
  s_add_u32 s73, s73, 52199424
  s_add_u32 s72, s72, 52174848
  s_waitcnt lgkmcnt(0)
  v_lshlrev_b32 v1, 4, v90
  s_lshl_b32 s67, s12, 10
  s_add_u32 s68, s67, 4096
  s_and_b32 s70, s12, 1
  s_lshl_b32 s70, s70, 10
  s_add_u32 s69, s70, 8192
  v_mov_b32 v20, 0x44444444
  v_mov_b32 v21, 0xeeeeeeee
  v_cmp_gt_u32 vcc, 8, v91
  s_nop 0
  s_mov_b64 s[80:81], vcc
  v_cndmask_b32 v18, v21, v20, vcc
  s_lshl_b32 s74, s12, 4
  v_add_u32 v20, s74, v91
  v_mul_u32_u24 v21, 32, v20
  v_and_b32 v22, 1, v92
  v_lshl_add_u32 v21, v22, 3, v21
  v_lshrrev_b32 v22, 1, v92
  v_lshl_add_u32 v21, v22, 2, v21
  v_add_u32 v2, 10240, v21
  v_lshrrev_b32 v22, 2, v91
  v_and_b32 v23, 3, v91
  v_lshl_add_u32 v20, v92, 2, v22
  v_mul_u32_u24 v20, 32, v20
  v_lshl_add_u32 v20, v23, 3, v20
  v_add_u32 v3, 10240, v20
  s_mul_i32 s74, s41, 3840
  s_mul_i32 s75, s42, 1280
  s_add_u32 s75, s75, s74
  v_mov_b32 v24, 2147483648
  v_add_u32 v20, s75, v1
  v_add_u32 v21, 128, v20
  v_cndmask_b32 v20, v24, v20, s[80:81]
  v_cndmask_b32 v21, v24, v21, s[80:81]
  v_lshlrev_b32 v25, 5, v91
  v_lshl_add_u32 v25, v92, 4, v25
  s_add_u32 s76, s75, 768
  v_add_u32 v25, s76, v25
  v_cmp_gt_u32 vcc, 2, v92
  s_nop 1
  v_cndmask_b32 v25, v24, v25, vcc
  v_cndmask_b32 v25, v25, v24, s[80:81]
  s_cmp_eq_u32 s12, 1
  s_cselect_b64 vcc, -1, 0
  v_cndmask_b32 v25, v25, v20, vcc
  s_cmp_eq_u32 s12, 2
  s_cselect_b64 vcc, -1, 0
  v_cndmask_b32 v25, v25, v21, vcc
  v_mov_b32 v4, v25
  s_mov_b32 s56, s74
  v_lshlrev_b32 v6, 2, v90
  v_add_u32 v5, s75, v1
  v_and_b32 v20, 1, v92
  v_lshrrev_b32 v21, 1, v92
  v_lshrrev_b32 v23, 3, v91
  s_mul_i32 s74, s41, 12
  s_lshl_b32 s75, s42, 2
  s_add_u32 s60, s75, s74
  s_lshl_b32 s60, s60, 8
  s_add_u32 s75, s75, s12
  s_add_u32 s76, s74, s75
  s_lshl_b32 s76, s76, 8
  v_lshl_add_u32 v25, v20, 1, v21
  v_lshlrev_b32 v22, 6, v25
  v_lshl_add_u32 v22, v91, 2, v22
  v_add_u32 v8, s76, v22
  v_mul_u32_u24 v25, 12, v25
  v_add_u32 v25, s75, v25
  v_cmp_gt_u32 vcc, 40, v25
  v_lshlrev_b32 v14, 11, v25
  v_lshl_add_u32 v14, v23, 10, v14
  v_and_b32 v22, 7, v91
  v_lshl_add_u32 v14, v22, 4, v14
  s_and_b32 s76, s41, 7
  s_lshl_b32 s76, s76, 7
  s_mul_i32 s77, s43, 0x14000
  s_add_u32 s76, s76, s77
  v_add_u32 v14, s76, v14
  v_cndmask_b32 v14, v24, v14, vcc
  v_lshlrev_b32 v25, 14, v25
  v_lshl_add_u32 v25, v91, 4, v25
  s_lshl_b32 s76, s41, 8
  v_add_u32 v25, s76, v25
  v_cndmask_b32 v13, v24, v25, vcc
  s_mul_i32 s76, s12, 3
  s_add_u32 s77, s76, s74
  s_lshl_b32 s77, s77, 8
  v_lshlrev_b32 v25, 2, v90
  v_add_u32 v9, s77, v25
  s_lshl_b32 s76, s76, 10
  s_add_u32 s76, s76, 36864
  v_add_u32 v10, s76, v1
  s_add_u32 s76, s12, 1
  s_and_b32 s76, s76, 1
  s_lshl_b32 s76, s76, 3
  s_add_u32 s76, s76, 32768
  v_add_u32 v11, s76, v1
  s_mul_i32 s48, s41, 12288
  s_lshl_b32 s77, s42, 12
  s_add_u32 s48, s48, s77
  s_add_u32 s48, s48, s67
  s_add_u32 s48, s48, 0
  s_add_u32 s58, s67, 32768
  s_mul_i32 s77, s67, 3
  s_lshl_b32 s49, s74, 10
  s_add_u32 s49, s49, s77
  s_add_u32 s49, s49, 25165824
  s_add_u32 s57, s77, 36864
  s_mul_i32 s76, s12, 768
  s_add_u32 s76, s76, 13312
  v_lshlrev_b32 v25, 7, v21
  v_lshl_add_u32 v25, v91, 4, v25
  v_lshl_add_u32 v25, v20, 3, v25
  v_add_u32 v25, s76, v25
  v_lshlrev_b32 v22, 3, v90
  v_add_u32 v22, 24576, v22
  v_cndmask_b32 v12, v22, v25, s[80:81]
  v_and_b32 v22, 7, v91
  v_lshlrev_b32 v25, 7, v92
  v_lshl_add_u32 v25, v22, 4, v25
  v_add_u32 v154, 13312, v25
  s_lshl_b32 s76, s79, 8
  v_lshlrev_b32 v25, 4, v91
  v_lshl_add_u32 v25, v20, 3, v25
  v_lshl_add_u32 v25, v21, 7, v25
  v_add_u32 v25, s76, v25
  v_cndmask_b32 v17, v24, v25, s[80:81]
  s_lshl_b32 s76, s40, 9
  v_add_u32 v25, s76, v1
  v_cmp_gt_u32 vcc, 32, v90
  s_nop 1
  v_cndmask_b32 v25, v24, v25, vcc
  s_cmp_ge_u32 s40, 20
  s_cselect_b64 vcc, -1, 0
  v_cndmask_b32 v15, v25, v24, vcc
  s_mul_i32 s64, s12, 5120
  v_min_u32 v25, 39, v90
  v_lshlrev_b32 v25, 7, v25
  v_and_b32 v22, 3, v90
  v_lshl_add_u32 v25, v22, 4, v25
  v_add_u32 v7, s64, v25
  s_mul_i32 s76, s41, 3072
  s_lshl_b32 s77, s42, 10
  s_add_u32 s76, s76, s77
  v_and_b32 v22, 7, v91
  v_lshlrev_b32 v25, 7, v92
  v_lshl_add_u32 v25, v22, 4, v25
  v_add_u32 v25, s76, v25
  v_cndmask_b32 v16, v25, v24, s[80:81]
  s_mov_b32 s65, 67108864
  s_mov_b32 s66, 75497472
  v_cmp_eq_u32 vcc, 0, v90
  s_nop 1
  v_cndmask_b32 v155, v24, v90, vcc
  v_and_b32 v25, 1, v91
  v_lshlrev_b32 v25, 4, v25
  v_mov_b32 v22, 0x3f80
  v_lshlrev_b32 v25, v25, v22
  v_lshrrev_b32 v22, 1, v91
  v_cmp_eq_u32 vcc, 0, v22
  s_nop 1
  v_cndmask_b32 v26, 0, v25, vcc
  v_cmp_eq_u32 vcc, 1, v22
  s_nop 1
  v_cndmask_b32 v27, 0, v25, vcc
  v_cmp_eq_u32 vcc, 2, v22
  s_nop 1
  v_cndmask_b32 v28, 0, v25, vcc
  v_cmp_eq_u32 vcc, 3, v22
  s_nop 1
  v_cndmask_b32 v29, 0, v25, vcc
  v_mov_b32 v30, -1
  v_mov_b32 v34, 0x3f803f80
  v_mov_b32 v31, -1
  v_mov_b32 v35, 0x3f803f80
  v_mov_b32 v32, -1
  v_mov_b32 v36, 0x3f803f80
  v_mov_b32 v33, -1
  v_mov_b32 v37, 0x3f803f80
  s_mov_b32 s78, 0x3dd53b95
  v_mov_b32 v156, 0
  v_mov_b32 v157, 0
  v_mov_b32 v158, 0
  v_mov_b32 v159, 0
  v_mov_b32 v160, 0
  v_mov_b32 v161, 0
  v_mov_b32 v162, 0
  v_mov_b32 v163, 0
  v_mov_b32 v164, 0
  v_mov_b32 v165, 0
  v_mov_b32 v166, 0
  v_mov_b32 v167, 0
  v_mov_b32 v78, 0
  v_mov_b32 v79, 0
  v_mov_b32 v80, 0
  v_mov_b32 v81, 0
  v_mov_b32 v82, 0
  v_mov_b32 v83, 0
  v_mov_b32 v84, 0
  v_mov_b32 v85, 0
  v_mov_b32 v86, 0
  v_mov_b32 v87, 0
  v_mov_b32 v88, 0
  v_mov_b32 v89, 0
  v_mov_b32 v146, 0
  v_mov_b32 v147, 0
  v_mov_b32 v148, 0
  v_mov_b32 v149, 0
  v_mov_b32 v150, 0
  v_mov_b32 v151, 0
  v_mov_b32 v152, 0
  v_mov_b32 v153, 0
  s_mul_i32 s63, s43, 10240
  s_add_u32 s63, s63, 51380224
  s_mov_b32 s74, 50331648
  s_mov_b32 s75, 50855936
  s_add_u32 s76, s63, 0
  buffer_store_dwordx4 v[30:33], v4, s[4:7], s74 offen sc1
  buffer_store_dword v30, v8, s[4:7], s75 offen sc1
  buffer_store_dwordx4 v[30:33], v15, s[4:7], s76 offen sc1
  s_mov_b32 s74, 50462720
  s_mov_b32 s75, 50987008
  s_add_u32 s76, s63, 65536
  buffer_store_dwordx4 v[30:33], v4, s[4:7], s74 offen sc1
  buffer_store_dword v30, v8, s[4:7], s75 offen sc1
  buffer_store_dwordx4 v[30:33], v15, s[4:7], s76 offen sc1
  s_mov_b32 s74, 50593792
  s_mov_b32 s75, 51118080
  s_add_u32 s76, s63, 131072
  buffer_store_dwordx4 v[30:33], v4, s[4:7], s74 offen sc1
  buffer_store_dword v30, v8, s[4:7], s75 offen sc1
  buffer_store_dwordx4 v[30:33], v15, s[4:7], s76 offen sc1
  s_mov_b32 s74, 50724864
  s_mov_b32 s75, 51249152
  s_add_u32 s76, s63, 196608
  buffer_store_dwordx4 v[30:33], v4, s[4:7], s74 offen sc1
  buffer_store_dword v30, v8, s[4:7], s75 offen sc1
  buffer_store_dwordx4 v[30:33], v15, s[4:7], s76 offen sc1
  s_and_b32 s74, s12, 1
  s_lshl_b32 s74, s74, 1
  v_lshrrev_b32 v22, 5, v90
  v_add_u32 v22, s74, v22
  v_lshlrev_b32 v22, 1, v22
  v_and_b32 v23, 7, v90
  v_xor_b32 v23, v23, v22
  v_lshlrev_b32 v23, 4, v23
  v_lshrrev_b32 v22, 3, v90
  s_mul_i32 s74, s41, 384
  s_lshl_b32 s75, s42, 7
  s_add_u32 s74, s74, s75
  v_mul_u32_u24 v25, 12288, v22
  v_add3_u32 v38, v25, v23, s74
  s_mul_i32 s74, s41, 245760
  s_add_u32 s74, s74, s75
  v_mul_u32_u24 v25, 1280, v22
  v_add3_u32 v39, v25, v23, s74
  s_cmp_eq_u32 s42, 0
  s_cselect_b64 vcc, -1, 0
  v_cndmask_b32 v43, v24, v39, vcc
  v_lshrrev_b32 v22, 3, v91
  v_bfe_u32 v23, v91, 2, 1
  v_lshlrev_b32 v25, 4, v21
  v_lshl_add_u32 v25, v22, 3, v25
  v_lshl_add_u32 v25, v20, 2, v25
  v_add_u32 v25, v25, v23
  v_lshlrev_b32 v25, 7, v25
  v_lshl_add_u32 v22, v22, 1, v20
  v_xor_b32 v22, s12, v22
  v_lshl_add_u32 v25, v22, 5, v25
  v_and_b32 v23, 3, v91
  v_lshl_add_u32 v40, v23, 3, v25
  v_lshlrev_b32 v25, 3, v21
  v_lshl_add_u32 v25, v20, 2, v25
  v_bfe_u32 v22, v91, 2, 1
  v_add_u32 v25, v25, v22
  v_lshlrev_b32 v25, 7, v25
  v_xor_b32 v22, s12, v92
  v_lshl_add_u32 v25, v22, 5, v25
  v_lshl_add_u32 v25, v23, 3, v25
  v_lshrrev_b32 v22, 3, v91
  v_mul_u32_u24 v22, 12288, v22
  v_add_u32 v42, v25, v22
  s_mov_b32 s20, s28
  s_mov_b32 s21, s29
  s_mov_b32 s22, 7864320
  s_mov_b32 s23, 0x20000
  s_mul_i32 s74, s12, 98304
  s_add_u32 s74, s74, 0
  s_add_u32 s75, s67, 21504
  s_mov_b32 m0, s75
  s_nop 0
  buffer_load_dwordx4 v38, s[20:23], s74 offen lds
  s_add_u32 s74, s74, 393216
  s_add_u32 s75, s75, 4096
  s_mov_b32 m0, s75
  s_nop 0
  buffer_load_dwordx4 v38, s[20:23], s74 offen lds
  s_add_u32 s74, s74, 393216
  s_add_u32 s75, s75, 4096
  s_mov_b32 m0, s75
  s_nop 0
  buffer_load_dwordx4 v38, s[20:23], s74 offen lds
  s_add_u32 s74, s74, 393216
  s_add_u32 s75, s75, 4096
  s_mov_b32 m0, s75
  s_nop 0
  buffer_load_dwordx4 v38, s[20:23], s74 offen lds
  s_add_u32 s74, s74, 393216
  s_add_u32 s75, s75, 4096
  s_mov_b32 m0, s75
  s_nop 0
  buffer_load_dwordx4 v38, s[20:23], s74 offen lds
  s_add_u32 s74, s74, 393216
  s_add_u32 s75, s75, 4096
  s_mov_b32 m0, s75
  s_nop 0
  buffer_load_dwordx4 v38, s[20:23], s74 offen lds
  s_add_u32 s74, s74, 393216
  s_add_u32 s75, s75, 4096
  s_mov_b32 m0, s75
  s_nop 0
  buffer_load_dwordx4 v38, s[20:23], s74 offen lds
  s_add_u32 s74, s74, 393216
  s_add_u32 s75, s75, 4096
  s_mov_b32 m0, s75
  s_nop 0
  buffer_load_dwordx4 v38, s[20:23], s74 offen lds
  s_add_u32 s74, s74, 393216
  s_add_u32 s75, s75, 4096
  s_mov_b32 m0, s75
  s_nop 0
  buffer_load_dwordx4 v38, s[20:23], s74 offen lds
  s_add_u32 s74, s74, 393216
  s_add_u32 s75, s75, 4096
  s_mov_b32 m0, s75
  s_nop 0
  buffer_load_dwordx4 v38, s[20:23], s74 offen lds
  s_mul_i32 s74, s12, 98304
  s_add_u32 s74, s74, 3932160
  s_add_u32 s75, s67, 62464
  s_mov_b32 m0, s75
  s_nop 0
  buffer_load_dwordx4 v38, s[20:23], s74 offen lds
  s_add_u32 s74, s74, 393216
  s_add_u32 s75, s75, 4096
  s_mov_b32 m0, s75
  s_nop 0
  buffer_load_dwordx4 v38, s[20:23], s74 offen lds
  s_add_u32 s74, s74, 393216
  s_add_u32 s75, s75, 4096
  s_mov_b32 m0, s75
  s_nop 0
  buffer_load_dwordx4 v38, s[20:23], s74 offen lds
  s_add_u32 s74, s74, 393216
  s_add_u32 s75, s75, 4096
  s_mov_b32 m0, s75
  s_nop 0
  buffer_load_dwordx4 v38, s[20:23], s74 offen lds
  s_add_u32 s74, s74, 393216
  s_add_u32 s75, s75, 4096
  s_mov_b32 m0, s75
  s_nop 0
  buffer_load_dwordx4 v38, s[20:23], s74 offen lds
  s_add_u32 s74, s74, 393216
  s_add_u32 s75, s75, 4096
  s_mov_b32 m0, s75
  s_nop 0
  buffer_load_dwordx4 v38, s[20:23], s74 offen lds
  s_add_u32 s74, s74, 393216
  s_add_u32 s75, s75, 4096
  s_mov_b32 m0, s75
  s_nop 0
  buffer_load_dwordx4 v38, s[20:23], s74 offen lds
  s_add_u32 s74, s74, 393216
  s_add_u32 s75, s75, 4096
  s_mov_b32 m0, s75
  s_nop 0
  buffer_load_dwordx4 v38, s[20:23], s74 offen lds
  s_add_u32 s74, s74, 393216
  s_add_u32 s75, s75, 4096
  s_mov_b32 m0, s75
  s_nop 0
  buffer_load_dwordx4 v38, s[20:23], s74 offen lds
  s_add_u32 s74, s74, 393216
  s_add_u32 s75, s75, 4096
  s_mov_b32 m0, s75
  s_nop 0
  buffer_load_dwordx4 v38, s[20:23], s74 offen lds
  s_mov_b32 s20, s30
  s_mov_b32 s21, s31
  s_mov_b32 s22, 7864320
  s_mov_b32 s23, 0x20000
  s_mul_i32 s74, s12, 98304
  s_add_u32 s74, s74, 0
  s_add_u32 s75, s67, 103424
  s_mov_b32 m0, s75
  s_nop 0
  buffer_load_dwordx4 v38, s[20:23], s74 offen lds
  s_add_u32 s74, s74, 393216
  s_add_u32 s75, s75, 4096
  s_mov_b32 m0, s75
  s_nop 0
  buffer_load_dwordx4 v38, s[20:23], s74 offen lds
  s_add_u32 s74, s74, 393216
  s_add_u32 s75, s75, 4096
  s_mov_b32 m0, s75
  s_nop 0
  buffer_load_dwordx4 v38, s[20:23], s74 offen lds
  s_add_u32 s74, s74, 393216
  s_add_u32 s75, s75, 4096
  s_mov_b32 m0, s75
  s_nop 0
  buffer_load_dwordx4 v38, s[20:23], s74 offen lds
  s_add_u32 s74, s74, 393216
  s_add_u32 s75, s75, 4096
  s_mov_b32 m0, s75
  s_nop 0
  buffer_load_dwordx4 v38, s[20:23], s74 offen lds
  s_add_u32 s74, s74, 393216
  s_add_u32 s75, s75, 4096
  s_mov_b32 m0, s75
  s_nop 0
  buffer_load_dwordx4 v38, s[20:23], s74 offen lds
  s_add_u32 s74, s74, 393216
  s_add_u32 s75, s75, 4096
  s_mov_b32 m0, s75
  s_nop 0
  buffer_load_dwordx4 v38, s[20:23], s74 offen lds
  s_add_u32 s74, s74, 393216
  s_add_u32 s75, s75, 4096
  s_mov_b32 m0, s75
  s_nop 0
  buffer_load_dwordx4 v38, s[20:23], s74 offen lds
  s_add_u32 s74, s74, 393216
  s_add_u32 s75, s75, 4096
  s_mov_b32 m0, s75
  s_nop 0
  buffer_load_dwordx4 v38, s[20:23], s74 offen lds
  s_add_u32 s74, s74, 393216
  s_add_u32 s75, s75, 4096
  s_mov_b32 m0, s75
  s_nop 0
  buffer_load_dwordx4 v38, s[20:23], s74 offen lds
  s_waitcnt vmcnt(20)
  s_barrier
  s_cmp_lg_u32 s12, 0
  s_cbranch_scc1 L_ch_arr
  v_mov_b32 v22, 1
  v_mov_b32 v25, 112
  s_mov_b64 exec, 1
  buffer_atomic_add v22, v25, s[8:11], 0 offen sc1
  s_mov_b64 exec, -1
L_ch_arr:
  v_add_u32 v41, 21504, v40
  ds_read_b64_tr_b16 a[0:1], v41 offset:0
  ds_read_b64_tr_b16 a[2:3], v41 offset:256
  ds_read_b64_tr_b16 a[4:5], v41 offset:4096
  ds_read_b64_tr_b16 a[6:7], v41 offset:4352
  ds_read_b64_tr_b16 a[8:9], v41 offset:8192
  ds_read_b64_tr_b16 a[10:11], v41 offset:8448
  ds_read_b64_tr_b16 a[12:13], v41 offset:12288
  ds_read_b64_tr_b16 a[14:15], v41 offset:12544
  ds_read_b64_tr_b16 a[16:17], v41 offset:16384
  ds_read_b64_tr_b16 a[18:19], v41 offset:16640
  ds_read_b64_tr_b16 a[20:21], v41 offset:20480
  ds_read_b64_tr_b16 a[22:23], v41 offset:20736
  ds_read_b64_tr_b16 a[24:25], v41 offset:24576
  ds_read_b64_tr_b16 a[26:27], v41 offset:24832
  ds_read_b64_tr_b16 a[28:29], v41 offset:28672
  ds_read_b64_tr_b16 a[30:31], v41 offset:28928
  ds_read_b64_tr_b16 a[32:33], v41 offset:32768
  ds_read_b64_tr_b16 a[34:35], v41 offset:33024
  ds_read_b64_tr_b16 a[36:37], v41 offset:36864
  ds_read_b64_tr_b16 a[38:39], v41 offset:37120
  s_waitcnt lgkmcnt(0)
  s_barrier
  s_mul_i32 s74, s12, 98304
  s_add_u32 s74, s74, 3932160
  s_add_u32 s75, s67, 21504
  s_mov_b32 m0, s75
  s_nop 0
  buffer_load_dwordx4 v38, s[20:23], s74 offen lds
  s_add_u32 s74, s74, 393216
  s_add_u32 s75, s75, 4096
  s_mov_b32 m0, s75
  s_nop 0
  buffer_load_dwordx4 v38, s[20:23], s74 offen lds
  s_add_u32 s74, s74, 393216
  s_add_u32 s75, s75, 4096
  s_mov_b32 m0, s75
  s_nop 0
  buffer_load_dwordx4 v38, s[20:23], s74 offen lds
  s_add_u32 s74, s74, 393216
  s_add_u32 s75, s75, 4096
  s_mov_b32 m0, s75
  s_nop 0
  buffer_load_dwordx4 v38, s[20:23], s74 offen lds
  s_add_u32 s74, s74, 393216
  s_add_u32 s75, s75, 4096
  s_mov_b32 m0, s75
  s_nop 0
  buffer_load_dwordx4 v38, s[20:23], s74 offen lds
  s_add_u32 s74, s74, 393216
  s_add_u32 s75, s75, 4096
  s_mov_b32 m0, s75
  s_nop 0
  buffer_load_dwordx4 v38, s[20:23], s74 offen lds
  s_add_u32 s74, s74, 393216
  s_add_u32 s75, s75, 4096
  s_mov_b32 m0, s75
  s_nop 0
  buffer_load_dwordx4 v38, s[20:23], s74 offen lds
  s_add_u32 s74, s74, 393216
  s_add_u32 s75, s75, 4096
  s_mov_b32 m0, s75
  s_nop 0
  buffer_load_dwordx4 v38, s[20:23], s74 offen lds
  s_add_u32 s74, s74, 393216
  s_add_u32 s75, s75, 4096
  s_mov_b32 m0, s75
  s_nop 0
  buffer_load_dwordx4 v38, s[20:23], s74 offen lds
  s_add_u32 s74, s74, 393216
  s_add_u32 s75, s75, 4096
  s_mov_b32 m0, s75
  s_nop 0
  buffer_load_dwordx4 v38, s[20:23], s74 offen lds
  s_waitcnt vmcnt(20)
  s_barrier
  v_add_u32 v41, 62464, v40
  ds_read_b64_tr_b16 a[40:41], v41 offset:0
  ds_read_b64_tr_b16 a[42:43], v41 offset:256
  ds_read_b64_tr_b16 a[44:45], v41 offset:4096
  ds_read_b64_tr_b16 a[46:47], v41 offset:4352
  ds_read_b64_tr_b16 a[48:49], v41 offset:8192
  ds_read_b64_tr_b16 a[50:51], v41 offset:8448
  ds_read_b64_tr_b16 a[52:53], v41 offset:12288
  ds_read_b64_tr_b16 a[54:55], v41 offset:12544
  ds_read_b64_tr_b16 a[56:57], v41 offset:16384
  ds_read_b64_tr_b16 a[58:59], v41 offset:16640
  ds_read_b64_tr_b16 a[60:61], v41 offset:20480
  ds_read_b64_tr_b16 a[62:63], v41 offset:20736
  ds_read_b64_tr_b16 a[64:65], v41 offset:24576
  ds_read_b64_tr_b16 a[66:67], v41 offset:24832
  ds_read_b64_tr_b16 a[68:69], v41 offset:28672
  ds_read_b64_tr_b16 a[70:71], v41 offset:28928
  ds_read_b64_tr_b16 a[72:73], v41 offset:32768
  ds_read_b64_tr_b16 a[74:75], v41 offset:33024
  ds_read_b64_tr_b16 a[76:77], v41 offset:36864
  ds_read_b64_tr_b16 a[78:79], v41 offset:37120
  s_waitcnt lgkmcnt(0)
  s_barrier
  s_mov_b32 s20, s32
  s_mov_b32 s21, s33
  s_mov_b32 s22, 7864320
  s_mov_b32 s23, 0x20000
  s_mul_i32 s74, s12, 98304
  s_add_u32 s74, s74, 0
  s_add_u32 s75, s67, 62464
  s_mov_b32 m0, s75
  s_nop 0
  buffer_load_dwordx4 v38, s[20:23], s74 offen lds
  s_add_u32 s74, s74, 393216
  s_add_u32 s75, s75, 4096
  s_mov_b32 m0, s75
  s_nop 0
  buffer_load_dwordx4 v38, s[20:23], s74 offen lds
  s_add_u32 s74, s74, 393216
  s_add_u32 s75, s75, 4096
  s_mov_b32 m0, s75
  s_nop 0
  buffer_load_dwordx4 v38, s[20:23], s74 offen lds
  s_add_u32 s74, s74, 393216
  s_add_u32 s75, s75, 4096
  s_mov_b32 m0, s75
  s_nop 0
  buffer_load_dwordx4 v38, s[20:23], s74 offen lds
  s_add_u32 s74, s74, 393216
  s_add_u32 s75, s75, 4096
  s_mov_b32 m0, s75
  s_nop 0
  buffer_load_dwordx4 v38, s[20:23], s74 offen lds
  s_add_u32 s74, s74, 393216
  s_add_u32 s75, s75, 4096
  s_mov_b32 m0, s75
  s_nop 0
  buffer_load_dwordx4 v38, s[20:23], s74 offen lds
  s_add_u32 s74, s74, 393216
  s_add_u32 s75, s75, 4096
  s_mov_b32 m0, s75
  s_nop 0
  buffer_load_dwordx4 v38, s[20:23], s74 offen lds
  s_add_u32 s74, s74, 393216
  s_add_u32 s75, s75, 4096
  s_mov_b32 m0, s75
  s_nop 0
  buffer_load_dwordx4 v38, s[20:23], s74 offen lds
  s_add_u32 s74, s74, 393216
  s_add_u32 s75, s75, 4096
  s_mov_b32 m0, s75
  s_nop 0
  buffer_load_dwordx4 v38, s[20:23], s74 offen lds
  s_add_u32 s74, s74, 393216
  s_add_u32 s75, s75, 4096
  s_mov_b32 m0, s75
  s_nop 0
  buffer_load_dwordx4 v38, s[20:23], s74 offen lds
  s_waitcnt vmcnt(20)
  s_barrier
  v_add_u32 v41, 103424, v40
  ds_read_b64_tr_b16 a[80:81], v41 offset:0
  ds_read_b64_tr_b16 a[82:83], v41 offset:256
  ds_read_b64_tr_b16 a[84:85], v41 offset:4096
  ds_read_b64_tr_b16 a[86:87], v41 offset:4352
  ds_read_b64_tr_b16 a[88:89], v41 offset:8192
  ds_read_b64_tr_b16 a[90:91], v41 offset:8448
  ds_read_b64_tr_b16 a[92:93], v41 offset:12288
  ds_read_b64_tr_b16 a[94:95], v41 offset:12544
  ds_read_b64_tr_b16 a[96:97], v41 offset:16384
  ds_read_b64_tr_b16 a[98:99], v41 offset:16640
  ds_read_b64_tr_b16 a[100:101], v41 offset:20480
  ds_read_b64_tr_b16 a[102:103], v41 offset:20736
  ds_read_b64_tr_b16 a[104:105], v41 offset:24576
  ds_read_b64_tr_b16 a[106:107], v41 offset:24832
  ds_read_b64_tr_b16 a[108:109], v41 offset:28672
  ds_read_b64_tr_b16 a[110:111], v41 offset:28928
  ds_read_b64_tr_b16 a[112:113], v41 offset:32768
  ds_read_b64_tr_b16 a[114:115], v41 offset:33024
  ds_read_b64_tr_b16 a[116:117], v41 offset:36864
  ds_read_b64_tr_b16 a[118:119], v41 offset:37120
  s_waitcnt lgkmcnt(0)
  s_barrier
  s_mul_i32 s74, s12, 98304
  s_add_u32 s74, s74, 3932160
  s_add_u32 s75, s67, 103424
  s_mov_b32 m0, s75
  s_nop 0
  buffer_load_dwordx4 v38, s[20:23], s74 offen lds
  s_add_u32 s74, s74, 393216
  s_add_u32 s75, s75, 4096
  s_mov_b32 m0, s75
  s_nop 0
  buffer_load_dwordx4 v38, s[20:23], s74 offen lds
  s_add_u32 s74, s74, 393216
  s_add_u32 s75, s75, 4096
  s_mov_b32 m0, s75
  s_nop 0
  buffer_load_dwordx4 v38, s[20:23], s74 offen lds
  s_add_u32 s74, s74, 393216
  s_add_u32 s75, s75, 4096
  s_mov_b32 m0, s75
  s_nop 0
  buffer_load_dwordx4 v38, s[20:23], s74 offen lds
  s_add_u32 s74, s74, 393216
  s_add_u32 s75, s75, 4096
  s_mov_b32 m0, s75
  s_nop 0
  buffer_load_dwordx4 v38, s[20:23], s74 offen lds
  s_add_u32 s74, s74, 393216
  s_add_u32 s75, s75, 4096
  s_mov_b32 m0, s75
  s_nop 0
  buffer_load_dwordx4 v38, s[20:23], s74 offen lds
  s_add_u32 s74, s74, 393216
  s_add_u32 s75, s75, 4096
  s_mov_b32 m0, s75
  s_nop 0
  buffer_load_dwordx4 v38, s[20:23], s74 offen lds
  s_add_u32 s74, s74, 393216
  s_add_u32 s75, s75, 4096
  s_mov_b32 m0, s75
  s_nop 0
  buffer_load_dwordx4 v38, s[20:23], s74 offen lds
  s_add_u32 s74, s74, 393216
  s_add_u32 s75, s75, 4096
  s_mov_b32 m0, s75
  s_nop 0
  buffer_load_dwordx4 v38, s[20:23], s74 offen lds
  s_add_u32 s74, s74, 393216
  s_add_u32 s75, s75, 4096
  s_mov_b32 m0, s75
  s_nop 0
  buffer_load_dwordx4 v38, s[20:23], s74 offen lds
  s_waitcnt vmcnt(20)
  s_barrier
  v_add_u32 v41, 21504, v40
  ds_read_b64_tr_b16 a[120:121], v41 offset:0
  ds_read_b64_tr_b16 a[122:123], v41 offset:256
  ds_read_b64_tr_b16 a[124:125], v41 offset:4096
  ds_read_b64_tr_b16 a[126:127], v41 offset:4352
  ds_read_b64_tr_b16 a[128:129], v41 offset:8192
  ds_read_b64_tr_b16 a[130:131], v41 offset:8448
  ds_read_b64_tr_b16 a[132:133], v41 offset:12288
  ds_read_b64_tr_b16 a[134:135], v41 offset:12544
  ds_read_b64_tr_b16 a[136:137], v41 offset:16384
  ds_read_b64_tr_b16 a[138:139], v41 offset:16640
  ds_read_b64_tr_b16 a[140:141], v41 offset:20480
  ds_read_b64_tr_b16 a[142:143], v41 offset:20736
  ds_read_b64_tr_b16 a[144:145], v41 offset:24576
  ds_read_b64_tr_b16 a[146:147], v41 offset:24832
  ds_read_b64_tr_b16 a[148:149], v41 offset:28672
  ds_read_b64_tr_b16 a[150:151], v41 offset:28928
  ds_read_b64_tr_b16 a[152:153], v41 offset:32768
  ds_read_b64_tr_b16 a[154:155], v41 offset:33024
  ds_read_b64_tr_b16 a[156:157], v41 offset:36864
  ds_read_b64_tr_b16 a[158:159], v41 offset:37120
  s_waitcnt lgkmcnt(0)
  s_barrier
  s_mov_b32 s20, s34
  s_mov_b32 s21, s35
  s_mov_b32 s22, 7864320
  s_mov_b32 s23, 0x20000
  s_mul_i32 s74, s12, 10240
  s_add_u32 s74, s74, 0
  s_add_u32 s75, s67, 21504
  s_mov_b32 m0, s75
  s_nop 0
  buffer_load_dwordx4 v39, s[20:23], s74 offen lds
  s_add_u32 s74, s74, 40960
  s_add_u32 s75, s75, 4096
  s_mov_b32 m0, s75
  s_nop 0
  buffer_load_dwordx4 v39, s[20:23], s74 offen lds
  s_add_u32 s74, s74, 40960
  s_add_u32 s75, s75, 4096
  s_mov_b32 m0, s75
  s_nop 0
  buffer_load_dwordx4 v39, s[20:23], s74 offen lds
  s_sub_u32 s74, s74, 81536
  s_add_u32 s75, s75, 4096
  s_mov_b32 m0, s75
  s_nop 0
  buffer_load_dwordx4 v39, s[20:23], s74 offen lds
  s_add_u32 s74, s74, 40960
  s_add_u32 s75, s75, 4096
  s_mov_b32 m0, s75
  s_nop 0
  buffer_load_dwordx4 v39, s[20:23], s74 offen lds
  s_add_u32 s74, s74, 40960
  s_add_u32 s75, s75, 4096
  s_mov_b32 m0, s75
  s_nop 0
  buffer_load_dwordx4 v39, s[20:23], s74 offen lds
  s_waitcnt vmcnt(16)
  s_barrier
  v_add_u32 v41, 62464, v40
  ds_read_b64_tr_b16 a[160:161], v41 offset:0
  ds_read_b64_tr_b16 a[162:163], v41 offset:256
  ds_read_b64_tr_b16 a[164:165], v41 offset:4096
  ds_read_b64_tr_b16 a[166:167], v41 offset:4352
  ds_read_b64_tr_b16 a[168:169], v41 offset:8192
  ds_read_b64_tr_b16 a[170:171], v41 offset:8448
  ds_read_b64_tr_b16 a[172:173], v41 offset:12288
  ds_read_b64_tr_b16 a[174:175], v41 offset:12544
  ds_read_b64_tr_b16 a[176:177], v41 offset:16384
  ds_read_b64_tr_b16 a[178:179], v41 offset:16640
  ds_read_b64_tr_b16 a[180:181], v41 offset:20480
  ds_read_b64_tr_b16 a[182:183], v41 offset:20736
  ds_read_b64_tr_b16 a[184:185], v41 offset:24576
  ds_read_b64_tr_b16 a[186:187], v41 offset:24832
  ds_read_b64_tr_b16 a[188:189], v41 offset:28672
  ds_read_b64_tr_b16 a[190:191], v41 offset:28928
  ds_read_b64_tr_b16 a[192:193], v41 offset:32768
  ds_read_b64_tr_b16 a[194:195], v41 offset:33024
  ds_read_b64_tr_b16 a[196:197], v41 offset:36864
  ds_read_b64_tr_b16 a[198:199], v41 offset:37120
  s_waitcnt lgkmcnt(0)
  s_barrier
  s_mul_i32 s74, s12, 10240
  s_add_u32 s74, s74, 122880
  s_add_u32 s75, s67, 62464
  s_mov_b32 m0, s75
  s_nop 0
  buffer_load_dwordx4 v39, s[20:23], s74 offen lds
  s_add_u32 s74, s74, 40960
  s_add_u32 s75, s75, 4096
  s_mov_b32 m0, s75
  s_nop 0
  buffer_load_dwordx4 v39, s[20:23], s74 offen lds
  s_add_u32 s74, s74, 40960
  s_add_u32 s75, s75, 4096
  s_mov_b32 m0, s75
  s_nop 0
  buffer_load_dwordx4 v39, s[20:23], s74 offen lds
  s_sub_u32 s74, s74, 81536
  s_add_u32 s75, s75, 4096
  s_mov_b32 m0, s75
  s_nop 0
  buffer_load_dwordx4 v39, s[20:23], s74 offen lds
  s_add_u32 s74, s74, 40960
  s_add_u32 s75, s75, 4096
  s_mov_b32 m0, s75
  s_nop 0
  buffer_load_dwordx4 v39, s[20:23], s74 offen lds
  s_add_u32 s74, s74, 40960
  s_add_u32 s75, s75, 4096
  s_mov_b32 m0, s75
  s_nop 0
  buffer_load_dwordx4 v39, s[20:23], s74 offen lds
  s_waitcnt vmcnt(12)
  s_barrier
  v_add_u32 v41, 103424, v40
  ds_read_b64_tr_b16 a[200:201], v41 offset:0
  ds_read_b64_tr_b16 a[202:203], v41 offset:256
  ds_read_b64_tr_b16 a[204:205], v41 offset:4096
  ds_read_b64_tr_b16 a[206:207], v41 offset:4352
  ds_read_b64_tr_b16 a[208:209], v41 offset:8192
  ds_read_b64_tr_b16 a[210:211], v41 offset:8448
  ds_read_b64_tr_b16 a[212:213], v41 offset:12288
  ds_read_b64_tr_b16 a[214:215], v41 offset:12544
  ds_read_b64_tr_b16 a[216:217], v41 offset:16384
  ds_read_b64_tr_b16 a[218:219], v41 offset:16640
  ds_read_b64_tr_b16 a[220:221], v41 offset:20480
  ds_read_b64_tr_b16 a[222:223], v41 offset:20736
  ds_read_b64_tr_b16 a[224:225], v41 offset:24576
  ds_read_b64_tr_b16 a[226:227], v41 offset:24832
  ds_read_b64_tr_b16 a[228:229], v41 offset:28672
  ds_read_b64_tr_b16 a[230:231], v41 offset:28928
  ds_read_b64_tr_b16 a[232:233], v41 offset:32768
  ds_read_b64_tr_b16 a[234:235], v41 offset:33024
  ds_read_b64_tr_b16 a[236:237], v41 offset:36864
  ds_read_b64_tr_b16 a[238:239], v41 offset:37120
  s_waitcnt lgkmcnt(0)
  s_barrier
  s_mul_i32 s74, s12, 10240
  s_add_u32 s74, s74, 768
  s_add_u32 s75, s67, 103424
  s_mov_b32 m0, s75
  s_nop 0
  buffer_load_dwordx4 v39, s[20:23], s74 offen lds
  s_add_u32 s74, s74, 40960
  s_add_u32 s75, s75, 4096
  s_mov_b32 m0, s75
  s_nop 0
  buffer_load_dwordx4 v39, s[20:23], s74 offen lds
  s_add_u32 s74, s74, 40960
  s_add_u32 s75, s75, 4096
  s_mov_b32 m0, s75
  s_nop 0
  buffer_load_dwordx4 v39, s[20:23], s74 offen lds
  s_sub_u32 s74, s74, 81536
  s_add_u32 s75, s75, 4096
  s_mov_b32 m0, s75
  s_nop 0
  buffer_load_dwordx4 v43, s[20:23], s74 offen lds
  s_add_u32 s74, s74, 40960
  s_add_u32 s75, s75, 4096
  s_mov_b32 m0, s75
  s_nop 0
  buffer_load_dwordx4 v43, s[20:23], s74 offen lds
  s_add_u32 s74, s74, 40960
  s_add_u32 s75, s75, 4096
  s_mov_b32 m0, s75
  s_nop 0
  buffer_load_dwordx4 v43, s[20:23], s74 offen lds
  s_waitcnt vmcnt(12)
  s_barrier
  v_add_u32 v41, 21504, v42
  ds_read_b64_tr_b16 a[240:241], v41 offset:0
  ds_read_b64_tr_b16 a[242:243], v41 offset:256
  ds_read_b64_tr_b16 a[244:245], v41 offset:2048
  ds_read_b64_tr_b16 a[246:247], v41 offset:2304
  ds_read_b64_tr_b16 a[248:249], v41 offset:4096
  ds_read_b64_tr_b16 a[250:251], v41 offset:4352
  ds_read_b64_tr_b16 a[252:253], v41 offset:6144
  ds_read_b64_tr_b16 a[254:255], v41 offset:6400
  ds_read_b64_tr_b16 v[176:177], v41 offset:8192
  ds_read_b64_tr_b16 v[178:179], v41 offset:8448
  ds_read_b64_tr_b16 v[180:181], v41 offset:10240
  ds_read_b64_tr_b16 v[182:183], v41 offset:10496
  s_waitcnt lgkmcnt(0)
  s_barrier
  s_mul_i32 s74, s12, 10240
  s_add_u32 s74, s74, 123648
  s_add_u32 s75, s67, 21504
  s_mov_b32 m0, s75
  s_nop 0
  buffer_load_dwordx4 v39, s[20:23], s74 offen lds
  s_add_u32 s74, s74, 40960
  s_add_u32 s75, s75, 4096
  s_mov_b32 m0, s75
  s_nop 0
  buffer_load_dwordx4 v39, s[20:23], s74 offen lds
  s_add_u32 s74, s74, 40960
  s_add_u32 s75, s75, 4096
  s_mov_b32 m0, s75
  s_nop 0
  buffer_load_dwordx4 v39, s[20:23], s74 offen lds
  s_sub_u32 s74, s74, 81536
  s_add_u32 s75, s75, 4096
  s_mov_b32 m0, s75
  s_nop 0
  buffer_load_dwordx4 v43, s[20:23], s74 offen lds
  s_add_u32 s74, s74, 40960
  s_add_u32 s75, s75, 4096
  s_mov_b32 m0, s75
  s_nop 0
  buffer_load_dwordx4 v43, s[20:23], s74 offen lds
  s_add_u32 s74, s74, 40960
  s_add_u32 s75, s75, 4096
  s_mov_b32 m0, s75
  s_nop 0
  buffer_load_dwordx4 v43, s[20:23], s74 offen lds
  s_mov_b32 s20, s24
  s_mov_b32 s21, s25
  s_mov_b32 s22, 10240
  s_mov_b32 s23, 0x20000
  v_and_b32 v22, 7, v90
  v_mul_u32_u24 v25, 1280, v22
  v_lshl_add_u32 v25, v92, 5, v25
  v_bfe_u32 v22, v90, 3, 1
  v_lshl_add_u32 v25, v22, 4, v25
  s_lshr_b32 s74, s67, 3
  s_mov_b32 m0, s67
  s_nop 0
  buffer_load_dwordx4 v25, s[20:23], s74 offen lds
  s_lshr_b32 s74, s68, 3
  s_mov_b32 m0, s68
  s_nop 0
  buffer_load_dwordx4 v25, s[20:23], s74 offen lds
  s_lshr_b32 s74, s69, 3
  s_mov_b32 m0, s69
  s_nop 0
  buffer_load_dwordx4 v25, s[20:23], s74 offen lds
  s_mov_b32 s74, 50331648
  s_mov_b32 s75, 50855936
  s_add_u32 s76, s63, 0
  buffer_load_dword v122, v4, s[4:7], s74 offen sc1
  buffer_load_dword v123, v8, s[4:7], s75 offen sc1
  buffer_load_dword v124, v15, s[4:7], s76 offen sc1
  s_mov_b32 s74, 50462720
  s_mov_b32 s75, 50987008
  s_add_u32 s76, s63, 65536
  buffer_load_dword v122, v4, s[4:7], s74 offen sc1
  buffer_load_dword v123, v8, s[4:7], s75 offen sc1
  buffer_load_dword v124, v15, s[4:7], s76 offen sc1
  s_mov_b32 s74, 50593792
  s_mov_b32 s75, 51118080
  s_add_u32 s76, s63, 131072
  buffer_load_dword v122, v4, s[4:7], s74 offen sc1
  buffer_load_dword v123, v8, s[4:7], s75 offen sc1
  buffer_load_dword v124, v15, s[4:7], s76 offen sc1
  s_mov_b32 s74, 50724864
  s_mov_b32 s75, 51249152
  s_add_u32 s76, s63, 196608
  buffer_load_dword v122, v4, s[4:7], s74 offen sc1
  buffer_load_dword v123, v8, s[4:7], s75 offen sc1
  buffer_load_dword v124, v15, s[4:7], s76 offen sc1
  v_and_b32 v126, 3, v0
  v_lshlrev_b32 v126, 6, v126
  v_and_b32 v125, 12, v0
  v_add_u32 v126, v126, v125
  s_mov_b32 s90, 240
  v_writelane_b32 v126, s90, 9
  s_mov_b32 s90, 112
  v_writelane_b32 v126, s90, 10
  s_mov_b32 s90, 116
  v_writelane_b32 v126, s90, 11
  s_mov_b32 s90, 48
  v_writelane_b32 v126, s90, 12
  buffer_load_dword v125, v126, s[8:11], 0 offen sc1
  s_waitcnt vmcnt(28)
  s_barrier
  v_add_u32 v41, 62464, v42
  ds_read_b64_tr_b16 v[184:185], v41 offset:0
  ds_read_b64_tr_b16 v[186:187], v41 offset:256
  ds_read_b64_tr_b16 v[188:189], v41 offset:2048
  ds_read_b64_tr_b16 v[190:191], v41 offset:2304
  ds_read_b64_tr_b16 v[192:193], v41 offset:4096
  ds_read_b64_tr_b16 v[194:195], v41 offset:4352
  ds_read_b64_tr_b16 v[196:197], v41 offset:6144
  ds_read_b64_tr_b16 v[198:199], v41 offset:6400
  ds_read_b64_tr_b16 v[200:201], v41 offset:8192
  ds_read_b64_tr_b16 v[202:203], v41 offset:8448
  ds_read_b64_tr_b16 v[204:205], v41 offset:10240
  ds_read_b64_tr_b16 v[206:207], v41 offset:10496
  s_waitcnt lgkmcnt(0)
  s_waitcnt vmcnt(22)
  s_barrier
  v_add_u32 v41, 103424, v42
  ds_read_b64_tr_b16 v[208:209], v41 offset:0
  ds_read_b64_tr_b16 v[210:211], v41 offset:256
  ds_read_b64_tr_b16 v[212:213], v41 offset:2048
  ds_read_b64_tr_b16 v[214:215], v41 offset:2304
  ds_read_b64_tr_b16 v[216:217], v41 offset:4096
  ds_read_b64_tr_b16 v[218:219], v41 offset:4352
  ds_read_b64_tr_b16 v[220:221], v41 offset:6144
  ds_read_b64_tr_b16 v[222:223], v41 offset:6400
  ds_read_b64_tr_b16 v[224:225], v41 offset:8192
  ds_read_b64_tr_b16 v[226:227], v41 offset:8448
  ds_read_b64_tr_b16 v[228:229], v41 offset:10240
  ds_read_b64_tr_b16 v[230:231], v41 offset:10496
  s_waitcnt lgkmcnt(0)
  s_waitcnt vmcnt(16)
  s_barrier
  v_add_u32 v41, 21504, v42
  ds_read_b64_tr_b16 v[232:233], v41 offset:0
  ds_read_b64_tr_b16 v[234:235], v41 offset:256
  ds_read_b64_tr_b16 v[236:237], v41 offset:2048
  ds_read_b64_tr_b16 v[238:239], v41 offset:2304
  ds_read_b64_tr_b16 v[240:241], v41 offset:4096
  ds_read_b64_tr_b16 v[242:243], v41 offset:4352
  ds_read_b64_tr_b16 v[244:245], v41 offset:6144
  ds_read_b64_tr_b16 v[246:247], v41 offset:6400
  ds_read_b64_tr_b16 v[248:249], v41 offset:8192
  ds_read_b64_tr_b16 v[250:251], v41 offset:8448
  ds_read_b64_tr_b16 v[252:253], v41 offset:10240
  ds_read_b64_tr_b16 v[254:255], v41 offset:10496
  s_waitcnt lgkmcnt(0)
  s_mov_b32 s15, 0
L_ch_st:
  s_waitcnt vmcnt(0)
  v_readlane_b32 s90, v125, 0
  v_readlane_b32 s91, v125, 1
  v_readlane_b32 s92, v125, 2
  v_readlane_b32 s93, v125, 3
  v_readlane_b32 s94, v125, 4
  v_readlane_b32 s95, v125, 5
  v_readlane_b32 s96, v125, 6
  v_readlane_b32 s97, v125, 7
  v_readlane_b32 s98, v125, 8
  v_readlane_b32 s14, v125, 9
  s_min_u32 s16, s90, s91
  s_min_u32 s16, s16, s92
  s_min_u32 s16, s16, s93
  s_add_u32 s90, s90, s91
  s_add_u32 s90, s90, s92
  s_add_u32 s90, s90, s93
  s_add_u32 s90, s90, s94
  s_add_u32 s90, s90, s95
  s_add_u32 s90, s90, s96
  s_add_u32 s90, s90, s97
  s_add_u32 s90, s90, s98
  v_readlane_b32 s91, v125, 10
  v_readlane_b32 s92, v125, 11
  v_readlane_b32 s93, v125, 12
  s_nop 0
  s_cmp_eq_u32 s93, 0
  s_cbranch_scc1 L_ch_st_no
  s_cmp_lt_u32 s90, 256
  s_cbranch_scc1 L_ch_st_no
  s_cmp_eq_u32 s14, 0
  s_cbranch_scc1 L_ch_st_no
  s_cmp_lt_u32 s91, 96
  s_cbranch_scc1 L_ch_st_no
  s_cmp_ge_u32 s92, 32
  s_cbranch_scc1 L_ch_st_ok
L_ch_st_no:
  buffer_load_dword v125, v126, s[8:11], 0 offen sc1
  s_add_u32 s15, s15, 1
  s_cmp_lt_u32 s15, 0x40000
  s_cbranch_scc1 L_ch_st
  s_branch L_fail
L_ch_st_ok:
  s_sub_u32 s14, s14, 1
  s_cmp_lt_u32 s16, 32
  s_cselect_b32 s16, 1, 0
  s_lshl_b32 s74, s14, 13
  s_xor_b32 s73, s73, s74
  s_xor_b32 s72, s72, s74
  s_mov_b32 s71, 0
  s_cmp_ge_u32 s71, 1
  s_cbranch_scc1 L_ch_kv0_e
  s_mov_b64 exec, 0xff
  s_mov_b32 s15, 0
L_ch_kv0:
  v_mov_b32 v20, 0
  buffer_atomic_add v20, v6, s[4:7], s72 offen sc0 sc1
  s_waitcnt vmcnt(0)
  v_cmp_gt_u32 vcc, 1, v20
  s_cbranch_vccz L_ch_kv0_ok
  s_sleep 2
  s_add_u32 s15, s15, 1
  s_cmp_lt_u32 s15, 262144
  s_cbranch_scc1 L_ch_kv0
  s_branch L_fail
L_ch_kv0_ok:
  v_readlane_b32 s71, v20, 0
  v_readlane_b32 s74, v20, 1
  s_nop 0
  s_min_u32 s71, s71, s74
  v_readlane_b32 s74, v20, 2
  s_nop 0
  s_min_u32 s71, s71, s74
  v_readlane_b32 s74, v20, 3
  s_nop 0
  s_min_u32 s71, s71, s74
  v_readlane_b32 s74, v20, 4
  s_nop 0
  s_min_u32 s71, s71, s74
  v_readlane_b32 s74, v20, 5
  s_nop 0
  s_min_u32 s71, s71, s74
  v_readlane_b32 s74, v20, 6
  s_nop 0
  s_min_u32 s71, s71, s74
  v_readlane_b32 s74, v20, 7
  s_nop 0
  s_min_u32 s71, s71, s74
  s_mov_b64 exec, -1
L_ch_kv0_e:
  s_barrier
  s_mov_b32 m0, s58
  s_nop 0
  buffer_load_dwordx4 v1, s[4:7], s48 offen offset:0 sc1 lds
  s_mov_b32 m0, s57
  s_nop 0
  buffer_load_dwordx4 v1, s[4:7], s49 offen offset:0 sc1 lds
  buffer_load_dwordx4 v1, s[4:7], s49 offen offset:1024 sc1 lds
  buffer_load_dwordx4 v1, s[4:7], s49 offen offset:2048 sc1 lds
  s_add_u32 s48, s48, 393216
  s_add_u32 s49, s49, 393216
  v_xor_b32 v113, 128, v1
  v_bfe_u32 v20, v0, 3, 1
  v_lshl_add_u32 v25, v20, 1, v154
  s_mov_b32 s44, 0
  s_mov_b32 s59, 1
  v_mov_b32 v20, 0
  ds_write_b32 v6, v20 offset:20480
  s_mov_b32 s54, 58730496
  s_and_b32 s74, s44, 3
  s_xor_b32 s75, s74, 2
  s_add_u32 s76, s44, 1
  s_and_b32 s76, s76, 3
  s_lshl_b32 s45, s74, 17
  s_add_u32 s45, s45, 50331648
  s_lshl_b32 s51, s75, 17
  s_add_u32 s51, s51, 50331648
  s_lshl_b32 s46, s74, 17
  s_add_u32 s46, s46, 50855936
  s_lshl_b32 s52, s75, 17
  s_add_u32 s52, s52, 50855936
  s_lshl_b32 s50, s76, 16
  s_add_u32 s50, s50, s63
  s_xor_b32 s76, s76, 2
  s_lshl_b32 s53, s76, 16
  s_add_u32 s53, s53, s63
  s_add_u32 s55, s45, s56
  s_mul_i32 s75, s44, 0x5556
  s_lshr_b32 s75, s75, 16
  s_mul_i32 s76, s75, 3
  s_sub_u32 s76, s44, s76
  s_mul_i32 s76, s76, 655360
  s_lshl_b32 s47, s75, 21
  s_add_u32 s47, s47, s76
  s_xor_b32 s75, s75, s14
  s_and_b32 s75, s75, 1
  s_lshl_b32 s75, s75, 13
  s_add_u32 s47, s47, s75
  s_add_u32 s47, s47, 83886080
  s_lshl_b32 s75, s79, 14
  s_add_u32 s75, s75, s47
  s_mov_b32 s20, s75
  s_add_u32 s21, s75, 4096
  s_mov_b32 s36, 0
  s_mov_b32 s37, 0
  s_mov_b32 s38, 0
  s_mov_b32 s39, 0
  s_waitcnt vmcnt(0) lgkmcnt(0)
  s_cmp_lg_u32 s16, 0
  s_cbranch_scc1 S_b1
  s_branch F_b1
F_b1:
  s_barrier
  ds_read_b128 v[38:41], v1 offset:0
  ds_read_b128 v[42:45], v1 offset:1024
  ds_read_b128 v[46:49], v1 offset:2048
  s_cmp_lg_u32 s12, 0
  s_cbranch_scc1 F_nofl
  v_mov_b32 v20, s44
  buffer_store_dword v20, v155, s[4:7], s73 offen sc1
F_nofl:
  s_waitcnt lgkmcnt(2)
  v_smfmac_f32_16x16x64_bf16 v[78:81], v[38:41], a[0:7], v18
  ds_read_b128 v[50:53], v1 offset:3072
  v_smfmac_f32_16x16x64_bf16 v[82:85], v[38:41], a[80:87], v18
  s_waitcnt lgkmcnt(2)
  v_smfmac_f32_16x16x64_bf16 v[78:81], v[42:45], a[8:15], v18
  ds_read_b128 v[54:57], v1 offset:4096
  v_smfmac_f32_16x16x64_bf16 v[82:85], v[42:45], a[88:95], v18
  s_waitcnt lgkmcnt(2)
  v_smfmac_f32_16x16x64_bf16 v[78:81], v[46:49], a[16:23], v18
  ds_read_b128 v[58:61], v1 offset:5120
  v_smfmac_f32_16x16x64_bf16 v[82:85], v[46:49], a[96:103], v18
  s_waitcnt lgkmcnt(2)
  v_smfmac_f32_16x16x64_bf16 v[78:81], v[50:53], a[24:31], v18
  ds_read_b128 v[62:65], v1 offset:6144
  v_smfmac_f32_16x16x64_bf16 v[82:85], v[50:53], a[104:111], v18
  s_waitcnt lgkmcnt(2)
  v_smfmac_f32_16x16x64_bf16 v[78:81], v[54:57], a[32:39], v18
  ds_read_b128 v[66:69], v1 offset:7168
  v_smfmac_f32_16x16x64_bf16 v[82:85], v[54:57], a[112:119], v18
  s_waitcnt lgkmcnt(2)
  v_smfmac_f32_16x16x64_bf16 v[78:81], v[58:61], a[40:47], v18
  ds_read_b128 v[70:73], v1 offset:8192
  v_smfmac_f32_16x16x64_bf16 v[82:85], v[58:61], a[120:127], v18
  s_waitcnt lgkmcnt(2)
  v_smfmac_f32_16x16x64_bf16 v[78:81], v[62:65], a[48:55], v18
  ds_read_b128 v[74:77], v1 offset:9216
  v_smfmac_f32_16x16x64_bf16 v[82:85], v[62:65], a[128:135], v18
  s_waitcnt lgkmcnt(2)
  v_smfmac_f32_16x16x64_bf16 v[78:81], v[66:69], a[56:63], v18
  s_waitcnt lgkmcnt(1)
  v_smfmac_f32_16x16x64_bf16 v[78:81], v[70:73], a[64:71], v18
  s_waitcnt lgkmcnt(0)
  v_smfmac_f32_16x16x64_bf16 v[78:81], v[74:77], a[72:79], v18
  v_smfmac_f32_16x16x64_bf16 v[82:85], v[66:69], a[136:143], v18
  ds_read_b64 v[90:91], v11 offset:0
  ds_read_b64 v[92:93], v11 offset:1024
  v_smfmac_f32_16x16x64_bf16 v[82:85], v[70:73], a[144:151], v18
  ds_read_b64 v[94:95], v11 offset:2048
  ds_read_b64 v[96:97], v11 offset:3072
  v_smfmac_f32_16x16x64_bf16 v[82:85], v[74:77], a[152:159], v18
  v_mov_b32 v19, 0
  v_permlane32_swap_b32 v78, v80
  v_permlane32_swap_b32 v79, v81
  v_add_f32 v78, v78, v80
  v_add_f32 v79, v79, v81
  v_cvt_pk_bf16_f32 v110, v78, v79
  v_cmp_u_f32 vcc, v78, v79
  v_mov_b32 v19, 0
  v_permlane32_swap_b32 v82, v84
  v_permlane32_swap_b32 v83, v85
  v_add_f32 v82, v82, v84
  v_add_f32 v83, v83, v85
  v_cvt_pk_bf16_f32 v111, v82, v83
  ds_write2_b32 v2, v110, v111 offset0:0 offset1:4
  s_cbranch_vccnz F_retry
F_mem_ok:
  v_smfmac_f32_16x16x64_bf16 v[86:89], v[38:41], a[160:167], v18
  v_smfmac_f32_16x16x64_bf16 v[86:89], v[42:45], a[168:175], v18
  v_smfmac_f32_16x16x64_bf16 v[86:89], v[46:49], a[176:183], v18
  v_smfmac_f32_16x16x64_bf16 v[86:89], v[50:53], a[184:191], v18
  s_cmp_eq_u32 s12, 3
  s_waitcnt lgkmcnt(0)
  s_barrier
  ds_read_b32 v24, v6 offset:20480
  s_cbranch_scc1 F_soft
  ds_read_b64_tr_b16 v[114:115], v3 offset:0
  ds_read_b64_tr_b16 v[116:117], v3 offset:512
  ds_read_b64_tr_b16 v[118:119], v3 offset:1024
  ds_read_b64_tr_b16 v[120:121], v3 offset:1536
  v_smfmac_f32_16x16x64_bf16 v[86:89], v[54:57], a[192:199], v18
  v_smfmac_f32_16x16x64_bf16 v[86:89], v[58:61], a[200:207], v18
  v_smfmac_f32_16x16x64_bf16 v[86:89], v[62:65], a[208:215], v18
  v_smfmac_f32_16x16x64_bf16 v[86:89], v[66:69], a[216:223], v18
  s_cmp_eq_u32 s12, 0
  s_waitcnt lgkmcnt(0)
  s_cbranch_scc1 F_sc0
  v_mfma_f32_16x16x32_bf16 v[78:81], v[90:93], v[114:117], 0
  v_mfma_f32_16x16x32_bf16 v[78:81], v[94:97], v[118:121], v[78:81]
F_sc1:
  v_cmp_eq_u32 vcc, s59, v24
  v_mov_b32 v82, 0
  v_mov_b32 v83, 0
  v_mov_b32 v84, 0
  v_mov_b32 v85, 0
  s_cbranch_vccnz F_redo
  v_mov_b32 v19, 0
  v_mov_b32 v19, 0
  buffer_store_dwordx4 v[78:81], v4, s[4:7], s45 offen
  v_smfmac_f32_16x16x64_bf16 v[86:89], v[70:73], a[224:231], v18
  v_smfmac_f32_16x16x64_bf16 v[86:89], v[74:77], a[232:239], v18
  ds_read_b128 v[98:101], v10 offset:0
  ds_read_b128 v[102:105], v10 offset:1024
  ds_read_b128 v[106:109], v10 offset:2048
  v_mov_b32 v78, 0
  v_mov_b32 v79, 0
  v_mov_b32 v80, 0
  v_mov_b32 v81, 0
  v_mov_b32 v19, 0
  v_permlane32_swap_b32 v86, v88
  v_permlane32_swap_b32 v87, v89
  v_add_f32 v86, v86, v88
  v_add_f32 v87, v87, v89
  v_cvt_pk_bf16_f32 v112, v86, v87
  buffer_store_dword v112, v8, s[4:7], s46 offen
  s_mov_b32 s15, 0
  s_add_u32 s61, s50, s64
  s_add_u32 s62, s61, 4096
  v_mov_b32 v86, 0
  v_mov_b32 v87, 0
  v_mov_b32 v88, 0
  v_mov_b32 v89, 0
  v_mov_b32 v146, 0
  v_mov_b32 v147, 0
  v_mov_b32 v148, 0
  v_mov_b32 v149, 0
  v_mov_b32 v150, 0
  v_mov_b32 v151, 0
  v_mov_b32 v152, 0
  v_mov_b32 v153, 0
  s_cmp_eq_u32 s44, 63
  s_cbranch_scc1 L_ch_last
  s_nop 15
  s_nop 15
  s_nop 7
F_pollV:
  buffer_load_dword v156, v9, s[4:7], s46 offen offset:0 sc1
  buffer_load_dword v158, v9, s[4:7], s46 offen offset:256 sc1
  buffer_load_dword v160, v9, s[4:7], s46 offen offset:512 sc1
  s_waitcnt vmcnt(0)
F_chkV:
  v_max3_u32 v23, v156, v158, v160
  v_cmp_eq_u32 vcc, -1, v23
  s_cbranch_vccnz F_againV
  s_cmp_eq_u32 s12, 1
  s_cbranch_scc1 F_mk1
  s_cmp_eq_u32 s12, 2
  s_cbranch_scc1 F_mk2
  buffer_store_dwordx4 v[30:33], v5, s[4:7], s51 offen
  s_mov_b64 exec, 0xffff
  buffer_store_dwordx4 v[30:33], v5, s[4:7], s51 offen offset:1024
  s_mov_b64 exec, -1
F_mke:
  s_waitcnt lgkmcnt(0)
  s_barrier
  ds_read_b128 v[58:61], v1 offset:16384
  ds_read_b32 v164, v6 offset:17408
  v_mov_b32 v19, 0
  v_mov_b32 v19, 0
  v_mov_b32 v19, 0
  s_waitcnt lgkmcnt(1)
  v_mfma_f32_16x16x32_bf16 v[46:49], v[98:101], v[58:61], 0
  v_mfma_f32_16x16x32_bf16 v[50:53], v[102:105], v[58:61], 0
  v_mfma_f32_16x16x32_bf16 v[54:57], v[106:109], v[58:61], 0
  s_waitcnt lgkmcnt(0)
F_pvm:
  v_mfma_f32_16x16x32_bf16 v[46:49], v[156:159], v[164:167], v[46:49]
  v_mfma_f32_16x16x32_bf16 v[50:53], v[158:161], v[164:167], v[50:53]
  v_mfma_f32_16x16x32_bf16 v[54:57], v[160:163], v[164:167], v[54:57]
  v_mov_b32 v19, 0
  v_mov_b32 v19, 0
  v_mov_b32 v19, 0
  v_mov_b32 v19, 0
  v_mov_b32 v19, 0
  v_mov_b32 v19, 0
  v_cvt_pk_bf16_f32 v46, v46, v47
  v_cvt_pk_bf16_f32 v47, v48, v49
  ds_write_b64 v12, v[46:47] offset:0
  v_cvt_pk_bf16_f32 v50, v50, v51
  v_cvt_pk_bf16_f32 v51, v52, v53
  ds_write_b64 v12, v[50:51] offset:256
  v_cvt_pk_bf16_f32 v54, v54, v55
  v_cvt_pk_bf16_f32 v55, v56, v57
  ds_write_b64 v12, v[54:55] offset:512
  v_mfma_f32_16x16x32_bf16 v[66:69], v[58:61], v[34:37], 0
  v_mfma_f32_16x16x32_bf16 v[66:69], v[164:167], v[34:37], v[66:69]
  s_cmp_eq_u32 s44, 0
  s_cbranch_scc1 F_kv1
F_kv1e:
  s_mov_b32 m0, s58
  s_nop 0
  buffer_load_dwordx4 v1, s[4:7], s48 offen offset:0 sc1 lds
  s_mov_b32 m0, s57
  s_nop 0
  buffer_load_dwordx4 v1, s[4:7], s49 offen offset:0 sc1 lds
  s_waitcnt lgkmcnt(0)
  s_barrier
  ds_read_b128 v[122:125], v154 offset:0
  ds_read_b128 v[126:129], v154 offset:512
  ds_read_b128 v[130:133], v154 offset:1024
  buffer_load_dwordx4 v1, s[4:7], s49 offen offset:1024 sc1 lds
  buffer_load_dwordx4 v1, s[4:7], s49 offen offset:2048 sc1 lds
  s_waitcnt lgkmcnt(2)
  v_smfmac_f32_16x16x64_bf16 v[146:149], v[122:125], a[240:247], v18
  ds_read_b128 v[134:137], v154 offset:1536
  s_waitcnt lgkmcnt(2)
  v_smfmac_f32_16x16x64_bf16 v[146:149], v[126:129], a[248:255], v18
  ds_read_b128 v[138:141], v154 offset:2048
  s_waitcnt lgkmcnt(2)
  v_smfmac_f32_16x16x64_bf16 v[146:149], v[130:133], v[176:183], v18
  ds_read_b128 v[142:145], v154 offset:2560
  s_waitcnt lgkmcnt(2)
  v_smfmac_f32_16x16x64_bf16 v[146:149], v[134:137], v[184:191], v18
  buffer_store_dword v112, v8, s[4:7], s66 offen sc1
  s_add_u32 s66, s66, 98304
  s_waitcnt lgkmcnt(1)
  v_smfmac_f32_16x16x64_bf16 v[146:149], v[138:141], v[192:199], v18
  s_waitcnt lgkmcnt(0)
  v_smfmac_f32_16x16x64_bf16 v[146:149], v[142:145], v[200:207], v18
  v_smfmac_f32_16x16x64_bf16 v[150:153], v[122:125], v[208:215], v18
  v_rcp_f32 v66, v66
  v_smfmac_f32_16x16x64_bf16 v[150:153], v[126:129], v[216:223], v18
  v_rcp_f32 v67, v67
  v_smfmac_f32_16x16x64_bf16 v[150:153], v[130:133], v[224:231], v18
  v_rcp_f32 v68, v68
  v_smfmac_f32_16x16x64_bf16 v[150:153], v[134:137], v[232:239], v18
  v_rcp_f32 v69, v69
  v_smfmac_f32_16x16x64_bf16 v[150:153], v[138:141], v[240:247], v18
  v_smfmac_f32_16x16x64_bf16 v[150:153], v[142:145], v[248:255], v18
  v_mul_f32 v146, v146, v66
  v_mul_f32 v147, v147, v67
  v_mul_f32 v148, v148, v68
  v_mul_f32 v149, v149, v69
  v_cvt_pk_bf16_f32 v46, v146, v147
  v_cvt_pk_bf16_f32 v47, v148, v149
  v_mov_b32 v19, 0
  v_mov_b32 v19, 0
  v_mul_f32 v150, v150, v66
  v_mul_f32 v151, v151, v67
  v_mul_f32 v152, v152, v68
  v_mul_f32 v153, v153, v69
  v_cvt_pk_bf16_f32 v48, v150, v151
  v_cvt_pk_bf16_f32 v49, v152, v153
  v_mov_b32 v19, 0
  v_permlane16_swap_b32 v46, v48
  v_permlane16_swap_b32 v47, v49
  buffer_store_dwordx4 v[46:49], v13, s[4:7], s47 offen sc1
  s_add_u32 s48, s48, 393216
  s_add_u32 s49, s49, 393216
  s_cmp_ge_u32 s44, 61
  s_cbranch_scc1 F_s62
  s_nop 11
F_s62e:
  s_cmp_ge_u32 s12, 2
  s_cbranch_scc1 F_reduce
  s_cmp_eq_u32 s12, 0
  s_cbranch_scc0 F_hk1
  s_add_u32 s75, s44, 3
  s_min_u32 s75, s75, 64
  s_cmp_ge_u32 s71, s75
  s_cbranch_scc1 F_kvw_e
  s_mov_b64 exec, 0xff
  s_mov_b32 s15, 0
F_kvw:
  v_mov_b32 v20, 0
  buffer_atomic_add v20, v6, s[4:7], s72 offen sc0 sc1
  s_waitcnt vmcnt(0)
  v_cmp_gt_u32 vcc, s75, v20
  s_cbranch_vccz F_kvw_ok
  s_sleep 2
  s_add_u32 s15, s15, 1
  s_cmp_lt_u32 s15, 262144
  s_cbranch_scc1 F_kvw
  s_branch L_fail
F_kvw_ok:
  v_readlane_b32 s71, v20, 0
  v_readlane_b32 s74, v20, 1
  s_nop 0
  s_min_u32 s71, s71, s74
  v_readlane_b32 s74, v20, 2
  s_nop 0
  s_min_u32 s71, s71, s74
  v_readlane_b32 s74, v20, 3
  s_nop 0
  s_min_u32 s71, s71, s74
  v_readlane_b32 s74, v20, 4
  s_nop 0
  s_min_u32 s71, s71, s74
  v_readlane_b32 s74, v20, 5
  s_nop 0
  s_min_u32 s71, s71, s74
  v_readlane_b32 s74, v20, 6
  s_nop 0
  s_min_u32 s71, s71, s74
  v_readlane_b32 s74, v20, 7
  s_nop 0
  s_min_u32 s71, s71, s74
  s_mov_b64 exec, -1
F_kvw_e:
  s_branch F_hk
F_hk1:
  s_cmp_ge_u32 s44, 61
  s_cbranch_scc1 F_kpd
  buffer_store_dwordx4 v[114:117], v16, s[4:7], s65 offen offset:0 sc1
  buffer_store_dwordx4 v[118:121], v16, s[4:7], s65 offen offset:512 sc1
  s_add_u32 s65, s65, 98304
F_kpd:
F_hk:
  s_add_u32 s44, s44, 1
  s_and_b32 s74, s44, 3
  s_xor_b32 s75, s74, 2
  s_add_u32 s76, s44, 1
  s_and_b32 s76, s76, 3
  s_lshl_b32 s45, s74, 17
  s_add_u32 s45, s45, 50331648
  s_lshl_b32 s51, s75, 17
  s_add_u32 s51, s51, 50331648
  s_lshl_b32 s46, s74, 17
  s_add_u32 s46, s46, 50855936
  s_lshl_b32 s52, s75, 17
  s_add_u32 s52, s52, 50855936
  s_lshl_b32 s50, s76, 16
  s_add_u32 s50, s50, s63
  s_xor_b32 s76, s76, 2
  s_lshl_b32 s53, s76, 16
  s_add_u32 s53, s53, s63
  s_add_u32 s55, s45, s56
  s_mul_i32 s75, s44, 0x5556
  s_lshr_b32 s75, s75, 16
  s_mul_i32 s76, s75, 3
  s_sub_u32 s76, s44, s76
  s_mul_i32 s76, s76, 655360
  s_lshl_b32 s47, s75, 21
  s_add_u32 s47, s47, s76
  s_xor_b32 s75, s75, s14
  s_and_b32 s75, s75, 1
  s_lshl_b32 s75, s75, 13
  s_add_u32 s47, s47, s75
  s_add_u32 s47, s47, 83886080
  s_lshl_b32 s75, s79, 14
  s_add_u32 s75, s75, s47
  s_mov_b32 s20, s75
  s_add_u32 s21, s75, 4096
  s_mov_b32 s15, 0
  s_sleep 8
  s_nop 11
F_gather:
  s_mov_b32 m0, s64
  s_add_u32 s74, s64, 4096
  buffer_load_dwordx4 v1, s[4:7], s61 offen offset:0 sc1 lds
  buffer_load_dwordx4 v1, s[4:7], s61 offen offset:1024 sc1 lds
  buffer_load_dwordx4 v1, s[4:7], s61 offen offset:2048 sc1 lds
  buffer_load_dwordx4 v1, s[4:7], s61 offen offset:3072 sc1 lds
  s_mov_b32 m0, s74
  s_nop 0
  buffer_load_dwordx4 v1, s[4:7], s62 offen sc1 lds
  s_nop 15
  s_nop 13
F_pollM:
  s_mov_b32 m0, s64
  s_add_u32 s74, s64, 4096
  buffer_load_dwordx4 v1, s[4:7], s61 offen offset:0 sc1 lds
  buffer_load_dwordx4 v1, s[4:7], s61 offen offset:1024 sc1 lds
  buffer_load_dwordx4 v1, s[4:7], s61 offen offset:2048 sc1 lds
  buffer_load_dwordx4 v1, s[4:7], s61 offen offset:3072 sc1 lds
  s_mov_b32 m0, s74
  s_nop 0
  buffer_load_dwordx4 v1, s[4:7], s62 offen sc1 lds
  s_waitcnt vmcnt(5)
  ds_read_b128 v[122:125], v7
  ds_read_b128 v[126:129], v7 offset:64
  s_waitcnt lgkmcnt(0)
  v_max3_u32 v20, v122, v123, v124
  v_max3_u32 v21, v125, v126, v127
  v_max3_u32 v20, v20, v128, v129
  v_max_u32 v20, v20, v21
  v_cmp_eq_u32 vcc, -1, v20
  s_cbranch_vccz F_b1
  s_add_u32 s15, s15, 1
  s_cmp_lt_u32 s15, 0x40000
  s_cbranch_scc1 F_pollM
  s_branch L_fail
F_retry:
  v_max3_u32 v20, v38, v39, v40
  v_max3_u32 v21, v41, v42, v43
  v_max3_u32 v20, v20, v44, v45
  v_max3_u32 v21, v21, v46, v47
  v_max3_u32 v20, v20, v48, v49
  v_max3_u32 v21, v21, v50, v51
  v_max3_u32 v20, v20, v52, v53
  v_max3_u32 v21, v21, v54, v55
  v_max3_u32 v20, v20, v56, v57
  v_max3_u32 v21, v21, v58, v59
  v_max3_u32 v20, v20, v60, v61
  v_max3_u32 v21, v21, v62, v63
  v_max3_u32 v20, v20, v64, v65
  v_max3_u32 v21, v21, v66, v67
  v_max3_u32 v20, v20, v68, v69
  v_max3_u32 v21, v21, v70, v71
  v_max3_u32 v20, v20, v72, v73
  v_max3_u32 v21, v21, v74, v75
  v_max3_u32 v20, v20, v76, v77
  v_max_u32 v20, v20, v21
  v_cmp_eq_u32 vcc, -1, v20
  s_cbranch_vccz F_mem_ok
  v_mov_b32 v20, s59
  ds_write_b32 v6, v20 offset:20480
  s_branch F_mem_ok
F_redo:
  s_nop 1
  v_mov_b32 v78, 0
  v_mov_b32 v79, 0
  v_mov_b32 v80, 0
  v_mov_b32 v81, 0
  v_mov_b32 v82, 0
  v_mov_b32 v83, 0
  v_mov_b32 v84, 0
  v_mov_b32 v85, 0
  v_mov_b32 v86, 0
  v_mov_b32 v87, 0
  v_mov_b32 v88, 0
  v_mov_b32 v89, 0
  s_waitcnt vmcnt(0) lgkmcnt(0)
  s_add_u32 s59, s59, 1
  s_cmp_ge_u32 s59, 0x20000
  s_cbranch_scc1 L_fail
  s_mov_b32 s15, 0
  s_add_u32 s75, s64, 4096
  s_cmp_ge_u32 s12, 2
  s_cbranch_scc1 F_b1
  s_branch F_gather
F_s62:
  s_cmp_lg_u32 s12, 1
  s_cbranch_scc1 F_s62a
  buffer_store_dwordx4 v[114:117], v16, s[4:7], s65 offen offset:0 sc1
  buffer_store_dwordx4 v[118:121], v16, s[4:7], s65 offen offset:512 sc1
  s_add_u32 s65, s65, 98304
F_s62a:
  s_waitcnt vmcnt(0)
  s_barrier
  s_cmp_ge_u32 s12, 2
  s_cbranch_scc1 F_red0
  s_cmp_lg_u32 s12, 0
  s_cbranch_scc1 F_s62e
  s_add_u32 s74, s44, 1
  v_mov_b32 v20, s74
  buffer_store_dword v20, v155, s[4:7], s73 offen sc1
  s_branch F_s62e
F_red0:
  s_cmp_ge_u32 s40, 20
  s_cbranch_scc1 F_nored
  s_branch F_red1
F_mk1:
  s_add_u32 s74, s52, s60
  buffer_store_dwordx4 v[30:33], v15, s[4:7], s53 offen
  buffer_store_dwordx4 v[30:33], v1, s[4:7], s74 offen
  s_branch F_mke
F_mk2:
  s_branch F_mke
F_kv1:
  s_cmp_ge_u32 s71, 2
  s_cbranch_scc1 F_kv1w_e
  s_mov_b64 exec, 0xff
  s_mov_b32 s15, 0
F_kv1w:
  v_mov_b32 v20, 0
  buffer_atomic_add v20, v6, s[4:7], s72 offen sc0 sc1
  s_waitcnt vmcnt(0)
  v_cmp_gt_u32 vcc, 2, v20
  s_cbranch_vccz F_kv1w_ok
  s_sleep 2
  s_add_u32 s15, s15, 1
  s_cmp_lt_u32 s15, 262144
  s_cbranch_scc1 F_kv1w
  s_branch L_fail
F_kv1w_ok:
  v_readlane_b32 s71, v20, 0
  v_readlane_b32 s74, v20, 1
  s_nop 0
  s_min_u32 s71, s71, s74
  v_readlane_b32 s74, v20, 2
  s_nop 0
  s_min_u32 s71, s71, s74
  v_readlane_b32 s74, v20, 3
  s_nop 0
  s_min_u32 s71, s71, s74
  v_readlane_b32 s74, v20, 4
  s_nop 0
  s_min_u32 s71, s71, s74
  v_readlane_b32 s74, v20, 5
  s_nop 0
  s_min_u32 s71, s71, s74
  v_readlane_b32 s74, v20, 6
  s_nop 0
  s_min_u32 s71, s71, s74
  v_readlane_b32 s74, v20, 7
  s_nop 0
  s_min_u32 s71, s71, s74
  s_mov_b64 exec, -1
F_kv1w_e:
  s_branch F_kv1e
F_againV:
  s_add_u32 s15, s15, 1
  s_cmp_lt_u32 s15, 0x40000
  s_cbranch_scc1 F_pollV
  s_branch L_fail
F_soft:
  v_smfmac_f32_16x16x64_bf16 v[86:89], v[54:57], a[192:199], v18
  v_smfmac_f32_16x16x64_bf16 v[86:89], v[58:61], a[200:207], v18
  v_smfmac_f32_16x16x64_bf16 v[86:89], v[62:65], a[208:215], v18
  v_smfmac_f32_16x16x64_bf16 v[86:89], v[66:69], a[216:223], v18
  v_smfmac_f32_16x16x64_bf16 v[86:89], v[70:73], a[224:231], v18
  v_smfmac_f32_16x16x64_bf16 v[86:89], v[74:77], a[232:239], v18
  s_waitcnt lgkmcnt(0)
  v_cmp_eq_u32 vcc, s59, v24
  v_mov_b32 v82, 0
  v_mov_b32 v83, 0
  v_mov_b32 v84, 0
  v_mov_b32 v85, 0
  s_cbranch_vccnz F_redo
  ds_read_b128 v[98:101], v10 offset:0
  ds_read_b128 v[102:105], v10 offset:1024
  ds_read_b128 v[106:109], v10 offset:2048
  v_mov_b32 v78, 0
  v_mov_b32 v79, 0
  v_mov_b32 v80, 0
  v_mov_b32 v81, 0
  v_permlane32_swap_b32 v86, v88
  v_permlane32_swap_b32 v87, v89
  v_add_f32 v86, v86, v88
  v_add_f32 v87, v87, v89
  v_cvt_pk_bf16_f32 v112, v86, v87
  buffer_store_dword v112, v8, s[4:7], s46 offen
  s_mov_b32 s15, 0
  s_add_u32 s61, s50, s64
  s_add_u32 s62, s61, 4096
  v_mov_b32 v86, 0
  v_mov_b32 v87, 0
  v_mov_b32 v88, 0
  v_mov_b32 v89, 0
  v_mov_b32 v146, 0
  v_mov_b32 v147, 0
  v_mov_b32 v148, 0
  v_mov_b32 v149, 0
  v_mov_b32 v150, 0
  v_mov_b32 v151, 0
  v_mov_b32 v152, 0
  v_mov_b32 v153, 0
  s_cmp_eq_u32 s44, 63
  s_cbranch_scc1 L_ch_last
  s_nop 15
  s_nop 13
  buffer_load_dwordx4 v[38:41], v1, s[4:7], s55 offen offset:0 sc1
  buffer_load_dwordx4 v[42:45], v1, s[4:7], s55 offen offset:1280 sc1
  buffer_load_dwordx4 v[46:49], v1, s[4:7], s55 offen offset:2560 sc1
  buffer_load_dword v50, v6, s[4:7], s55 offen offset:1024 sc1
  buffer_load_dword v51, v6, s[4:7], s55 offen offset:2304 sc1
  buffer_load_dword v52, v6, s[4:7], s55 offen offset:3584 sc1
  v_mov_b32 v19, 0
  v_mov_b32 v19, 0
  v_mov_b32 v19, 0
  v_mov_b32 v19, 0
  v_mov_b32 v19, 0
  v_mov_b32 v19, 0
  v_mov_b32 v19, 0
  v_mov_b32 v19, 0
  v_mov_b32 v19, 0
  v_mov_b32 v19, 0
  v_mov_b32 v19, 0
  v_mov_b32 v19, 0
  v_mov_b32 v19, 0
  v_mov_b32 v19, 0
  v_mov_b32 v19, 0
  v_mov_b32 v19, 0
  v_mov_b32 v19, 0
  v_mov_b32 v19, 0
  v_mov_b32 v19, 0
  v_mov_b32 v19, 0
F_pollS:
  buffer_load_dwordx4 v[122:125], v1, s[4:7], s55 offen offset:0 sc1
  buffer_load_dwordx4 v[126:129], v1, s[4:7], s55 offen offset:1280 sc1
  buffer_load_dwordx4 v[130:133], v1, s[4:7], s55 offen offset:2560 sc1
  buffer_load_dword v134, v6, s[4:7], s55 offen offset:1024 sc1
  buffer_load_dword v135, v6, s[4:7], s55 offen offset:2304 sc1
  buffer_load_dword v136, v6, s[4:7], s55 offen offset:3584 sc1
  s_waitcnt vmcnt(6)
  v_add_f32 v70, v38, v42
  v_add_f32 v71, v39, v43
  v_add_f32 v72, v40, v44
  v_add_f32 v73, v41, v45
  v_add_f32 v74, v50, v51
  v_add_f32 v70, v70, v46
  v_add_f32 v71, v71, v47
  v_add_f32 v72, v72, v48
  v_add_f32 v73, v73, v49
  v_add_f32 v74, v74, v52
  v_max3_f32 v20, v70, v71, v74
  v_max3_f32 v20, v20, v72, v73
  v_add_f32 v22, v70, v71
  v_add_f32 v23, v72, v73
  v_max_f32_dpp v20, v20, v20 row_ror:8 row_mask:0xf bank_mask:0xf
  v_add_f32 v22, v22, v74
  v_cmp_u_f32 vcc, v22, v23
  v_mov_b32 v21, v20
  s_cbranch_vccz F_haveS
  v_max3_u32 v22, v38, v39, v40
  v_max3_u32 v23, v41, v42, v43
  v_max3_u32 v22, v22, v44, v45
  v_max3_u32 v23, v23, v46, v47
  v_max3_u32 v22, v22, v48, v49
  v_max3_u32 v23, v23, v50, v51
  v_max3_u32 v22, v22, v23, v52
  v_cmp_eq_u32 vcc, -1, v22
  s_cbranch_vccz F_haveS
  buffer_load_dwordx4 v[38:41], v1, s[4:7], s55 offen offset:0 sc1
  buffer_load_dwordx4 v[42:45], v1, s[4:7], s55 offen offset:1280 sc1
  buffer_load_dwordx4 v[46:49], v1, s[4:7], s55 offen offset:2560 sc1
  buffer_load_dword v50, v6, s[4:7], s55 offen offset:1024 sc1
  buffer_load_dword v51, v6, s[4:7], s55 offen offset:2304 sc1
  buffer_load_dword v52, v6, s[4:7], s55 offen offset:3584 sc1
  s_waitcnt vmcnt(6)
  v_add_f32 v70, v122, v126
  v_add_f32 v71, v123, v127
  v_add_f32 v72, v124, v128
  v_add_f32 v73, v125, v129
  v_add_f32 v74, v134, v135
  v_add_f32 v70, v70, v130
  v_add_f32 v71, v71, v131
  v_add_f32 v72, v72, v132
  v_add_f32 v73, v73, v133
  v_add_f32 v74, v74, v136
  v_max3_f32 v20, v70, v71, v74
  v_max3_f32 v20, v20, v72, v73
  v_add_f32 v22, v70, v71
  v_add_f32 v23, v72, v73
  v_max_f32_dpp v20, v20, v20 row_ror:8 row_mask:0xf bank_mask:0xf
  v_add_f32 v22, v22, v74
  v_cmp_u_f32 vcc, v22, v23
  v_mov_b32 v21, v20
  s_cbranch_vccz F_haveS
  v_max3_u32 v22, v122, v123, v124
  v_max3_u32 v23, v125, v126, v127
  v_max3_u32 v22, v22, v128, v129
  v_max3_u32 v23, v23, v130, v131
  v_max3_u32 v22, v22, v132, v133
  v_max3_u32 v23, v23, v134, v135
  v_max3_u32 v22, v22, v23, v136
  v_cmp_eq_u32 vcc, -1, v22
  s_cbranch_vccz F_haveS
  s_add_u32 s15, s15, 1
  s_cmp_lt_u32 s15, 0x40000
  s_cbranch_scc1 F_pollS
  s_branch L_fail
F_haveS:
  buffer_load_dword v156, v9, s[4:7], s46 offen offset:0 sc1
  v_permlane16_swap_b32 v20, v21
  v_max_f32 v20, v20, v21
  v_mov_b32 v21, v20
  buffer_load_dword v158, v9, s[4:7], s46 offen offset:256 sc1
  buffer_load_dword v160, v9, s[4:7], s46 offen offset:512 sc1
  v_permlane32_swap_b32 v20, v21
  v_max_f32 v20, v20, v21
  v_mul_f32 v20, s78, v20
  v_fma_f32 v70, v70, s78, -v20
  v_fma_f32 v71, v71, s78, -v20
  v_fma_f32 v72, v72, s78, -v20
  v_fma_f32 v73, v73, s78, -v20
  v_fma_f32 v74, v74, s78, -v20
  v_exp_f32 v70, v70
  v_exp_f32 v71, v71
  v_exp_f32 v72, v72
  v_exp_f32 v73, v73
  v_exp_f32 v74, v74
  v_cvt_pk_bf16_f32 v58, v70, v71
  v_cvt_pk_bf16_f32 v59, v72, v73
  v_mov_b32_dpp v22, v74 row_ror:8 row_mask:0xf bank_mask:0xf
  v_mov_b32_dpp v60, v58 row_ror:8 row_mask:0xf bank_mask:0xf
  v_mov_b32_dpp v61, v59 row_ror:8 row_mask:0xf bank_mask:0xf
  v_cvt_pk_bf16_f32 v164, v74, v22
  ds_write_b128 v1, v[58:61] offset:16384
  ds_write_b32 v6, v164 offset:17408
  s_waitcnt lgkmcnt(0)
  s_barrier
  s_waitcnt vmcnt(3)
  v_mfma_f32_16x16x32_bf16 v[46:49], v[98:101], v[58:61], 0
  v_mfma_f32_16x16x32_bf16 v[50:53], v[102:105], v[58:61], 0
  v_mfma_f32_16x16x32_bf16 v[54:57], v[106:109], v[58:61], 0
F_chkV3:
  s_waitcnt vmcnt(0)
  v_max3_u32 v23, v156, v158, v160
  v_cmp_eq_u32 vcc, -1, v23
  s_cbranch_vccz F_pvm
  buffer_load_dword v156, v9, s[4:7], s46 offen offset:0 sc1
  buffer_load_dword v158, v9, s[4:7], s46 offen offset:256 sc1
  buffer_load_dword v160, v9, s[4:7], s46 offen offset:512 sc1
  s_add_u32 s15, s15, 1
  s_cmp_lt_u32 s15, 0x40000
  s_cbranch_scc1 F_chkV3
  s_branch L_fail
F_sc0:
  v_mfma_f32_16x16x32_bf16 v[78:81], v[114:117], v[114:117], 0
  v_mfma_f32_16x16x32_bf16 v[78:81], v[118:121], v[118:121], v[78:81]
  s_branch F_sc1
F_againC:
  v_max3_u32 v20, v38, v39, v40
  v_max3_u32 v21, v41, v42, v43
  v_max3_u32 v20, v20, v44, v45
  v_max3_u32 v21, v21, v46, v47
  v_max3_u32 v20, v20, v48, v49
  v_max3_u32 v21, v21, v50, v51
  v_max3_u32 v20, v20, v52, v53
  v_max3_u32 v21, v21, v54, v55
  v_max3_u32 v20, v20, v56, v57
  v_max3_u32 v21, v21, v58, v59
  v_max3_u32 v20, v20, v60, v61
  v_max3_u32 v21, v21, v62, v63
  v_max3_u32 v20, v20, v64, v65
  v_max3_u32 v21, v21, v66, v67
  v_max3_u32 v20, v20, v68, v69
  v_max_u32 v20, v20, v21
  v_cmp_eq_u32 vcc, -1, v20
  s_cbranch_vccz F_have_c
  s_add_u32 s15, s15, 1
  s_cmp_lt_u32 s15, 0x40000
  s_cbranch_scc1 F_pollC
  s_branch L_fail
F_reduce:
  s_cmp_ge_u32 s40, 20
  s_cbranch_scc1 F_nored
  s_sleep 5
  s_nop 9
F_red1:
  s_mov_b32 s15, 0
F_pollC:
  buffer_load_dwordx4 v[38:41], v1, s[4:7], s20 offen offset:0 sc1
  buffer_load_dwordx4 v[42:45], v1, s[4:7], s20 offen offset:1024 sc1
  buffer_load_dwordx4 v[46:49], v1, s[4:7], s20 offen offset:2048 sc1
  buffer_load_dwordx4 v[50:53], v1, s[4:7], s20 offen offset:3072 sc1
  buffer_load_dwordx4 v[54:57], v1, s[4:7], s21 offen offset:0 sc1
  buffer_load_dwordx4 v[58:61], v1, s[4:7], s21 offen offset:1024 sc1
  buffer_load_dwordx4 v[62:65], v1, s[4:7], s21 offen offset:2048 sc1
  buffer_load_dwordx4 v[66:69], v1, s[4:7], s21 offen offset:3072 sc1
  s_waitcnt vmcnt(7)
  v_mfma_f32_16x16x32_bf16 v[114:117], v[38:41], v[26:29], 0
  s_waitcnt vmcnt(6)
  v_mfma_f32_16x16x32_bf16 v[114:117], v[42:45], v[26:29], v[114:117]
  s_waitcnt vmcnt(5)
  v_mfma_f32_16x16x32_bf16 v[114:117], v[46:49], v[26:29], v[114:117]
  s_waitcnt vmcnt(4)
  v_mfma_f32_16x16x32_bf16 v[114:117], v[50:53], v[26:29], v[114:117]
  s_waitcnt vmcnt(3)
  v_mfma_f32_16x16x32_bf16 v[114:117], v[54:57], v[26:29], v[114:117]
  s_waitcnt vmcnt(2)
  v_mfma_f32_16x16x32_bf16 v[114:117], v[58:61], v[26:29], v[114:117]
  s_waitcnt vmcnt(1)
  v_mfma_f32_16x16x32_bf16 v[114:117], v[62:65], v[26:29], v[114:117]
  s_waitcnt vmcnt(0)
  v_mfma_f32_16x16x32_bf16 v[114:117], v[66:69], v[26:29], v[114:117]
  s_nop 7
  v_cmp_u_f32 vcc, v114, v115
  v_cmp_u_f32 s[68:69], v116, v117
  v_cvt_pk_bf16_f32 v118, v114, v115
  v_cvt_pk_bf16_f32 v119, v116, v117
  s_or_b64 vcc, vcc, s[68:69]
  s_cbranch_scc1 F_againC
F_have_c:
  buffer_store_dwordx2 v[118:119], v17, s[4:7], s50 offen
F_nored:
  s_cmp_lt_u32 s40, 20
  s_cbranch_scc1 F_nw
  s_waitcnt vmcnt(0)
F_nw:
  s_add_u32 s44, s44, 1
  s_and_b32 s74, s44, 3
  s_xor_b32 s75, s74, 2
  s_add_u32 s76, s44, 1
  s_and_b32 s76, s76, 3
  s_lshl_b32 s45, s74, 17
  s_add_u32 s45, s45, 50331648
  s_lshl_b32 s51, s75, 17
  s_add_u32 s51, s51, 50331648
  s_lshl_b32 s46, s74, 17
  s_add_u32 s46, s46, 50855936
  s_lshl_b32 s52, s75, 17
  s_add_u32 s52, s52, 50855936
  s_lshl_b32 s50, s76, 16
  s_add_u32 s50, s50, s63
  s_xor_b32 s76, s76, 2
  s_lshl_b32 s53, s76, 16
  s_add_u32 s53, s53, s63
  s_add_u32 s55, s45, s56
  s_mul_i32 s75, s44, 0x5556
  s_lshr_b32 s75, s75, 16
  s_mul_i32 s76, s75, 3
  s_sub_u32 s76, s44, s76
  s_mul_i32 s76, s76, 655360
  s_lshl_b32 s47, s75, 21
  s_add_u32 s47, s47, s76
  s_xor_b32 s75, s75, s14
  s_and_b32 s75, s75, 1
  s_lshl_b32 s75, s75, 13
  s_add_u32 s47, s47, s75
  s_add_u32 s47, s47, 83886080
  s_lshl_b32 s75, s79, 14
  s_add_u32 s75, s75, s47
  s_mov_b32 s20, s75
  s_add_u32 s21, s75, 4096
  s_branch F_b1
S_b1:
  s_barrier
  ds_read_b128 v[38:41], v1 offset:0
  ds_read_b128 v[42:45], v1 offset:1024
  ds_read_b128 v[46:49], v1 offset:2048
  s_cmp_lg_u32 s12, 0
  s_cbranch_scc1 S_nofl
  v_mov_b32 v20, s44
  buffer_store_dword v20, v155, s[4:7], s73 offen sc1
S_nofl:
  s_waitcnt lgkmcnt(2)
  v_smfmac_f32_16x16x64_bf16 v[78:81], v[38:41], a[0:7], v18
  ds_read_b128 v[50:53], v1 offset:3072
  v_smfmac_f32_16x16x64_bf16 v[82:85], v[38:41], a[80:87], v18
  s_waitcnt lgkmcnt(2)
  v_smfmac_f32_16x16x64_bf16 v[78:81], v[42:45], a[8:15], v18
  ds_read_b128 v[54:57], v1 offset:4096
  v_smfmac_f32_16x16x64_bf16 v[82:85], v[42:45], a[88:95], v18
  s_waitcnt lgkmcnt(2)
  v_smfmac_f32_16x16x64_bf16 v[78:81], v[46:49], a[16:23], v18
  ds_read_b128 v[58:61], v1 offset:5120
  v_smfmac_f32_16x16x64_bf16 v[82:85], v[46:49], a[96:103], v18
  s_waitcnt lgkmcnt(2)
  v_smfmac_f32_16x16x64_bf16 v[78:81], v[50:53], a[24:31], v18
  ds_read_b128 v[62:65], v1 offset:6144
  v_smfmac_f32_16x16x64_bf16 v[82:85], v[50:53], a[104:111], v18
  s_waitcnt lgkmcnt(2)
  v_smfmac_f32_16x16x64_bf16 v[78:81], v[54:57], a[32:39], v18
  ds_read_b128 v[66:69], v1 offset:7168
  v_smfmac_f32_16x16x64_bf16 v[82:85], v[54:57], a[112:119], v18
  s_waitcnt lgkmcnt(2)
  v_smfmac_f32_16x16x64_bf16 v[78:81], v[58:61], a[40:47], v18
  ds_read_b128 v[70:73], v1 offset:8192
  v_smfmac_f32_16x16x64_bf16 v[82:85], v[58:61], a[120:127], v18
  s_waitcnt lgkmcnt(2)
  v_smfmac_f32_16x16x64_bf16 v[78:81], v[62:65], a[48:55], v18
  ds_read_b128 v[74:77], v1 offset:9216
  v_smfmac_f32_16x16x64_bf16 v[82:85], v[62:65], a[128:135], v18
  s_waitcnt lgkmcnt(2)
  v_smfmac_f32_16x16x64_bf16 v[78:81], v[66:69], a[56:63], v18
  s_waitcnt lgkmcnt(1)
  v_smfmac_f32_16x16x64_bf16 v[78:81], v[70:73], a[64:71], v18
  s_waitcnt lgkmcnt(0)
  v_smfmac_f32_16x16x64_bf16 v[78:81], v[74:77], a[72:79], v18
  v_smfmac_f32_16x16x64_bf16 v[82:85], v[66:69], a[136:143], v18
  ds_read_b64 v[90:91], v11 offset:0
  ds_read_b64 v[92:93], v11 offset:1024
  v_smfmac_f32_16x16x64_bf16 v[82:85], v[70:73], a[144:151], v18
  ds_read_b64 v[94:95], v11 offset:2048
  ds_read_b64 v[96:97], v11 offset:3072
  v_smfmac_f32_16x16x64_bf16 v[82:85], v[74:77], a[152:159], v18
  v_mov_b32 v19, 0
  v_permlane32_swap_b32 v78, v80
  v_permlane32_swap_b32 v79, v81
  v_add_f32 v78, v78, v80
  v_add_f32 v79, v79, v81
  v_cvt_pk_bf16_f32 v110, v78, v79
  v_cmp_u_f32 vcc, v78, v79
  v_mov_b32 v19, 0
  v_permlane32_swap_b32 v82, v84
  v_permlane32_swap_b32 v83, v85
  v_add_f32 v82, v82, v84
  v_add_f32 v83, v83, v85
  v_cvt_pk_bf16_f32 v111, v82, v83
  ds_write2_b32 v2, v110, v111 offset0:0 offset1:4
  s_cbranch_vccnz S_retry
S_mem_ok:
  v_smfmac_f32_16x16x64_bf16 v[86:89], v[38:41], a[160:167], v18
  v_smfmac_f32_16x16x64_bf16 v[86:89], v[42:45], a[168:175], v18
  v_smfmac_f32_16x16x64_bf16 v[86:89], v[46:49], a[176:183], v18
  v_smfmac_f32_16x16x64_bf16 v[86:89], v[50:53], a[184:191], v18
  s_cmp_eq_u32 s12, 3
  s_waitcnt lgkmcnt(0)
  s_barrier
  ds_read_b32 v24, v6 offset:20480
  s_cbranch_scc1 S_soft
  ds_read_b64_tr_b16 v[114:115], v3 offset:0
  ds_read_b64_tr_b16 v[116:117], v3 offset:512
  ds_read_b64_tr_b16 v[118:119], v3 offset:1024
  ds_read_b64_tr_b16 v[120:121], v3 offset:1536
  v_smfmac_f32_16x16x64_bf16 v[86:89], v[54:57], a[192:199], v18
  v_smfmac_f32_16x16x64_bf16 v[86:89], v[58:61], a[200:207], v18
  v_smfmac_f32_16x16x64_bf16 v[86:89], v[62:65], a[208:215], v18
  v_smfmac_f32_16x16x64_bf16 v[86:89], v[66:69], a[216:223], v18
  s_cmp_eq_u32 s12, 0
  s_waitcnt lgkmcnt(0)
  s_cbranch_scc1 S_sc0
  v_mfma_f32_16x16x32_bf16 v[78:81], v[90:93], v[114:117], 0
  v_mfma_f32_16x16x32_bf16 v[78:81], v[94:97], v[118:121], v[78:81]
S_sc1:
  v_cmp_eq_u32 vcc, s59, v24
  v_mov_b32 v82, 0
  v_mov_b32 v83, 0
  v_mov_b32 v84, 0
  v_mov_b32 v85, 0
  s_cbranch_vccnz S_redo
  v_mov_b32 v19, 0
  v_mov_b32 v19, 0
  buffer_store_dwordx4 v[78:81], v4, s[4:7], s45 offen sc1
  v_smfmac_f32_16x16x64_bf16 v[86:89], v[70:73], a[224:231], v18
  v_smfmac_f32_16x16x64_bf16 v[86:89], v[74:77], a[232:239], v18
  ds_read_b128 v[98:101], v10 offset:0
  ds_read_b128 v[102:105], v10 offset:1024
  ds_read_b128 v[106:109], v10 offset:2048
  v_mov_b32 v78, 0
  v_mov_b32 v79, 0
  v_mov_b32 v80, 0
  v_mov_b32 v81, 0
  v_mov_b32 v19, 0
  v_permlane32_swap_b32 v86, v88
  v_permlane32_swap_b32 v87, v89
  v_add_f32 v86, v86, v88
  v_add_f32 v87, v87, v89
  v_cvt_pk_bf16_f32 v112, v86, v87
  buffer_store_dword v112, v8, s[4:7], s46 offen sc1
  s_mov_b32 s15, 0
  s_add_u32 s61, s50, s64
  s_add_u32 s62, s61, 4096
  v_mov_b32 v86, 0
  v_mov_b32 v87, 0
  v_mov_b32 v88, 0
  v_mov_b32 v89, 0
  v_mov_b32 v146, 0
  v_mov_b32 v147, 0
  v_mov_b32 v148, 0
  v_mov_b32 v149, 0
  v_mov_b32 v150, 0
  v_mov_b32 v151, 0
  v_mov_b32 v152, 0
  v_mov_b32 v153, 0
  s_cmp_eq_u32 s44, 63
  s_cbranch_scc1 L_ch_last
  s_nop 15
  s_nop 15
  s_nop 7
S_pollV:
  buffer_load_dword v156, v9, s[4:7], s46 offen offset:0 sc1
  buffer_load_dword v158, v9, s[4:7], s46 offen offset:256 sc1
  buffer_load_dword v160, v9, s[4:7], s46 offen offset:512 sc1
  s_waitcnt vmcnt(0)
S_chkV:
  v_max3_u32 v23, v156, v158, v160
  v_cmp_eq_u32 vcc, -1, v23
  s_cbranch_vccnz S_againV
  s_cmp_eq_u32 s12, 1
  s_cbranch_scc1 S_mk1
  s_cmp_eq_u32 s12, 2
  s_cbranch_scc1 S_mk2
  buffer_store_dwordx4 v[30:33], v5, s[4:7], s51 offen sc1
  s_mov_b64 exec, 0xffff
  buffer_store_dwordx4 v[30:33], v5, s[4:7], s51 offen offset:1024 sc1
  s_mov_b64 exec, -1
S_mke:
  s_waitcnt lgkmcnt(0)
  s_barrier
  ds_read_b128 v[58:61], v1 offset:16384
  ds_read_b32 v164, v6 offset:17408
  v_mov_b32 v19, 0
  v_mov_b32 v19, 0
  v_mov_b32 v19, 0
  s_waitcnt lgkmcnt(1)
  v_mfma_f32_16x16x32_bf16 v[46:49], v[98:101], v[58:61], 0
  v_mfma_f32_16x16x32_bf16 v[50:53], v[102:105], v[58:61], 0
  v_mfma_f32_16x16x32_bf16 v[54:57], v[106:109], v[58:61], 0
  s_waitcnt lgkmcnt(0)
S_pvm:
  v_mfma_f32_16x16x32_bf16 v[46:49], v[156:159], v[164:167], v[46:49]
  v_mfma_f32_16x16x32_bf16 v[50:53], v[158:161], v[164:167], v[50:53]
  v_mfma_f32_16x16x32_bf16 v[54:57], v[160:163], v[164:167], v[54:57]
  v_mov_b32 v19, 0
  v_mov_b32 v19, 0
  v_mov_b32 v19, 0
  v_mov_b32 v19, 0
  v_mov_b32 v19, 0
  v_mov_b32 v19, 0
  v_cvt_pk_bf16_f32 v46, v46, v47
  v_cvt_pk_bf16_f32 v47, v48, v49
  ds_write_b64 v12, v[46:47] offset:0
  v_cvt_pk_bf16_f32 v50, v50, v51
  v_cvt_pk_bf16_f32 v51, v52, v53
  ds_write_b64 v12, v[50:51] offset:256
  v_cvt_pk_bf16_f32 v54, v54, v55
  v_cvt_pk_bf16_f32 v55, v56, v57
  ds_write_b64 v12, v[54:55] offset:512
  v_mfma_f32_16x16x32_bf16 v[66:69], v[58:61], v[34:37], 0
  v_mfma_f32_16x16x32_bf16 v[66:69], v[164:167], v[34:37], v[66:69]
  s_cmp_eq_u32 s44, 0
  s_cbranch_scc1 S_kv1
S_kv1e:
  s_mov_b32 m0, s58
  s_nop 0
  buffer_load_dwordx4 v1, s[4:7], s48 offen offset:0 sc1 lds
  s_mov_b32 m0, s57
  s_nop 0
  buffer_load_dwordx4 v1, s[4:7], s49 offen offset:0 sc1 lds
  s_waitcnt lgkmcnt(0)
  s_barrier
  ds_read_b128 v[122:125], v154 offset:0
  ds_read_b128 v[126:129], v154 offset:512
  ds_read_b128 v[130:133], v154 offset:1024
  buffer_load_dwordx4 v1, s[4:7], s49 offen offset:1024 sc1 lds
  buffer_load_dwordx4 v1, s[4:7], s49 offen offset:2048 sc1 lds
  s_waitcnt lgkmcnt(2)
  v_smfmac_f32_16x16x64_bf16 v[146:149], v[122:125], a[240:247], v18
  ds_read_b128 v[134:137], v154 offset:1536
  s_waitcnt lgkmcnt(2)
  v_smfmac_f32_16x16x64_bf16 v[146:149], v[126:129], a[248:255], v18
  ds_read_b128 v[138:141], v154 offset:2048
  s_waitcnt lgkmcnt(2)
  v_smfmac_f32_16x16x64_bf16 v[146:149], v[130:133], v[176:183], v18
  ds_read_b128 v[142:145], v154 offset:2560
  s_waitcnt lgkmcnt(2)
  v_smfmac_f32_16x16x64_bf16 v[146:149], v[134:137], v[184:191], v18
  buffer_store_dword v112, v8, s[4:7], s66 offen sc1
  s_add_u32 s66, s66, 98304
  s_waitcnt lgkmcnt(1)
  v_smfmac_f32_16x16x64_bf16 v[146:149], v[138:141], v[192:199], v18
  s_waitcnt lgkmcnt(0)
  v_smfmac_f32_16x16x64_bf16 v[146:149], v[142:145], v[200:207], v18
  v_smfmac_f32_16x16x64_bf16 v[150:153], v[122:125], v[208:215], v18
  v_rcp_f32 v66, v66
  v_smfmac_f32_16x16x64_bf16 v[150:153], v[126:129], v[216:223], v18
  v_rcp_f32 v67, v67
  v_smfmac_f32_16x16x64_bf16 v[150:153], v[130:133], v[224:231], v18
  v_rcp_f32 v68, v68
  v_smfmac_f32_16x16x64_bf16 v[150:153], v[134:137], v[232:239], v18
  v_rcp_f32 v69, v69
  v_smfmac_f32_16x16x64_bf16 v[150:153], v[138:141], v[240:247], v18
  v_smfmac_f32_16x16x64_bf16 v[150:153], v[142:145], v[248:255], v18
  v_mul_f32 v146, v146, v66
  v_mul_f32 v147, v147, v67
  v_mul_f32 v148, v148, v68
  v_mul_f32 v149, v149, v69
  v_cvt_pk_bf16_f32 v46, v146, v147
  v_cvt_pk_bf16_f32 v47, v148, v149
  v_mov_b32 v19, 0
  v_mov_b32 v19, 0
  v_mul_f32 v150, v150, v66
  v_mul_f32 v151, v151, v67
  v_mul_f32 v152, v152, v68
  v_mul_f32 v153, v153, v69
  v_cvt_pk_bf16_f32 v48, v150, v151
  v_cvt_pk_bf16_f32 v49, v152, v153
  v_mov_b32 v19, 0
  v_permlane16_swap_b32 v46, v48
  v_permlane16_swap_b32 v47, v49
  buffer_store_dwordx4 v[46:49], v13, s[4:7], s47 offen sc1
  s_add_u32 s48, s48, 393216
  s_add_u32 s49, s49, 393216
  s_cmp_ge_u32 s44, 61
  s_cbranch_scc1 S_s62
  s_nop 11
S_s62e:
  s_cmp_ge_u32 s12, 2
  s_cbranch_scc1 S_reduce
  s_cmp_eq_u32 s12, 0
  s_cbranch_scc0 S_hk1
  s_add_u32 s75, s44, 3
  s_min_u32 s75, s75, 64
  s_cmp_ge_u32 s71, s75
  s_cbranch_scc1 S_kvw_e
  s_mov_b64 exec, 0xff
  s_mov_b32 s15, 0
S_kvw:
  v_mov_b32 v20, 0
  buffer_atomic_add v20, v6, s[4:7], s72 offen sc0 sc1
  s_waitcnt vmcnt(0)
  v_cmp_gt_u32 vcc, s75, v20
  s_cbranch_vccz S_kvw_ok
  s_sleep 2
  s_add_u32 s15, s15, 1
  s_cmp_lt_u32 s15, 262144
  s_cbranch_scc1 S_kvw
  s_branch L_fail
S_kvw_ok:
  v_readlane_b32 s71, v20, 0
  v_readlane_b32 s74, v20, 1
  s_nop 0
  s_min_u32 s71, s71, s74
  v_readlane_b32 s74, v20, 2
  s_nop 0
  s_min_u32 s71, s71, s74
  v_readlane_b32 s74, v20, 3
  s_nop 0
  s_min_u32 s71, s71, s74
  v_readlane_b32 s74, v20, 4
  s_nop 0
  s_min_u32 s71, s71, s74
  v_readlane_b32 s74, v20, 5
  s_nop 0
  s_min_u32 s71, s71, s74
  v_readlane_b32 s74, v20, 6
  s_nop 0
  s_min_u32 s71, s71, s74
  v_readlane_b32 s74, v20, 7
  s_nop 0
  s_min_u32 s71, s71, s74
  s_mov_b64 exec, -1
S_kvw_e:
  s_branch S_hk
S_hk1:
  s_cmp_ge_u32 s44, 61
  s_cbranch_scc1 S_kpd
  buffer_store_dwordx4 v[114:117], v16, s[4:7], s65 offen offset:0 sc1
  buffer_store_dwordx4 v[118:121], v16, s[4:7], s65 offen offset:512 sc1
  s_add_u32 s65, s65, 98304
S_kpd:
S_hk:
  s_add_u32 s44, s44, 1
  s_and_b32 s74, s44, 3
  s_xor_b32 s75, s74, 2
  s_add_u32 s76, s44, 1
  s_and_b32 s76, s76, 3
  s_lshl_b32 s45, s74, 17
  s_add_u32 s45, s45, 50331648
  s_lshl_b32 s51, s75, 17
  s_add_u32 s51, s51, 50331648
  s_lshl_b32 s46, s74, 17
  s_add_u32 s46, s46, 50855936
  s_lshl_b32 s52, s75, 17
  s_add_u32 s52, s52, 50855936
  s_lshl_b32 s50, s76, 16
  s_add_u32 s50, s50, s63
  s_xor_b32 s76, s76, 2
  s_lshl_b32 s53, s76, 16
  s_add_u32 s53, s53, s63
  s_add_u32 s55, s45, s56
  s_mul_i32 s75, s44, 0x5556
  s_lshr_b32 s75, s75, 16
  s_mul_i32 s76, s75, 3
  s_sub_u32 s76, s44, s76
  s_mul_i32 s76, s76, 655360
  s_lshl_b32 s47, s75, 21
  s_add_u32 s47, s47, s76
  s_xor_b32 s75, s75, s14
  s_and_b32 s75, s75, 1
  s_lshl_b32 s75, s75, 13
  s_add_u32 s47, s47, s75
  s_add_u32 s47, s47, 83886080
  s_lshl_b32 s75, s79, 14
  s_add_u32 s75, s75, s47
  s_mov_b32 s20, s75
  s_add_u32 s21, s75, 4096
  s_mov_b32 s15, 0
  s_sleep 8
  s_nop 11
S_gather:
  s_mov_b32 m0, s64
  s_add_u32 s74, s64, 4096
  buffer_load_dwordx4 v1, s[4:7], s61 offen offset:0 sc1 lds
  buffer_load_dwordx4 v1, s[4:7], s61 offen offset:1024 sc1 lds
  buffer_load_dwordx4 v1, s[4:7], s61 offen offset:2048 sc1 lds
  buffer_load_dwordx4 v1, s[4:7], s61 offen offset:3072 sc1 lds
  s_mov_b32 m0, s74
  s_nop 0
  buffer_load_dwordx4 v1, s[4:7], s62 offen sc1 lds
  s_nop 15
  s_nop 13
S_pollM:
  s_mov_b32 m0, s64
  s_add_u32 s74, s64, 4096
  buffer_load_dwordx4 v1, s[4:7], s61 offen offset:0 sc1 lds
  buffer_load_dwordx4 v1, s[4:7], s61 offen offset:1024 sc1 lds
  buffer_load_dwordx4 v1, s[4:7], s61 offen offset:2048 sc1 lds
  buffer_load_dwordx4 v1, s[4:7], s61 offen offset:3072 sc1 lds
  s_mov_b32 m0, s74
  s_nop 0
  buffer_load_dwordx4 v1, s[4:7], s62 offen sc1 lds
  s_waitcnt vmcnt(5)
  ds_read_b128 v[122:125], v7
  ds_read_b128 v[126:129], v7 offset:64
  s_waitcnt lgkmcnt(0)
  v_max3_u32 v20, v122, v123, v124
  v_max3_u32 v21, v125, v126, v127
  v_max3_u32 v20, v20, v128, v129
  v_max_u32 v20, v20, v21
  v_cmp_eq_u32 vcc, -1, v20
  s_cbranch_vccz S_b1
  s_add_u32 s15, s15, 1
  s_cmp_lt_u32 s15, 0x40000
  s_cbranch_scc1 S_pollM
  s_branch L_fail
S_retry:
  v_max3_u32 v20, v38, v39, v40
  v_max3_u32 v21, v41, v42, v43
  v_max3_u32 v20, v20, v44, v45
  v_max3_u32 v21, v21, v46, v47
  v_max3_u32 v20, v20, v48, v49
  v_max3_u32 v21, v21, v50, v51
  v_max3_u32 v20, v20, v52, v53
  v_max3_u32 v21, v21, v54, v55
  v_max3_u32 v20, v20, v56, v57
  v_max3_u32 v21, v21, v58, v59
  v_max3_u32 v20, v20, v60, v61
  v_max3_u32 v21, v21, v62, v63
  v_max3_u32 v20, v20, v64, v65
  v_max3_u32 v21, v21, v66, v67
  v_max3_u32 v20, v20, v68, v69
  v_max3_u32 v21, v21, v70, v71
  v_max3_u32 v20, v20, v72, v73
  v_max3_u32 v21, v21, v74, v75
  v_max3_u32 v20, v20, v76, v77
  v_max_u32 v20, v20, v21
  v_cmp_eq_u32 vcc, -1, v20
  s_cbranch_vccz S_mem_ok
  v_mov_b32 v20, s59
  ds_write_b32 v6, v20 offset:20480
  s_branch S_mem_ok
S_redo:
  s_nop 1
  v_mov_b32 v78, 0
  v_mov_b32 v79, 0
  v_mov_b32 v80, 0
  v_mov_b32 v81, 0
  v_mov_b32 v82, 0
  v_mov_b32 v83, 0
  v_mov_b32 v84, 0
  v_mov_b32 v85, 0
  v_mov_b32 v86, 0
  v_mov_b32 v87, 0
  v_mov_b32 v88, 0
  v_mov_b32 v89, 0
  s_waitcnt vmcnt(0) lgkmcnt(0)
  s_add_u32 s59, s59, 1
  s_cmp_ge_u32 s59, 0x20000
  s_cbranch_scc1 L_fail
  s_mov_b32 s15, 0
  s_add_u32 s75, s64, 4096
  s_cmp_ge_u32 s12, 2
  s_cbranch_scc1 S_b1
  s_branch S_gather
S_s62:
  s_cmp_lg_u32 s12, 1
  s_cbranch_scc1 S_s62a
  buffer_store_dwordx4 v[114:117], v16, s[4:7], s65 offen offset:0 sc1
  buffer_store_dwordx4 v[118:121], v16, s[4:7], s65 offen offset:512 sc1
  s_add_u32 s65, s65, 98304
S_s62a:
  s_waitcnt vmcnt(0)
  s_barrier
  s_cmp_ge_u32 s12, 2
  s_cbranch_scc1 S_red0
  s_cmp_lg_u32 s12, 0
  s_cbranch_scc1 S_s62e
  s_add_u32 s74, s44, 1
  v_mov_b32 v20, s74
  buffer_store_dword v20, v155, s[4:7], s73 offen sc1
  s_branch S_s62e
S_red0:
  s_cmp_ge_u32 s40, 20
  s_cbranch_scc1 S_nored
  s_branch S_red1
S_mk1:
  s_add_u32 s74, s52, s60
  buffer_store_dwordx4 v[30:33], v15, s[4:7], s53 offen sc1
  buffer_store_dwordx4 v[30:33], v1, s[4:7], s74 offen sc1
  s_branch S_mke
S_mk2:
  s_branch S_mke
S_kv1:
  s_cmp_ge_u32 s71, 2
  s_cbranch_scc1 S_kv1w_e
  s_mov_b64 exec, 0xff
  s_mov_b32 s15, 0
S_kv1w:
  v_mov_b32 v20, 0
  buffer_atomic_add v20, v6, s[4:7], s72 offen sc0 sc1
  s_waitcnt vmcnt(0)
  v_cmp_gt_u32 vcc, 2, v20
  s_cbranch_vccz S_kv1w_ok
  s_sleep 2
  s_add_u32 s15, s15, 1
  s_cmp_lt_u32 s15, 262144
  s_cbranch_scc1 S_kv1w
  s_branch L_fail
S_kv1w_ok:
  v_readlane_b32 s71, v20, 0
  v_readlane_b32 s74, v20, 1
  s_nop 0
  s_min_u32 s71, s71, s74
  v_readlane_b32 s74, v20, 2
  s_nop 0
  s_min_u32 s71, s71, s74
  v_readlane_b32 s74, v20, 3
  s_nop 0
  s_min_u32 s71, s71, s74
  v_readlane_b32 s74, v20, 4
  s_nop 0
  s_min_u32 s71, s71, s74
  v_readlane_b32 s74, v20, 5
  s_nop 0
  s_min_u32 s71, s71, s74
  v_readlane_b32 s74, v20, 6
  s_nop 0
  s_min_u32 s71, s71, s74
  v_readlane_b32 s74, v20, 7
  s_nop 0
  s_min_u32 s71, s71, s74
  s_mov_b64 exec, -1
S_kv1w_e:
  s_branch S_kv1e
S_againV:
  s_add_u32 s15, s15, 1
  s_cmp_lt_u32 s15, 0x40000
  s_cbranch_scc1 S_pollV
  s_branch L_fail
S_soft:
  v_smfmac_f32_16x16x64_bf16 v[86:89], v[54:57], a[192:199], v18
  v_smfmac_f32_16x16x64_bf16 v[86:89], v[58:61], a[200:207], v18
  v_smfmac_f32_16x16x64_bf16 v[86:89], v[62:65], a[208:215], v18
  v_smfmac_f32_16x16x64_bf16 v[86:89], v[66:69], a[216:223], v18
  v_smfmac_f32_16x16x64_bf16 v[86:89], v[70:73], a[224:231], v18
  v_smfmac_f32_16x16x64_bf16 v[86:89], v[74:77], a[232:239], v18
  s_waitcnt lgkmcnt(0)
  v_cmp_eq_u32 vcc, s59, v24
  v_mov_b32 v82, 0
  v_mov_b32 v83, 0
  v_mov_b32 v84, 0
  v_mov_b32 v85, 0
  s_cbranch_vccnz S_redo
  ds_read_b128 v[98:101], v10 offset:0
  ds_read_b128 v[102:105], v10 offset:1024
  ds_read_b128 v[106:109], v10 offset:2048
  v_mov_b32 v78, 0
  v_mov_b32 v79, 0
  v_mov_b32 v80, 0
  v_mov_b32 v81, 0
  v_permlane32_swap_b32 v86, v88
  v_permlane32_swap_b32 v87, v89
  v_add_f32 v86, v86, v88
  v_add_f32 v87, v87, v89
  v_cvt_pk_bf16_f32 v112, v86, v87
  buffer_store_dword v112, v8, s[4:7], s46 offen sc1
  s_mov_b32 s15, 0
  s_add_u32 s61, s50, s64
  s_add_u32 s62, s61, 4096
  v_mov_b32 v86, 0
  v_mov_b32 v87, 0
  v_mov_b32 v88, 0
  v_mov_b32 v89, 0
  v_mov_b32 v146, 0
  v_mov_b32 v147, 0
  v_mov_b32 v148, 0
  v_mov_b32 v149, 0
  v_mov_b32 v150, 0
  v_mov_b32 v151, 0
  v_mov_b32 v152, 0
  v_mov_b32 v153, 0
  s_cmp_eq_u32 s44, 63
  s_cbranch_scc1 L_ch_last
  s_nop 15
  s_nop 13
  buffer_load_dwordx4 v[38:41], v1, s[4:7], s55 offen offset:0 sc1
  buffer_load_dwordx4 v[42:45], v1, s[4:7], s55 offen offset:1280 sc1
  buffer_load_dwordx4 v[46:49], v1, s[4:7], s55 offen offset:2560 sc1
  buffer_load_dword v50, v6, s[4:7], s55 offen offset:1024 sc1
  buffer_load_dword v51, v6, s[4:7], s55 offen offset:2304 sc1
  buffer_load_dword v52, v6, s[4:7], s55 offen offset:3584 sc1
  v_mov_b32 v19, 0
  v_mov_b32 v19, 0
  v_mov_b32 v19, 0
  v_mov_b32 v19, 0
  v_mov_b32 v19, 0
  v_mov_b32 v19, 0
  v_mov_b32 v19, 0
  v_mov_b32 v19, 0
  v_mov_b32 v19, 0
  v_mov_b32 v19, 0
  v_mov_b32 v19, 0
  v_mov_b32 v19, 0
  v_mov_b32 v19, 0
  v_mov_b32 v19, 0
  v_mov_b32 v19, 0
  v_mov_b32 v19, 0
  v_mov_b32 v19, 0
  v_mov_b32 v19, 0
  v_mov_b32 v19, 0
  v_mov_b32 v19, 0
S_pollS:
  buffer_load_dwordx4 v[122:125], v1, s[4:7], s55 offen offset:0 sc1
  buffer_load_dwordx4 v[126:129], v1, s[4:7], s55 offen offset:1280 sc1
  buffer_load_dwordx4 v[130:133], v1, s[4:7], s55 offen offset:2560 sc1
  buffer_load_dword v134, v6, s[4:7], s55 offen offset:1024 sc1
  buffer_load_dword v135, v6, s[4:7], s55 offen offset:2304 sc1
  buffer_load_dword v136, v6, s[4:7], s55 offen offset:3584 sc1
  s_waitcnt vmcnt(6)
  v_add_f32 v70, v38, v42
  v_add_f32 v71, v39, v43
  v_add_f32 v72, v40, v44
  v_add_f32 v73, v41, v45
  v_add_f32 v74, v50, v51
  v_add_f32 v70, v70, v46
  v_add_f32 v71, v71, v47
  v_add_f32 v72, v72, v48
  v_add_f32 v73, v73, v49
  v_add_f32 v74, v74, v52
  v_max3_f32 v20, v70, v71, v74
  v_max3_f32 v20, v20, v72, v73
  v_add_f32 v22, v70, v71
  v_add_f32 v23, v72, v73
  v_max_f32_dpp v20, v20, v20 row_ror:8 row_mask:0xf bank_mask:0xf
  v_add_f32 v22, v22, v74
  v_cmp_u_f32 vcc, v22, v23
  v_mov_b32 v21, v20
  s_cbranch_vccz S_haveS
  v_max3_u32 v22, v38, v39, v40
  v_max3_u32 v23, v41, v42, v43
  v_max3_u32 v22, v22, v44, v45
  v_max3_u32 v23, v23, v46, v47
  v_max3_u32 v22, v22, v48, v49
  v_max3_u32 v23, v23, v50, v51
  v_max3_u32 v22, v22, v23, v52
  v_cmp_eq_u32 vcc, -1, v22
  s_cbranch_vccz S_haveS
  buffer_load_dwordx4 v[38:41], v1, s[4:7], s55 offen offset:0 sc1
  buffer_load_dwordx4 v[42:45], v1, s[4:7], s55 offen offset:1280 sc1
  buffer_load_dwordx4 v[46:49], v1, s[4:7], s55 offen offset:2560 sc1
  buffer_load_dword v50, v6, s[4:7], s55 offen offset:1024 sc1
  buffer_load_dword v51, v6, s[4:7], s55 offen offset:2304 sc1
  buffer_load_dword v52, v6, s[4:7], s55 offen offset:3584 sc1
  s_waitcnt vmcnt(6)
  v_add_f32 v70, v122, v126
  v_add_f32 v71, v123, v127
  v_add_f32 v72, v124, v128
  v_add_f32 v73, v125, v129
  v_add_f32 v74, v134, v135
  v_add_f32 v70, v70, v130
  v_add_f32 v71, v71, v131
  v_add_f32 v72, v72, v132
  v_add_f32 v73, v73, v133
  v_add_f32 v74, v74, v136
  v_max3_f32 v20, v70, v71, v74
  v_max3_f32 v20, v20, v72, v73
  v_add_f32 v22, v70, v71
  v_add_f32 v23, v72, v73
  v_max_f32_dpp v20, v20, v20 row_ror:8 row_mask:0xf bank_mask:0xf
  v_add_f32 v22, v22, v74
  v_cmp_u_f32 vcc, v22, v23
  v_mov_b32 v21, v20
  s_cbranch_vccz S_haveS
  v_max3_u32 v22, v122, v123, v124
  v_max3_u32 v23, v125, v126, v127
  v_max3_u32 v22, v22, v128, v129
  v_max3_u32 v23, v23, v130, v131
  v_max3_u32 v22, v22, v132, v133
  v_max3_u32 v23, v23, v134, v135
  v_max3_u32 v22, v22, v23, v136
  v_cmp_eq_u32 vcc, -1, v22
  s_cbranch_vccz S_haveS
  s_add_u32 s15, s15, 1
  s_cmp_lt_u32 s15, 0x40000
  s_cbranch_scc1 S_pollS
  s_branch L_fail
S_haveS:
  buffer_load_dword v156, v9, s[4:7], s46 offen offset:0 sc1
  v_permlane16_swap_b32 v20, v21
  v_max_f32 v20, v20, v21
  v_mov_b32 v21, v20
  buffer_load_dword v158, v9, s[4:7], s46 offen offset:256 sc1
  buffer_load_dword v160, v9, s[4:7], s46 offen offset:512 sc1
  v_permlane32_swap_b32 v20, v21
  v_max_f32 v20, v20, v21
  v_mul_f32 v20, s78, v20
  v_fma_f32 v70, v70, s78, -v20
  v_fma_f32 v71, v71, s78, -v20
  v_fma_f32 v72, v72, s78, -v20
  v_fma_f32 v73, v73, s78, -v20
  v_fma_f32 v74, v74, s78, -v20
  v_exp_f32 v70, v70
  v_exp_f32 v71, v71
  v_exp_f32 v72, v72
  v_exp_f32 v73, v73
  v_exp_f32 v74, v74
  v_cvt_pk_bf16_f32 v58, v70, v71
  v_cvt_pk_bf16_f32 v59, v72, v73
  v_mov_b32_dpp v22, v74 row_ror:8 row_mask:0xf bank_mask:0xf
  v_mov_b32_dpp v60, v58 row_ror:8 row_mask:0xf bank_mask:0xf
  v_mov_b32_dpp v61, v59 row_ror:8 row_mask:0xf bank_mask:0xf
  v_cvt_pk_bf16_f32 v164, v74, v22
  ds_write_b128 v1, v[58:61] offset:16384
  ds_write_b32 v6, v164 offset:17408
  s_waitcnt lgkmcnt(0)
  s_barrier
  s_waitcnt vmcnt(3)
  v_mfma_f32_16x16x32_bf16 v[46:49], v[98:101], v[58:61], 0
  v_mfma_f32_16x16x32_bf16 v[50:53], v[102:105], v[58:61], 0
  v_mfma_f32_16x16x32_bf16 v[54:57], v[106:109], v[58:61], 0
S_chkV3:
  s_waitcnt vmcnt(0)
  v_max3_u32 v23, v156, v158, v160
  v_cmp_eq_u32 vcc, -1, v23
  s_cbranch_vccz S_pvm
  buffer_load_dword v156, v9, s[4:7], s46 offen offset:0 sc1
  buffer_load_dword v158, v9, s[4:7], s46 offen offset:256 sc1
  buffer_load_dword v160, v9, s[4:7], s46 offen offset:512 sc1
  s_add_u32 s15, s15, 1
  s_cmp_lt_u32 s15, 0x40000
  s_cbranch_scc1 S_chkV3
  s_branch L_fail
S_sc0:
  v_mfma_f32_16x16x32_bf16 v[78:81], v[114:117], v[114:117], 0
  v_mfma_f32_16x16x32_bf16 v[78:81], v[118:121], v[118:121], v[78:81]
  s_branch S_sc1
S_againC:
  v_max3_u32 v20, v38, v39, v40
  v_max3_u32 v21, v41, v42, v43
  v_max3_u32 v20, v20, v44, v45
  v_max3_u32 v21, v21, v46, v47
  v_max3_u32 v20, v20, v48, v49
  v_max3_u32 v21, v21, v50, v51
  v_max3_u32 v20, v20, v52, v53
  v_max3_u32 v21, v21, v54, v55
  v_max3_u32 v20, v20, v56, v57
  v_max3_u32 v21, v21, v58, v59
  v_max3_u32 v20, v20, v60, v61
  v_max3_u32 v21, v21, v62, v63
  v_max3_u32 v20, v20, v64, v65
  v_max3_u32 v21, v21, v66, v67
  v_max3_u32 v20, v20, v68, v69
  v_max_u32 v20, v20, v21
  v_cmp_eq_u32 vcc, -1, v20
  s_cbranch_vccz S_have_c
  s_add_u32 s15, s15, 1
  s_cmp_lt_u32 s15, 0x40000
  s_cbranch_scc1 S_pollC
  s_branch L_fail
S_reduce:
  s_cmp_ge_u32 s40, 20
  s_cbranch_scc1 S_nored
  s_sleep 5
  s_nop 9
S_red1:
  s_mov_b32 s15, 0
S_pollC:
  buffer_load_dwordx4 v[38:41], v1, s[4:7], s20 offen offset:0 sc1
  buffer_load_dwordx4 v[42:45], v1, s[4:7], s20 offen offset:1024 sc1
  buffer_load_dwordx4 v[46:49], v1, s[4:7], s20 offen offset:2048 sc1
  buffer_load_dwordx4 v[50:53], v1, s[4:7], s20 offen offset:3072 sc1
  buffer_load_dwordx4 v[54:57], v1, s[4:7], s21 offen offset:0 sc1
  buffer_load_dwordx4 v[58:61], v1, s[4:7], s21 offen offset:1024 sc1
  buffer_load_dwordx4 v[62:65], v1, s[4:7], s21 offen offset:2048 sc1
  buffer_load_dwordx4 v[66:69], v1, s[4:7], s21 offen offset:3072 sc1
  s_waitcnt vmcnt(7)
  v_mfma_f32_16x16x32_bf16 v[114:117], v[38:41], v[26:29], 0
  s_waitcnt vmcnt(6)
  v_mfma_f32_16x16x32_bf16 v[114:117], v[42:45], v[26:29], v[114:117]
  s_waitcnt vmcnt(5)
  v_mfma_f32_16x16x32_bf16 v[114:117], v[46:49], v[26:29], v[114:117]
  s_waitcnt vmcnt(4)
  v_mfma_f32_16x16x32_bf16 v[114:117], v[50:53], v[26:29], v[114:117]
  s_waitcnt vmcnt(3)
  v_mfma_f32_16x16x32_bf16 v[114:117], v[54:57], v[26:29], v[114:117]
  s_waitcnt vmcnt(2)
  v_mfma_f32_16x16x32_bf16 v[114:117], v[58:61], v[26:29], v[114:117]
  s_waitcnt vmcnt(1)
  v_mfma_f32_16x16x32_bf16 v[114:117], v[62:65], v[26:29], v[114:117]
  s_waitcnt vmcnt(0)
  v_mfma_f32_16x16x32_bf16 v[114:117], v[66:69], v[26:29], v[114:117]
  s_nop 7
  v_cmp_u_f32 vcc, v114, v115
  v_cmp_u_f32 s[68:69], v116, v117
  v_cvt_pk_bf16_f32 v118, v114, v115
  v_cvt_pk_bf16_f32 v119, v116, v117
  s_or_b64 vcc, vcc, s[68:69]
  s_cbranch_scc1 S_againC
S_have_c:
  buffer_store_dwordx2 v[118:119], v17, s[4:7], s50 offen sc1
S_nored:
  s_cmp_lt_u32 s40, 20
  s_cbranch_scc1 S_nw
  s_waitcnt vmcnt(0)
S_nw:
  s_add_u32 s44, s44, 1
  s_and_b32 s74, s44, 3
  s_xor_b32 s75, s74, 2
  s_add_u32 s76, s44, 1
  s_and_b32 s76, s76, 3
  s_lshl_b32 s45, s74, 17
  s_add_u32 s45, s45, 50331648
  s_lshl_b32 s51, s75, 17
  s_add_u32 s51, s51, 50331648
  s_lshl_b32 s46, s74, 17
  s_add_u32 s46, s46, 50855936
  s_lshl_b32 s52, s75, 17
  s_add_u32 s52, s52, 50855936
  s_lshl_b32 s50, s76, 16
  s_add_u32 s50, s50, s63
  s_xor_b32 s76, s76, 2
  s_lshl_b32 s53, s76, 16
  s_add_u32 s53, s53, s63
  s_add_u32 s55, s45, s56
  s_mul_i32 s75, s44, 0x5556
  s_lshr_b32 s75, s75, 16
  s_mul_i32 s76, s75, 3
  s_sub_u32 s76, s44, s76
  s_mul_i32 s76, s76, 655360
  s_lshl_b32 s47, s75, 21
  s_add_u32 s47, s47, s76
  s_xor_b32 s75, s75, s14
  s_and_b32 s75, s75, 1
  s_lshl_b32 s75, s75, 13
  s_add_u32 s47, s47, s75
  s_add_u32 s47, s47, 83886080
  s_lshl_b32 s75, s79, 14
  s_add_u32 s75, s75, s47
  s_mov_b32 s20, s75
  s_add_u32 s21, s75, 4096
  s_branch S_b1
L_ch_last:
  buffer_store_dword v112, v8, s[4:7], s66 offen sc1
  s_cmp_lg_u32 s12, 1
  s_cbranch_scc1 L_ch_l1
  buffer_store_dwordx4 v[114:117], v16, s[4:7], s65 offen offset:0 sc1
  buffer_store_dwordx4 v[118:121], v16, s[4:7], s65 offen offset:512 sc1
  s_add_u32 s65, s65, 98304
L_ch_l1:
  s_waitcnt vmcnt(0) lgkmcnt(0)
  s_barrier
  s_cmp_lg_u32 s12, 0
  s_cbranch_scc1 L_ch_l2
  s_mov_b64 exec, 1
  v_mov_b32 v20, 64
  buffer_store_dword v20, v6, s[4:7], s73 offen sc1
  s_mov_b64 exec, -1
L_ch_l2:
  s_waitcnt vmcnt(0)
  s_branch L_exit
L_worker:
  s_sub_u32 s20, s20, 4
  s_lshl_b32 s13, s20, 3
  s_lshr_b32 s22, s21, 2
  s_add_u32 s13, s13, s22
  s_and_b32 s21, s21, 3
  s_cmp_eq_u32 s21, 1
  s_cbranch_scc1 L_role_v
  s_cmp_eq_u32 s21, 2
  s_cbranch_scc1 L_role_qa
  s_cmp_eq_u32 s21, 3
  s_cbranch_scc1 L_role_wo
  s_and_b32 s28, s13, 31
  s_load_dwordx2 s[24:25], s[0:1], 24
  s_load_dwordx2 s[26:27], s[0:1], 0
  s_waitcnt lgkmcnt(0)
  s_mov_b32 s16, s24
  s_mov_b32 s17, s25
  s_mov_b32 s18, 7864320
  s_mov_b32 s19, 0x20000
  s_mov_b32 s20, s26
  s_mov_b32 s21, s27
  s_mov_b32 s22, 2621440
  s_mov_b32 s23, 0x20000
  s_add_u32 s36, s12, 0
  s_lshl_b32 s36, s36, 2
  v_bfe_u32 v26, v0, 4, 2
  v_add_u32 v26, s36, v26
  v_cmp_gt_u32 vcc, 40, v26
  v_lshlrev_b32 v27, 14, v26
  v_and_b32 v26, 15, v0
  v_lshl_add_u32 v27, v26, 4, v27
  s_lshl_b32 s36, s28, 8
  v_add_u32 v27, s36, v27
  v_mov_b32 v26, 2147483648
  v_cndmask_b32 v17, v26, v27, vcc
  s_add_u32 s36, s12, 4
  s_lshl_b32 s36, s36, 2
  v_bfe_u32 v26, v0, 4, 2
  v_add_u32 v26, s36, v26
  v_cmp_gt_u32 vcc, 40, v26
  v_lshlrev_b32 v27, 14, v26
  v_and_b32 v26, 15, v0
  v_lshl_add_u32 v27, v26, 4, v27
  s_lshl_b32 s36, s28, 8
  v_add_u32 v27, s36, v27
  v_mov_b32 v26, 2147483648
  v_cndmask_b32 v18, v26, v27, vcc
  s_add_u32 s36, s12, 8
  s_lshl_b32 s36, s36, 2
  v_bfe_u32 v26, v0, 4, 2
  v_add_u32 v26, s36, v26
  v_cmp_gt_u32 vcc, 40, v26
  v_lshlrev_b32 v27, 14, v26
  v_and_b32 v26, 15, v0
  v_lshl_add_u32 v27, v26, 4, v27
  s_lshl_b32 s36, s28, 8
  v_add_u32 v27, s36, v27
  v_mov_b32 v26, 2147483648
  v_cndmask_b32 v19, v26, v27, vcc
  v_mov_b32 v20, -1
  v_mov_b32 v21, -1
  v_mov_b32 v22, -1
  v_mov_b32 v23, -1
  s_mov_b32 s34, 83886080
  buffer_store_dwordx4 v[20:23], v17, s[4:7], s34 offen sc1
  buffer_store_dwordx4 v[20:23], v18, s[4:7], s34 offen sc1
  buffer_store_dwordx4 v[20:23], v19, s[4:7], s34 offen sc1
  s_mov_b32 s34, 83894272
  buffer_store_dwordx4 v[20:23], v17, s[4:7], s34 offen sc1
  buffer_store_dwordx4 v[20:23], v18, s[4:7], s34 offen sc1
  buffer_store_dwordx4 v[20:23], v19, s[4:7], s34 offen sc1
  v_and_b32 v32, 63, v0
  v_add_u32 v32, 0, v32
  v_mul_u32_u24 v33, 2731, v32
  v_lshrrev_b32 v33, 16, v33
  v_mul_u32_u24 v26, 24, v33
  v_sub_u32 v32, v32, v26
  v_mul_u32_u24 v26, 12288, v33
  v_and_b32 v33, 2, v33
  s_and_b32 s36, s12, 1
  s_lshl_b32 s36, s36, 2
  v_or_b32 v33, s36, v33
  v_xor_b32 v32, v32, v33
  v_lshl_add_u32 v26, v32, 4, v26
  v_and_b32 v32, 63, v0
  v_add_u32 v32, 64, v32
  v_mul_u32_u24 v33, 2731, v32
  v_lshrrev_b32 v33, 16, v33
  v_mul_u32_u24 v27, 24, v33
  v_sub_u32 v32, v32, v27
  v_mul_u32_u24 v27, 12288, v33
  v_and_b32 v33, 2, v33
  s_and_b32 s36, s12, 1
  s_lshl_b32 s36, s36, 2
  v_or_b32 v33, s36, v33
  v_xor_b32 v32, v32, v33
  v_lshl_add_u32 v27, v32, 4, v27
  v_and_b32 v32, 63, v0
  v_add_u32 v32, 128, v32
  v_mul_u32_u24 v33, 2731, v32
  v_lshrrev_b32 v33, 16, v33
  v_mul_u32_u24 v28, 24, v33
  v_sub_u32 v32, v32, v28
  v_mul_u32_u24 v28, 12288, v33
  v_and_b32 v33, 2, v33
  s_and_b32 s36, s12, 1
  s_lshl_b32 s36, s36, 2
  v_or_b32 v33, s36, v33
  v_xor_b32 v32, v32, v33
  v_lshl_add_u32 v28, v32, 4, v28
  v_bfe_u32 v32, v0, 3, 1
  v_bfe_u32 v33, v0, 4, 1
  v_lshl_or_b32 v32, v33, 1, v32
  s_mul_i32 s36, s12, 3
  s_add_u32 s36, s36, 0
  v_xor_b32 v29, s36, v32
  v_lshlrev_b32 v29, 5, v29
  s_mul_i32 s36, s12, 3
  s_add_u32 s36, s36, 1
  v_xor_b32 v30, s36, v32
  v_lshlrev_b32 v30, 5, v30
  s_mul_i32 s36, s12, 3
  s_add_u32 s36, s36, 2
  v_xor_b32 v31, s36, v32
  v_lshlrev_b32 v31, 5, v31
  v_bfe_u32 v32, v0, 4, 2
  v_bfe_u32 v33, v0, 2, 2
  v_lshl_add_u32 v32, v32, 3, v33
  v_mul_u32_u24 v32, 384, v32
  v_and_b32 v33, 3, v0
  v_lshl_add_u32 v32, v33, 3, v32
  v_add3_u32 v29, v29, v32, 0
  v_add3_u32 v30, v30, v32, 0
  v_add3_u32 v31, v31, v32, 0
  s_mul_i32 s36, s12, 98304
  s_mul_i32 s37, s28, 384
  s_add_u32 s36, s36, s37
  s_add_u32 s36, s36, 0
  s_mul_i32 s37, s12, 3072
  s_add_u32 s37, s37, 0
  s_add_u32 m0, s37, 0
  s_nop 0
  buffer_load_dwordx4 v26, s[16:19], s36 offen lds
  s_add_u32 m0, s37, 1024
  s_nop 0
  buffer_load_dwordx4 v27, s[16:19], s36 offen lds
  s_add_u32 m0, s37, 2048
  s_nop 0
  buffer_load_dwordx4 v28, s[16:19], s36 offen lds
  s_add_u32 s36, s36, 393216
  s_add_u32 m0, s37, 12288
  s_nop 0
  buffer_load_dwordx4 v26, s[16:19], s36 offen lds
  s_add_u32 m0, s37, 13312
  s_nop 0
  buffer_load_dwordx4 v27, s[16:19], s36 offen lds
  s_add_u32 m0, s37, 14336
  s_nop 0
  buffer_load_dwordx4 v28, s[16:19], s36 offen lds
  s_add_u32 s36, s36, 393216
  s_add_u32 m0, s37, 24576
  s_nop 0
  buffer_load_dwordx4 v26, s[16:19], s36 offen lds
  s_add_u32 m0, s37, 25600
  s_nop 0
  buffer_load_dwordx4 v27, s[16:19], s36 offen lds
  s_add_u32 m0, s37, 26624
  s_nop 0
  buffer_load_dwordx4 v28, s[16:19], s36 offen lds
  s_add_u32 s36, s36, 393216
  s_add_u32 m0, s37, 36864
  s_nop 0
  buffer_load_dwordx4 v26, s[16:19], s36 offen lds
  s_add_u32 m0, s37, 37888
  s_nop 0
  buffer_load_dwordx4 v27, s[16:19], s36 offen lds
  s_add_u32 m0, s37, 38912
  s_nop 0
  buffer_load_dwordx4 v28, s[16:19], s36 offen lds
  s_add_u32 s36, s36, 393216
  s_add_u32 m0, s37, 49152
  s_nop 0
  buffer_load_dwordx4 v26, s[16:19], s36 offen lds
  s_add_u32 m0, s37, 50176
  s_nop 0
  buffer_load_dwordx4 v27, s[16:19], s36 offen lds
  s_add_u32 m0, s37, 51200
  s_nop 0
  buffer_load_dwordx4 v28, s[16:19], s36 offen lds
  s_mul_i32 s36, s12, 98304
  s_mul_i32 s37, s28, 384
  s_add_u32 s36, s36, s37
  s_add_u32 s36, s36, 1966080
  s_mul_i32 s37, s12, 3072
  s_add_u32 s37, s37, 61440
  s_add_u32 m0, s37, 0
  s_nop 0
  buffer_load_dwordx4 v26, s[16:19], s36 offen lds
  s_add_u32 m0, s37, 1024
  s_nop 0
  buffer_load_dwordx4 v27, s[16:19], s36 offen lds
  s_add_u32 m0, s37, 2048
  s_nop 0
  buffer_load_dwordx4 v28, s[16:19], s36 offen lds
  s_add_u32 s36, s36, 393216
  s_add_u32 m0, s37, 12288
  s_nop 0
  buffer_load_dwordx4 v26, s[16:19], s36 offen lds
  s_add_u32 m0, s37, 13312
  s_nop 0
  buffer_load_dwordx4 v27, s[16:19], s36 offen lds
  s_add_u32 m0, s37, 14336
  s_nop 0
  buffer_load_dwordx4 v28, s[16:19], s36 offen lds
  s_add_u32 s36, s36, 393216
  s_add_u32 m0, s37, 24576
  s_nop 0
  buffer_load_dwordx4 v26, s[16:19], s36 offen lds
  s_add_u32 m0, s37, 25600
  s_nop 0
  buffer_load_dwordx4 v27, s[16:19], s36 offen lds
  s_add_u32 m0, s37, 26624
  s_nop 0
  buffer_load_dwordx4 v28, s[16:19], s36 offen lds
  s_add_u32 s36, s36, 393216
  s_add_u32 m0, s37, 36864
  s_nop 0
  buffer_load_dwordx4 v26, s[16:19], s36 offen lds
  s_add_u32 m0, s37, 37888
  s_nop 0
  buffer_load_dwordx4 v27, s[16:19], s36 offen lds
  s_add_u32 m0, s37, 38912
  s_nop 0
  buffer_load_dwordx4 v28, s[16:19], s36 offen lds
  s_add_u32 s36, s36, 393216
  s_add_u32 m0, s37, 49152
  s_nop 0
  buffer_load_dwordx4 v26, s[16:19], s36 offen lds
  s_add_u32 m0, s37, 50176
  s_nop 0
  buffer_load_dwordx4 v27, s[16:19], s36 offen lds
  s_add_u32 m0, s37, 51200
  s_nop 0
  buffer_load_dwordx4 v28, s[16:19], s36 offen lds
  s_waitcnt vmcnt(15)
  s_barrier
  s_cmp_lg_u32 s12, 0
  s_cbranch_scc1 L_k_a_1
  v_mov_b32 v32, 1
  v_mov_b32 v33, 116
  s_mov_b64 exec, 1
  buffer_atomic_add v32, v33, s[8:11], 0 offen sc1
  s_mov_b64 exec, -1
L_k_a_1:
  ds_read_b64_tr_b16 a[0:1], v29 offset:0
  ds_read_b64_tr_b16 a[2:3], v29 offset:1536
  ds_read_b64_tr_b16 a[80:81], v30 offset:0
  ds_read_b64_tr_b16 a[82:83], v30 offset:1536
  ds_read_b64_tr_b16 a[160:161], v31 offset:0
  ds_read_b64_tr_b16 a[162:163], v31 offset:1536
  s_waitcnt lgkmcnt(6)
  ds_read_b64_tr_b16 a[4:5], v29 offset:12288
  ds_read_b64_tr_b16 a[6:7], v29 offset:13824
  ds_read_b64_tr_b16 a[84:85], v30 offset:12288
  ds_read_b64_tr_b16 a[86:87], v30 offset:13824
  ds_read_b64_tr_b16 a[164:165], v31 offset:12288
  ds_read_b64_tr_b16 a[166:167], v31 offset:13824
  s_waitcnt lgkmcnt(6)
  ds_read_b64_tr_b16 a[8:9], v29 offset:24576
  ds_read_b64_tr_b16 a[10:11], v29 offset:26112
  ds_read_b64_tr_b16 a[88:89], v30 offset:24576
  ds_read_b64_tr_b16 a[90:91], v30 offset:26112
  ds_read_b64_tr_b16 a[168:169], v31 offset:24576
  ds_read_b64_tr_b16 a[170:171], v31 offset:26112
  s_waitcnt lgkmcnt(6)
  ds_read_b64_tr_b16 a[12:13], v29 offset:36864
  ds_read_b64_tr_b16 a[14:15], v29 offset:38400
  ds_read_b64_tr_b16 a[92:93], v30 offset:36864
  ds_read_b64_tr_b16 a[94:95], v30 offset:38400
  ds_read_b64_tr_b16 a[172:173], v31 offset:36864
  ds_read_b64_tr_b16 a[174:175], v31 offset:38400
  s_waitcnt lgkmcnt(6)
  ds_read_b64_tr_b16 a[16:17], v29 offset:49152
  ds_read_b64_tr_b16 a[18:19], v29 offset:50688
  ds_read_b64_tr_b16 a[96:97], v30 offset:49152
  ds_read_b64_tr_b16 a[98:99], v30 offset:50688
  ds_read_b64_tr_b16 a[176:177], v31 offset:49152
  ds_read_b64_tr_b16 a[178:179], v31 offset:50688
  s_waitcnt lgkmcnt(6)
  v_add_u32 v29, 61440, v29
  v_add_u32 v30, 61440, v30
  v_add_u32 v31, 61440, v31
  s_waitcnt lgkmcnt(0)
  s_barrier
  s_mul_i32 s36, s12, 98304
  s_mul_i32 s37, s28, 384
  s_add_u32 s36, s36, s37
  s_add_u32 s36, s36, 3932160
  s_mul_i32 s37, s12, 3072
  s_add_u32 s37, s37, 0
  s_add_u32 m0, s37, 0
  s_nop 0
  buffer_load_dwordx4 v26, s[16:19], s36 offen lds
  s_add_u32 m0, s37, 1024
  s_nop 0
  buffer_load_dwordx4 v27, s[16:19], s36 offen lds
  s_add_u32 m0, s37, 2048
  s_nop 0
  buffer_load_dwordx4 v28, s[16:19], s36 offen lds
  s_add_u32 s36, s36, 393216
  s_add_u32 m0, s37, 12288
  s_nop 0
  buffer_load_dwordx4 v26, s[16:19], s36 offen lds
  s_add_u32 m0, s37, 13312
  s_nop 0
  buffer_load_dwordx4 v27, s[16:19], s36 offen lds
  s_add_u32 m0, s37, 14336
  s_nop 0
  buffer_load_dwordx4 v28, s[16:19], s36 offen lds
  s_add_u32 s36, s36, 393216
  s_add_u32 m0, s37, 24576
  s_nop 0
  buffer_load_dwordx4 v26, s[16:19], s36 offen lds
  s_add_u32 m0, s37, 25600
  s_nop 0
  buffer_load_dwordx4 v27, s[16:19], s36 offen lds
  s_add_u32 m0, s37, 26624
  s_nop 0
  buffer_load_dwordx4 v28, s[16:19], s36 offen lds
  s_add_u32 s36, s36, 393216
  s_add_u32 m0, s37, 36864
  s_nop 0
  buffer_load_dwordx4 v26, s[16:19], s36 offen lds
  s_add_u32 m0, s37, 37888
  s_nop 0
  buffer_load_dwordx4 v27, s[16:19], s36 offen lds
  s_add_u32 m0, s37, 38912
  s_nop 0
  buffer_load_dwordx4 v28, s[16:19], s36 offen lds
  s_add_u32 s36, s36, 393216
  s_add_u32 m0, s37, 49152
  s_nop 0
  buffer_load_dwordx4 v26, s[16:19], s36 offen lds
  s_add_u32 m0, s37, 50176
  s_nop 0
  buffer_load_dwordx4 v27, s[16:19], s36 offen lds
  s_add_u32 m0, s37, 51200
  s_nop 0
  buffer_load_dwordx4 v28, s[16:19], s36 offen lds
  s_waitcnt vmcnt(15)
  s_barrier
  ds_read_b64_tr_b16 a[20:21], v29 offset:0
  ds_read_b64_tr_b16 a[22:23], v29 offset:1536
  ds_read_b64_tr_b16 a[100:101], v30 offset:0
  ds_read_b64_tr_b16 a[102:103], v30 offset:1536
  ds_read_b64_tr_b16 a[180:181], v31 offset:0
  ds_read_b64_tr_b16 a[182:183], v31 offset:1536
  s_waitcnt lgkmcnt(6)
  ds_read_b64_tr_b16 a[24:25], v29 offset:12288
  ds_read_b64_tr_b16 a[26:27], v29 offset:13824
  ds_read_b64_tr_b16 a[104:105], v30 offset:12288
  ds_read_b64_tr_b16 a[106:107], v30 offset:13824
  ds_read_b64_tr_b16 a[184:185], v31 offset:12288
  ds_read_b64_tr_b16 a[186:187], v31 offset:13824
  s_waitcnt lgkmcnt(6)
  ds_read_b64_tr_b16 a[28:29], v29 offset:24576
  ds_read_b64_tr_b16 a[30:31], v29 offset:26112
  ds_read_b64_tr_b16 a[108:109], v30 offset:24576
  ds_read_b64_tr_b16 a[110:111], v30 offset:26112
  ds_read_b64_tr_b16 a[188:189], v31 offset:24576
  ds_read_b64_tr_b16 a[190:191], v31 offset:26112
  s_waitcnt lgkmcnt(6)
  ds_read_b64_tr_b16 a[32:33], v29 offset:36864
  ds_read_b64_tr_b16 a[34:35], v29 offset:38400
  ds_read_b64_tr_b16 a[112:113], v30 offset:36864
  ds_read_b64_tr_b16 a[114:115], v30 offset:38400
  ds_read_b64_tr_b16 a[192:193], v31 offset:36864
  ds_read_b64_tr_b16 a[194:195], v31 offset:38400
  s_waitcnt lgkmcnt(6)
  ds_read_b64_tr_b16 a[36:37], v29 offset:49152
  ds_read_b64_tr_b16 a[38:39], v29 offset:50688
  ds_read_b64_tr_b16 a[116:117], v30 offset:49152
  ds_read_b64_tr_b16 a[118:119], v30 offset:50688
  ds_read_b64_tr_b16 a[196:197], v31 offset:49152
  ds_read_b64_tr_b16 a[198:199], v31 offset:50688
  s_waitcnt lgkmcnt(6)
  v_subrev_u32 v29, 61440, v29
  v_subrev_u32 v30, 61440, v30
  v_subrev_u32 v31, 61440, v31
  s_waitcnt lgkmcnt(0)
  s_barrier
  s_mul_i32 s36, s12, 98304
  s_mul_i32 s37, s28, 384
  s_add_u32 s36, s36, s37
  s_add_u32 s36, s36, 5898240
  s_mul_i32 s37, s12, 3072
  s_add_u32 s37, s37, 61440
  s_add_u32 m0, s37, 0
  s_nop 0
  buffer_load_dwordx4 v26, s[16:19], s36 offen lds
  s_add_u32 m0, s37, 1024
  s_nop 0
  buffer_load_dwordx4 v27, s[16:19], s36 offen lds
  s_add_u32 m0, s37, 2048
  s_nop 0
  buffer_load_dwordx4 v28, s[16:19], s36 offen lds
  s_add_u32 s36, s36, 393216
  s_add_u32 m0, s37, 12288
  s_nop 0
  buffer_load_dwordx4 v26, s[16:19], s36 offen lds
  s_add_u32 m0, s37, 13312
  s_nop 0
  buffer_load_dwordx4 v27, s[16:19], s36 offen lds
  s_add_u32 m0, s37, 14336
  s_nop 0
  buffer_load_dwordx4 v28, s[16:19], s36 offen lds
  s_add_u32 s36, s36, 393216
  s_add_u32 m0, s37, 24576
  s_nop 0
  buffer_load_dwordx4 v26, s[16:19], s36 offen lds
  s_add_u32 m0, s37, 25600
  s_nop 0
  buffer_load_dwordx4 v27, s[16:19], s36 offen lds
  s_add_u32 m0, s37, 26624
  s_nop 0
  buffer_load_dwordx4 v28, s[16:19], s36 offen lds
  s_add_u32 s36, s36, 393216
  s_add_u32 m0, s37, 36864
  s_nop 0
  buffer_load_dwordx4 v26, s[16:19], s36 offen lds
  s_add_u32 m0, s37, 37888
  s_nop 0
  buffer_load_dwordx4 v27, s[16:19], s36 offen lds
  s_add_u32 m0, s37, 38912
  s_nop 0
  buffer_load_dwordx4 v28, s[16:19], s36 offen lds
  s_add_u32 s36, s36, 393216
  s_add_u32 m0, s37, 49152
  s_nop 0
  buffer_load_dwordx4 v26, s[16:19], s36 offen lds
  s_add_u32 m0, s37, 50176
  s_nop 0
  buffer_load_dwordx4 v27, s[16:19], s36 offen lds
  s_add_u32 m0, s37, 51200
  s_nop 0
  buffer_load_dwordx4 v28, s[16:19], s36 offen lds
  s_waitcnt vmcnt(15)
  s_barrier
  ds_read_b64_tr_b16 a[40:41], v29 offset:0
  ds_read_b64_tr_b16 a[42:43], v29 offset:1536
  ds_read_b64_tr_b16 a[120:121], v30 offset:0
  ds_read_b64_tr_b16 a[122:123], v30 offset:1536
  ds_read_b64_tr_b16 a[200:201], v31 offset:0
  ds_read_b64_tr_b16 a[202:203], v31 offset:1536
  s_waitcnt lgkmcnt(6)
  ds_read_b64_tr_b16 a[44:45], v29 offset:12288
  ds_read_b64_tr_b16 a[46:47], v29 offset:13824
  ds_read_b64_tr_b16 a[124:125], v30 offset:12288
  ds_read_b64_tr_b16 a[126:127], v30 offset:13824
  ds_read_b64_tr_b16 a[204:205], v31 offset:12288
  ds_read_b64_tr_b16 a[206:207], v31 offset:13824
  s_waitcnt lgkmcnt(6)
  ds_read_b64_tr_b16 a[48:49], v29 offset:24576
  ds_read_b64_tr_b16 a[50:51], v29 offset:26112
  ds_read_b64_tr_b16 a[128:129], v30 offset:24576
  ds_read_b64_tr_b16 a[130:131], v30 offset:26112
  ds_read_b64_tr_b16 a[208:209], v31 offset:24576
  ds_read_b64_tr_b16 a[210:211], v31 offset:26112
  s_waitcnt lgkmcnt(6)
  ds_read_b64_tr_b16 a[52:53], v29 offset:36864
  ds_read_b64_tr_b16 a[54:55], v29 offset:38400
  ds_read_b64_tr_b16 a[132:133], v30 offset:36864
  ds_read_b64_tr_b16 a[134:135], v30 offset:38400
  ds_read_b64_tr_b16 a[212:213], v31 offset:36864
  ds_read_b64_tr_b16 a[214:215], v31 offset:38400
  s_waitcnt lgkmcnt(6)
  ds_read_b64_tr_b16 a[56:57], v29 offset:49152
  ds_read_b64_tr_b16 a[58:59], v29 offset:50688
  ds_read_b64_tr_b16 a[136:137], v30 offset:49152
  ds_read_b64_tr_b16 a[138:139], v30 offset:50688
  ds_read_b64_tr_b16 a[216:217], v31 offset:49152
  ds_read_b64_tr_b16 a[218:219], v31 offset:50688
  s_waitcnt lgkmcnt(6)
  v_add_u32 v29, 61440, v29
  v_add_u32 v30, 61440, v30
  v_add_u32 v31, 61440, v31
  s_waitcnt lgkmcnt(0)
  s_barrier
  s_waitcnt vmcnt(0)
  s_barrier
  ds_read_b64_tr_b16 a[60:61], v29 offset:0
  ds_read_b64_tr_b16 a[62:63], v29 offset:1536
  ds_read_b64_tr_b16 a[140:141], v30 offset:0
  ds_read_b64_tr_b16 a[142:143], v30 offset:1536
  ds_read_b64_tr_b16 a[220:221], v31 offset:0
  ds_read_b64_tr_b16 a[222:223], v31 offset:1536
  s_waitcnt lgkmcnt(6)
  ds_read_b64_tr_b16 a[64:65], v29 offset:12288
  ds_read_b64_tr_b16 a[66:67], v29 offset:13824
  ds_read_b64_tr_b16 a[144:145], v30 offset:12288
  ds_read_b64_tr_b16 a[146:147], v30 offset:13824
  ds_read_b64_tr_b16 a[224:225], v31 offset:12288
  ds_read_b64_tr_b16 a[226:227], v31 offset:13824
  s_waitcnt lgkmcnt(6)
  ds_read_b64_tr_b16 a[68:69], v29 offset:24576
  ds_read_b64_tr_b16 a[70:71], v29 offset:26112
  ds_read_b64_tr_b16 a[148:149], v30 offset:24576
  ds_read_b64_tr_b16 a[150:151], v30 offset:26112
  ds_read_b64_tr_b16 a[228:229], v31 offset:24576
  ds_read_b64_tr_b16 a[230:231], v31 offset:26112
  s_waitcnt lgkmcnt(6)
  ds_read_b64_tr_b16 a[72:73], v29 offset:36864
  ds_read_b64_tr_b16 a[74:75], v29 offset:38400
  ds_read_b64_tr_b16 a[152:153], v30 offset:36864
  ds_read_b64_tr_b16 a[154:155], v30 offset:38400
  ds_read_b64_tr_b16 a[232:233], v31 offset:36864
  ds_read_b64_tr_b16 a[234:235], v31 offset:38400
  s_waitcnt lgkmcnt(6)
  ds_read_b64_tr_b16 a[76:77], v29 offset:49152
  ds_read_b64_tr_b16 a[78:79], v29 offset:50688
  ds_read_b64_tr_b16 a[156:157], v30 offset:49152
  ds_read_b64_tr_b16 a[158:159], v30 offset:50688
  ds_read_b64_tr_b16 a[236:237], v31 offset:49152
  ds_read_b64_tr_b16 a[238:239], v31 offset:50688
  s_waitcnt lgkmcnt(6)
  v_subrev_u32 v29, 61440, v29
  v_subrev_u32 v30, 61440, v30
  v_subrev_u32 v31, 61440, v31
  s_waitcnt lgkmcnt(0)
  s_barrier
  s_and_b32 s36, s12, 1
  s_lshl_b32 s36, s36, 3
  v_and_b32 v26, 63, v0
  v_add_u32 v26, 0, v26
  v_mul_u32_u24 v27, 820, v26
  v_lshrrev_b32 v27, 16, v27
  v_mul_u32_u24 v2, 80, v27
  v_sub_u32 v26, v26, v2
  v_mul_u32_u24 v2, 1280, v27
  v_or_b32 v27, s36, v27
  v_xor_b32 v26, v26, v27
  v_lshl_add_u32 v2, v26, 4, v2
  v_and_b32 v26, 63, v0
  v_add_u32 v26, 64, v26
  v_mul_u32_u24 v27, 820, v26
  v_lshrrev_b32 v27, 16, v27
  v_mul_u32_u24 v3, 80, v27
  v_sub_u32 v26, v26, v3
  v_mul_u32_u24 v3, 1280, v27
  v_or_b32 v27, s36, v27
  v_xor_b32 v26, v26, v27
  v_lshl_add_u32 v3, v26, 4, v3
  v_and_b32 v26, 63, v0
  v_add_u32 v26, 128, v26
  v_mul_u32_u24 v27, 820, v26
  v_lshrrev_b32 v27, 16, v27
  v_mul_u32_u24 v4, 80, v27
  v_sub_u32 v26, v26, v4
  v_mul_u32_u24 v4, 1280, v27
  v_or_b32 v27, s36, v27
  v_xor_b32 v26, v26, v27
  v_lshl_add_u32 v4, v26, 4, v4
  v_and_b32 v26, 63, v0
  v_add_u32 v26, 192, v26
  v_mul_u32_u24 v27, 820, v26
  v_lshrrev_b32 v27, 16, v27
  v_mul_u32_u24 v5, 80, v27
  v_sub_u32 v26, v26, v5
  v_mul_u32_u24 v5, 1280, v27
  v_or_b32 v27, s36, v27
  v_xor_b32 v26, v26, v27
  v_lshl_add_u32 v5, v26, 4, v5
  v_and_b32 v26, 63, v0
  v_add_u32 v26, 256, v26
  v_mul_u32_u24 v27, 820, v26
  v_lshrrev_b32 v27, 16, v27
  v_mul_u32_u24 v6, 80, v27
  v_sub_u32 v26, v26, v6
  v_mul_u32_u24 v6, 1280, v27
  v_or_b32 v27, s36, v27
  v_xor_b32 v26, v26, v27
  v_lshl_add_u32 v6, v26, 4, v6
  v_and_b32 v26, 63, v0
  v_add_u32 v26, 320, v26
  v_mul_u32_u24 v27, 820, v26
  v_lshrrev_b32 v27, 16, v27
  v_mul_u32_u24 v7, 80, v27
  v_sub_u32 v26, v26, v7
  v_mul_u32_u24 v7, 1280, v27
  v_or_b32 v27, s36, v27
  v_xor_b32 v26, v26, v27
  v_lshl_add_u32 v7, v26, 4, v7
  v_and_b32 v26, 63, v0
  v_add_u32 v26, 384, v26
  v_mul_u32_u24 v27, 820, v26
  v_lshrrev_b32 v27, 16, v27
  v_mul_u32_u24 v8, 80, v27
  v_sub_u32 v26, v26, v8
  v_mul_u32_u24 v8, 1280, v27
  v_or_b32 v27, s36, v27
  v_xor_b32 v26, v26, v27
  v_lshl_add_u32 v8, v26, 4, v8
  v_and_b32 v26, 63, v0
  v_add_u32 v26, 448, v26
  v_mul_u32_u24 v27, 820, v26
  v_lshrrev_b32 v27, 16, v27
  v_mul_u32_u24 v9, 80, v27
  v_sub_u32 v26, v26, v9
  v_mul_u32_u24 v9, 1280, v27
  v_or_b32 v27, s36, v27
  v_xor_b32 v26, v26, v27
  v_lshl_add_u32 v9, v26, 4, v9
  v_and_b32 v26, 63, v0
  v_add_u32 v26, 512, v26
  v_mul_u32_u24 v27, 820, v26
  v_lshrrev_b32 v27, 16, v27
  v_mul_u32_u24 v10, 80, v27
  v_sub_u32 v26, v26, v10
  v_mul_u32_u24 v10, 1280, v27
  v_or_b32 v27, s36, v27
  v_xor_b32 v26, v26, v27
  v_lshl_add_u32 v10, v26, 4, v10
  v_and_b32 v26, 63, v0
  v_add_u32 v26, 576, v26
  v_mul_u32_u24 v27, 820, v26
  v_lshrrev_b32 v27, 16, v27
  v_mul_u32_u24 v11, 80, v27
  v_sub_u32 v26, v26, v11
  v_mul_u32_u24 v11, 1280, v27
  v_or_b32 v27, s36, v27
  v_xor_b32 v26, v26, v27
  v_lshl_add_u32 v11, v26, 4, v11
  v_and_b32 v27, 15, v0
  v_bfe_u32 v26, v0, 4, 2
  v_add_u32 v26, 0, v26
  v_xor_b32 v26, v26, v27
  v_lshlrev_b32 v26, 4, v26
  v_mul_u32_u24 v12, 1280, v27
  v_add_u32 v12, v12, v26
  v_bfe_u32 v26, v0, 4, 2
  v_add_u32 v26, 4, v26
  v_xor_b32 v26, v26, v27
  v_lshlrev_b32 v26, 4, v26
  v_mul_u32_u24 v13, 1280, v27
  v_add_u32 v13, v13, v26
  v_bfe_u32 v26, v0, 4, 2
  v_add_u32 v26, 8, v26
  v_xor_b32 v26, v26, v27
  v_lshlrev_b32 v26, 4, v26
  v_mul_u32_u24 v14, 1280, v27
  v_add_u32 v14, v14, v26
  v_bfe_u32 v26, v0, 4, 2
  v_add_u32 v26, 12, v26
  v_xor_b32 v26, v26, v27
  v_lshlrev_b32 v26, 4, v26
  v_mul_u32_u24 v15, 1280, v27
  v_add_u32 v15, v15, v26
  s_mul_i32 s30, s12, 10240
  s_mov_b32 s31, s30
  s_add_u32 s32, s30, 40960
  s_add_u32 m0, s31, 0
  s_nop 0
  buffer_load_dwordx4 v2, s[20:23], s30 offen lds
  s_add_u32 m0, s31, 1024
  s_nop 0
  buffer_load_dwordx4 v3, s[20:23], s30 offen lds
  s_add_u32 m0, s31, 2048
  s_nop 0
  buffer_load_dwordx4 v4, s[20:23], s30 offen lds
  s_add_u32 m0, s31, 3072
  s_nop 0
  buffer_load_dwordx4 v5, s[20:23], s30 offen lds
  s_add_u32 m0, s31, 4096
  s_nop 0
  buffer_load_dwordx4 v6, s[20:23], s30 offen lds
  s_add_u32 m0, s31, 5120
  s_nop 0
  buffer_load_dwordx4 v7, s[20:23], s30 offen lds
  s_add_u32 m0, s31, 6144
  s_nop 0
  buffer_load_dwordx4 v8, s[20:23], s30 offen lds
  s_add_u32 m0, s31, 7168
  s_nop 0
  buffer_load_dwordx4 v9, s[20:23], s30 offen lds
  s_add_u32 m0, s31, 8192
  s_nop 0
  buffer_load_dwordx4 v10, s[20:23], s30 offen lds
  s_add_u32 m0, s31, 9216
  s_nop 0
  buffer_load_dwordx4 v11, s[20:23], s30 offen lds
  s_add_u32 s30, s30, 40960
  v_and_b32 v16, 63, v0
  v_lshlrev_b32 v16, 4, v16
  s_mul_i32 s33, s28, 12288
  s_mul_i32 s36, s12, 3072
  s_add_u32 s33, s33, s36
  s_add_u32 s33, s33, 0
  s_lshl_b32 s35, s28, 7
  s_lshl_b32 s36, s12, 2
  s_add_u32 s35, s35, s36
  s_add_u32 s35, s35, 52174848
  v_mov_b32 v24, 0
  v_mov_b32 v26, 48
  s_mov_b32 s14, 240
  v_writelane_b32 v26, s14, 0
  s_mov_b32 s15, 0
L_k_go:
  buffer_load_dword v27, v26, s[8:11], 0 offen sc1
  s_waitcnt vmcnt(0)
  v_cmp_eq_u32 vcc, 0, v27
  s_cbranch_vccz L_k_go_ok
  s_sleep 2
  s_add_u32 s15, s15, 1
  s_cmp_lt_u32 s15, 262144
  s_cbranch_scc1 L_k_go
  s_branch L_fail
L_k_go_ok:
  v_readfirstlane_b32 s14, v27
  s_nop 0
  s_sub_u32 s14, s14, 1
  s_lshl_b32 s36, s14, 13
  s_xor_b32 s35, s35, s36
  s_mov_b32 s29, 0
  s_waitcnt vmcnt(0)
  s_waitcnt vmcnt(1)
  s_barrier
  ds_read_b128 v[34:37], v12 offset:0
  ds_read_b128 v[38:41], v12 offset:20480
  ds_read_b128 v[42:45], v13 offset:0
  ds_read_b128 v[46:49], v13 offset:20480
  ds_read_b128 v[50:53], v14 offset:0
  ds_read_b128 v[54:57], v14 offset:20480
  s_waitcnt lgkmcnt(4)
  v_mfma_f32_16x16x32_bf16 v[58:61], a[0:3], v[34:37], 0
  v_mfma_f32_16x16x32_bf16 v[62:65], a[0:3], v[38:41], 0
  s_add_u32 m0, s32, 0
  s_nop 0
  buffer_load_dwordx4 v2, s[20:23], s30 offen lds
  v_mfma_f32_16x16x32_bf16 v[66:69], a[80:83], v[34:37], 0
  v_mfma_f32_16x16x32_bf16 v[70:73], a[80:83], v[38:41], 0
  v_mfma_f32_16x16x32_bf16 v[74:77], a[160:163], v[34:37], 0
  v_mfma_f32_16x16x32_bf16 v[78:81], a[160:163], v[38:41], 0
  s_add_u32 m0, s32, 1024
  s_nop 0
  buffer_load_dwordx4 v3, s[20:23], s30 offen lds
  ds_read_b128 v[34:37], v15 offset:0
  ds_read_b128 v[38:41], v15 offset:20480
  s_waitcnt lgkmcnt(4)
  v_mfma_f32_16x16x32_bf16 v[58:61], a[4:7], v[42:45], v[58:61]
  v_mfma_f32_16x16x32_bf16 v[62:65], a[4:7], v[46:49], v[62:65]
  s_add_u32 m0, s32, 2048
  s_nop 0
  buffer_load_dwordx4 v4, s[20:23], s30 offen lds
  v_mfma_f32_16x16x32_bf16 v[66:69], a[84:87], v[42:45], v[66:69]
  v_mfma_f32_16x16x32_bf16 v[70:73], a[84:87], v[46:49], v[70:73]
  v_mfma_f32_16x16x32_bf16 v[74:77], a[164:167], v[42:45], v[74:77]
  v_mfma_f32_16x16x32_bf16 v[78:81], a[164:167], v[46:49], v[78:81]
  s_add_u32 m0, s32, 3072
  s_nop 0
  buffer_load_dwordx4 v5, s[20:23], s30 offen lds
  ds_read_b128 v[42:45], v12 offset:256
  ds_read_b128 v[46:49], v12 offset:20736
  s_waitcnt lgkmcnt(4)
  v_mfma_f32_16x16x32_bf16 v[58:61], a[8:11], v[50:53], v[58:61]
  v_mfma_f32_16x16x32_bf16 v[62:65], a[8:11], v[54:57], v[62:65]
  s_add_u32 m0, s32, 4096
  s_nop 0
  buffer_load_dwordx4 v6, s[20:23], s30 offen lds
  v_mfma_f32_16x16x32_bf16 v[66:69], a[88:91], v[50:53], v[66:69]
  v_mfma_f32_16x16x32_bf16 v[70:73], a[88:91], v[54:57], v[70:73]
  v_mfma_f32_16x16x32_bf16 v[74:77], a[168:171], v[50:53], v[74:77]
  v_mfma_f32_16x16x32_bf16 v[78:81], a[168:171], v[54:57], v[78:81]
  s_add_u32 m0, s32, 5120
  s_nop 0
  buffer_load_dwordx4 v7, s[20:23], s30 offen lds
  ds_read_b128 v[50:53], v13 offset:256
  ds_read_b128 v[54:57], v13 offset:20736
  s_waitcnt lgkmcnt(4)
  v_mfma_f32_16x16x32_bf16 v[58:61], a[12:15], v[34:37], v[58:61]
  v_mfma_f32_16x16x32_bf16 v[62:65], a[12:15], v[38:41], v[62:65]
  s_add_u32 m0, s32, 6144
  s_nop 0
  buffer_load_dwordx4 v8, s[20:23], s30 offen lds
  v_mfma_f32_16x16x32_bf16 v[66:69], a[92:95], v[34:37], v[66:69]
  v_mfma_f32_16x16x32_bf16 v[70:73], a[92:95], v[38:41], v[70:73]
  v_mfma_f32_16x16x32_bf16 v[74:77], a[172:175], v[34:37], v[74:77]
  v_mfma_f32_16x16x32_bf16 v[78:81], a[172:175], v[38:41], v[78:81]
  s_add_u32 m0, s32, 7168
  s_nop 0
  buffer_load_dwordx4 v9, s[20:23], s30 offen lds
  ds_read_b128 v[34:37], v14 offset:256
  ds_read_b128 v[38:41], v14 offset:20736
  s_waitcnt lgkmcnt(4)
  v_mfma_f32_16x16x32_bf16 v[58:61], a[16:19], v[42:45], v[58:61]
  v_mfma_f32_16x16x32_bf16 v[62:65], a[16:19], v[46:49], v[62:65]
  s_add_u32 m0, s32, 8192
  s_nop 0
  buffer_load_dwordx4 v10, s[20:23], s30 offen lds
  v_mfma_f32_16x16x32_bf16 v[66:69], a[96:99], v[42:45], v[66:69]
  v_mfma_f32_16x16x32_bf16 v[70:73], a[96:99], v[46:49], v[70:73]
  v_mfma_f32_16x16x32_bf16 v[74:77], a[176:179], v[42:45], v[74:77]
  v_mfma_f32_16x16x32_bf16 v[78:81], a[176:179], v[46:49], v[78:81]
  s_add_u32 m0, s32, 9216
  s_nop 0
  buffer_load_dwordx4 v11, s[20:23], s30 offen lds
  ds_read_b128 v[42:45], v15 offset:256
  ds_read_b128 v[46:49], v15 offset:20736
  s_waitcnt lgkmcnt(4)
  v_mfma_f32_16x16x32_bf16 v[58:61], a[20:23], v[50:53], v[58:61]
  v_mfma_f32_16x16x32_bf16 v[62:65], a[20:23], v[54:57], v[62:65]
  v_mfma_f32_16x16x32_bf16 v[66:69], a[100:103], v[50:53], v[66:69]
  v_mfma_f32_16x16x32_bf16 v[70:73], a[100:103], v[54:57], v[70:73]
  v_mfma_f32_16x16x32_bf16 v[74:77], a[180:183], v[50:53], v[74:77]
  v_mfma_f32_16x16x32_bf16 v[78:81], a[180:183], v[54:57], v[78:81]
  ds_read_b128 v[50:53], v12 offset:512
  ds_read_b128 v[54:57], v12 offset:20992
  s_waitcnt lgkmcnt(4)
  v_mfma_f32_16x16x32_bf16 v[58:61], a[24:27], v[34:37], v[58:61]
  v_mfma_f32_16x16x32_bf16 v[62:65], a[24:27], v[38:41], v[62:65]
  v_mfma_f32_16x16x32_bf16 v[66:69], a[104:107], v[34:37], v[66:69]
  v_mfma_f32_16x16x32_bf16 v[70:73], a[104:107], v[38:41], v[70:73]
  v_mfma_f32_16x16x32_bf16 v[74:77], a[184:187], v[34:37], v[74:77]
  v_mfma_f32_16x16x32_bf16 v[78:81], a[184:187], v[38:41], v[78:81]
  ds_read_b128 v[34:37], v13 offset:512
  ds_read_b128 v[38:41], v13 offset:20992
  s_waitcnt lgkmcnt(4)
  v_mfma_f32_16x16x32_bf16 v[58:61], a[28:31], v[42:45], v[58:61]
  v_mfma_f32_16x16x32_bf16 v[62:65], a[28:31], v[46:49], v[62:65]
  v_mfma_f32_16x16x32_bf16 v[66:69], a[108:111], v[42:45], v[66:69]
  v_mfma_f32_16x16x32_bf16 v[70:73], a[108:111], v[46:49], v[70:73]
  v_mfma_f32_16x16x32_bf16 v[74:77], a[188:191], v[42:45], v[74:77]
  v_mfma_f32_16x16x32_bf16 v[78:81], a[188:191], v[46:49], v[78:81]
  ds_read_b128 v[42:45], v14 offset:512
  ds_read_b128 v[46:49], v14 offset:20992
  s_waitcnt lgkmcnt(4)
  v_mfma_f32_16x16x32_bf16 v[58:61], a[32:35], v[50:53], v[58:61]
  v_mfma_f32_16x16x32_bf16 v[62:65], a[32:35], v[54:57], v[62:65]
  v_mfma_f32_16x16x32_bf16 v[66:69], a[112:115], v[50:53], v[66:69]
  v_mfma_f32_16x16x32_bf16 v[70:73], a[112:115], v[54:57], v[70:73]
  v_mfma_f32_16x16x32_bf16 v[74:77], a[192:195], v[50:53], v[74:77]
  v_mfma_f32_16x16x32_bf16 v[78:81], a[192:195], v[54:57], v[78:81]
  ds_read_b128 v[50:53], v15 offset:512
  ds_read_b128 v[54:57], v15 offset:20992
  s_waitcnt lgkmcnt(4)
  v_mfma_f32_16x16x32_bf16 v[58:61], a[36:39], v[34:37], v[58:61]
  v_mfma_f32_16x16x32_bf16 v[62:65], a[36:39], v[38:41], v[62:65]
  v_mfma_f32_16x16x32_bf16 v[66:69], a[116:119], v[34:37], v[66:69]
  v_mfma_f32_16x16x32_bf16 v[70:73], a[116:119], v[38:41], v[70:73]
  v_mfma_f32_16x16x32_bf16 v[74:77], a[196:199], v[34:37], v[74:77]
  v_mfma_f32_16x16x32_bf16 v[78:81], a[196:199], v[38:41], v[78:81]
  ds_read_b128 v[34:37], v12 offset:768
  ds_read_b128 v[38:41], v12 offset:21248
  s_waitcnt lgkmcnt(4)
  v_mfma_f32_16x16x32_bf16 v[58:61], a[40:43], v[42:45], v[58:61]
  v_mfma_f32_16x16x32_bf16 v[62:65], a[40:43], v[46:49], v[62:65]
  v_mfma_f32_16x16x32_bf16 v[66:69], a[120:123], v[42:45], v[66:69]
  v_mfma_f32_16x16x32_bf16 v[70:73], a[120:123], v[46:49], v[70:73]
  v_mfma_f32_16x16x32_bf16 v[74:77], a[200:203], v[42:45], v[74:77]
  v_mfma_f32_16x16x32_bf16 v[78:81], a[200:203], v[46:49], v[78:81]
  ds_read_b128 v[42:45], v13 offset:768
  ds_read_b128 v[46:49], v13 offset:21248
  s_waitcnt lgkmcnt(4)
  v_mfma_f32_16x16x32_bf16 v[58:61], a[44:47], v[50:53], v[58:61]
  v_mfma_f32_16x16x32_bf16 v[62:65], a[44:47], v[54:57], v[62:65]
  v_mfma_f32_16x16x32_bf16 v[66:69], a[124:127], v[50:53], v[66:69]
  v_mfma_f32_16x16x32_bf16 v[70:73], a[124:127], v[54:57], v[70:73]
  v_mfma_f32_16x16x32_bf16 v[74:77], a[204:207], v[50:53], v[74:77]
  v_mfma_f32_16x16x32_bf16 v[78:81], a[204:207], v[54:57], v[78:81]
  ds_read_b128 v[50:53], v14 offset:768
  ds_read_b128 v[54:57], v14 offset:21248
  s_waitcnt lgkmcnt(4)
  v_mfma_f32_16x16x32_bf16 v[58:61], a[48:51], v[34:37], v[58:61]
  v_mfma_f32_16x16x32_bf16 v[62:65], a[48:51], v[38:41], v[62:65]
  v_mfma_f32_16x16x32_bf16 v[66:69], a[128:131], v[34:37], v[66:69]
  v_mfma_f32_16x16x32_bf16 v[70:73], a[128:131], v[38:41], v[70:73]
  v_mfma_f32_16x16x32_bf16 v[74:77], a[208:211], v[34:37], v[74:77]
  v_mfma_f32_16x16x32_bf16 v[78:81], a[208:211], v[38:41], v[78:81]
  ds_read_b128 v[34:37], v15 offset:768
  ds_read_b128 v[38:41], v15 offset:21248
  s_waitcnt lgkmcnt(4)
  v_mfma_f32_16x16x32_bf16 v[58:61], a[52:55], v[42:45], v[58:61]
  v_mfma_f32_16x16x32_bf16 v[62:65], a[52:55], v[46:49], v[62:65]
  v_mfma_f32_16x16x32_bf16 v[66:69], a[132:135], v[42:45], v[66:69]
  v_mfma_f32_16x16x32_bf16 v[70:73], a[132:135], v[46:49], v[70:73]
  v_mfma_f32_16x16x32_bf16 v[74:77], a[212:215], v[42:45], v[74:77]
  v_mfma_f32_16x16x32_bf16 v[78:81], a[212:215], v[46:49], v[78:81]
  ds_read_b128 v[42:45], v12 offset:1024
  ds_read_b128 v[46:49], v12 offset:21504
  s_waitcnt lgkmcnt(4)
  v_mfma_f32_16x16x32_bf16 v[58:61], a[56:59], v[50:53], v[58:61]
  v_mfma_f32_16x16x32_bf16 v[62:65], a[56:59], v[54:57], v[62:65]
  v_mfma_f32_16x16x32_bf16 v[66:69], a[136:139], v[50:53], v[66:69]
  v_mfma_f32_16x16x32_bf16 v[70:73], a[136:139], v[54:57], v[70:73]
  v_mfma_f32_16x16x32_bf16 v[74:77], a[216:219], v[50:53], v[74:77]
  v_mfma_f32_16x16x32_bf16 v[78:81], a[216:219], v[54:57], v[78:81]
  ds_read_b128 v[50:53], v13 offset:1024
  ds_read_b128 v[54:57], v13 offset:21504
  s_waitcnt lgkmcnt(4)
  v_mfma_f32_16x16x32_bf16 v[58:61], a[60:63], v[34:37], v[58:61]
  v_mfma_f32_16x16x32_bf16 v[62:65], a[60:63], v[38:41], v[62:65]
  v_mfma_f32_16x16x32_bf16 v[66:69], a[140:143], v[34:37], v[66:69]
  v_mfma_f32_16x16x32_bf16 v[70:73], a[140:143], v[38:41], v[70:73]
  v_mfma_f32_16x16x32_bf16 v[74:77], a[220:223], v[34:37], v[74:77]
  v_mfma_f32_16x16x32_bf16 v[78:81], a[220:223], v[38:41], v[78:81]
  ds_read_b128 v[34:37], v14 offset:1024
  ds_read_b128 v[38:41], v14 offset:21504
  s_waitcnt lgkmcnt(4)
  v_mfma_f32_16x16x32_bf16 v[58:61], a[64:67], v[42:45], v[58:61]
  v_mfma_f32_16x16x32_bf16 v[62:65], a[64:67], v[46:49], v[62:65]
  v_mfma_f32_16x16x32_bf16 v[66:69], a[144:147], v[42:45], v[66:69]
  v_mfma_f32_16x16x32_bf16 v[70:73], a[144:147], v[46:49], v[70:73]
  v_mfma_f32_16x16x32_bf16 v[74:77], a[224:227], v[42:45], v[74:77]
  v_mfma_f32_16x16x32_bf16 v[78:81], a[224:227], v[46:49], v[78:81]
  ds_read_b128 v[42:45], v15 offset:1024
  ds_read_b128 v[46:49], v15 offset:21504
  s_waitcnt lgkmcnt(4)
  v_mfma_f32_16x16x32_bf16 v[58:61], a[68:71], v[50:53], v[58:61]
  v_mfma_f32_16x16x32_bf16 v[62:65], a[68:71], v[54:57], v[62:65]
  v_mfma_f32_16x16x32_bf16 v[66:69], a[148:151], v[50:53], v[66:69]
  v_mfma_f32_16x16x32_bf16 v[70:73], a[148:151], v[54:57], v[70:73]
  v_mfma_f32_16x16x32_bf16 v[74:77], a[228:231], v[50:53], v[74:77]
  v_mfma_f32_16x16x32_bf16 v[78:81], a[228:231], v[54:57], v[78:81]
  s_waitcnt lgkmcnt(2)
  v_mfma_f32_16x16x32_bf16 v[58:61], a[72:75], v[34:37], v[58:61]
  v_mfma_f32_16x16x32_bf16 v[62:65], a[72:75], v[38:41], v[62:65]
  v_mfma_f32_16x16x32_bf16 v[66:69], a[152:155], v[34:37], v[66:69]
  v_mfma_f32_16x16x32_bf16 v[70:73], a[152:155], v[38:41], v[70:73]
  v_mfma_f32_16x16x32_bf16 v[74:77], a[232:235], v[34:37], v[74:77]
  v_mfma_f32_16x16x32_bf16 v[78:81], a[232:235], v[38:41], v[78:81]
  s_waitcnt lgkmcnt(0)
  v_mfma_f32_16x16x32_bf16 v[58:61], a[76:79], v[42:45], v[58:61]
  v_mfma_f32_16x16x32_bf16 v[62:65], a[76:79], v[46:49], v[62:65]
  v_mfma_f32_16x16x32_bf16 v[66:69], a[156:159], v[42:45], v[66:69]
  v_mfma_f32_16x16x32_bf16 v[70:73], a[156:159], v[46:49], v[70:73]
  v_mfma_f32_16x16x32_bf16 v[74:77], a[236:239], v[42:45], v[74:77]
  v_mfma_f32_16x16x32_bf16 v[78:81], a[236:239], v[46:49], v[78:81]
  s_add_u32 s30, s30, 40960
  s_add_u32 s29, s29, 1
  s_mul_i32 s36, s29, 0x5556
  s_lshr_b32 s36, s36, 16
  s_mul_i32 s37, s36, 3
  s_sub_u32 s37, s29, s37
  s_mul_i32 s37, s37, 655360
  s_lshl_b32 s34, s36, 21
  s_add_u32 s34, s34, s37
  s_xor_b32 s36, s36, s14
  s_and_b32 s36, s36, 1
  s_lshl_b32 s36, s36, 13
  s_add_u32 s34, s34, s36
  s_add_u32 s34, s34, 83886080
  v_cvt_pk_bf16_f32 v106, v58, v59
  v_cvt_pk_bf16_f32 v107, v60, v61
  v_cvt_pk_bf16_f32 v108, v62, v63
  v_cvt_pk_bf16_f32 v109, v64, v65
  buffer_store_dwordx4 v[106:109], v16, s[4:7], s33 offen offset:0 sc1
  v_cvt_pk_bf16_f32 v110, v66, v67
  v_cvt_pk_bf16_f32 v111, v68, v69
  v_cvt_pk_bf16_f32 v112, v70, v71
  v_cvt_pk_bf16_f32 v113, v72, v73
  buffer_store_dwordx4 v[110:113], v16, s[4:7], s33 offen offset:1024 sc1
  v_cvt_pk_bf16_f32 v114, v74, v75
  v_cvt_pk_bf16_f32 v115, v76, v77
  v_cvt_pk_bf16_f32 v116, v78, v79
  v_cvt_pk_bf16_f32 v117, v80, v81
  buffer_store_dwordx4 v[114:117], v16, s[4:7], s33 offen offset:2048 sc1
  s_add_u32 s33, s33, 393216
  buffer_store_dwordx4 v[20:23], v17, s[4:7], s34 offen sc1
  buffer_store_dwordx4 v[20:23], v18, s[4:7], s34 offen sc1
  buffer_store_dwordx4 v[20:23], v19, s[4:7], s34 offen sc1
  s_waitcnt vmcnt(0)
  v_mov_b32 v26, 1
  s_mov_b64 exec, 1
  buffer_store_dword v26, v24, s[4:7], s35 offen sc1
  s_mov_b64 exec, -1
  s_waitcnt vmcnt(1)
  s_barrier
  ds_read_b128 v[34:37], v12 offset:40960
  ds_read_b128 v[38:41], v12 offset:61440
  ds_read_b128 v[42:45], v13 offset:40960
  ds_read_b128 v[46:49], v13 offset:61440
  ds_read_b128 v[50:53], v14 offset:40960
  ds_read_b128 v[54:57], v14 offset:61440
  s_waitcnt lgkmcnt(4)
  v_mfma_f32_16x16x32_bf16 v[82:85], a[0:3], v[34:37], 0
  v_mfma_f32_16x16x32_bf16 v[86:89], a[0:3], v[38:41], 0
  s_add_u32 m0, s31, 0
  s_nop 0
  buffer_load_dwordx4 v2, s[20:23], s30 offen lds
  v_mfma_f32_16x16x32_bf16 v[90:93], a[80:83], v[34:37], 0
  v_mfma_f32_16x16x32_bf16 v[94:97], a[80:83], v[38:41], 0
  v_mfma_f32_16x16x32_bf16 v[98:101], a[160:163], v[34:37], 0
  v_mfma_f32_16x16x32_bf16 v[102:105], a[160:163], v[38:41], 0
  s_add_u32 m0, s31, 1024
  s_nop 0
  buffer_load_dwordx4 v3, s[20:23], s30 offen lds
  ds_read_b128 v[34:37], v15 offset:40960
  ds_read_b128 v[38:41], v15 offset:61440
  s_waitcnt lgkmcnt(4)
  v_mfma_f32_16x16x32_bf16 v[82:85], a[4:7], v[42:45], v[82:85]
  v_mfma_f32_16x16x32_bf16 v[86:89], a[4:7], v[46:49], v[86:89]
  s_add_u32 m0, s31, 2048
  s_nop 0
  buffer_load_dwordx4 v4, s[20:23], s30 offen lds
  v_mfma_f32_16x16x32_bf16 v[90:93], a[84:87], v[42:45], v[90:93]
  v_mfma_f32_16x16x32_bf16 v[94:97], a[84:87], v[46:49], v[94:97]
  v_mfma_f32_16x16x32_bf16 v[98:101], a[164:167], v[42:45], v[98:101]
  v_mfma_f32_16x16x32_bf16 v[102:105], a[164:167], v[46:49], v[102:105]
  s_add_u32 m0, s31, 3072
  s_nop 0
  buffer_load_dwordx4 v5, s[20:23], s30 offen lds
  ds_read_b128 v[42:45], v12 offset:41216
  ds_read_b128 v[46:49], v12 offset:61696
  s_waitcnt lgkmcnt(4)
  v_mfma_f32_16x16x32_bf16 v[82:85], a[8:11], v[50:53], v[82:85]
  v_mfma_f32_16x16x32_bf16 v[86:89], a[8:11], v[54:57], v[86:89]
  s_add_u32 m0, s31, 4096
  s_nop 0
  buffer_load_dwordx4 v6, s[20:23], s30 offen lds
  v_mfma_f32_16x16x32_bf16 v[90:93], a[88:91], v[50:53], v[90:93]
  v_mfma_f32_16x16x32_bf16 v[94:97], a[88:91], v[54:57], v[94:97]
  v_mfma_f32_16x16x32_bf16 v[98:101], a[168:171], v[50:53], v[98:101]
  v_mfma_f32_16x16x32_bf16 v[102:105], a[168:171], v[54:57], v[102:105]
  s_add_u32 m0, s31, 5120
  s_nop 0
  buffer_load_dwordx4 v7, s[20:23], s30 offen lds
  ds_read_b128 v[50:53], v13 offset:41216
  ds_read_b128 v[54:57], v13 offset:61696
  s_waitcnt lgkmcnt(4)
  v_mfma_f32_16x16x32_bf16 v[82:85], a[12:15], v[34:37], v[82:85]
  v_mfma_f32_16x16x32_bf16 v[86:89], a[12:15], v[38:41], v[86:89]
  s_add_u32 m0, s31, 6144
  s_nop 0
  buffer_load_dwordx4 v8, s[20:23], s30 offen lds
  v_mfma_f32_16x16x32_bf16 v[90:93], a[92:95], v[34:37], v[90:93]
  v_mfma_f32_16x16x32_bf16 v[94:97], a[92:95], v[38:41], v[94:97]
  v_mfma_f32_16x16x32_bf16 v[98:101], a[172:175], v[34:37], v[98:101]
  v_mfma_f32_16x16x32_bf16 v[102:105], a[172:175], v[38:41], v[102:105]
  s_add_u32 m0, s31, 7168
  s_nop 0
  buffer_load_dwordx4 v9, s[20:23], s30 offen lds
  ds_read_b128 v[34:37], v14 offset:41216
  ds_read_b128 v[38:41], v14 offset:61696
  s_waitcnt lgkmcnt(4)
  v_mfma_f32_16x16x32_bf16 v[82:85], a[16:19], v[42:45], v[82:85]
  v_mfma_f32_16x16x32_bf16 v[86:89], a[16:19], v[46:49], v[86:89]
  s_add_u32 m0, s31, 8192
  s_nop 0
  buffer_load_dwordx4 v10, s[20:23], s30 offen lds
  v_mfma_f32_16x16x32_bf16 v[90:93], a[96:99], v[42:45], v[90:93]
  v_mfma_f32_16x16x32_bf16 v[94:97], a[96:99], v[46:49], v[94:97]
  v_mfma_f32_16x16x32_bf16 v[98:101], a[176:179], v[42:45], v[98:101]
  v_mfma_f32_16x16x32_bf16 v[102:105], a[176:179], v[46:49], v[102:105]
  s_add_u32 m0, s31, 9216
  s_nop 0
  buffer_load_dwordx4 v11, s[20:23], s30 offen lds
  ds_read_b128 v[42:45], v15 offset:41216
  ds_read_b128 v[46:49], v15 offset:61696
  s_waitcnt lgkmcnt(4)
  v_mfma_f32_16x16x32_bf16 v[82:85], a[20:23], v[50:53], v[82:85]
  v_mfma_f32_16x16x32_bf16 v[86:89], a[20:23], v[54:57], v[86:89]
  v_mfma_f32_16x16x32_bf16 v[90:93], a[100:103], v[50:53], v[90:93]
  v_mfma_f32_16x16x32_bf16 v[94:97], a[100:103], v[54:57], v[94:97]
  v_mfma_f32_16x16x32_bf16 v[98:101], a[180:183], v[50:53], v[98:101]
  v_mfma_f32_16x16x32_bf16 v[102:105], a[180:183], v[54:57], v[102:105]
  ds_read_b128 v[50:53], v12 offset:41472
  ds_read_b128 v[54:57], v12 offset:61952
  s_waitcnt lgkmcnt(4)
  v_mfma_f32_16x16x32_bf16 v[82:85], a[24:27], v[34:37], v[82:85]
  v_mfma_f32_16x16x32_bf16 v[86:89], a[24:27], v[38:41], v[86:89]
  v_mfma_f32_16x16x32_bf16 v[90:93], a[104:107], v[34:37], v[90:93]
  v_mfma_f32_16x16x32_bf16 v[94:97], a[104:107], v[38:41], v[94:97]
  v_mfma_f32_16x16x32_bf16 v[98:101], a[184:187], v[34:37], v[98:101]
  v_mfma_f32_16x16x32_bf16 v[102:105], a[184:187], v[38:41], v[102:105]
  ds_read_b128 v[34:37], v13 offset:41472
  ds_read_b128 v[38:41], v13 offset:61952
  s_waitcnt lgkmcnt(4)
  v_mfma_f32_16x16x32_bf16 v[82:85], a[28:31], v[42:45], v[82:85]
  v_mfma_f32_16x16x32_bf16 v[86:89], a[28:31], v[46:49], v[86:89]
  v_mfma_f32_16x16x32_bf16 v[90:93], a[108:111], v[42:45], v[90:93]
  v_mfma_f32_16x16x32_bf16 v[94:97], a[108:111], v[46:49], v[94:97]
  v_mfma_f32_16x16x32_bf16 v[98:101], a[188:191], v[42:45], v[98:101]
  v_mfma_f32_16x16x32_bf16 v[102:105], a[188:191], v[46:49], v[102:105]
  ds_read_b128 v[42:45], v14 offset:41472
  ds_read_b128 v[46:49], v14 offset:61952
  s_waitcnt lgkmcnt(4)
  v_mfma_f32_16x16x32_bf16 v[82:85], a[32:35], v[50:53], v[82:85]
  v_mfma_f32_16x16x32_bf16 v[86:89], a[32:35], v[54:57], v[86:89]
  v_mfma_f32_16x16x32_bf16 v[90:93], a[112:115], v[50:53], v[90:93]
  v_mfma_f32_16x16x32_bf16 v[94:97], a[112:115], v[54:57], v[94:97]
  v_mfma_f32_16x16x32_bf16 v[98:101], a[192:195], v[50:53], v[98:101]
  v_mfma_f32_16x16x32_bf16 v[102:105], a[192:195], v[54:57], v[102:105]
  ds_read_b128 v[50:53], v15 offset:41472
  ds_read_b128 v[54:57], v15 offset:61952
  s_waitcnt lgkmcnt(4)
  v_mfma_f32_16x16x32_bf16 v[82:85], a[36:39], v[34:37], v[82:85]
  v_mfma_f32_16x16x32_bf16 v[86:89], a[36:39], v[38:41], v[86:89]
  v_mfma_f32_16x16x32_bf16 v[90:93], a[116:119], v[34:37], v[90:93]
  v_mfma_f32_16x16x32_bf16 v[94:97], a[116:119], v[38:41], v[94:97]
  v_mfma_f32_16x16x32_bf16 v[98:101], a[196:199], v[34:37], v[98:101]
  v_mfma_f32_16x16x32_bf16 v[102:105], a[196:199], v[38:41], v[102:105]
  ds_read_b128 v[34:37], v12 offset:41728
  ds_read_b128 v[38:41], v12 offset:62208
  s_waitcnt lgkmcnt(4)
  v_mfma_f32_16x16x32_bf16 v[82:85], a[40:43], v[42:45], v[82:85]
  v_mfma_f32_16x16x32_bf16 v[86:89], a[40:43], v[46:49], v[86:89]
  v_mfma_f32_16x16x32_bf16 v[90:93], a[120:123], v[42:45], v[90:93]
  v_mfma_f32_16x16x32_bf16 v[94:97], a[120:123], v[46:49], v[94:97]
  v_mfma_f32_16x16x32_bf16 v[98:101], a[200:203], v[42:45], v[98:101]
  v_mfma_f32_16x16x32_bf16 v[102:105], a[200:203], v[46:49], v[102:105]
  ds_read_b128 v[42:45], v13 offset:41728
  ds_read_b128 v[46:49], v13 offset:62208
  s_waitcnt lgkmcnt(4)
  v_mfma_f32_16x16x32_bf16 v[82:85], a[44:47], v[50:53], v[82:85]
  v_mfma_f32_16x16x32_bf16 v[86:89], a[44:47], v[54:57], v[86:89]
  v_mfma_f32_16x16x32_bf16 v[90:93], a[124:127], v[50:53], v[90:93]
  v_mfma_f32_16x16x32_bf16 v[94:97], a[124:127], v[54:57], v[94:97]
  v_mfma_f32_16x16x32_bf16 v[98:101], a[204:207], v[50:53], v[98:101]
  v_mfma_f32_16x16x32_bf16 v[102:105], a[204:207], v[54:57], v[102:105]
  ds_read_b128 v[50:53], v14 offset:41728
  ds_read_b128 v[54:57], v14 offset:62208
  s_waitcnt lgkmcnt(4)
  v_mfma_f32_16x16x32_bf16 v[82:85], a[48:51], v[34:37], v[82:85]
  v_mfma_f32_16x16x32_bf16 v[86:89], a[48:51], v[38:41], v[86:89]
  v_mfma_f32_16x16x32_bf16 v[90:93], a[128:131], v[34:37], v[90:93]
  v_mfma_f32_16x16x32_bf16 v[94:97], a[128:131], v[38:41], v[94:97]
  v_mfma_f32_16x16x32_bf16 v[98:101], a[208:211], v[34:37], v[98:101]
  v_mfma_f32_16x16x32_bf16 v[102:105], a[208:211], v[38:41], v[102:105]
  ds_read_b128 v[34:37], v15 offset:41728
  ds_read_b128 v[38:41], v15 offset:62208
  s_waitcnt lgkmcnt(4)
  v_mfma_f32_16x16x32_bf16 v[82:85], a[52:55], v[42:45], v[82:85]
  v_mfma_f32_16x16x32_bf16 v[86:89], a[52:55], v[46:49], v[86:89]
  v_mfma_f32_16x16x32_bf16 v[90:93], a[132:135], v[42:45], v[90:93]
  v_mfma_f32_16x16x32_bf16 v[94:97], a[132:135], v[46:49], v[94:97]
  v_mfma_f32_16x16x32_bf16 v[98:101], a[212:215], v[42:45], v[98:101]
  v_mfma_f32_16x16x32_bf16 v[102:105], a[212:215], v[46:49], v[102:105]
  ds_read_b128 v[42:45], v12 offset:41984
  ds_read_b128 v[46:49], v12 offset:62464
  s_waitcnt lgkmcnt(4)
  v_mfma_f32_16x16x32_bf16 v[82:85], a[56:59], v[50:53], v[82:85]
  v_mfma_f32_16x16x32_bf16 v[86:89], a[56:59], v[54:57], v[86:89]
  v_mfma_f32_16x16x32_bf16 v[90:93], a[136:139], v[50:53], v[90:93]
  v_mfma_f32_16x16x32_bf16 v[94:97], a[136:139], v[54:57], v[94:97]
  v_mfma_f32_16x16x32_bf16 v[98:101], a[216:219], v[50:53], v[98:101]
  v_mfma_f32_16x16x32_bf16 v[102:105], a[216:219], v[54:57], v[102:105]
  ds_read_b128 v[50:53], v13 offset:41984
  ds_read_b128 v[54:57], v13 offset:62464
  s_waitcnt lgkmcnt(4)
  v_mfma_f32_16x16x32_bf16 v[82:85], a[60:63], v[34:37], v[82:85]
  v_mfma_f32_16x16x32_bf16 v[86:89], a[60:63], v[38:41], v[86:89]
  v_mfma_f32_16x16x32_bf16 v[90:93], a[140:143], v[34:37], v[90:93]
  v_mfma_f32_16x16x32_bf16 v[94:97], a[140:143], v[38:41], v[94:97]
  v_mfma_f32_16x16x32_bf16 v[98:101], a[220:223], v[34:37], v[98:101]
  v_mfma_f32_16x16x32_bf16 v[102:105], a[220:223], v[38:41], v[102:105]
  ds_read_b128 v[34:37], v14 offset:41984
  ds_read_b128 v[38:41], v14 offset:62464
  s_waitcnt lgkmcnt(4)
  v_mfma_f32_16x16x32_bf16 v[82:85], a[64:67], v[42:45], v[82:85]
  v_mfma_f32_16x16x32_bf16 v[86:89], a[64:67], v[46:49], v[86:89]
  v_mfma_f32_16x16x32_bf16 v[90:93], a[144:147], v[42:45], v[90:93]
  v_mfma_f32_16x16x32_bf16 v[94:97], a[144:147], v[46:49], v[94:97]
  v_mfma_f32_16x16x32_bf16 v[98:101], a[224:227], v[42:45], v[98:101]
  v_mfma_f32_16x16x32_bf16 v[102:105], a[224:227], v[46:49], v[102:105]
  ds_read_b128 v[42:45], v15 offset:41984
  ds_read_b128 v[46:49], v15 offset:62464
  s_waitcnt lgkmcnt(4)
  v_mfma_f32_16x16x32_bf16 v[82:85], a[68:71], v[50:53], v[82:85]
  v_mfma_f32_16x16x32_bf16 v[86:89], a[68:71], v[54:57], v[86:89]
  v_mfma_f32_16x16x32_bf16 v[90:93], a[148:151], v[50:53], v[90:93]
  v_mfma_f32_16x16x32_bf16 v[94:97], a[148:151], v[54:57], v[94:97]
  v_mfma_f32_16x16x32_bf16 v[98:101], a[228:231], v[50:53], v[98:101]
  v_mfma_f32_16x16x32_bf16 v[102:105], a[228:231], v[54:57], v[102:105]
  s_waitcnt lgkmcnt(2)
  v_mfma_f32_16x16x32_bf16 v[82:85], a[72:75], v[34:37], v[82:85]
  v_mfma_f32_16x16x32_bf16 v[86:89], a[72:75], v[38:41], v[86:89]
  v_mfma_f32_16x16x32_bf16 v[90:93], a[152:155], v[34:37], v[90:93]
  v_mfma_f32_16x16x32_bf16 v[94:97], a[152:155], v[38:41], v[94:97]
  v_mfma_f32_16x16x32_bf16 v[98:101], a[232:235], v[34:37], v[98:101]
  v_mfma_f32_16x16x32_bf16 v[102:105], a[232:235], v[38:41], v[102:105]
  s_waitcnt lgkmcnt(0)
  v_mfma_f32_16x16x32_bf16 v[82:85], a[76:79], v[42:45], v[82:85]
  v_mfma_f32_16x16x32_bf16 v[86:89], a[76:79], v[46:49], v[86:89]
  v_mfma_f32_16x16x32_bf16 v[90:93], a[156:159], v[42:45], v[90:93]
  v_mfma_f32_16x16x32_bf16 v[94:97], a[156:159], v[46:49], v[94:97]
  v_mfma_f32_16x16x32_bf16 v[98:101], a[236:239], v[42:45], v[98:101]
  v_mfma_f32_16x16x32_bf16 v[102:105], a[236:239], v[46:49], v[102:105]
  s_add_u32 s30, s30, 40960
  s_add_u32 s29, s29, 1
  s_mul_i32 s36, s29, 0x5556
  s_lshr_b32 s36, s36, 16
  s_mul_i32 s37, s36, 3
  s_sub_u32 s37, s29, s37
  s_mul_i32 s37, s37, 655360
  s_lshl_b32 s34, s36, 21
  s_add_u32 s34, s34, s37
  s_xor_b32 s36, s36, s14
  s_and_b32 s36, s36, 1
  s_lshl_b32 s36, s36, 13
  s_add_u32 s34, s34, s36
  s_add_u32 s34, s34, 83886080
  v_cvt_pk_bf16_f32 v106, v82, v83
  v_cvt_pk_bf16_f32 v107, v84, v85
  v_cvt_pk_bf16_f32 v108, v86, v87
  v_cvt_pk_bf16_f32 v109, v88, v89
  buffer_store_dwordx4 v[106:109], v16, s[4:7], s33 offen offset:0 sc1
  v_cvt_pk_bf16_f32 v110, v90, v91
  v_cvt_pk_bf16_f32 v111, v92, v93
  v_cvt_pk_bf16_f32 v112, v94, v95
  v_cvt_pk_bf16_f32 v113, v96, v97
  buffer_store_dwordx4 v[110:113], v16, s[4:7], s33 offen offset:1024 sc1
  v_cvt_pk_bf16_f32 v114, v98, v99
  v_cvt_pk_bf16_f32 v115, v100, v101
  v_cvt_pk_bf16_f32 v116, v102, v103
  v_cvt_pk_bf16_f32 v117, v104, v105
  buffer_store_dwordx4 v[114:117], v16, s[4:7], s33 offen offset:2048 sc1
  s_add_u32 s33, s33, 393216
  buffer_store_dwordx4 v[20:23], v17, s[4:7], s34 offen sc1
  buffer_store_dwordx4 v[20:23], v18, s[4:7], s34 offen sc1
  buffer_store_dwordx4 v[20:23], v19, s[4:7], s34 offen sc1
  s_waitcnt vmcnt(0)
  v_mov_b32 v26, 2
  s_mov_b64 exec, 1
  buffer_store_dword v26, v24, s[4:7], s35 offen sc1
  s_mov_b64 exec, -1
  s_waitcnt vmcnt(1)
  s_barrier
  ds_read_b128 v[34:37], v12 offset:0
  ds_read_b128 v[38:41], v12 offset:20480
  ds_read_b128 v[42:45], v13 offset:0
  ds_read_b128 v[46:49], v13 offset:20480
  ds_read_b128 v[50:53], v14 offset:0
  ds_read_b128 v[54:57], v14 offset:20480
  s_waitcnt lgkmcnt(4)
  v_mfma_f32_16x16x32_bf16 v[58:61], a[0:3], v[34:37], 0
  v_mfma_f32_16x16x32_bf16 v[62:65], a[0:3], v[38:41], 0
  s_add_u32 m0, s32, 0
  s_nop 0
  buffer_load_dwordx4 v2, s[20:23], s30 offen lds
  v_mfma_f32_16x16x32_bf16 v[66:69], a[80:83], v[34:37], 0
  v_mfma_f32_16x16x32_bf16 v[70:73], a[80:83], v[38:41], 0
  v_mfma_f32_16x16x32_bf16 v[74:77], a[160:163], v[34:37], 0
  v_mfma_f32_16x16x32_bf16 v[78:81], a[160:163], v[38:41], 0
  s_add_u32 m0, s32, 1024
  s_nop 0
  buffer_load_dwordx4 v3, s[20:23], s30 offen lds
  ds_read_b128 v[34:37], v15 offset:0
  ds_read_b128 v[38:41], v15 offset:20480
  s_waitcnt lgkmcnt(4)
  v_mfma_f32_16x16x32_bf16 v[58:61], a[4:7], v[42:45], v[58:61]
  v_mfma_f32_16x16x32_bf16 v[62:65], a[4:7], v[46:49], v[62:65]
  s_add_u32 m0, s32, 2048
  s_nop 0
  buffer_load_dwordx4 v4, s[20:23], s30 offen lds
  v_mfma_f32_16x16x32_bf16 v[66:69], a[84:87], v[42:45], v[66:69]
  v_mfma_f32_16x16x32_bf16 v[70:73], a[84:87], v[46:49], v[70:73]
  v_mfma_f32_16x16x32_bf16 v[74:77], a[164:167], v[42:45], v[74:77]
  v_mfma_f32_16x16x32_bf16 v[78:81], a[164:167], v[46:49], v[78:81]
  s_add_u32 m0, s32, 3072
  s_nop 0
  buffer_load_dwordx4 v5, s[20:23], s30 offen lds
  ds_read_b128 v[42:45], v12 offset:256
  ds_read_b128 v[46:49], v12 offset:20736
  s_waitcnt lgkmcnt(4)
  v_mfma_f32_16x16x32_bf16 v[58:61], a[8:11], v[50:53], v[58:61]
  v_mfma_f32_16x16x32_bf16 v[62:65], a[8:11], v[54:57], v[62:65]
  s_add_u32 m0, s32, 4096
  s_nop 0
  buffer_load_dwordx4 v6, s[20:23], s30 offen lds
  v_mfma_f32_16x16x32_bf16 v[66:69], a[88:91], v[50:53], v[66:69]
  v_mfma_f32_16x16x32_bf16 v[70:73], a[88:91], v[54:57], v[70:73]
  v_mfma_f32_16x16x32_bf16 v[74:77], a[168:171], v[50:53], v[74:77]
  v_mfma_f32_16x16x32_bf16 v[78:81], a[168:171], v[54:57], v[78:81]
  s_add_u32 m0, s32, 5120
  s_nop 0
  buffer_load_dwordx4 v7, s[20:23], s30 offen lds
  ds_read_b128 v[50:53], v13 offset:256
  ds_read_b128 v[54:57], v13 offset:20736
  s_waitcnt lgkmcnt(4)
  v_mfma_f32_16x16x32_bf16 v[58:61], a[12:15], v[34:37], v[58:61]
  v_mfma_f32_16x16x32_bf16 v[62:65], a[12:15], v[38:41], v[62:65]
  s_add_u32 m0, s32, 6144
  s_nop 0
  buffer_load_dwordx4 v8, s[20:23], s30 offen lds
  v_mfma_f32_16x16x32_bf16 v[66:69], a[92:95], v[34:37], v[66:69]
  v_mfma_f32_16x16x32_bf16 v[70:73], a[92:95], v[38:41], v[70:73]
  v_mfma_f32_16x16x32_bf16 v[74:77], a[172:175], v[34:37], v[74:77]
  v_mfma_f32_16x16x32_bf16 v[78:81], a[172:175], v[38:41], v[78:81]
  s_add_u32 m0, s32, 7168
  s_nop 0
  buffer_load_dwordx4 v9, s[20:23], s30 offen lds
  ds_read_b128 v[34:37], v14 offset:256
  ds_read_b128 v[38:41], v14 offset:20736
  s_waitcnt lgkmcnt(4)
  v_mfma_f32_16x16x32_bf16 v[58:61], a[16:19], v[42:45], v[58:61]
  v_mfma_f32_16x16x32_bf16 v[62:65], a[16:19], v[46:49], v[62:65]
  s_add_u32 m0, s32, 8192
  s_nop 0
  buffer_load_dwordx4 v10, s[20:23], s30 offen lds
  v_mfma_f32_16x16x32_bf16 v[66:69], a[96:99], v[42:45], v[66:69]
  v_mfma_f32_16x16x32_bf16 v[70:73], a[96:99], v[46:49], v[70:73]
  v_mfma_f32_16x16x32_bf16 v[74:77], a[176:179], v[42:45], v[74:77]
  v_mfma_f32_16x16x32_bf16 v[78:81], a[176:179], v[46:49], v[78:81]
  s_add_u32 m0, s32, 9216
  s_nop 0
  buffer_load_dwordx4 v11, s[20:23], s30 offen lds
  ds_read_b128 v[42:45], v15 offset:256
  ds_read_b128 v[46:49], v15 offset:20736
  s_waitcnt lgkmcnt(4)
  v_mfma_f32_16x16x32_bf16 v[58:61], a[20:23], v[50:53], v[58:61]
  v_mfma_f32_16x16x32_bf16 v[62:65], a[20:23], v[54:57], v[62:65]
  v_mfma_f32_16x16x32_bf16 v[66:69], a[100:103], v[50:53], v[66:69]
  v_mfma_f32_16x16x32_bf16 v[70:73], a[100:103], v[54:57], v[70:73]
  v_mfma_f32_16x16x32_bf16 v[74:77], a[180:183], v[50:53], v[74:77]
  v_mfma_f32_16x16x32_bf16 v[78:81], a[180:183], v[54:57], v[78:81]
  ds_read_b128 v[50:53], v12 offset:512
  ds_read_b128 v[54:57], v12 offset:20992
  s_waitcnt lgkmcnt(4)
  v_mfma_f32_16x16x32_bf16 v[58:61], a[24:27], v[34:37], v[58:61]
  v_mfma_f32_16x16x32_bf16 v[62:65], a[24:27], v[38:41], v[62:65]
  v_mfma_f32_16x16x32_bf16 v[66:69], a[104:107], v[34:37], v[66:69]
  v_mfma_f32_16x16x32_bf16 v[70:73], a[104:107], v[38:41], v[70:73]
  v_mfma_f32_16x16x32_bf16 v[74:77], a[184:187], v[34:37], v[74:77]
  v_mfma_f32_16x16x32_bf16 v[78:81], a[184:187], v[38:41], v[78:81]
  ds_read_b128 v[34:37], v13 offset:512
  ds_read_b128 v[38:41], v13 offset:20992
  s_waitcnt lgkmcnt(4)
  v_mfma_f32_16x16x32_bf16 v[58:61], a[28:31], v[42:45], v[58:61]
  v_mfma_f32_16x16x32_bf16 v[62:65], a[28:31], v[46:49], v[62:65]
  v_mfma_f32_16x16x32_bf16 v[66:69], a[108:111], v[42:45], v[66:69]
  v_mfma_f32_16x16x32_bf16 v[70:73], a[108:111], v[46:49], v[70:73]
  v_mfma_f32_16x16x32_bf16 v[74:77], a[188:191], v[42:45], v[74:77]
  v_mfma_f32_16x16x32_bf16 v[78:81], a[188:191], v[46:49], v[78:81]
  ds_read_b128 v[42:45], v14 offset:512
  ds_read_b128 v[46:49], v14 offset:20992
  s_waitcnt lgkmcnt(4)
  v_mfma_f32_16x16x32_bf16 v[58:61], a[32:35], v[50:53], v[58:61]
  v_mfma_f32_16x16x32_bf16 v[62:65], a[32:35], v[54:57], v[62:65]
  v_mfma_f32_16x16x32_bf16 v[66:69], a[112:115], v[50:53], v[66:69]
  v_mfma_f32_16x16x32_bf16 v[70:73], a[112:115], v[54:57], v[70:73]
  v_mfma_f32_16x16x32_bf16 v[74:77], a[192:195], v[50:53], v[74:77]
  v_mfma_f32_16x16x32_bf16 v[78:81], a[192:195], v[54:57], v[78:81]
  ds_read_b128 v[50:53], v15 offset:512
  ds_read_b128 v[54:57], v15 offset:20992
  s_waitcnt lgkmcnt(4)
  v_mfma_f32_16x16x32_bf16 v[58:61], a[36:39], v[34:37], v[58:61]
  v_mfma_f32_16x16x32_bf16 v[62:65], a[36:39], v[38:41], v[62:65]
  v_mfma_f32_16x16x32_bf16 v[66:69], a[116:119], v[34:37], v[66:69]
  v_mfma_f32_16x16x32_bf16 v[70:73], a[116:119], v[38:41], v[70:73]
  v_mfma_f32_16x16x32_bf16 v[74:77], a[196:199], v[34:37], v[74:77]
  v_mfma_f32_16x16x32_bf16 v[78:81], a[196:199], v[38:41], v[78:81]
  ds_read_b128 v[34:37], v12 offset:768
  ds_read_b128 v[38:41], v12 offset:21248
  s_waitcnt lgkmcnt(4)
  v_mfma_f32_16x16x32_bf16 v[58:61], a[40:43], v[42:45], v[58:61]
  v_mfma_f32_16x16x32_bf16 v[62:65], a[40:43], v[46:49], v[62:65]
  v_mfma_f32_16x16x32_bf16 v[66:69], a[120:123], v[42:45], v[66:69]
  v_mfma_f32_16x16x32_bf16 v[70:73], a[120:123], v[46:49], v[70:73]
  v_mfma_f32_16x16x32_bf16 v[74:77], a[200:203], v[42:45], v[74:77]
  v_mfma_f32_16x16x32_bf16 v[78:81], a[200:203], v[46:49], v[78:81]
  ds_read_b128 v[42:45], v13 offset:768
  ds_read_b128 v[46:49], v13 offset:21248
  s_waitcnt lgkmcnt(4)
  v_mfma_f32_16x16x32_bf16 v[58:61], a[44:47], v[50:53], v[58:61]
  v_mfma_f32_16x16x32_bf16 v[62:65], a[44:47], v[54:57], v[62:65]
  v_mfma_f32_16x16x32_bf16 v[66:69], a[124:127], v[50:53], v[66:69]
  v_mfma_f32_16x16x32_bf16 v[70:73], a[124:127], v[54:57], v[70:73]
  v_mfma_f32_16x16x32_bf16 v[74:77], a[204:207], v[50:53], v[74:77]
  v_mfma_f32_16x16x32_bf16 v[78:81], a[204:207], v[54:57], v[78:81]
  ds_read_b128 v[50:53], v14 offset:768
  ds_read_b128 v[54:57], v14 offset:21248
  s_waitcnt lgkmcnt(4)
  v_mfma_f32_16x16x32_bf16 v[58:61], a[48:51], v[34:37], v[58:61]
  v_mfma_f32_16x16x32_bf16 v[62:65], a[48:51], v[38:41], v[62:65]
  v_mfma_f32_16x16x32_bf16 v[66:69], a[128:131], v[34:37], v[66:69]
  v_mfma_f32_16x16x32_bf16 v[70:73], a[128:131], v[38:41], v[70:73]
  v_mfma_f32_16x16x32_bf16 v[74:77], a[208:211], v[34:37], v[74:77]
  v_mfma_f32_16x16x32_bf16 v[78:81], a[208:211], v[38:41], v[78:81]
  ds_read_b128 v[34:37], v15 offset:768
  ds_read_b128 v[38:41], v15 offset:21248
  s_waitcnt lgkmcnt(4)
  v_mfma_f32_16x16x32_bf16 v[58:61], a[52:55], v[42:45], v[58:61]
  v_mfma_f32_16x16x32_bf16 v[62:65], a[52:55], v[46:49], v[62:65]
  v_mfma_f32_16x16x32_bf16 v[66:69], a[132:135], v[42:45], v[66:69]
  v_mfma_f32_16x16x32_bf16 v[70:73], a[132:135], v[46:49], v[70:73]
  v_mfma_f32_16x16x32_bf16 v[74:77], a[212:215], v[42:45], v[74:77]
  v_mfma_f32_16x16x32_bf16 v[78:81], a[212:215], v[46:49], v[78:81]
  ds_read_b128 v[42:45], v12 offset:1024
  ds_read_b128 v[46:49], v12 offset:21504
  s_waitcnt lgkmcnt(4)
  v_mfma_f32_16x16x32_bf16 v[58:61], a[56:59], v[50:53], v[58:61]
  v_mfma_f32_16x16x32_bf16 v[62:65], a[56:59], v[54:57], v[62:65]
  v_mfma_f32_16x16x32_bf16 v[66:69], a[136:139], v[50:53], v[66:69]
  v_mfma_f32_16x16x32_bf16 v[70:73], a[136:139], v[54:57], v[70:73]
  v_mfma_f32_16x16x32_bf16 v[74:77], a[216:219], v[50:53], v[74:77]
  v_mfma_f32_16x16x32_bf16 v[78:81], a[216:219], v[54:57], v[78:81]
  ds_read_b128 v[50:53], v13 offset:1024
  ds_read_b128 v[54:57], v13 offset:21504
  s_waitcnt lgkmcnt(4)
  v_mfma_f32_16x16x32_bf16 v[58:61], a[60:63], v[34:37], v[58:61]
  v_mfma_f32_16x16x32_bf16 v[62:65], a[60:63], v[38:41], v[62:65]
  v_mfma_f32_16x16x32_bf16 v[66:69], a[140:143], v[34:37], v[66:69]
  v_mfma_f32_16x16x32_bf16 v[70:73], a[140:143], v[38:41], v[70:73]
  v_mfma_f32_16x16x32_bf16 v[74:77], a[220:223], v[34:37], v[74:77]
  v_mfma_f32_16x16x32_bf16 v[78:81], a[220:223], v[38:41], v[78:81]
  ds_read_b128 v[34:37], v14 offset:1024
  ds_read_b128 v[38:41], v14 offset:21504
  s_waitcnt lgkmcnt(4)
  v_mfma_f32_16x16x32_bf16 v[58:61], a[64:67], v[42:45], v[58:61]
  v_mfma_f32_16x16x32_bf16 v[62:65], a[64:67], v[46:49], v[62:65]
  v_mfma_f32_16x16x32_bf16 v[66:69], a[144:147], v[42:45], v[66:69]
  v_mfma_f32_16x16x32_bf16 v[70:73], a[144:147], v[46:49], v[70:73]
  v_mfma_f32_16x16x32_bf16 v[74:77], a[224:227], v[42:45], v[74:77]
  v_mfma_f32_16x16x32_bf16 v[78:81], a[224:227], v[46:49], v[78:81]
  ds_read_b128 v[42:45], v15 offset:1024
  ds_read_b128 v[46:49], v15 offset:21504
  s_waitcnt lgkmcnt(4)
  v_mfma_f32_16x16x32_bf16 v[58:61], a[68:71], v[50:53], v[58:61]
  v_mfma_f32_16x16x32_bf16 v[62:65], a[68:71], v[54:57], v[62:65]
  v_mfma_f32_16x16x32_bf16 v[66:69], a[148:151], v[50:53], v[66:69]
  v_mfma_f32_16x16x32_bf16 v[70:73], a[148:151], v[54:57], v[70:73]
  v_mfma_f32_16x16x32_bf16 v[74:77], a[228:231], v[50:53], v[74:77]
  v_mfma_f32_16x16x32_bf16 v[78:81], a[228:231], v[54:57], v[78:81]
  s_waitcnt lgkmcnt(2)
  v_mfma_f32_16x16x32_bf16 v[58:61], a[72:75], v[34:37], v[58:61]
  v_mfma_f32_16x16x32_bf16 v[62:65], a[72:75], v[38:41], v[62:65]
  v_mfma_f32_16x16x32_bf16 v[66:69], a[152:155], v[34:37], v[66:69]
  v_mfma_f32_16x16x32_bf16 v[70:73], a[152:155], v[38:41], v[70:73]
  v_mfma_f32_16x16x32_bf16 v[74:77], a[232:235], v[34:37], v[74:77]
  v_mfma_f32_16x16x32_bf16 v[78:81], a[232:235], v[38:41], v[78:81]
  s_waitcnt lgkmcnt(0)
  v_mfma_f32_16x16x32_bf16 v[58:61], a[76:79], v[42:45], v[58:61]
  v_mfma_f32_16x16x32_bf16 v[62:65], a[76:79], v[46:49], v[62:65]
  v_mfma_f32_16x16x32_bf16 v[66:69], a[156:159], v[42:45], v[66:69]
  v_mfma_f32_16x16x32_bf16 v[70:73], a[156:159], v[46:49], v[70:73]
  v_mfma_f32_16x16x32_bf16 v[74:77], a[236:239], v[42:45], v[74:77]
  v_mfma_f32_16x16x32_bf16 v[78:81], a[236:239], v[46:49], v[78:81]
  s_add_u32 s30, s30, 40960
  s_add_u32 s29, s29, 1
  s_waitcnt vmcnt(0)
  s_branch L_k_odd
  s_waitcnt vmcnt(0)
L_k_loop:
  s_waitcnt vmcnt(6)
  s_barrier
  ds_read_b128 v[34:37], v12 offset:0
  ds_read_b128 v[38:41], v12 offset:20480
  ds_read_b128 v[42:45], v13 offset:0
  ds_read_b128 v[46:49], v13 offset:20480
  s_mul_i32 s36, s29, 0x5556
  s_lshr_b32 s36, s36, 16
  s_mul_i32 s37, s36, 3
  s_sub_u32 s37, s29, s37
  s_mul_i32 s37, s37, 655360
  s_lshl_b32 s34, s36, 21
  s_add_u32 s34, s34, s37
  s_xor_b32 s36, s36, s14
  s_and_b32 s36, s36, 1
  s_lshl_b32 s36, s36, 13
  s_add_u32 s34, s34, s36
  s_add_u32 s34, s34, 83886080
  ds_read_b128 v[50:53], v14 offset:0
  ds_read_b128 v[54:57], v14 offset:20480
  s_waitcnt lgkmcnt(4)
  v_mfma_f32_16x16x32_bf16 v[58:61], a[0:3], v[34:37], 0
  v_mfma_f32_16x16x32_bf16 v[62:65], a[0:3], v[38:41], 0
  s_add_u32 m0, s32, 0
  s_nop 0
  buffer_load_dwordx4 v2, s[20:23], s30 offen lds
  v_mfma_f32_16x16x32_bf16 v[66:69], a[80:83], v[34:37], 0
  v_mfma_f32_16x16x32_bf16 v[70:73], a[80:83], v[38:41], 0
  v_mfma_f32_16x16x32_bf16 v[74:77], a[160:163], v[34:37], 0
  v_mfma_f32_16x16x32_bf16 v[78:81], a[160:163], v[38:41], 0
  s_add_u32 m0, s32, 1024
  s_nop 0
  buffer_load_dwordx4 v3, s[20:23], s30 offen lds
  ds_read_b128 v[34:37], v15 offset:0
  ds_read_b128 v[38:41], v15 offset:20480
  s_waitcnt lgkmcnt(4)
  v_mfma_f32_16x16x32_bf16 v[58:61], a[4:7], v[42:45], v[58:61]
  v_mfma_f32_16x16x32_bf16 v[62:65], a[4:7], v[46:49], v[62:65]
  s_add_u32 m0, s32, 2048
  s_nop 0
  buffer_load_dwordx4 v4, s[20:23], s30 offen lds
  v_mfma_f32_16x16x32_bf16 v[66:69], a[84:87], v[42:45], v[66:69]
  v_mfma_f32_16x16x32_bf16 v[70:73], a[84:87], v[46:49], v[70:73]
  v_mfma_f32_16x16x32_bf16 v[74:77], a[164:167], v[42:45], v[74:77]
  v_mfma_f32_16x16x32_bf16 v[78:81], a[164:167], v[46:49], v[78:81]
  s_add_u32 m0, s32, 3072
  s_nop 0
  buffer_load_dwordx4 v5, s[20:23], s30 offen lds
  ds_read_b128 v[42:45], v12 offset:256
  ds_read_b128 v[46:49], v12 offset:20736
  s_waitcnt lgkmcnt(4)
  v_mfma_f32_16x16x32_bf16 v[58:61], a[8:11], v[50:53], v[58:61]
  v_mfma_f32_16x16x32_bf16 v[62:65], a[8:11], v[54:57], v[62:65]
  s_add_u32 m0, s32, 4096
  s_nop 0
  buffer_load_dwordx4 v6, s[20:23], s30 offen lds
  v_mfma_f32_16x16x32_bf16 v[66:69], a[88:91], v[50:53], v[66:69]
  v_mfma_f32_16x16x32_bf16 v[70:73], a[88:91], v[54:57], v[70:73]
  v_mfma_f32_16x16x32_bf16 v[74:77], a[168:171], v[50:53], v[74:77]
  v_mfma_f32_16x16x32_bf16 v[78:81], a[168:171], v[54:57], v[78:81]
  s_add_u32 m0, s32, 5120
  s_nop 0
  buffer_load_dwordx4 v7, s[20:23], s30 offen lds
  ds_read_b128 v[50:53], v13 offset:256
  ds_read_b128 v[54:57], v13 offset:20736
  s_waitcnt lgkmcnt(4)
  v_mfma_f32_16x16x32_bf16 v[58:61], a[12:15], v[34:37], v[58:61]
  v_mfma_f32_16x16x32_bf16 v[62:65], a[12:15], v[38:41], v[62:65]
  s_add_u32 m0, s32, 6144
  s_nop 0
  buffer_load_dwordx4 v8, s[20:23], s30 offen lds
  v_mfma_f32_16x16x32_bf16 v[66:69], a[92:95], v[34:37], v[66:69]
  v_mfma_f32_16x16x32_bf16 v[70:73], a[92:95], v[38:41], v[70:73]
  v_mfma_f32_16x16x32_bf16 v[74:77], a[172:175], v[34:37], v[74:77]
  v_mfma_f32_16x16x32_bf16 v[78:81], a[172:175], v[38:41], v[78:81]
  s_add_u32 m0, s32, 7168
  s_nop 0
  buffer_load_dwordx4 v9, s[20:23], s30 offen lds
  ds_read_b128 v[34:37], v14 offset:256
  ds_read_b128 v[38:41], v14 offset:20736
  s_waitcnt lgkmcnt(4)
  v_mfma_f32_16x16x32_bf16 v[58:61], a[16:19], v[42:45], v[58:61]
  v_mfma_f32_16x16x32_bf16 v[62:65], a[16:19], v[46:49], v[62:65]
  s_add_u32 m0, s32, 8192
  s_nop 0
  buffer_load_dwordx4 v10, s[20:23], s30 offen lds
  v_mfma_f32_16x16x32_bf16 v[66:69], a[96:99], v[42:45], v[66:69]
  v_mfma_f32_16x16x32_bf16 v[70:73], a[96:99], v[46:49], v[70:73]
  v_mfma_f32_16x16x32_bf16 v[74:77], a[176:179], v[42:45], v[74:77]
  v_mfma_f32_16x16x32_bf16 v[78:81], a[176:179], v[46:49], v[78:81]
  s_add_u32 m0, s32, 9216
  s_nop 0
  buffer_load_dwordx4 v11, s[20:23], s30 offen lds
  s_waitcnt vmcnt(10)
  s_sub_u32 s38, s29, 1
  v_mov_b32 v26, s38
  s_mov_b64 exec, 1
  buffer_store_dword v26, v24, s[4:7], s35 offen sc1
  s_mov_b64 exec, -1
  ds_read_b128 v[42:45], v15 offset:256
  ds_read_b128 v[46:49], v15 offset:20736
  s_waitcnt lgkmcnt(4)
  v_mfma_f32_16x16x32_bf16 v[58:61], a[20:23], v[50:53], v[58:61]
  v_mfma_f32_16x16x32_bf16 v[62:65], a[20:23], v[54:57], v[62:65]
  v_cvt_pk_bf16_f32 v106, v82, v83
  v_cvt_pk_bf16_f32 v107, v84, v85
  v_mfma_f32_16x16x32_bf16 v[66:69], a[100:103], v[50:53], v[66:69]
  v_mfma_f32_16x16x32_bf16 v[70:73], a[100:103], v[54:57], v[70:73]
  v_cvt_pk_bf16_f32 v108, v86, v87
  v_cvt_pk_bf16_f32 v109, v88, v89
  v_mfma_f32_16x16x32_bf16 v[74:77], a[180:183], v[50:53], v[74:77]
  v_mfma_f32_16x16x32_bf16 v[78:81], a[180:183], v[54:57], v[78:81]
  buffer_store_dwordx4 v[106:109], v16, s[4:7], s33 offen offset:0 sc1
  ds_read_b128 v[50:53], v12 offset:512
  ds_read_b128 v[54:57], v12 offset:20992
  s_waitcnt lgkmcnt(4)
  v_mfma_f32_16x16x32_bf16 v[58:61], a[24:27], v[34:37], v[58:61]
  v_mfma_f32_16x16x32_bf16 v[62:65], a[24:27], v[38:41], v[62:65]
  v_cvt_pk_bf16_f32 v110, v90, v91
  v_cvt_pk_bf16_f32 v111, v92, v93
  v_mfma_f32_16x16x32_bf16 v[66:69], a[104:107], v[34:37], v[66:69]
  v_mfma_f32_16x16x32_bf16 v[70:73], a[104:107], v[38:41], v[70:73]
  v_cvt_pk_bf16_f32 v112, v94, v95
  v_cvt_pk_bf16_f32 v113, v96, v97
  v_mfma_f32_16x16x32_bf16 v[74:77], a[184:187], v[34:37], v[74:77]
  v_mfma_f32_16x16x32_bf16 v[78:81], a[184:187], v[38:41], v[78:81]
  buffer_store_dwordx4 v[110:113], v16, s[4:7], s33 offen offset:1024 sc1
  ds_read_b128 v[34:37], v13 offset:512
  ds_read_b128 v[38:41], v13 offset:20992
  s_waitcnt lgkmcnt(4)
  v_mfma_f32_16x16x32_bf16 v[58:61], a[28:31], v[42:45], v[58:61]
  v_mfma_f32_16x16x32_bf16 v[62:65], a[28:31], v[46:49], v[62:65]
  v_cvt_pk_bf16_f32 v114, v98, v99
  v_cvt_pk_bf16_f32 v115, v100, v101
  v_mfma_f32_16x16x32_bf16 v[66:69], a[108:111], v[42:45], v[66:69]
  v_mfma_f32_16x16x32_bf16 v[70:73], a[108:111], v[46:49], v[70:73]
  v_cvt_pk_bf16_f32 v116, v102, v103
  v_cvt_pk_bf16_f32 v117, v104, v105
  v_mfma_f32_16x16x32_bf16 v[74:77], a[188:191], v[42:45], v[74:77]
  v_mfma_f32_16x16x32_bf16 v[78:81], a[188:191], v[46:49], v[78:81]
  buffer_store_dwordx4 v[114:117], v16, s[4:7], s33 offen offset:2048 sc1
  s_add_u32 s33, s33, 393216
  ds_read_b128 v[42:45], v14 offset:512
  ds_read_b128 v[46:49], v14 offset:20992
  s_waitcnt lgkmcnt(4)
  v_mfma_f32_16x16x32_bf16 v[58:61], a[32:35], v[50:53], v[58:61]
  v_mfma_f32_16x16x32_bf16 v[62:65], a[32:35], v[54:57], v[62:65]
  buffer_store_dwordx4 v[20:23], v17, s[4:7], s34 offen sc1
  v_mfma_f32_16x16x32_bf16 v[66:69], a[112:115], v[50:53], v[66:69]
  v_mfma_f32_16x16x32_bf16 v[70:73], a[112:115], v[54:57], v[70:73]
  buffer_store_dwordx4 v[20:23], v18, s[4:7], s34 offen sc1
  v_mfma_f32_16x16x32_bf16 v[74:77], a[192:195], v[50:53], v[74:77]
  v_mfma_f32_16x16x32_bf16 v[78:81], a[192:195], v[54:57], v[78:81]
  buffer_store_dwordx4 v[20:23], v19, s[4:7], s34 offen sc1
  ds_read_b128 v[50:53], v15 offset:512
  ds_read_b128 v[54:57], v15 offset:20992
  s_waitcnt lgkmcnt(4)
  v_mfma_f32_16x16x32_bf16 v[58:61], a[36:39], v[34:37], v[58:61]
  v_mfma_f32_16x16x32_bf16 v[62:65], a[36:39], v[38:41], v[62:65]
  v_mfma_f32_16x16x32_bf16 v[66:69], a[116:119], v[34:37], v[66:69]
  v_mfma_f32_16x16x32_bf16 v[70:73], a[116:119], v[38:41], v[70:73]
  v_mfma_f32_16x16x32_bf16 v[74:77], a[196:199], v[34:37], v[74:77]
  v_mfma_f32_16x16x32_bf16 v[78:81], a[196:199], v[38:41], v[78:81]
  ds_read_b128 v[34:37], v12 offset:768
  ds_read_b128 v[38:41], v12 offset:21248
  s_waitcnt lgkmcnt(4)
  v_mfma_f32_16x16x32_bf16 v[58:61], a[40:43], v[42:45], v[58:61]
  v_mfma_f32_16x16x32_bf16 v[62:65], a[40:43], v[46:49], v[62:65]
  v_mfma_f32_16x16x32_bf16 v[66:69], a[120:123], v[42:45], v[66:69]
  v_mfma_f32_16x16x32_bf16 v[70:73], a[120:123], v[46:49], v[70:73]
  v_mfma_f32_16x16x32_bf16 v[74:77], a[200:203], v[42:45], v[74:77]
  v_mfma_f32_16x16x32_bf16 v[78:81], a[200:203], v[46:49], v[78:81]
  ds_read_b128 v[42:45], v13 offset:768
  ds_read_b128 v[46:49], v13 offset:21248
  s_waitcnt lgkmcnt(4)
  v_mfma_f32_16x16x32_bf16 v[58:61], a[44:47], v[50:53], v[58:61]
  v_mfma_f32_16x16x32_bf16 v[62:65], a[44:47], v[54:57], v[62:65]
  v_mfma_f32_16x16x32_bf16 v[66:69], a[124:127], v[50:53], v[66:69]
  v_mfma_f32_16x16x32_bf16 v[70:73], a[124:127], v[54:57], v[70:73]
  v_mfma_f32_16x16x32_bf16 v[74:77], a[204:207], v[50:53], v[74:77]
  v_mfma_f32_16x16x32_bf16 v[78:81], a[204:207], v[54:57], v[78:81]
  ds_read_b128 v[50:53], v14 offset:768
  ds_read_b128 v[54:57], v14 offset:21248
  s_waitcnt lgkmcnt(4)
  v_mfma_f32_16x16x32_bf16 v[58:61], a[48:51], v[34:37], v[58:61]
  v_mfma_f32_16x16x32_bf16 v[62:65], a[48:51], v[38:41], v[62:65]
  v_mfma_f32_16x16x32_bf16 v[66:69], a[128:131], v[34:37], v[66:69]
  v_mfma_f32_16x16x32_bf16 v[70:73], a[128:131], v[38:41], v[70:73]
  v_mfma_f32_16x16x32_bf16 v[74:77], a[208:211], v[34:37], v[74:77]
  v_mfma_f32_16x16x32_bf16 v[78:81], a[208:211], v[38:41], v[78:81]
  ds_read_b128 v[34:37], v15 offset:768
  ds_read_b128 v[38:41], v15 offset:21248
  s_waitcnt lgkmcnt(4)
  v_mfma_f32_16x16x32_bf16 v[58:61], a[52:55], v[42:45], v[58:61]
  v_mfma_f32_16x16x32_bf16 v[62:65], a[52:55], v[46:49], v[62:65]
  v_mfma_f32_16x16x32_bf16 v[66:69], a[132:135], v[42:45], v[66:69]
  v_mfma_f32_16x16x32_bf16 v[70:73], a[132:135], v[46:49], v[70:73]
  v_mfma_f32_16x16x32_bf16 v[74:77], a[212:215], v[42:45], v[74:77]
  v_mfma_f32_16x16x32_bf16 v[78:81], a[212:215], v[46:49], v[78:81]
  ds_read_b128 v[42:45], v12 offset:1024
  ds_read_b128 v[46:49], v12 offset:21504
  s_waitcnt lgkmcnt(4)
  v_mfma_f32_16x16x32_bf16 v[58:61], a[56:59], v[50:53], v[58:61]
  v_mfma_f32_16x16x32_bf16 v[62:65], a[56:59], v[54:57], v[62:65]
  v_mfma_f32_16x16x32_bf16 v[66:69], a[136:139], v[50:53], v[66:69]
  v_mfma_f32_16x16x32_bf16 v[70:73], a[136:139], v[54:57], v[70:73]
  v_mfma_f32_16x16x32_bf16 v[74:77], a[216:219], v[50:53], v[74:77]
  v_mfma_f32_16x16x32_bf16 v[78:81], a[216:219], v[54:57], v[78:81]
  ds_read_b128 v[50:53], v13 offset:1024
  ds_read_b128 v[54:57], v13 offset:21504
  s_waitcnt lgkmcnt(4)
  v_mfma_f32_16x16x32_bf16 v[58:61], a[60:63], v[34:37], v[58:61]
  v_mfma_f32_16x16x32_bf16 v[62:65], a[60:63], v[38:41], v[62:65]
  v_mfma_f32_16x16x32_bf16 v[66:69], a[140:143], v[34:37], v[66:69]
  v_mfma_f32_16x16x32_bf16 v[70:73], a[140:143], v[38:41], v[70:73]
  v_mfma_f32_16x16x32_bf16 v[74:77], a[220:223], v[34:37], v[74:77]
  v_mfma_f32_16x16x32_bf16 v[78:81], a[220:223], v[38:41], v[78:81]
  ds_read_b128 v[34:37], v14 offset:1024
  ds_read_b128 v[38:41], v14 offset:21504
  s_waitcnt lgkmcnt(4)
  v_mfma_f32_16x16x32_bf16 v[58:61], a[64:67], v[42:45], v[58:61]
  v_mfma_f32_16x16x32_bf16 v[62:65], a[64:67], v[46:49], v[62:65]
  v_mfma_f32_16x16x32_bf16 v[66:69], a[144:147], v[42:45], v[66:69]
  v_mfma_f32_16x16x32_bf16 v[70:73], a[144:147], v[46:49], v[70:73]
  v_mfma_f32_16x16x32_bf16 v[74:77], a[224:227], v[42:45], v[74:77]
  v_mfma_f32_16x16x32_bf16 v[78:81], a[224:227], v[46:49], v[78:81]
  ds_read_b128 v[42:45], v15 offset:1024
  ds_read_b128 v[46:49], v15 offset:21504
  s_waitcnt lgkmcnt(4)
  v_mfma_f32_16x16x32_bf16 v[58:61], a[68:71], v[50:53], v[58:61]
  v_mfma_f32_16x16x32_bf16 v[62:65], a[68:71], v[54:57], v[62:65]
  v_mfma_f32_16x16x32_bf16 v[66:69], a[148:151], v[50:53], v[66:69]
  v_mfma_f32_16x16x32_bf16 v[70:73], a[148:151], v[54:57], v[70:73]
  v_mfma_f32_16x16x32_bf16 v[74:77], a[228:231], v[50:53], v[74:77]
  v_mfma_f32_16x16x32_bf16 v[78:81], a[228:231], v[54:57], v[78:81]
  s_waitcnt lgkmcnt(2)
  v_mfma_f32_16x16x32_bf16 v[58:61], a[72:75], v[34:37], v[58:61]
  v_mfma_f32_16x16x32_bf16 v[62:65], a[72:75], v[38:41], v[62:65]
  v_mfma_f32_16x16x32_bf16 v[66:69], a[152:155], v[34:37], v[66:69]
  v_mfma_f32_16x16x32_bf16 v[70:73], a[152:155], v[38:41], v[70:73]
  v_mfma_f32_16x16x32_bf16 v[74:77], a[232:235], v[34:37], v[74:77]
  v_mfma_f32_16x16x32_bf16 v[78:81], a[232:235], v[38:41], v[78:81]
  s_waitcnt lgkmcnt(0)
  v_mfma_f32_16x16x32_bf16 v[58:61], a[76:79], v[42:45], v[58:61]
  v_mfma_f32_16x16x32_bf16 v[62:65], a[76:79], v[46:49], v[62:65]
  v_mfma_f32_16x16x32_bf16 v[66:69], a[156:159], v[42:45], v[66:69]
  v_mfma_f32_16x16x32_bf16 v[70:73], a[156:159], v[46:49], v[70:73]
  v_mfma_f32_16x16x32_bf16 v[74:77], a[236:239], v[42:45], v[74:77]
  v_mfma_f32_16x16x32_bf16 v[78:81], a[236:239], v[46:49], v[78:81]
  s_add_u32 s30, s30, 40960
  s_add_u32 s29, s29, 1
L_k_odd:
  s_waitcnt vmcnt(6)
  s_barrier
  ds_read_b128 v[34:37], v12 offset:40960
  ds_read_b128 v[38:41], v12 offset:61440
  ds_read_b128 v[42:45], v13 offset:40960
  ds_read_b128 v[46:49], v13 offset:61440
  s_mul_i32 s36, s29, 0x5556
  s_lshr_b32 s36, s36, 16
  s_mul_i32 s37, s36, 3
  s_sub_u32 s37, s29, s37
  s_mul_i32 s37, s37, 655360
  s_lshl_b32 s34, s36, 21
  s_add_u32 s34, s34, s37
  s_xor_b32 s36, s36, s14
  s_and_b32 s36, s36, 1
  s_lshl_b32 s36, s36, 13
  s_add_u32 s34, s34, s36
  s_add_u32 s34, s34, 83886080
  ds_read_b128 v[50:53], v14 offset:40960
  ds_read_b128 v[54:57], v14 offset:61440
  s_waitcnt lgkmcnt(4)
  v_mfma_f32_16x16x32_bf16 v[82:85], a[0:3], v[34:37], 0
  v_mfma_f32_16x16x32_bf16 v[86:89], a[0:3], v[38:41], 0
  s_add_u32 m0, s31, 0
  s_nop 0
  buffer_load_dwordx4 v2, s[20:23], s30 offen lds
  v_mfma_f32_16x16x32_bf16 v[90:93], a[80:83], v[34:37], 0
  v_mfma_f32_16x16x32_bf16 v[94:97], a[80:83], v[38:41], 0
  v_mfma_f32_16x16x32_bf16 v[98:101], a[160:163], v[34:37], 0
  v_mfma_f32_16x16x32_bf16 v[102:105], a[160:163], v[38:41], 0
  s_add_u32 m0, s31, 1024
  s_nop 0
  buffer_load_dwordx4 v3, s[20:23], s30 offen lds
  ds_read_b128 v[34:37], v15 offset:40960
  ds_read_b128 v[38:41], v15 offset:61440
  s_waitcnt lgkmcnt(4)
  v_mfma_f32_16x16x32_bf16 v[82:85], a[4:7], v[42:45], v[82:85]
  v_mfma_f32_16x16x32_bf16 v[86:89], a[4:7], v[46:49], v[86:89]
  s_add_u32 m0, s31, 2048
  s_nop 0
  buffer_load_dwordx4 v4, s[20:23], s30 offen lds
  v_mfma_f32_16x16x32_bf16 v[90:93], a[84:87], v[42:45], v[90:93]
  v_mfma_f32_16x16x32_bf16 v[94:97], a[84:87], v[46:49], v[94:97]
  v_mfma_f32_16x16x32_bf16 v[98:101], a[164:167], v[42:45], v[98:101]
  v_mfma_f32_16x16x32_bf16 v[102:105], a[164:167], v[46:49], v[102:105]
  s_add_u32 m0, s31, 3072
  s_nop 0
  buffer_load_dwordx4 v5, s[20:23], s30 offen lds
  ds_read_b128 v[42:45], v12 offset:41216
  ds_read_b128 v[46:49], v12 offset:61696
  s_waitcnt lgkmcnt(4)
  v_mfma_f32_16x16x32_bf16 v[82:85], a[8:11], v[50:53], v[82:85]
  v_mfma_f32_16x16x32_bf16 v[86:89], a[8:11], v[54:57], v[86:89]
  s_add_u32 m0, s31, 4096
  s_nop 0
  buffer_load_dwordx4 v6, s[20:23], s30 offen lds
  v_mfma_f32_16x16x32_bf16 v[90:93], a[88:91], v[50:53], v[90:93]
  v_mfma_f32_16x16x32_bf16 v[94:97], a[88:91], v[54:57], v[94:97]
  v_mfma_f32_16x16x32_bf16 v[98:101], a[168:171], v[50:53], v[98:101]
  v_mfma_f32_16x16x32_bf16 v[102:105], a[168:171], v[54:57], v[102:105]
  s_add_u32 m0, s31, 5120
  s_nop 0
  buffer_load_dwordx4 v7, s[20:23], s30 offen lds
  ds_read_b128 v[50:53], v13 offset:41216
  ds_read_b128 v[54:57], v13 offset:61696
  s_waitcnt lgkmcnt(4)
  v_mfma_f32_16x16x32_bf16 v[82:85], a[12:15], v[34:37], v[82:85]
  v_mfma_f32_16x16x32_bf16 v[86:89], a[12:15], v[38:41], v[86:89]
  s_add_u32 m0, s31, 6144
  s_nop 0
  buffer_load_dwordx4 v8, s[20:23], s30 offen lds
  v_mfma_f32_16x16x32_bf16 v[90:93], a[92:95], v[34:37], v[90:93]
  v_mfma_f32_16x16x32_bf16 v[94:97], a[92:95], v[38:41], v[94:97]
  v_mfma_f32_16x16x32_bf16 v[98:101], a[172:175], v[34:37], v[98:101]
  v_mfma_f32_16x16x32_bf16 v[102:105], a[172:175], v[38:41], v[102:105]
  s_add_u32 m0, s31, 7168
  s_nop 0
  buffer_load_dwordx4 v9, s[20:23], s30 offen lds
  ds_read_b128 v[34:37], v14 offset:41216
  ds_read_b128 v[38:41], v14 offset:61696
  s_waitcnt lgkmcnt(4)
  v_mfma_f32_16x16x32_bf16 v[82:85], a[16:19], v[42:45], v[82:85]
  v_mfma_f32_16x16x32_bf16 v[86:89], a[16:19], v[46:49], v[86:89]
  s_add_u32 m0, s31, 8192
  s_nop 0
  buffer_load_dwordx4 v10, s[20:23], s30 offen lds
  v_mfma_f32_16x16x32_bf16 v[90:93], a[96:99], v[42:45], v[90:93]
  v_mfma_f32_16x16x32_bf16 v[94:97], a[96:99], v[46:49], v[94:97]
  v_mfma_f32_16x16x32_bf16 v[98:101], a[176:179], v[42:45], v[98:101]
  v_mfma_f32_16x16x32_bf16 v[102:105], a[176:179], v[46:49], v[102:105]
  s_add_u32 m0, s31, 9216
  s_nop 0
  buffer_load_dwordx4 v11, s[20:23], s30 offen lds
  s_waitcnt vmcnt(10)
  s_sub_u32 s38, s29, 1
  v_mov_b32 v26, s38
  s_mov_b64 exec, 1
  buffer_store_dword v26, v24, s[4:7], s35 offen sc1
  s_mov_b64 exec, -1
  ds_read_b128 v[42:45], v15 offset:41216
  ds_read_b128 v[46:49], v15 offset:61696
  s_waitcnt lgkmcnt(4)
  v_mfma_f32_16x16x32_bf16 v[82:85], a[20:23], v[50:53], v[82:85]
  v_mfma_f32_16x16x32_bf16 v[86:89], a[20:23], v[54:57], v[86:89]
  v_cvt_pk_bf16_f32 v106, v58, v59
  v_cvt_pk_bf16_f32 v107, v60, v61
  v_mfma_f32_16x16x32_bf16 v[90:93], a[100:103], v[50:53], v[90:93]
  v_mfma_f32_16x16x32_bf16 v[94:97], a[100:103], v[54:57], v[94:97]
  v_cvt_pk_bf16_f32 v108, v62, v63
  v_cvt_pk_bf16_f32 v109, v64, v65
  v_mfma_f32_16x16x32_bf16 v[98:101], a[180:183], v[50:53], v[98:101]
  v_mfma_f32_16x16x32_bf16 v[102:105], a[180:183], v[54:57], v[102:105]
  buffer_store_dwordx4 v[106:109], v16, s[4:7], s33 offen offset:0 sc1
  ds_read_b128 v[50:53], v12 offset:41472
  ds_read_b128 v[54:57], v12 offset:61952
  s_waitcnt lgkmcnt(4)
  v_mfma_f32_16x16x32_bf16 v[82:85], a[24:27], v[34:37], v[82:85]
  v_mfma_f32_16x16x32_bf16 v[86:89], a[24:27], v[38:41], v[86:89]
  v_cvt_pk_bf16_f32 v110, v66, v67
  v_cvt_pk_bf16_f32 v111, v68, v69
  v_mfma_f32_16x16x32_bf16 v[90:93], a[104:107], v[34:37], v[90:93]
  v_mfma_f32_16x16x32_bf16 v[94:97], a[104:107], v[38:41], v[94:97]
  v_cvt_pk_bf16_f32 v112, v70, v71
  v_cvt_pk_bf16_f32 v113, v72, v73
  v_mfma_f32_16x16x32_bf16 v[98:101], a[184:187], v[34:37], v[98:101]
  v_mfma_f32_16x16x32_bf16 v[102:105], a[184:187], v[38:41], v[102:105]
  buffer_store_dwordx4 v[110:113], v16, s[4:7], s33 offen offset:1024 sc1
  ds_read_b128 v[34:37], v13 offset:41472
  ds_read_b128 v[38:41], v13 offset:61952
  s_waitcnt lgkmcnt(4)
  v_mfma_f32_16x16x32_bf16 v[82:85], a[28:31], v[42:45], v[82:85]
  v_mfma_f32_16x16x32_bf16 v[86:89], a[28:31], v[46:49], v[86:89]
  v_cvt_pk_bf16_f32 v114, v74, v75
  v_cvt_pk_bf16_f32 v115, v76, v77
  v_mfma_f32_16x16x32_bf16 v[90:93], a[108:111], v[42:45], v[90:93]
  v_mfma_f32_16x16x32_bf16 v[94:97], a[108:111], v[46:49], v[94:97]
  v_cvt_pk_bf16_f32 v116, v78, v79
  v_cvt_pk_bf16_f32 v117, v80, v81
  v_mfma_f32_16x16x32_bf16 v[98:101], a[188:191], v[42:45], v[98:101]
  v_mfma_f32_16x16x32_bf16 v[102:105], a[188:191], v[46:49], v[102:105]
  buffer_store_dwordx4 v[114:117], v16, s[4:7], s33 offen offset:2048 sc1
  s_add_u32 s33, s33, 393216
  ds_read_b128 v[42:45], v14 offset:41472
  ds_read_b128 v[46:49], v14 offset:61952
  s_waitcnt lgkmcnt(4)
  v_mfma_f32_16x16x32_bf16 v[82:85], a[32:35], v[50:53], v[82:85]
  v_mfma_f32_16x16x32_bf16 v[86:89], a[32:35], v[54:57], v[86:89]
  buffer_store_dwordx4 v[20:23], v17, s[4:7], s34 offen sc1
  v_mfma_f32_16x16x32_bf16 v[90:93], a[112:115], v[50:53], v[90:93]
  v_mfma_f32_16x16x32_bf16 v[94:97], a[112:115], v[54:57], v[94:97]
  buffer_store_dwordx4 v[20:23], v18, s[4:7], s34 offen sc1
  v_mfma_f32_16x16x32_bf16 v[98:101], a[192:195], v[50:53], v[98:101]
  v_mfma_f32_16x16x32_bf16 v[102:105], a[192:195], v[54:57], v[102:105]
  buffer_store_dwordx4 v[20:23], v19, s[4:7], s34 offen sc1
  ds_read_b128 v[50:53], v15 offset:41472
  ds_read_b128 v[54:57], v15 offset:61952
  s_waitcnt lgkmcnt(4)
  v_mfma_f32_16x16x32_bf16 v[82:85], a[36:39], v[34:37], v[82:85]
  v_mfma_f32_16x16x32_bf16 v[86:89], a[36:39], v[38:41], v[86:89]
  v_mfma_f32_16x16x32_bf16 v[90:93], a[116:119], v[34:37], v[90:93]
  v_mfma_f32_16x16x32_bf16 v[94:97], a[116:119], v[38:41], v[94:97]
  v_mfma_f32_16x16x32_bf16 v[98:101], a[196:199], v[34:37], v[98:101]
  v_mfma_f32_16x16x32_bf16 v[102:105], a[196:199], v[38:41], v[102:105]
  ds_read_b128 v[34:37], v12 offset:41728
  ds_read_b128 v[38:41], v12 offset:62208
  s_waitcnt lgkmcnt(4)
  v_mfma_f32_16x16x32_bf16 v[82:85], a[40:43], v[42:45], v[82:85]
  v_mfma_f32_16x16x32_bf16 v[86:89], a[40:43], v[46:49], v[86:89]
  v_mfma_f32_16x16x32_bf16 v[90:93], a[120:123], v[42:45], v[90:93]
  v_mfma_f32_16x16x32_bf16 v[94:97], a[120:123], v[46:49], v[94:97]
  v_mfma_f32_16x16x32_bf16 v[98:101], a[200:203], v[42:45], v[98:101]
  v_mfma_f32_16x16x32_bf16 v[102:105], a[200:203], v[46:49], v[102:105]
  ds_read_b128 v[42:45], v13 offset:41728
  ds_read_b128 v[46:49], v13 offset:62208
  s_waitcnt lgkmcnt(4)
  v_mfma_f32_16x16x32_bf16 v[82:85], a[44:47], v[50:53], v[82:85]
  v_mfma_f32_16x16x32_bf16 v[86:89], a[44:47], v[54:57], v[86:89]
  v_mfma_f32_16x16x32_bf16 v[90:93], a[124:127], v[50:53], v[90:93]
  v_mfma_f32_16x16x32_bf16 v[94:97], a[124:127], v[54:57], v[94:97]
  v_mfma_f32_16x16x32_bf16 v[98:101], a[204:207], v[50:53], v[98:101]
  v_mfma_f32_16x16x32_bf16 v[102:105], a[204:207], v[54:57], v[102:105]
  ds_read_b128 v[50:53], v14 offset:41728
  ds_read_b128 v[54:57], v14 offset:62208
  s_waitcnt lgkmcnt(4)
  v_mfma_f32_16x16x32_bf16 v[82:85], a[48:51], v[34:37], v[82:85]
  v_mfma_f32_16x16x32_bf16 v[86:89], a[48:51], v[38:41], v[86:89]
  v_mfma_f32_16x16x32_bf16 v[90:93], a[128:131], v[34:37], v[90:93]
  v_mfma_f32_16x16x32_bf16 v[94:97], a[128:131], v[38:41], v[94:97]
  v_mfma_f32_16x16x32_bf16 v[98:101], a[208:211], v[34:37], v[98:101]
  v_mfma_f32_16x16x32_bf16 v[102:105], a[208:211], v[38:41], v[102:105]
  ds_read_b128 v[34:37], v15 offset:41728
  ds_read_b128 v[38:41], v15 offset:62208
  s_waitcnt lgkmcnt(4)
  v_mfma_f32_16x16x32_bf16 v[82:85], a[52:55], v[42:45], v[82:85]
  v_mfma_f32_16x16x32_bf16 v[86:89], a[52:55], v[46:49], v[86:89]
  v_mfma_f32_16x16x32_bf16 v[90:93], a[132:135], v[42:45], v[90:93]
  v_mfma_f32_16x16x32_bf16 v[94:97], a[132:135], v[46:49], v[94:97]
  v_mfma_f32_16x16x32_bf16 v[98:101], a[212:215], v[42:45], v[98:101]
  v_mfma_f32_16x16x32_bf16 v[102:105], a[212:215], v[46:49], v[102:105]
  ds_read_b128 v[42:45], v12 offset:41984
  ds_read_b128 v[46:49], v12 offset:62464
  s_waitcnt lgkmcnt(4)
  v_mfma_f32_16x16x32_bf16 v[82:85], a[56:59], v[50:53], v[82:85]
  v_mfma_f32_16x16x32_bf16 v[86:89], a[56:59], v[54:57], v[86:89]
  v_mfma_f32_16x16x32_bf16 v[90:93], a[136:139], v[50:53], v[90:93]
  v_mfma_f32_16x16x32_bf16 v[94:97], a[136:139], v[54:57], v[94:97]
  v_mfma_f32_16x16x32_bf16 v[98:101], a[216:219], v[50:53], v[98:101]
  v_mfma_f32_16x16x32_bf16 v[102:105], a[216:219], v[54:57], v[102:105]
  ds_read_b128 v[50:53], v13 offset:41984
  ds_read_b128 v[54:57], v13 offset:62464
  s_waitcnt lgkmcnt(4)
  v_mfma_f32_16x16x32_bf16 v[82:85], a[60:63], v[34:37], v[82:85]
  v_mfma_f32_16x16x32_bf16 v[86:89], a[60:63], v[38:41], v[86:89]
  v_mfma_f32_16x16x32_bf16 v[90:93], a[140:143], v[34:37], v[90:93]
  v_mfma_f32_16x16x32_bf16 v[94:97], a[140:143], v[38:41], v[94:97]
  v_mfma_f32_16x16x32_bf16 v[98:101], a[220:223], v[34:37], v[98:101]
  v_mfma_f32_16x16x32_bf16 v[102:105], a[220:223], v[38:41], v[102:105]
  ds_read_b128 v[34:37], v14 offset:41984
  ds_read_b128 v[38:41], v14 offset:62464
  s_waitcnt lgkmcnt(4)
  v_mfma_f32_16x16x32_bf16 v[82:85], a[64:67], v[42:45], v[82:85]
  v_mfma_f32_16x16x32_bf16 v[86:89], a[64:67], v[46:49], v[86:89]
  v_mfma_f32_16x16x32_bf16 v[90:93], a[144:147], v[42:45], v[90:93]
  v_mfma_f32_16x16x32_bf16 v[94:97], a[144:147], v[46:49], v[94:97]
  v_mfma_f32_16x16x32_bf16 v[98:101], a[224:227], v[42:45], v[98:101]
  v_mfma_f32_16x16x32_bf16 v[102:105], a[224:227], v[46:49], v[102:105]
  ds_read_b128 v[42:45], v15 offset:41984
  ds_read_b128 v[46:49], v15 offset:62464
  s_waitcnt lgkmcnt(4)
  v_mfma_f32_16x16x32_bf16 v[82:85], a[68:71], v[50:53], v[82:85]
  v_mfma_f32_16x16x32_bf16 v[86:89], a[68:71], v[54:57], v[86:89]
  v_mfma_f32_16x16x32_bf16 v[90:93], a[148:151], v[50:53], v[90:93]
  v_mfma_f32_16x16x32_bf16 v[94:97], a[148:151], v[54:57], v[94:97]
  v_mfma_f32_16x16x32_bf16 v[98:101], a[228:231], v[50:53], v[98:101]
  v_mfma_f32_16x16x32_bf16 v[102:105], a[228:231], v[54:57], v[102:105]
  s_waitcnt lgkmcnt(2)
  v_mfma_f32_16x16x32_bf16 v[82:85], a[72:75], v[34:37], v[82:85]
  v_mfma_f32_16x16x32_bf16 v[86:89], a[72:75], v[38:41], v[86:89]
  v_mfma_f32_16x16x32_bf16 v[90:93], a[152:155], v[34:37], v[90:93]
  v_mfma_f32_16x16x32_bf16 v[94:97], a[152:155], v[38:41], v[94:97]
  v_mfma_f32_16x16x32_bf16 v[98:101], a[232:235], v[34:37], v[98:101]
  v_mfma_f32_16x16x32_bf16 v[102:105], a[232:235], v[38:41], v[102:105]
  s_waitcnt lgkmcnt(0)
  v_mfma_f32_16x16x32_bf16 v[82:85], a[76:79], v[42:45], v[82:85]
  v_mfma_f32_16x16x32_bf16 v[86:89], a[76:79], v[46:49], v[86:89]
  v_mfma_f32_16x16x32_bf16 v[90:93], a[156:159], v[42:45], v[90:93]
  v_mfma_f32_16x16x32_bf16 v[94:97], a[156:159], v[46:49], v[94:97]
  v_mfma_f32_16x16x32_bf16 v[98:101], a[236:239], v[42:45], v[98:101]
  v_mfma_f32_16x16x32_bf16 v[102:105], a[236:239], v[46:49], v[102:105]
  s_add_u32 s30, s30, 40960
  s_add_u32 s29, s29, 1
  s_cmp_lt_u32 s29, 64
  s_cbranch_scc1 L_k_loop
  v_cvt_pk_bf16_f32 v106, v82, v83
  v_cvt_pk_bf16_f32 v107, v84, v85
  v_cvt_pk_bf16_f32 v108, v86, v87
  v_cvt_pk_bf16_f32 v109, v88, v89
  buffer_store_dwordx4 v[106:109], v16, s[4:7], s33 offen offset:0 sc1
  v_cvt_pk_bf16_f32 v110, v90, v91
  v_cvt_pk_bf16_f32 v111, v92, v93
  v_cvt_pk_bf16_f32 v112, v94, v95
  v_cvt_pk_bf16_f32 v113, v96, v97
  buffer_store_dwordx4 v[110:113], v16, s[4:7], s33 offen offset:1024 sc1
  v_cvt_pk_bf16_f32 v114, v98, v99
  v_cvt_pk_bf16_f32 v115, v100, v101
  v_cvt_pk_bf16_f32 v116, v102, v103
  v_cvt_pk_bf16_f32 v117, v104, v105
  buffer_store_dwordx4 v[114:117], v16, s[4:7], s33 offen offset:2048 sc1
  s_add_u32 s33, s33, 393216
  s_waitcnt vmcnt(0)
  v_mov_b32 v26, 64
  s_mov_b64 exec, 1
  buffer_store_dword v26, v24, s[4:7], s35 offen sc1
  s_mov_b64 exec, -1
  s_waitcnt vmcnt(0)
  s_branch L_post
L_role_v:
  s_add_u32 s13, s13, 32
  s_and_b32 s28, s13, 31
  s_load_dwordx2 s[24:25], s[0:1], 32
  s_load_dwordx2 s[26:27], s[0:1], 0
  s_waitcnt lgkmcnt(0)
  s_mov_b32 s16, s24
  s_mov_b32 s17, s25
  s_mov_b32 s18, 7864320
  s_mov_b32 s19, 0x20000
  s_mov_b32 s20, s26
  s_mov_b32 s21, s27
  s_mov_b32 s22, 2621440
  s_mov_b32 s23, 0x20000
  v_and_b32 v32, 63, v0
  v_add_u32 v32, 0, v32
  v_mul_u32_u24 v33, 2731, v32
  v_lshrrev_b32 v33, 16, v33
  v_mul_u32_u24 v26, 24, v33
  v_sub_u32 v32, v32, v26
  v_mul_u32_u24 v26, 12288, v33
  v_and_b32 v33, 2, v33
  s_and_b32 s36, s12, 1
  s_lshl_b32 s36, s36, 2
  v_or_b32 v33, s36, v33
  v_xor_b32 v32, v32, v33
  v_lshl_add_u32 v26, v32, 4, v26
  v_and_b32 v32, 63, v0
  v_add_u32 v32, 64, v32
  v_mul_u32_u24 v33, 2731, v32
  v_lshrrev_b32 v33, 16, v33
  v_mul_u32_u24 v27, 24, v33
  v_sub_u32 v32, v32, v27
  v_mul_u32_u24 v27, 12288, v33
  v_and_b32 v33, 2, v33
  s_and_b32 s36, s12, 1
  s_lshl_b32 s36, s36, 2
  v_or_b32 v33, s36, v33
  v_xor_b32 v32, v32, v33
  v_lshl_add_u32 v27, v32, 4, v27
  v_and_b32 v32, 63, v0
  v_add_u32 v32, 128, v32
  v_mul_u32_u24 v33, 2731, v32
  v_lshrrev_b32 v33, 16, v33
  v_mul_u32_u24 v28, 24, v33
  v_sub_u32 v32, v32, v28
  v_mul_u32_u24 v28, 12288, v33
  v_and_b32 v33, 2, v33
  s_and_b32 s36, s12, 1
  s_lshl_b32 s36, s36, 2
  v_or_b32 v33, s36, v33
  v_xor_b32 v32, v32, v33
  v_lshl_add_u32 v28, v32, 4, v28
  v_bfe_u32 v32, v0, 3, 1
  v_bfe_u32 v33, v0, 4, 1
  v_lshl_or_b32 v32, v33, 1, v32
  s_mul_i32 s36, s12, 3
  s_add_u32 s36, s36, 0
  v_xor_b32 v29, s36, v32
  v_lshlrev_b32 v29, 5, v29
  s_mul_i32 s36, s12, 3
  s_add_u32 s36, s36, 1
  v_xor_b32 v30, s36, v32
  v_lshlrev_b32 v30, 5, v30
  s_mul_i32 s36, s12, 3
  s_add_u32 s36, s36, 2
  v_xor_b32 v31, s36, v32
  v_lshlrev_b32 v31, 5, v31
  v_bfe_u32 v32, v0, 4, 2
  v_bfe_u32 v33, v0, 2, 2
  v_lshl_add_u32 v32, v32, 3, v33
  v_mul_u32_u24 v32, 384, v32
  v_and_b32 v33, 3, v0
  v_lshl_add_u32 v32, v33, 3, v32
  v_add3_u32 v29, v29, v32, 0
  v_add3_u32 v30, v30, v32, 0
  v_add3_u32 v31, v31, v32, 0
  s_mul_i32 s36, s12, 98304
  s_mul_i32 s37, s28, 384
  s_add_u32 s36, s36, s37
  s_add_u32 s36, s36, 0
  s_mul_i32 s37, s12, 3072
  s_add_u32 s37, s37, 0
  s_add_u32 m0, s37, 0
  s_nop 0
  buffer_load_dwordx4 v26, s[16:19], s36 offen lds
  s_add_u32 m0, s37, 1024
  s_nop 0
  buffer_load_dwordx4 v27, s[16:19], s36 offen lds
  s_add_u32 m0, s37, 2048
  s_nop 0
  buffer_load_dwordx4 v28, s[16:19], s36 offen lds
  s_add_u32 s36, s36, 393216
  s_add_u32 m0, s37, 12288
  s_nop 0
  buffer_load_dwordx4 v26, s[16:19], s36 offen lds
  s_add_u32 m0, s37, 13312
  s_nop 0
  buffer_load_dwordx4 v27, s[16:19], s36 offen lds
  s_add_u32 m0, s37, 14336
  s_nop 0
  buffer_load_dwordx4 v28, s[16:19], s36 offen lds
  s_add_u32 s36, s36, 393216
  s_add_u32 m0, s37, 24576
  s_nop 0
  buffer_load_dwordx4 v26, s[16:19], s36 offen lds
  s_add_u32 m0, s37, 25600
  s_nop 0
  buffer_load_dwordx4 v27, s[16:19], s36 offen lds
  s_add_u32 m0, s37, 26624
  s_nop 0
  buffer_load_dwordx4 v28, s[16:19], s36 offen lds
  s_add_u32 s36, s36, 393216
  s_add_u32 m0, s37, 36864
  s_nop 0
  buffer_load_dwordx4 v26, s[16:19], s36 offen lds
  s_add_u32 m0, s37, 37888
  s_nop 0
  buffer_load_dwordx4 v27, s[16:19], s36 offen lds
  s_add_u32 m0, s37, 38912
  s_nop 0
  buffer_load_dwordx4 v28, s[16:19], s36 offen lds
  s_add_u32 s36, s36, 393216
  s_add_u32 m0, s37, 49152
  s_nop 0
  buffer_load_dwordx4 v26, s[16:19], s36 offen lds
  s_add_u32 m0, s37, 50176
  s_nop 0
  buffer_load_dwordx4 v27, s[16:19], s36 offen lds
  s_add_u32 m0, s37, 51200
  s_nop 0
  buffer_load_dwordx4 v28, s[16:19], s36 offen lds
  s_mul_i32 s36, s12, 98304
  s_mul_i32 s37, s28, 384
  s_add_u32 s36, s36, s37
  s_add_u32 s36, s36, 1966080
  s_mul_i32 s37, s12, 3072
  s_add_u32 s37, s37, 61440
  s_add_u32 m0, s37, 0
  s_nop 0
  buffer_load_dwordx4 v26, s[16:19], s36 offen lds
  s_add_u32 m0, s37, 1024
  s_nop 0
  buffer_load_dwordx4 v27, s[16:19], s36 offen lds
  s_add_u32 m0, s37, 2048
  s_nop 0
  buffer_load_dwordx4 v28, s[16:19], s36 offen lds
  s_add_u32 s36, s36, 393216
  s_add_u32 m0, s37, 12288
  s_nop 0
  buffer_load_dwordx4 v26, s[16:19], s36 offen lds
  s_add_u32 m0, s37, 13312
  s_nop 0
  buffer_load_dwordx4 v27, s[16:19], s36 offen lds
  s_add_u32 m0, s37, 14336
  s_nop 0
  buffer_load_dwordx4 v28, s[16:19], s36 offen lds
  s_add_u32 s36, s36, 393216
  s_add_u32 m0, s37, 24576
  s_nop 0
  buffer_load_dwordx4 v26, s[16:19], s36 offen lds
  s_add_u32 m0, s37, 25600
  s_nop 0
  buffer_load_dwordx4 v27, s[16:19], s36 offen lds
  s_add_u32 m0, s37, 26624
  s_nop 0
  buffer_load_dwordx4 v28, s[16:19], s36 offen lds
  s_add_u32 s36, s36, 393216
  s_add_u32 m0, s37, 36864
  s_nop 0
  buffer_load_dwordx4 v26, s[16:19], s36 offen lds
  s_add_u32 m0, s37, 37888
  s_nop 0
  buffer_load_dwordx4 v27, s[16:19], s36 offen lds
  s_add_u32 m0, s37, 38912
  s_nop 0
  buffer_load_dwordx4 v28, s[16:19], s36 offen lds
  s_add_u32 s36, s36, 393216
  s_add_u32 m0, s37, 49152
  s_nop 0
  buffer_load_dwordx4 v26, s[16:19], s36 offen lds
  s_add_u32 m0, s37, 50176
  s_nop 0
  buffer_load_dwordx4 v27, s[16:19], s36 offen lds
  s_add_u32 m0, s37, 51200
  s_nop 0
  buffer_load_dwordx4 v28, s[16:19], s36 offen lds
  s_waitcnt vmcnt(15)
  s_barrier
  ds_read_b64_tr_b16 a[0:1], v29 offset:0
  ds_read_b64_tr_b16 a[2:3], v29 offset:1536
  ds_read_b64_tr_b16 a[80:81], v30 offset:0
  ds_read_b64_tr_b16 a[82:83], v30 offset:1536
  ds_read_b64_tr_b16 a[160:161], v31 offset:0
  ds_read_b64_tr_b16 a[162:163], v31 offset:1536
  s_waitcnt lgkmcnt(6)
  ds_read_b64_tr_b16 a[4:5], v29 offset:12288
  ds_read_b64_tr_b16 a[6:7], v29 offset:13824
  ds_read_b64_tr_b16 a[84:85], v30 offset:12288
  ds_read_b64_tr_b16 a[86:87], v30 offset:13824
  ds_read_b64_tr_b16 a[164:165], v31 offset:12288
  ds_read_b64_tr_b16 a[166:167], v31 offset:13824
  s_waitcnt lgkmcnt(6)
  ds_read_b64_tr_b16 a[8:9], v29 offset:24576
  ds_read_b64_tr_b16 a[10:11], v29 offset:26112
  ds_read_b64_tr_b16 a[88:89], v30 offset:24576
  ds_read_b64_tr_b16 a[90:91], v30 offset:26112
  ds_read_b64_tr_b16 a[168:169], v31 offset:24576
  ds_read_b64_tr_b16 a[170:171], v31 offset:26112
  s_waitcnt lgkmcnt(6)
  ds_read_b64_tr_b16 a[12:13], v29 offset:36864
  ds_read_b64_tr_b16 a[14:15], v29 offset:38400
  ds_read_b64_tr_b16 a[92:93], v30 offset:36864
  ds_read_b64_tr_b16 a[94:95], v30 offset:38400
  ds_read_b64_tr_b16 a[172:173], v31 offset:36864
  ds_read_b64_tr_b16 a[174:175], v31 offset:38400
  s_waitcnt lgkmcnt(6)
  ds_read_b64_tr_b16 a[16:17], v29 offset:49152
  ds_read_b64_tr_b16 a[18:19], v29 offset:50688
  ds_read_b64_tr_b16 a[96:97], v30 offset:49152
  ds_read_b64_tr_b16 a[98:99], v30 offset:50688
  ds_read_b64_tr_b16 a[176:177], v31 offset:49152
  ds_read_b64_tr_b16 a[178:179], v31 offset:50688
  s_waitcnt lgkmcnt(6)
  v_add_u32 v29, 61440, v29
  v_add_u32 v30, 61440, v30
  v_add_u32 v31, 61440, v31
  s_waitcnt lgkmcnt(0)
  s_barrier
  s_mul_i32 s36, s12, 98304
  s_mul_i32 s37, s28, 384
  s_add_u32 s36, s36, s37
  s_add_u32 s36, s36, 3932160
  s_mul_i32 s37, s12, 3072
  s_add_u32 s37, s37, 0
  s_add_u32 m0, s37, 0
  s_nop 0
  buffer_load_dwordx4 v26, s[16:19], s36 offen lds
  s_add_u32 m0, s37, 1024
  s_nop 0
  buffer_load_dwordx4 v27, s[16:19], s36 offen lds
  s_add_u32 m0, s37, 2048
  s_nop 0
  buffer_load_dwordx4 v28, s[16:19], s36 offen lds
  s_add_u32 s36, s36, 393216
  s_add_u32 m0, s37, 12288
  s_nop 0
  buffer_load_dwordx4 v26, s[16:19], s36 offen lds
  s_add_u32 m0, s37, 13312
  s_nop 0
  buffer_load_dwordx4 v27, s[16:19], s36 offen lds
  s_add_u32 m0, s37, 14336
  s_nop 0
  buffer_load_dwordx4 v28, s[16:19], s36 offen lds
  s_add_u32 s36, s36, 393216
  s_add_u32 m0, s37, 24576
  s_nop 0
  buffer_load_dwordx4 v26, s[16:19], s36 offen lds
  s_add_u32 m0, s37, 25600
  s_nop 0
  buffer_load_dwordx4 v27, s[16:19], s36 offen lds
  s_add_u32 m0, s37, 26624
  s_nop 0
  buffer_load_dwordx4 v28, s[16:19], s36 offen lds
  s_add_u32 s36, s36, 393216
  s_add_u32 m0, s37, 36864
  s_nop 0
  buffer_load_dwordx4 v26, s[16:19], s36 offen lds
  s_add_u32 m0, s37, 37888
  s_nop 0
  buffer_load_dwordx4 v27, s[16:19], s36 offen lds
  s_add_u32 m0, s37, 38912
  s_nop 0
  buffer_load_dwordx4 v28, s[16:19], s36 offen lds
  s_add_u32 s36, s36, 393216
  s_add_u32 m0, s37, 49152
  s_nop 0
  buffer_load_dwordx4 v26, s[16:19], s36 offen lds
  s_add_u32 m0, s37, 50176
  s_nop 0
  buffer_load_dwordx4 v27, s[16:19], s36 offen lds
  s_add_u32 m0, s37, 51200
  s_nop 0
  buffer_load_dwordx4 v28, s[16:19], s36 offen lds
  s_waitcnt vmcnt(15)
  s_barrier
  ds_read_b64_tr_b16 a[20:21], v29 offset:0
  ds_read_b64_tr_b16 a[22:23], v29 offset:1536
  ds_read_b64_tr_b16 a[100:101], v30 offset:0
  ds_read_b64_tr_b16 a[102:103], v30 offset:1536
  ds_read_b64_tr_b16 a[180:181], v31 offset:0
  ds_read_b64_tr_b16 a[182:183], v31 offset:1536
  s_waitcnt lgkmcnt(6)
  ds_read_b64_tr_b16 a[24:25], v29 offset:12288
  ds_read_b64_tr_b16 a[26:27], v29 offset:13824
  ds_read_b64_tr_b16 a[104:105], v30 offset:12288
  ds_read_b64_tr_b16 a[106:107], v30 offset:13824
  ds_read_b64_tr_b16 a[184:185], v31 offset:12288
  ds_read_b64_tr_b16 a[186:187], v31 offset:13824
  s_waitcnt lgkmcnt(6)
  ds_read_b64_tr_b16 a[28:29], v29 offset:24576
  ds_read_b64_tr_b16 a[30:31], v29 offset:26112
  ds_read_b64_tr_b16 a[108:109], v30 offset:24576
  ds_read_b64_tr_b16 a[110:111], v30 offset:26112
  ds_read_b64_tr_b16 a[188:189], v31 offset:24576
  ds_read_b64_tr_b16 a[190:191], v31 offset:26112
  s_waitcnt lgkmcnt(6)
  ds_read_b64_tr_b16 a[32:33], v29 offset:36864
  ds_read_b64_tr_b16 a[34:35], v29 offset:38400
  ds_read_b64_tr_b16 a[112:113], v30 offset:36864
  ds_read_b64_tr_b16 a[114:115], v30 offset:38400
  ds_read_b64_tr_b16 a[192:193], v31 offset:36864
  ds_read_b64_tr_b16 a[194:195], v31 offset:38400
  s_waitcnt lgkmcnt(6)
  ds_read_b64_tr_b16 a[36:37], v29 offset:49152
  ds_read_b64_tr_b16 a[38:39], v29 offset:50688
  ds_read_b64_tr_b16 a[116:117], v30 offset:49152
  ds_read_b64_tr_b16 a[118:119], v30 offset:50688
  ds_read_b64_tr_b16 a[196:197], v31 offset:49152
  ds_read_b64_tr_b16 a[198:199], v31 offset:50688
  s_waitcnt lgkmcnt(6)
  v_subrev_u32 v29, 61440, v29
  v_subrev_u32 v30, 61440, v30
  v_subrev_u32 v31, 61440, v31
  s_waitcnt lgkmcnt(0)
  s_barrier
  s_mul_i32 s36, s12, 98304
  s_mul_i32 s37, s28, 384
  s_add_u32 s36, s36, s37
  s_add_u32 s36, s36, 5898240
  s_mul_i32 s37, s12, 3072
  s_add_u32 s37, s37, 61440
  s_add_u32 m0, s37, 0
  s_nop 0
  buffer_load_dwordx4 v26, s[16:19], s36 offen lds
  s_add_u32 m0, s37, 1024
  s_nop 0
  buffer_load_dwordx4 v27, s[16:19], s36 offen lds
  s_add_u32 m0, s37, 2048
  s_nop 0
  buffer_load_dwordx4 v28, s[16:19], s36 offen lds
  s_add_u32 s36, s36, 393216
  s_add_u32 m0, s37, 12288
  s_nop 0
  buffer_load_dwordx4 v26, s[16:19], s36 offen lds
  s_add_u32 m0, s37, 13312
  s_nop 0
  buffer_load_dwordx4 v27, s[16:19], s36 offen lds
  s_add_u32 m0, s37, 14336
  s_nop 0
  buffer_load_dwordx4 v28, s[16:19], s36 offen lds
  s_add_u32 s36, s36, 393216
  s_add_u32 m0, s37, 24576
  s_nop 0
  buffer_load_dwordx4 v26, s[16:19], s36 offen lds
  s_add_u32 m0, s37, 25600
  s_nop 0
  buffer_load_dwordx4 v27, s[16:19], s36 offen lds
  s_add_u32 m0, s37, 26624
  s_nop 0
  buffer_load_dwordx4 v28, s[16:19], s36 offen lds
  s_add_u32 s36, s36, 393216
  s_add_u32 m0, s37, 36864
  s_nop 0
  buffer_load_dwordx4 v26, s[16:19], s36 offen lds
  s_add_u32 m0, s37, 37888
  s_nop 0
  buffer_load_dwordx4 v27, s[16:19], s36 offen lds
  s_add_u32 m0, s37, 38912
  s_nop 0
  buffer_load_dwordx4 v28, s[16:19], s36 offen lds
  s_add_u32 s36, s36, 393216
  s_add_u32 m0, s37, 49152
  s_nop 0
  buffer_load_dwordx4 v26, s[16:19], s36 offen lds
  s_add_u32 m0, s37, 50176
  s_nop 0
  buffer_load_dwordx4 v27, s[16:19], s36 offen lds
  s_add_u32 m0, s37, 51200
  s_nop 0
  buffer_load_dwordx4 v28, s[16:19], s36 offen lds
  s_waitcnt vmcnt(15)
  s_barrier
  ds_read_b64_tr_b16 a[40:41], v29 offset:0
  ds_read_b64_tr_b16 a[42:43], v29 offset:1536
  ds_read_b64_tr_b16 a[120:121], v30 offset:0
  ds_read_b64_tr_b16 a[122:123], v30 offset:1536
  ds_read_b64_tr_b16 a[200:201], v31 offset:0
  ds_read_b64_tr_b16 a[202:203], v31 offset:1536
  s_waitcnt lgkmcnt(6)
  ds_read_b64_tr_b16 a[44:45], v29 offset:12288
  ds_read_b64_tr_b16 a[46:47], v29 offset:13824
  ds_read_b64_tr_b16 a[124:125], v30 offset:12288
  ds_read_b64_tr_b16 a[126:127], v30 offset:13824
  ds_read_b64_tr_b16 a[204:205], v31 offset:12288
  ds_read_b64_tr_b16 a[206:207], v31 offset:13824
  s_waitcnt lgkmcnt(6)
  ds_read_b64_tr_b16 a[48:49], v29 offset:24576
  ds_read_b64_tr_b16 a[50:51], v29 offset:26112
  ds_read_b64_tr_b16 a[128:129], v30 offset:24576
  ds_read_b64_tr_b16 a[130:131], v30 offset:26112
  ds_read_b64_tr_b16 a[208:209], v31 offset:24576
  ds_read_b64_tr_b16 a[210:211], v31 offset:26112
  s_waitcnt lgkmcnt(6)
  ds_read_b64_tr_b16 a[52:53], v29 offset:36864
  ds_read_b64_tr_b16 a[54:55], v29 offset:38400
  ds_read_b64_tr_b16 a[132:133], v30 offset:36864
  ds_read_b64_tr_b16 a[134:135], v30 offset:38400
  ds_read_b64_tr_b16 a[212:213], v31 offset:36864
  ds_read_b64_tr_b16 a[214:215], v31 offset:38400
  s_waitcnt lgkmcnt(6)
  ds_read_b64_tr_b16 a[56:57], v29 offset:49152
  ds_read_b64_tr_b16 a[58:59], v29 offset:50688
  ds_read_b64_tr_b16 a[136:137], v30 offset:49152
  ds_read_b64_tr_b16 a[138:139], v30 offset:50688
  ds_read_b64_tr_b16 a[216:217], v31 offset:49152
  ds_read_b64_tr_b16 a[218:219], v31 offset:50688
  s_waitcnt lgkmcnt(6)
  v_add_u32 v29, 61440, v29
  v_add_u32 v30, 61440, v30
  v_add_u32 v31, 61440, v31
  s_waitcnt lgkmcnt(0)
  s_barrier
  s_waitcnt vmcnt(0)
  s_barrier
  ds_read_b64_tr_b16 a[60:61], v29 offset:0
  ds_read_b64_tr_b16 a[62:63], v29 offset:1536
  ds_read_b64_tr_b16 a[140:141], v30 offset:0
  ds_read_b64_tr_b16 a[142:143], v30 offset:1536
  ds_read_b64_tr_b16 a[220:221], v31 offset:0
  ds_read_b64_tr_b16 a[222:223], v31 offset:1536
  s_waitcnt lgkmcnt(6)
  ds_read_b64_tr_b16 a[64:65], v29 offset:12288
  ds_read_b64_tr_b16 a[66:67], v29 offset:13824
  ds_read_b64_tr_b16 a[144:145], v30 offset:12288
  ds_read_b64_tr_b16 a[146:147], v30 offset:13824
  ds_read_b64_tr_b16 a[224:225], v31 offset:12288
  ds_read_b64_tr_b16 a[226:227], v31 offset:13824
  s_waitcnt lgkmcnt(6)
  ds_read_b64_tr_b16 a[68:69], v29 offset:24576
  ds_read_b64_tr_b16 a[70:71], v29 offset:26112
  ds_read_b64_tr_b16 a[148:149], v30 offset:24576
  ds_read_b64_tr_b16 a[150:151], v30 offset:26112
  ds_read_b64_tr_b16 a[228:229], v31 offset:24576
  ds_read_b64_tr_b16 a[230:231], v31 offset:26112
  s_waitcnt lgkmcnt(6)
  ds_read_b64_tr_b16 a[72:73], v29 offset:36864
  ds_read_b64_tr_b16 a[74:75], v29 offset:38400
  ds_read_b64_tr_b16 a[152:153], v30 offset:36864
  ds_read_b64_tr_b16 a[154:155], v30 offset:38400
  ds_read_b64_tr_b16 a[232:233], v31 offset:36864
  ds_read_b64_tr_b16 a[234:235], v31 offset:38400
  s_waitcnt lgkmcnt(6)
  ds_read_b64_tr_b16 a[76:77], v29 offset:49152
  ds_read_b64_tr_b16 a[78:79], v29 offset:50688
  ds_read_b64_tr_b16 a[156:157], v30 offset:49152
  ds_read_b64_tr_b16 a[158:159], v30 offset:50688
  ds_read_b64_tr_b16 a[236:237], v31 offset:49152
  ds_read_b64_tr_b16 a[238:239], v31 offset:50688
  s_waitcnt lgkmcnt(6)
  v_subrev_u32 v29, 61440, v29
  v_subrev_u32 v30, 61440, v30
  v_subrev_u32 v31, 61440, v31
  s_waitcnt lgkmcnt(0)
  s_barrier
  s_and_b32 s36, s12, 1
  s_lshl_b32 s36, s36, 3
  v_and_b32 v26, 63, v0
  v_add_u32 v26, 0, v26
  v_mul_u32_u24 v27, 820, v26
  v_lshrrev_b32 v27, 16, v27
  v_mul_u32_u24 v2, 80, v27
  v_sub_u32 v26, v26, v2
  v_mul_u32_u24 v2, 1280, v27
  v_or_b32 v27, s36, v27
  v_xor_b32 v26, v26, v27
  v_lshl_add_u32 v2, v26, 4, v2
  v_and_b32 v26, 63, v0
  v_add_u32 v26, 64, v26
  v_mul_u32_u24 v27, 820, v26
  v_lshrrev_b32 v27, 16, v27
  v_mul_u32_u24 v3, 80, v27
  v_sub_u32 v26, v26, v3
  v_mul_u32_u24 v3, 1280, v27
  v_or_b32 v27, s36, v27
  v_xor_b32 v26, v26, v27
  v_lshl_add_u32 v3, v26, 4, v3
  v_and_b32 v26, 63, v0
  v_add_u32 v26, 128, v26
  v_mul_u32_u24 v27, 820, v26
  v_lshrrev_b32 v27, 16, v27
  v_mul_u32_u24 v4, 80, v27
  v_sub_u32 v26, v26, v4
  v_mul_u32_u24 v4, 1280, v27
  v_or_b32 v27, s36, v27
  v_xor_b32 v26, v26, v27
  v_lshl_add_u32 v4, v26, 4, v4
  v_and_b32 v26, 63, v0
  v_add_u32 v26, 192, v26
  v_mul_u32_u24 v27, 820, v26
  v_lshrrev_b32 v27, 16, v27
  v_mul_u32_u24 v5, 80, v27
  v_sub_u32 v26, v26, v5
  v_mul_u32_u24 v5, 1280, v27
  v_or_b32 v27, s36, v27
  v_xor_b32 v26, v26, v27
  v_lshl_add_u32 v5, v26, 4, v5
  v_and_b32 v26, 63, v0
  v_add_u32 v26, 256, v26
  v_mul_u32_u24 v27, 820, v26
  v_lshrrev_b32 v27, 16, v27
  v_mul_u32_u24 v6, 80, v27
  v_sub_u32 v26, v26, v6
  v_mul_u32_u24 v6, 1280, v27
  v_or_b32 v27, s36, v27
  v_xor_b32 v26, v26, v27
  v_lshl_add_u32 v6, v26, 4, v6
  v_and_b32 v26, 63, v0
  v_add_u32 v26, 320, v26
  v_mul_u32_u24 v27, 820, v26
  v_lshrrev_b32 v27, 16, v27
  v_mul_u32_u24 v7, 80, v27
  v_sub_u32 v26, v26, v7
  v_mul_u32_u24 v7, 1280, v27
  v_or_b32 v27, s36, v27
  v_xor_b32 v26, v26, v27
  v_lshl_add_u32 v7, v26, 4, v7
  v_and_b32 v26, 63, v0
  v_add_u32 v26, 384, v26
  v_mul_u32_u24 v27, 820, v26
  v_lshrrev_b32 v27, 16, v27
  v_mul_u32_u24 v8, 80, v27
  v_sub_u32 v26, v26, v8
  v_mul_u32_u24 v8, 1280, v27
  v_or_b32 v27, s36, v27
  v_xor_b32 v26, v26, v27
  v_lshl_add_u32 v8, v26, 4, v8
  v_and_b32 v26, 63, v0
  v_add_u32 v26, 448, v26
  v_mul_u32_u24 v27, 820, v26
  v_lshrrev_b32 v27, 16, v27
  v_mul_u32_u24 v9, 80, v27
  v_sub_u32 v26, v26, v9
  v_mul_u32_u24 v9, 1280, v27
  v_or_b32 v27, s36, v27
  v_xor_b32 v26, v26, v27
  v_lshl_add_u32 v9, v26, 4, v9
  v_and_b32 v26, 63, v0
  v_add_u32 v26, 512, v26
  v_mul_u32_u24 v27, 820, v26
  v_lshrrev_b32 v27, 16, v27
  v_mul_u32_u24 v10, 80, v27
  v_sub_u32 v26, v26, v10
  v_mul_u32_u24 v10, 1280, v27
  v_or_b32 v27, s36, v27
  v_xor_b32 v26, v26, v27
  v_lshl_add_u32 v10, v26, 4, v10
  v_and_b32 v26, 63, v0
  v_add_u32 v26, 576, v26
  v_mul_u32_u24 v27, 820, v26
  v_lshrrev_b32 v27, 16, v27
  v_mul_u32_u24 v11, 80, v27
  v_sub_u32 v26, v26, v11
  v_mul_u32_u24 v11, 1280, v27
  v_or_b32 v27, s36, v27
  v_xor_b32 v26, v26, v27
  v_lshl_add_u32 v11, v26, 4, v11
  v_and_b32 v27, 15, v0
  v_bfe_u32 v26, v0, 4, 2
  v_add_u32 v26, 0, v26
  v_xor_b32 v26, v26, v27
  v_lshlrev_b32 v26, 4, v26
  v_mul_u32_u24 v12, 1280, v27
  v_add_u32 v12, v12, v26
  v_bfe_u32 v26, v0, 4, 2
  v_add_u32 v26, 4, v26
  v_xor_b32 v26, v26, v27
  v_lshlrev_b32 v26, 4, v26
  v_mul_u32_u24 v13, 1280, v27
  v_add_u32 v13, v13, v26
  v_bfe_u32 v26, v0, 4, 2
  v_add_u32 v26, 8, v26
  v_xor_b32 v26, v26, v27
  v_lshlrev_b32 v26, 4, v26
  v_mul_u32_u24 v14, 1280, v27
  v_add_u32 v14, v14, v26
  v_bfe_u32 v26, v0, 4, 2
  v_add_u32 v26, 12, v26
  v_xor_b32 v26, v26, v27
  v_lshlrev_b32 v26, 4, v26
  v_mul_u32_u24 v15, 1280, v27
  v_add_u32 v15, v15, v26
  s_mul_i32 s30, s12, 10240
  s_mov_b32 s31, s30
  s_add_u32 s32, s30, 40960
  s_add_u32 m0, s31, 0
  s_nop 0
  buffer_load_dwordx4 v2, s[20:23], s30 offen lds
  s_add_u32 m0, s31, 1024
  s_nop 0
  buffer_load_dwordx4 v3, s[20:23], s30 offen lds
  s_add_u32 m0, s31, 2048
  s_nop 0
  buffer_load_dwordx4 v4, s[20:23], s30 offen lds
  s_add_u32 m0, s31, 3072
  s_nop 0
  buffer_load_dwordx4 v5, s[20:23], s30 offen lds
  s_add_u32 m0, s31, 4096
  s_nop 0
  buffer_load_dwordx4 v6, s[20:23], s30 offen lds
  s_add_u32 m0, s31, 5120
  s_nop 0
  buffer_load_dwordx4 v7, s[20:23], s30 offen lds
  s_add_u32 m0, s31, 6144
  s_nop 0
  buffer_load_dwordx4 v8, s[20:23], s30 offen lds
  s_add_u32 m0, s31, 7168
  s_nop 0
  buffer_load_dwordx4 v9, s[20:23], s30 offen lds
  s_add_u32 m0, s31, 8192
  s_nop 0
  buffer_load_dwordx4 v10, s[20:23], s30 offen lds
  s_add_u32 m0, s31, 9216
  s_nop 0
  buffer_load_dwordx4 v11, s[20:23], s30 offen lds
  s_add_u32 s30, s30, 40960
  v_and_b32 v16, 63, v0
  v_lshlrev_b32 v16, 4, v16
  s_mul_i32 s33, s28, 12288
  s_mul_i32 s36, s12, 3072
  s_add_u32 s33, s33, s36
  s_add_u32 s33, s33, 25165824
  s_lshl_b32 s35, s28, 7
  s_lshl_b32 s36, s12, 2
  s_add_u32 s35, s35, s36
  s_add_u32 s35, s35, 52174864
  v_mov_b32 v24, 0
  v_mov_b32 v26, 48
  s_mov_b32 s14, 240
  v_writelane_b32 v26, s14, 0
  s_mov_b32 s15, 0
L_v_go:
  buffer_load_dword v27, v26, s[8:11], 0 offen sc1
  s_waitcnt vmcnt(0)
  v_cmp_eq_u32 vcc, 0, v27
  s_cbranch_vccz L_v_go_ok
  s_sleep 2
  s_add_u32 s15, s15, 1
  s_cmp_lt_u32 s15, 262144
  s_cbranch_scc1 L_v_go
  s_branch L_fail
L_v_go_ok:
  v_readfirstlane_b32 s14, v27
  s_nop 0
  s_sub_u32 s14, s14, 1
  s_lshl_b32 s36, s14, 13
  s_xor_b32 s35, s35, s36
  s_mov_b32 s29, 0
  s_waitcnt vmcnt(0)
  s_waitcnt vmcnt(1)
  s_barrier
  ds_read_b128 v[34:37], v12 offset:0
  ds_read_b128 v[38:41], v12 offset:20480
  ds_read_b128 v[42:45], v13 offset:0
  ds_read_b128 v[46:49], v13 offset:20480
  ds_read_b128 v[50:53], v14 offset:0
  ds_read_b128 v[54:57], v14 offset:20480
  s_waitcnt lgkmcnt(4)
  v_mfma_f32_16x16x32_bf16 v[58:61], v[34:37], a[0:3], 0
  v_mfma_f32_16x16x32_bf16 v[62:65], v[38:41], a[0:3], 0
  s_add_u32 m0, s32, 0
  s_nop 0
  buffer_load_dwordx4 v2, s[20:23], s30 offen lds
  v_mfma_f32_16x16x32_bf16 v[66:69], v[34:37], a[80:83], 0
  v_mfma_f32_16x16x32_bf16 v[70:73], v[38:41], a[80:83], 0
  v_mfma_f32_16x16x32_bf16 v[74:77], v[34:37], a[160:163], 0
  v_mfma_f32_16x16x32_bf16 v[78:81], v[38:41], a[160:163], 0
  s_add_u32 m0, s32, 1024
  s_nop 0
  buffer_load_dwordx4 v3, s[20:23], s30 offen lds
  ds_read_b128 v[34:37], v15 offset:0
  ds_read_b128 v[38:41], v15 offset:20480
  s_waitcnt lgkmcnt(4)
  v_mfma_f32_16x16x32_bf16 v[58:61], v[42:45], a[4:7], v[58:61]
  v_mfma_f32_16x16x32_bf16 v[62:65], v[46:49], a[4:7], v[62:65]
  s_add_u32 m0, s32, 2048
  s_nop 0
  buffer_load_dwordx4 v4, s[20:23], s30 offen lds
  v_mfma_f32_16x16x32_bf16 v[66:69], v[42:45], a[84:87], v[66:69]
  v_mfma_f32_16x16x32_bf16 v[70:73], v[46:49], a[84:87], v[70:73]
  v_mfma_f32_16x16x32_bf16 v[74:77], v[42:45], a[164:167], v[74:77]
  v_mfma_f32_16x16x32_bf16 v[78:81], v[46:49], a[164:167], v[78:81]
  s_add_u32 m0, s32, 3072
  s_nop 0
  buffer_load_dwordx4 v5, s[20:23], s30 offen lds
  ds_read_b128 v[42:45], v12 offset:256
  ds_read_b128 v[46:49], v12 offset:20736
  s_waitcnt lgkmcnt(4)
  v_mfma_f32_16x16x32_bf16 v[58:61], v[50:53], a[8:11], v[58:61]
  v_mfma_f32_16x16x32_bf16 v[62:65], v[54:57], a[8:11], v[62:65]
  s_add_u32 m0, s32, 4096
  s_nop 0
  buffer_load_dwordx4 v6, s[20:23], s30 offen lds
  v_mfma_f32_16x16x32_bf16 v[66:69], v[50:53], a[88:91], v[66:69]
  v_mfma_f32_16x16x32_bf16 v[70:73], v[54:57], a[88:91], v[70:73]
  v_mfma_f32_16x16x32_bf16 v[74:77], v[50:53], a[168:171], v[74:77]
  v_mfma_f32_16x16x32_bf16 v[78:81], v[54:57], a[168:171], v[78:81]
  s_add_u32 m0, s32, 5120
  s_nop 0
  buffer_load_dwordx4 v7, s[20:23], s30 offen lds
  ds_read_b128 v[50:53], v13 offset:256
  ds_read_b128 v[54:57], v13 offset:20736
  s_waitcnt lgkmcnt(4)
  v_mfma_f32_16x16x32_bf16 v[58:61], v[34:37], a[12:15], v[58:61]
  v_mfma_f32_16x16x32_bf16 v[62:65], v[38:41], a[12:15], v[62:65]
  s_add_u32 m0, s32, 6144
  s_nop 0
  buffer_load_dwordx4 v8, s[20:23], s30 offen lds
  v_mfma_f32_16x16x32_bf16 v[66:69], v[34:37], a[92:95], v[66:69]
  v_mfma_f32_16x16x32_bf16 v[70:73], v[38:41], a[92:95], v[70:73]
  v_mfma_f32_16x16x32_bf16 v[74:77], v[34:37], a[172:175], v[74:77]
  v_mfma_f32_16x16x32_bf16 v[78:81], v[38:41], a[172:175], v[78:81]
  s_add_u32 m0, s32, 7168
  s_nop 0
  buffer_load_dwordx4 v9, s[20:23], s30 offen lds
  ds_read_b128 v[34:37], v14 offset:256
  ds_read_b128 v[38:41], v14 offset:20736
  s_waitcnt lgkmcnt(4)
  v_mfma_f32_16x16x32_bf16 v[58:61], v[42:45], a[16:19], v[58:61]
  v_mfma_f32_16x16x32_bf16 v[62:65], v[46:49], a[16:19], v[62:65]
  s_add_u32 m0, s32, 8192
  s_nop 0
  buffer_load_dwordx4 v10, s[20:23], s30 offen lds
  v_mfma_f32_16x16x32_bf16 v[66:69], v[42:45], a[96:99], v[66:69]
  v_mfma_f32_16x16x32_bf16 v[70:73], v[46:49], a[96:99], v[70:73]
  v_mfma_f32_16x16x32_bf16 v[74:77], v[42:45], a[176:179], v[74:77]
  v_mfma_f32_16x16x32_bf16 v[78:81], v[46:49], a[176:179], v[78:81]
  s_add_u32 m0, s32, 9216
  s_nop 0
  buffer_load_dwordx4 v11, s[20:23], s30 offen lds
  ds_read_b128 v[42:45], v15 offset:256
  ds_read_b128 v[46:49], v15 offset:20736
  s_waitcnt lgkmcnt(4)
  v_mfma_f32_16x16x32_bf16 v[58:61], v[50:53], a[20:23], v[58:61]
  v_mfma_f32_16x16x32_bf16 v[62:65], v[54:57], a[20:23], v[62:65]
  v_mfma_f32_16x16x32_bf16 v[66:69], v[50:53], a[100:103], v[66:69]
  v_mfma_f32_16x16x32_bf16 v[70:73], v[54:57], a[100:103], v[70:73]
  v_mfma_f32_16x16x32_bf16 v[74:77], v[50:53], a[180:183], v[74:77]
  v_mfma_f32_16x16x32_bf16 v[78:81], v[54:57], a[180:183], v[78:81]
  ds_read_b128 v[50:53], v12 offset:512
  ds_read_b128 v[54:57], v12 offset:20992
  s_waitcnt lgkmcnt(4)
  v_mfma_f32_16x16x32_bf16 v[58:61], v[34:37], a[24:27], v[58:61]
  v_mfma_f32_16x16x32_bf16 v[62:65], v[38:41], a[24:27], v[62:65]
  v_mfma_f32_16x16x32_bf16 v[66:69], v[34:37], a[104:107], v[66:69]
  v_mfma_f32_16x16x32_bf16 v[70:73], v[38:41], a[104:107], v[70:73]
  v_mfma_f32_16x16x32_bf16 v[74:77], v[34:37], a[184:187], v[74:77]
  v_mfma_f32_16x16x32_bf16 v[78:81], v[38:41], a[184:187], v[78:81]
  ds_read_b128 v[34:37], v13 offset:512
  ds_read_b128 v[38:41], v13 offset:20992
  s_waitcnt lgkmcnt(4)
  v_mfma_f32_16x16x32_bf16 v[58:61], v[42:45], a[28:31], v[58:61]
  v_mfma_f32_16x16x32_bf16 v[62:65], v[46:49], a[28:31], v[62:65]
  v_mfma_f32_16x16x32_bf16 v[66:69], v[42:45], a[108:111], v[66:69]
  v_mfma_f32_16x16x32_bf16 v[70:73], v[46:49], a[108:111], v[70:73]
  v_mfma_f32_16x16x32_bf16 v[74:77], v[42:45], a[188:191], v[74:77]
  v_mfma_f32_16x16x32_bf16 v[78:81], v[46:49], a[188:191], v[78:81]
  ds_read_b128 v[42:45], v14 offset:512
  ds_read_b128 v[46:49], v14 offset:20992
  s_waitcnt lgkmcnt(4)
  v_mfma_f32_16x16x32_bf16 v[58:61], v[50:53], a[32:35], v[58:61]
  v_mfma_f32_16x16x32_bf16 v[62:65], v[54:57], a[32:35], v[62:65]
  v_mfma_f32_16x16x32_bf16 v[66:69], v[50:53], a[112:115], v[66:69]
  v_mfma_f32_16x16x32_bf16 v[70:73], v[54:57], a[112:115], v[70:73]
  v_mfma_f32_16x16x32_bf16 v[74:77], v[50:53], a[192:195], v[74:77]
  v_mfma_f32_16x16x32_bf16 v[78:81], v[54:57], a[192:195], v[78:81]
  ds_read_b128 v[50:53], v15 offset:512
  ds_read_b128 v[54:57], v15 offset:20992
  s_waitcnt lgkmcnt(4)
  v_mfma_f32_16x16x32_bf16 v[58:61], v[34:37], a[36:39], v[58:61]
  v_mfma_f32_16x16x32_bf16 v[62:65], v[38:41], a[36:39], v[62:65]
  v_mfma_f32_16x16x32_bf16 v[66:69], v[34:37], a[116:119], v[66:69]
  v_mfma_f32_16x16x32_bf16 v[70:73], v[38:41], a[116:119], v[70:73]
  v_mfma_f32_16x16x32_bf16 v[74:77], v[34:37], a[196:199], v[74:77]
  v_mfma_f32_16x16x32_bf16 v[78:81], v[38:41], a[196:199], v[78:81]
  ds_read_b128 v[34:37], v12 offset:768
  ds_read_b128 v[38:41], v12 offset:21248
  s_waitcnt lgkmcnt(4)
  v_mfma_f32_16x16x32_bf16 v[58:61], v[42:45], a[40:43], v[58:61]
  v_mfma_f32_16x16x32_bf16 v[62:65], v[46:49], a[40:43], v[62:65]
  v_mfma_f32_16x16x32_bf16 v[66:69], v[42:45], a[120:123], v[66:69]
  v_mfma_f32_16x16x32_bf16 v[70:73], v[46:49], a[120:123], v[70:73]
  v_mfma_f32_16x16x32_bf16 v[74:77], v[42:45], a[200:203], v[74:77]
  v_mfma_f32_16x16x32_bf16 v[78:81], v[46:49], a[200:203], v[78:81]
  ds_read_b128 v[42:45], v13 offset:768
  ds_read_b128 v[46:49], v13 offset:21248
  s_waitcnt lgkmcnt(4)
  v_mfma_f32_16x16x32_bf16 v[58:61], v[50:53], a[44:47], v[58:61]
  v_mfma_f32_16x16x32_bf16 v[62:65], v[54:57], a[44:47], v[62:65]
  v_mfma_f32_16x16x32_bf16 v[66:69], v[50:53], a[124:127], v[66:69]
  v_mfma_f32_16x16x32_bf16 v[70:73], v[54:57], a[124:127], v[70:73]
  v_mfma_f32_16x16x32_bf16 v[74:77], v[50:53], a[204:207], v[74:77]
  v_mfma_f32_16x16x32_bf16 v[78:81], v[54:57], a[204:207], v[78:81]
  ds_read_b128 v[50:53], v14 offset:768
  ds_read_b128 v[54:57], v14 offset:21248
  s_waitcnt lgkmcnt(4)
  v_mfma_f32_16x16x32_bf16 v[58:61], v[34:37], a[48:51], v[58:61]
  v_mfma_f32_16x16x32_bf16 v[62:65], v[38:41], a[48:51], v[62:65]
  v_mfma_f32_16x16x32_bf16 v[66:69], v[34:37], a[128:131], v[66:69]
  v_mfma_f32_16x16x32_bf16 v[70:73], v[38:41], a[128:131], v[70:73]
  v_mfma_f32_16x16x32_bf16 v[74:77], v[34:37], a[208:211], v[74:77]
  v_mfma_f32_16x16x32_bf16 v[78:81], v[38:41], a[208:211], v[78:81]
  ds_read_b128 v[34:37], v15 offset:768
  ds_read_b128 v[38:41], v15 offset:21248
  s_waitcnt lgkmcnt(4)
  v_mfma_f32_16x16x32_bf16 v[58:61], v[42:45], a[52:55], v[58:61]
  v_mfma_f32_16x16x32_bf16 v[62:65], v[46:49], a[52:55], v[62:65]
  v_mfma_f32_16x16x32_bf16 v[66:69], v[42:45], a[132:135], v[66:69]
  v_mfma_f32_16x16x32_bf16 v[70:73], v[46:49], a[132:135], v[70:73]
  v_mfma_f32_16x16x32_bf16 v[74:77], v[42:45], a[212:215], v[74:77]
  v_mfma_f32_16x16x32_bf16 v[78:81], v[46:49], a[212:215], v[78:81]
  ds_read_b128 v[42:45], v12 offset:1024
  ds_read_b128 v[46:49], v12 offset:21504
  s_waitcnt lgkmcnt(4)
  v_mfma_f32_16x16x32_bf16 v[58:61], v[50:53], a[56:59], v[58:61]
  v_mfma_f32_16x16x32_bf16 v[62:65], v[54:57], a[56:59], v[62:65]
  v_mfma_f32_16x16x32_bf16 v[66:69], v[50:53], a[136:139], v[66:69]
  v_mfma_f32_16x16x32_bf16 v[70:73], v[54:57], a[136:139], v[70:73]
  v_mfma_f32_16x16x32_bf16 v[74:77], v[50:53], a[216:219], v[74:77]
  v_mfma_f32_16x16x32_bf16 v[78:81], v[54:57], a[216:219], v[78:81]
  ds_read_b128 v[50:53], v13 offset:1024
  ds_read_b128 v[54:57], v13 offset:21504
  s_waitcnt lgkmcnt(4)
  v_mfma_f32_16x16x32_bf16 v[58:61], v[34:37], a[60:63], v[58:61]
  v_mfma_f32_16x16x32_bf16 v[62:65], v[38:41], a[60:63], v[62:65]
  v_mfma_f32_16x16x32_bf16 v[66:69], v[34:37], a[140:143], v[66:69]
  v_mfma_f32_16x16x32_bf16 v[70:73], v[38:41], a[140:143], v[70:73]
  v_mfma_f32_16x16x32_bf16 v[74:77], v[34:37], a[220:223], v[74:77]
  v_mfma_f32_16x16x32_bf16 v[78:81], v[38:41], a[220:223], v[78:81]
  ds_read_b128 v[34:37], v14 offset:1024
  ds_read_b128 v[38:41], v14 offset:21504
  s_waitcnt lgkmcnt(4)
  v_mfma_f32_16x16x32_bf16 v[58:61], v[42:45], a[64:67], v[58:61]
  v_mfma_f32_16x16x32_bf16 v[62:65], v[46:49], a[64:67], v[62:65]
  v_mfma_f32_16x16x32_bf16 v[66:69], v[42:45], a[144:147], v[66:69]
  v_mfma_f32_16x16x32_bf16 v[70:73], v[46:49], a[144:147], v[70:73]
  v_mfma_f32_16x16x32_bf16 v[74:77], v[42:45], a[224:227], v[74:77]
  v_mfma_f32_16x16x32_bf16 v[78:81], v[46:49], a[224:227], v[78:81]
  ds_read_b128 v[42:45], v15 offset:1024
  ds_read_b128 v[46:49], v15 offset:21504
  s_waitcnt lgkmcnt(4)
  v_mfma_f32_16x16x32_bf16 v[58:61], v[50:53], a[68:71], v[58:61]
  v_mfma_f32_16x16x32_bf16 v[62:65], v[54:57], a[68:71], v[62:65]
  v_mfma_f32_16x16x32_bf16 v[66:69], v[50:53], a[148:151], v[66:69]
  v_mfma_f32_16x16x32_bf16 v[70:73], v[54:57], a[148:151], v[70:73]
  v_mfma_f32_16x16x32_bf16 v[74:77], v[50:53], a[228:231], v[74:77]
  v_mfma_f32_16x16x32_bf16 v[78:81], v[54:57], a[228:231], v[78:81]
  s_waitcnt lgkmcnt(2)
  v_mfma_f32_16x16x32_bf16 v[58:61], v[34:37], a[72:75], v[58:61]
  v_mfma_f32_16x16x32_bf16 v[62:65], v[38:41], a[72:75], v[62:65]
  v_mfma_f32_16x16x32_bf16 v[66:69], v[34:37], a[152:155], v[66:69]
  v_mfma_f32_16x16x32_bf16 v[70:73], v[38:41], a[152:155], v[70:73]
  v_mfma_f32_16x16x32_bf16 v[74:77], v[34:37], a[232:235], v[74:77]
  v_mfma_f32_16x16x32_bf16 v[78:81], v[38:41], a[232:235], v[78:81]
  s_waitcnt lgkmcnt(0)
  v_mfma_f32_16x16x32_bf16 v[58:61], v[42:45], a[76:79], v[58:61]
  v_mfma_f32_16x16x32_bf16 v[62:65], v[46:49], a[76:79], v[62:65]
  v_mfma_f32_16x16x32_bf16 v[66:69], v[42:45], a[156:159], v[66:69]
  v_mfma_f32_16x16x32_bf16 v[70:73], v[46:49], a[156:159], v[70:73]
  v_mfma_f32_16x16x32_bf16 v[74:77], v[42:45], a[236:239], v[74:77]
  v_mfma_f32_16x16x32_bf16 v[78:81], v[46:49], a[236:239], v[78:81]
  s_add_u32 s30, s30, 40960
  s_add_u32 s29, s29, 1
  s_nop 0
  v_cvt_pk_bf16_f32 v106, v58, v59
  v_cvt_pk_bf16_f32 v107, v60, v61
  v_cvt_pk_bf16_f32 v108, v62, v63
  v_cvt_pk_bf16_f32 v109, v64, v65
  buffer_store_dwordx4 v[106:109], v16, s[4:7], s33 offen offset:0 sc1
  v_cvt_pk_bf16_f32 v110, v66, v67
  v_cvt_pk_bf16_f32 v111, v68, v69
  v_cvt_pk_bf16_f32 v112, v70, v71
  v_cvt_pk_bf16_f32 v113, v72, v73
  buffer_store_dwordx4 v[110:113], v16, s[4:7], s33 offen offset:1024 sc1
  v_cvt_pk_bf16_f32 v114, v74, v75
  v_cvt_pk_bf16_f32 v115, v76, v77
  v_cvt_pk_bf16_f32 v116, v78, v79
  v_cvt_pk_bf16_f32 v117, v80, v81
  buffer_store_dwordx4 v[114:117], v16, s[4:7], s33 offen offset:2048 sc1
  s_add_u32 s33, s33, 393216
  s_waitcnt vmcnt(0)
  v_mov_b32 v26, 1
  s_mov_b64 exec, 1
  buffer_store_dword v26, v24, s[4:7], s35 offen sc1
  s_mov_b64 exec, -1
  s_waitcnt vmcnt(1)
  s_barrier
  ds_read_b128 v[34:37], v12 offset:40960
  ds_read_b128 v[38:41], v12 offset:61440
  ds_read_b128 v[42:45], v13 offset:40960
  ds_read_b128 v[46:49], v13 offset:61440
  ds_read_b128 v[50:53], v14 offset:40960
  ds_read_b128 v[54:57], v14 offset:61440
  s_waitcnt lgkmcnt(4)
  v_mfma_f32_16x16x32_bf16 v[82:85], v[34:37], a[0:3], 0
  v_mfma_f32_16x16x32_bf16 v[86:89], v[38:41], a[0:3], 0
  s_add_u32 m0, s31, 0
  s_nop 0
  buffer_load_dwordx4 v2, s[20:23], s30 offen lds
  v_mfma_f32_16x16x32_bf16 v[90:93], v[34:37], a[80:83], 0
  v_mfma_f32_16x16x32_bf16 v[94:97], v[38:41], a[80:83], 0
  v_mfma_f32_16x16x32_bf16 v[98:101], v[34:37], a[160:163], 0
  v_mfma_f32_16x16x32_bf16 v[102:105], v[38:41], a[160:163], 0
  s_add_u32 m0, s31, 1024
  s_nop 0
  buffer_load_dwordx4 v3, s[20:23], s30 offen lds
  ds_read_b128 v[34:37], v15 offset:40960
  ds_read_b128 v[38:41], v15 offset:61440
  s_waitcnt lgkmcnt(4)
  v_mfma_f32_16x16x32_bf16 v[82:85], v[42:45], a[4:7], v[82:85]
  v_mfma_f32_16x16x32_bf16 v[86:89], v[46:49], a[4:7], v[86:89]
  s_add_u32 m0, s31, 2048
  s_nop 0
  buffer_load_dwordx4 v4, s[20:23], s30 offen lds
  v_mfma_f32_16x16x32_bf16 v[90:93], v[42:45], a[84:87], v[90:93]
  v_mfma_f32_16x16x32_bf16 v[94:97], v[46:49], a[84:87], v[94:97]
  v_mfma_f32_16x16x32_bf16 v[98:101], v[42:45], a[164:167], v[98:101]
  v_mfma_f32_16x16x32_bf16 v[102:105], v[46:49], a[164:167], v[102:105]
  s_add_u32 m0, s31, 3072
  s_nop 0
  buffer_load_dwordx4 v5, s[20:23], s30 offen lds
  ds_read_b128 v[42:45], v12 offset:41216
  ds_read_b128 v[46:49], v12 offset:61696
  s_waitcnt lgkmcnt(4)
  v_mfma_f32_16x16x32_bf16 v[82:85], v[50:53], a[8:11], v[82:85]
  v_mfma_f32_16x16x32_bf16 v[86:89], v[54:57], a[8:11], v[86:89]
  s_add_u32 m0, s31, 4096
  s_nop 0
  buffer_load_dwordx4 v6, s[20:23], s30 offen lds
  v_mfma_f32_16x16x32_bf16 v[90:93], v[50:53], a[88:91], v[90:93]
  v_mfma_f32_16x16x32_bf16 v[94:97], v[54:57], a[88:91], v[94:97]
  v_mfma_f32_16x16x32_bf16 v[98:101], v[50:53], a[168:171], v[98:101]
  v_mfma_f32_16x16x32_bf16 v[102:105], v[54:57], a[168:171], v[102:105]
  s_add_u32 m0, s31, 5120
  s_nop 0
  buffer_load_dwordx4 v7, s[20:23], s30 offen lds
  ds_read_b128 v[50:53], v13 offset:41216
  ds_read_b128 v[54:57], v13 offset:61696
  s_waitcnt lgkmcnt(4)
  v_mfma_f32_16x16x32_bf16 v[82:85], v[34:37], a[12:15], v[82:85]
  v_mfma_f32_16x16x32_bf16 v[86:89], v[38:41], a[12:15], v[86:89]
  s_add_u32 m0, s31, 6144
  s_nop 0
  buffer_load_dwordx4 v8, s[20:23], s30 offen lds
  v_mfma_f32_16x16x32_bf16 v[90:93], v[34:37], a[92:95], v[90:93]
  v_mfma_f32_16x16x32_bf16 v[94:97], v[38:41], a[92:95], v[94:97]
  v_mfma_f32_16x16x32_bf16 v[98:101], v[34:37], a[172:175], v[98:101]
  v_mfma_f32_16x16x32_bf16 v[102:105], v[38:41], a[172:175], v[102:105]
  s_add_u32 m0, s31, 7168
  s_nop 0
  buffer_load_dwordx4 v9, s[20:23], s30 offen lds
  ds_read_b128 v[34:37], v14 offset:41216
  ds_read_b128 v[38:41], v14 offset:61696
  s_waitcnt lgkmcnt(4)
  v_mfma_f32_16x16x32_bf16 v[82:85], v[42:45], a[16:19], v[82:85]
  v_mfma_f32_16x16x32_bf16 v[86:89], v[46:49], a[16:19], v[86:89]
  s_add_u32 m0, s31, 8192
  s_nop 0
  buffer_load_dwordx4 v10, s[20:23], s30 offen lds
  v_mfma_f32_16x16x32_bf16 v[90:93], v[42:45], a[96:99], v[90:93]
  v_mfma_f32_16x16x32_bf16 v[94:97], v[46:49], a[96:99], v[94:97]
  v_mfma_f32_16x16x32_bf16 v[98:101], v[42:45], a[176:179], v[98:101]
  v_mfma_f32_16x16x32_bf16 v[102:105], v[46:49], a[176:179], v[102:105]
  s_add_u32 m0, s31, 9216
  s_nop 0
  buffer_load_dwordx4 v11, s[20:23], s30 offen lds
  ds_read_b128 v[42:45], v15 offset:41216
  ds_read_b128 v[46:49], v15 offset:61696
  s_waitcnt lgkmcnt(4)
  v_mfma_f32_16x16x32_bf16 v[82:85], v[50:53], a[20:23], v[82:85]
  v_mfma_f32_16x16x32_bf16 v[86:89], v[54:57], a[20:23], v[86:89]
  v_mfma_f32_16x16x32_bf16 v[90:93], v[50:53], a[100:103], v[90:93]
  v_mfma_f32_16x16x32_bf16 v[94:97], v[54:57], a[100:103], v[94:97]
  v_mfma_f32_16x16x32_bf16 v[98:101], v[50:53], a[180:183], v[98:101]
  v_mfma_f32_16x16x32_bf16 v[102:105], v[54:57], a[180:183], v[102:105]
  ds_read_b128 v[50:53], v12 offset:41472
  ds_read_b128 v[54:57], v12 offset:61952
  s_waitcnt lgkmcnt(4)
  v_mfma_f32_16x16x32_bf16 v[82:85], v[34:37], a[24:27], v[82:85]
  v_mfma_f32_16x16x32_bf16 v[86:89], v[38:41], a[24:27], v[86:89]
  v_mfma_f32_16x16x32_bf16 v[90:93], v[34:37], a[104:107], v[90:93]
  v_mfma_f32_16x16x32_bf16 v[94:97], v[38:41], a[104:107], v[94:97]
  v_mfma_f32_16x16x32_bf16 v[98:101], v[34:37], a[184:187], v[98:101]
  v_mfma_f32_16x16x32_bf16 v[102:105], v[38:41], a[184:187], v[102:105]
  ds_read_b128 v[34:37], v13 offset:41472
  ds_read_b128 v[38:41], v13 offset:61952
  s_waitcnt lgkmcnt(4)
  v_mfma_f32_16x16x32_bf16 v[82:85], v[42:45], a[28:31], v[82:85]
  v_mfma_f32_16x16x32_bf16 v[86:89], v[46:49], a[28:31], v[86:89]
  v_mfma_f32_16x16x32_bf16 v[90:93], v[42:45], a[108:111], v[90:93]
  v_mfma_f32_16x16x32_bf16 v[94:97], v[46:49], a[108:111], v[94:97]
  v_mfma_f32_16x16x32_bf16 v[98:101], v[42:45], a[188:191], v[98:101]
  v_mfma_f32_16x16x32_bf16 v[102:105], v[46:49], a[188:191], v[102:105]
  ds_read_b128 v[42:45], v14 offset:41472
  ds_read_b128 v[46:49], v14 offset:61952
  s_waitcnt lgkmcnt(4)
  v_mfma_f32_16x16x32_bf16 v[82:85], v[50:53], a[32:35], v[82:85]
  v_mfma_f32_16x16x32_bf16 v[86:89], v[54:57], a[32:35], v[86:89]
  v_mfma_f32_16x16x32_bf16 v[90:93], v[50:53], a[112:115], v[90:93]
  v_mfma_f32_16x16x32_bf16 v[94:97], v[54:57], a[112:115], v[94:97]
  v_mfma_f32_16x16x32_bf16 v[98:101], v[50:53], a[192:195], v[98:101]
  v_mfma_f32_16x16x32_bf16 v[102:105], v[54:57], a[192:195], v[102:105]
  ds_read_b128 v[50:53], v15 offset:41472
  ds_read_b128 v[54:57], v15 offset:61952
  s_waitcnt lgkmcnt(4)
  v_mfma_f32_16x16x32_bf16 v[82:85], v[34:37], a[36:39], v[82:85]
  v_mfma_f32_16x16x32_bf16 v[86:89], v[38:41], a[36:39], v[86:89]
  v_mfma_f32_16x16x32_bf16 v[90:93], v[34:37], a[116:119], v[90:93]
  v_mfma_f32_16x16x32_bf16 v[94:97], v[38:41], a[116:119], v[94:97]
  v_mfma_f32_16x16x32_bf16 v[98:101], v[34:37], a[196:199], v[98:101]
  v_mfma_f32_16x16x32_bf16 v[102:105], v[38:41], a[196:199], v[102:105]
  ds_read_b128 v[34:37], v12 offset:41728
  ds_read_b128 v[38:41], v12 offset:62208
  s_waitcnt lgkmcnt(4)
  v_mfma_f32_16x16x32_bf16 v[82:85], v[42:45], a[40:43], v[82:85]
  v_mfma_f32_16x16x32_bf16 v[86:89], v[46:49], a[40:43], v[86:89]
  v_mfma_f32_16x16x32_bf16 v[90:93], v[42:45], a[120:123], v[90:93]
  v_mfma_f32_16x16x32_bf16 v[94:97], v[46:49], a[120:123], v[94:97]
  v_mfma_f32_16x16x32_bf16 v[98:101], v[42:45], a[200:203], v[98:101]
  v_mfma_f32_16x16x32_bf16 v[102:105], v[46:49], a[200:203], v[102:105]
  ds_read_b128 v[42:45], v13 offset:41728
  ds_read_b128 v[46:49], v13 offset:62208
  s_waitcnt lgkmcnt(4)
  v_mfma_f32_16x16x32_bf16 v[82:85], v[50:53], a[44:47], v[82:85]
  v_mfma_f32_16x16x32_bf16 v[86:89], v[54:57], a[44:47], v[86:89]
  v_mfma_f32_16x16x32_bf16 v[90:93], v[50:53], a[124:127], v[90:93]
  v_mfma_f32_16x16x32_bf16 v[94:97], v[54:57], a[124:127], v[94:97]
  v_mfma_f32_16x16x32_bf16 v[98:101], v[50:53], a[204:207], v[98:101]
  v_mfma_f32_16x16x32_bf16 v[102:105], v[54:57], a[204:207], v[102:105]
  ds_read_b128 v[50:53], v14 offset:41728
  ds_read_b128 v[54:57], v14 offset:62208
  s_waitcnt lgkmcnt(4)
  v_mfma_f32_16x16x32_bf16 v[82:85], v[34:37], a[48:51], v[82:85]
  v_mfma_f32_16x16x32_bf16 v[86:89], v[38:41], a[48:51], v[86:89]
  v_mfma_f32_16x16x32_bf16 v[90:93], v[34:37], a[128:131], v[90:93]
  v_mfma_f32_16x16x32_bf16 v[94:97], v[38:41], a[128:131], v[94:97]
  v_mfma_f32_16x16x32_bf16 v[98:101], v[34:37], a[208:211], v[98:101]
  v_mfma_f32_16x16x32_bf16 v[102:105], v[38:41], a[208:211], v[102:105]
  ds_read_b128 v[34:37], v15 offset:41728
  ds_read_b128 v[38:41], v15 offset:62208
  s_waitcnt lgkmcnt(4)
  v_mfma_f32_16x16x32_bf16 v[82:85], v[42:45], a[52:55], v[82:85]
  v_mfma_f32_16x16x32_bf16 v[86:89], v[46:49], a[52:55], v[86:89]
  v_mfma_f32_16x16x32_bf16 v[90:93], v[42:45], a[132:135], v[90:93]
  v_mfma_f32_16x16x32_bf16 v[94:97], v[46:49], a[132:135], v[94:97]
  v_mfma_f32_16x16x32_bf16 v[98:101], v[42:45], a[212:215], v[98:101]
  v_mfma_f32_16x16x32_bf16 v[102:105], v[46:49], a[212:215], v[102:105]
  ds_read_b128 v[42:45], v12 offset:41984
  ds_read_b128 v[46:49], v12 offset:62464
  s_waitcnt lgkmcnt(4)
  v_mfma_f32_16x16x32_bf16 v[82:85], v[50:53], a[56:59], v[82:85]
  v_mfma_f32_16x16x32_bf16 v[86:89], v[54:57], a[56:59], v[86:89]
  v_mfma_f32_16x16x32_bf16 v[90:93], v[50:53], a[136:139], v[90:93]
  v_mfma_f32_16x16x32_bf16 v[94:97], v[54:57], a[136:139], v[94:97]
  v_mfma_f32_16x16x32_bf16 v[98:101], v[50:53], a[216:219], v[98:101]
  v_mfma_f32_16x16x32_bf16 v[102:105], v[54:57], a[216:219], v[102:105]
  ds_read_b128 v[50:53], v13 offset:41984
  ds_read_b128 v[54:57], v13 offset:62464
  s_waitcnt lgkmcnt(4)
  v_mfma_f32_16x16x32_bf16 v[82:85], v[34:37], a[60:63], v[82:85]
  v_mfma_f32_16x16x32_bf16 v[86:89], v[38:41], a[60:63], v[86:89]
  v_mfma_f32_16x16x32_bf16 v[90:93], v[34:37], a[140:143], v[90:93]
  v_mfma_f32_16x16x32_bf16 v[94:97], v[38:41], a[140:143], v[94:97]
  v_mfma_f32_16x16x32_bf16 v[98:101], v[34:37], a[220:223], v[98:101]
  v_mfma_f32_16x16x32_bf16 v[102:105], v[38:41], a[220:223], v[102:105]
  ds_read_b128 v[34:37], v14 offset:41984
  ds_read_b128 v[38:41], v14 offset:62464
  s_waitcnt lgkmcnt(4)
  v_mfma_f32_16x16x32_bf16 v[82:85], v[42:45], a[64:67], v[82:85]
  v_mfma_f32_16x16x32_bf16 v[86:89], v[46:49], a[64:67], v[86:89]
  v_mfma_f32_16x16x32_bf16 v[90:93], v[42:45], a[144:147], v[90:93]
  v_mfma_f32_16x16x32_bf16 v[94:97], v[46:49], a[144:147], v[94:97]
  v_mfma_f32_16x16x32_bf16 v[98:101], v[42:45], a[224:227], v[98:101]
  v_mfma_f32_16x16x32_bf16 v[102:105], v[46:49], a[224:227], v[102:105]
  ds_read_b128 v[42:45], v15 offset:41984
  ds_read_b128 v[46:49], v15 offset:62464
  s_waitcnt lgkmcnt(4)
  v_mfma_f32_16x16x32_bf16 v[82:85], v[50:53], a[68:71], v[82:85]
  v_mfma_f32_16x16x32_bf16 v[86:89], v[54:57], a[68:71], v[86:89]
  v_mfma_f32_16x16x32_bf16 v[90:93], v[50:53], a[148:151], v[90:93]
  v_mfma_f32_16x16x32_bf16 v[94:97], v[54:57], a[148:151], v[94:97]
  v_mfma_f32_16x16x32_bf16 v[98:101], v[50:53], a[228:231], v[98:101]
  v_mfma_f32_16x16x32_bf16 v[102:105], v[54:57], a[228:231], v[102:105]
  s_waitcnt lgkmcnt(2)
  v_mfma_f32_16x16x32_bf16 v[82:85], v[34:37], a[72:75], v[82:85]
  v_mfma_f32_16x16x32_bf16 v[86:89], v[38:41], a[72:75], v[86:89]
  v_mfma_f32_16x16x32_bf16 v[90:93], v[34:37], a[152:155], v[90:93]
  v_mfma_f32_16x16x32_bf16 v[94:97], v[38:41], a[152:155], v[94:97]
  v_mfma_f32_16x16x32_bf16 v[98:101], v[34:37], a[232:235], v[98:101]
  v_mfma_f32_16x16x32_bf16 v[102:105], v[38:41], a[232:235], v[102:105]
  s_waitcnt lgkmcnt(0)
  v_mfma_f32_16x16x32_bf16 v[82:85], v[42:45], a[76:79], v[82:85]
  v_mfma_f32_16x16x32_bf16 v[86:89], v[46:49], a[76:79], v[86:89]
  v_mfma_f32_16x16x32_bf16 v[90:93], v[42:45], a[156:159], v[90:93]
  v_mfma_f32_16x16x32_bf16 v[94:97], v[46:49], a[156:159], v[94:97]
  v_mfma_f32_16x16x32_bf16 v[98:101], v[42:45], a[236:239], v[98:101]
  v_mfma_f32_16x16x32_bf16 v[102:105], v[46:49], a[236:239], v[102:105]
  s_add_u32 s30, s30, 40960
  s_add_u32 s29, s29, 1
  s_nop 0
  v_cvt_pk_bf16_f32 v106, v82, v83
  v_cvt_pk_bf16_f32 v107, v84, v85
  v_cvt_pk_bf16_f32 v108, v86, v87
  v_cvt_pk_bf16_f32 v109, v88, v89
  buffer_store_dwordx4 v[106:109], v16, s[4:7], s33 offen offset:0 sc1
  v_cvt_pk_bf16_f32 v110, v90, v91
  v_cvt_pk_bf16_f32 v111, v92, v93
  v_cvt_pk_bf16_f32 v112, v94, v95
  v_cvt_pk_bf16_f32 v113, v96, v97
  buffer_store_dwordx4 v[110:113], v16, s[4:7], s33 offen offset:1024 sc1
  v_cvt_pk_bf16_f32 v114, v98, v99
  v_cvt_pk_bf16_f32 v115, v100, v101
  v_cvt_pk_bf16_f32 v116, v102, v103
  v_cvt_pk_bf16_f32 v117, v104, v105
  buffer_store_dwordx4 v[114:117], v16, s[4:7], s33 offen offset:2048 sc1
  s_add_u32 s33, s33, 393216
  s_waitcnt vmcnt(0)
  v_mov_b32 v26, 2
  s_mov_b64 exec, 1
  buffer_store_dword v26, v24, s[4:7], s35 offen sc1
  s_mov_b64 exec, -1
  s_waitcnt vmcnt(1)
  s_barrier
  ds_read_b128 v[34:37], v12 offset:0
  ds_read_b128 v[38:41], v12 offset:20480
  ds_read_b128 v[42:45], v13 offset:0
  ds_read_b128 v[46:49], v13 offset:20480
  ds_read_b128 v[50:53], v14 offset:0
  ds_read_b128 v[54:57], v14 offset:20480
  s_waitcnt lgkmcnt(4)
  v_mfma_f32_16x16x32_bf16 v[58:61], v[34:37], a[0:3], 0
  v_mfma_f32_16x16x32_bf16 v[62:65], v[38:41], a[0:3], 0
  s_add_u32 m0, s32, 0
  s_nop 0
  buffer_load_dwordx4 v2, s[20:23], s30 offen lds
  v_mfma_f32_16x16x32_bf16 v[66:69], v[34:37], a[80:83], 0
  v_mfma_f32_16x16x32_bf16 v[70:73], v[38:41], a[80:83], 0
  v_mfma_f32_16x16x32_bf16 v[74:77], v[34:37], a[160:163], 0
  v_mfma_f32_16x16x32_bf16 v[78:81], v[38:41], a[160:163], 0
  s_add_u32 m0, s32, 1024
  s_nop 0
  buffer_load_dwordx4 v3, s[20:23], s30 offen lds
  ds_read_b128 v[34:37], v15 offset:0
  ds_read_b128 v[38:41], v15 offset:20480
  s_waitcnt lgkmcnt(4)
  v_mfma_f32_16x16x32_bf16 v[58:61], v[42:45], a[4:7], v[58:61]
  v_mfma_f32_16x16x32_bf16 v[62:65], v[46:49], a[4:7], v[62:65]
  s_add_u32 m0, s32, 2048
  s_nop 0
  buffer_load_dwordx4 v4, s[20:23], s30 offen lds
  v_mfma_f32_16x16x32_bf16 v[66:69], v[42:45], a[84:87], v[66:69]
  v_mfma_f32_16x16x32_bf16 v[70:73], v[46:49], a[84:87], v[70:73]
  v_mfma_f32_16x16x32_bf16 v[74:77], v[42:45], a[164:167], v[74:77]
  v_mfma_f32_16x16x32_bf16 v[78:81], v[46:49], a[164:167], v[78:81]
  s_add_u32 m0, s32, 3072
  s_nop 0
  buffer_load_dwordx4 v5, s[20:23], s30 offen lds
  ds_read_b128 v[42:45], v12 offset:256
  ds_read_b128 v[46:49], v12 offset:20736
  s_waitcnt lgkmcnt(4)
  v_mfma_f32_16x16x32_bf16 v[58:61], v[50:53], a[8:11], v[58:61]
  v_mfma_f32_16x16x32_bf16 v[62:65], v[54:57], a[8:11], v[62:65]
  s_add_u32 m0, s32, 4096
  s_nop 0
  buffer_load_dwordx4 v6, s[20:23], s30 offen lds
  v_mfma_f32_16x16x32_bf16 v[66:69], v[50:53], a[88:91], v[66:69]
  v_mfma_f32_16x16x32_bf16 v[70:73], v[54:57], a[88:91], v[70:73]
  v_mfma_f32_16x16x32_bf16 v[74:77], v[50:53], a[168:171], v[74:77]
  v_mfma_f32_16x16x32_bf16 v[78:81], v[54:57], a[168:171], v[78:81]
  s_add_u32 m0, s32, 5120
  s_nop 0
  buffer_load_dwordx4 v7, s[20:23], s30 offen lds
  ds_read_b128 v[50:53], v13 offset:256
  ds_read_b128 v[54:57], v13 offset:20736
  s_waitcnt lgkmcnt(4)
  v_mfma_f32_16x16x32_bf16 v[58:61], v[34:37], a[12:15], v[58:61]
  v_mfma_f32_16x16x32_bf16 v[62:65], v[38:41], a[12:15], v[62:65]
  s_add_u32 m0, s32, 6144
  s_nop 0
  buffer_load_dwordx4 v8, s[20:23], s30 offen lds
  v_mfma_f32_16x16x32_bf16 v[66:69], v[34:37], a[92:95], v[66:69]
  v_mfma_f32_16x16x32_bf16 v[70:73], v[38:41], a[92:95], v[70:73]
  v_mfma_f32_16x16x32_bf16 v[74:77], v[34:37], a[172:175], v[74:77]
  v_mfma_f32_16x16x32_bf16 v[78:81], v[38:41], a[172:175], v[78:81]
  s_add_u32 m0, s32, 7168
  s_nop 0
  buffer_load_dwordx4 v9, s[20:23], s30 offen lds
  ds_read_b128 v[34:37], v14 offset:256
  ds_read_b128 v[38:41], v14 offset:20736
  s_waitcnt lgkmcnt(4)
  v_mfma_f32_16x16x32_bf16 v[58:61], v[42:45], a[16:19], v[58:61]
  v_mfma_f32_16x16x32_bf16 v[62:65], v[46:49], a[16:19], v[62:65]
  s_add_u32 m0, s32, 8192
  s_nop 0
  buffer_load_dwordx4 v10, s[20:23], s30 offen lds
  v_mfma_f32_16x16x32_bf16 v[66:69], v[42:45], a[96:99], v[66:69]
  v_mfma_f32_16x16x32_bf16 v[70:73], v[46:49], a[96:99], v[70:73]
  v_mfma_f32_16x16x32_bf16 v[74:77], v[42:45], a[176:179], v[74:77]
  v_mfma_f32_16x16x32_bf16 v[78:81], v[46:49], a[176:179], v[78:81]
  s_add_u32 m0, s32, 9216
  s_nop 0
  buffer_load_dwordx4 v11, s[20:23], s30 offen lds
  ds_read_b128 v[42:45], v15 offset:256
  ds_read_b128 v[46:49], v15 offset:20736
  s_waitcnt lgkmcnt(4)
  v_mfma_f32_16x16x32_bf16 v[58:61], v[50:53], a[20:23], v[58:61]
  v_mfma_f32_16x16x32_bf16 v[62:65], v[54:57], a[20:23], v[62:65]
  v_mfma_f32_16x16x32_bf16 v[66:69], v[50:53], a[100:103], v[66:69]
  v_mfma_f32_16x16x32_bf16 v[70:73], v[54:57], a[100:103], v[70:73]
  v_mfma_f32_16x16x32_bf16 v[74:77], v[50:53], a[180:183], v[74:77]
  v_mfma_f32_16x16x32_bf16 v[78:81], v[54:57], a[180:183], v[78:81]
  ds_read_b128 v[50:53], v12 offset:512
  ds_read_b128 v[54:57], v12 offset:20992
  s_waitcnt lgkmcnt(4)
  v_mfma_f32_16x16x32_bf16 v[58:61], v[34:37], a[24:27], v[58:61]
  v_mfma_f32_16x16x32_bf16 v[62:65], v[38:41], a[24:27], v[62:65]
  v_mfma_f32_16x16x32_bf16 v[66:69], v[34:37], a[104:107], v[66:69]
  v_mfma_f32_16x16x32_bf16 v[70:73], v[38:41], a[104:107], v[70:73]
  v_mfma_f32_16x16x32_bf16 v[74:77], v[34:37], a[184:187], v[74:77]
  v_mfma_f32_16x16x32_bf16 v[78:81], v[38:41], a[184:187], v[78:81]
  ds_read_b128 v[34:37], v13 offset:512
  ds_read_b128 v[38:41], v13 offset:20992
  s_waitcnt lgkmcnt(4)
  v_mfma_f32_16x16x32_bf16 v[58:61], v[42:45], a[28:31], v[58:61]
  v_mfma_f32_16x16x32_bf16 v[62:65], v[46:49], a[28:31], v[62:65]
  v_mfma_f32_16x16x32_bf16 v[66:69], v[42:45], a[108:111], v[66:69]
  v_mfma_f32_16x16x32_bf16 v[70:73], v[46:49], a[108:111], v[70:73]
  v_mfma_f32_16x16x32_bf16 v[74:77], v[42:45], a[188:191], v[74:77]
  v_mfma_f32_16x16x32_bf16 v[78:81], v[46:49], a[188:191], v[78:81]
  ds_read_b128 v[42:45], v14 offset:512
  ds_read_b128 v[46:49], v14 offset:20992
  s_waitcnt lgkmcnt(4)
  v_mfma_f32_16x16x32_bf16 v[58:61], v[50:53], a[32:35], v[58:61]
  v_mfma_f32_16x16x32_bf16 v[62:65], v[54:57], a[32:35], v[62:65]
  v_mfma_f32_16x16x32_bf16 v[66:69], v[50:53], a[112:115], v[66:69]
  v_mfma_f32_16x16x32_bf16 v[70:73], v[54:57], a[112:115], v[70:73]
  v_mfma_f32_16x16x32_bf16 v[74:77], v[50:53], a[192:195], v[74:77]
  v_mfma_f32_16x16x32_bf16 v[78:81], v[54:57], a[192:195], v[78:81]
  ds_read_b128 v[50:53], v15 offset:512
  ds_read_b128 v[54:57], v15 offset:20992
  s_waitcnt lgkmcnt(4)
  v_mfma_f32_16x16x32_bf16 v[58:61], v[34:37], a[36:39], v[58:61]
  v_mfma_f32_16x16x32_bf16 v[62:65], v[38:41], a[36:39], v[62:65]
  v_mfma_f32_16x16x32_bf16 v[66:69], v[34:37], a[116:119], v[66:69]
  v_mfma_f32_16x16x32_bf16 v[70:73], v[38:41], a[116:119], v[70:73]
  v_mfma_f32_16x16x32_bf16 v[74:77], v[34:37], a[196:199], v[74:77]
  v_mfma_f32_16x16x32_bf16 v[78:81], v[38:41], a[196:199], v[78:81]
  ds_read_b128 v[34:37], v12 offset:768
  ds_read_b128 v[38:41], v12 offset:21248
  s_waitcnt lgkmcnt(4)
  v_mfma_f32_16x16x32_bf16 v[58:61], v[42:45], a[40:43], v[58:61]
  v_mfma_f32_16x16x32_bf16 v[62:65], v[46:49], a[40:43], v[62:65]
  v_mfma_f32_16x16x32_bf16 v[66:69], v[42:45], a[120:123], v[66:69]
  v_mfma_f32_16x16x32_bf16 v[70:73], v[46:49], a[120:123], v[70:73]
  v_mfma_f32_16x16x32_bf16 v[74:77], v[42:45], a[200:203], v[74:77]
  v_mfma_f32_16x16x32_bf16 v[78:81], v[46:49], a[200:203], v[78:81]
  ds_read_b128 v[42:45], v13 offset:768
  ds_read_b128 v[46:49], v13 offset:21248
  s_waitcnt lgkmcnt(4)
  v_mfma_f32_16x16x32_bf16 v[58:61], v[50:53], a[44:47], v[58:61]
  v_mfma_f32_16x16x32_bf16 v[62:65], v[54:57], a[44:47], v[62:65]
  v_mfma_f32_16x16x32_bf16 v[66:69], v[50:53], a[124:127], v[66:69]
  v_mfma_f32_16x16x32_bf16 v[70:73], v[54:57], a[124:127], v[70:73]
  v_mfma_f32_16x16x32_bf16 v[74:77], v[50:53], a[204:207], v[74:77]
  v_mfma_f32_16x16x32_bf16 v[78:81], v[54:57], a[204:207], v[78:81]
  ds_read_b128 v[50:53], v14 offset:768
  ds_read_b128 v[54:57], v14 offset:21248
  s_waitcnt lgkmcnt(4)
  v_mfma_f32_16x16x32_bf16 v[58:61], v[34:37], a[48:51], v[58:61]
  v_mfma_f32_16x16x32_bf16 v[62:65], v[38:41], a[48:51], v[62:65]
  v_mfma_f32_16x16x32_bf16 v[66:69], v[34:37], a[128:131], v[66:69]
  v_mfma_f32_16x16x32_bf16 v[70:73], v[38:41], a[128:131], v[70:73]
  v_mfma_f32_16x16x32_bf16 v[74:77], v[34:37], a[208:211], v[74:77]
  v_mfma_f32_16x16x32_bf16 v[78:81], v[38:41], a[208:211], v[78:81]
  ds_read_b128 v[34:37], v15 offset:768
  ds_read_b128 v[38:41], v15 offset:21248
  s_waitcnt lgkmcnt(4)
  v_mfma_f32_16x16x32_bf16 v[58:61], v[42:45], a[52:55], v[58:61]
  v_mfma_f32_16x16x32_bf16 v[62:65], v[46:49], a[52:55], v[62:65]
  v_mfma_f32_16x16x32_bf16 v[66:69], v[42:45], a[132:135], v[66:69]
  v_mfma_f32_16x16x32_bf16 v[70:73], v[46:49], a[132:135], v[70:73]
  v_mfma_f32_16x16x32_bf16 v[74:77], v[42:45], a[212:215], v[74:77]
  v_mfma_f32_16x16x32_bf16 v[78:81], v[46:49], a[212:215], v[78:81]
  ds_read_b128 v[42:45], v12 offset:1024
  ds_read_b128 v[46:49], v12 offset:21504
  s_waitcnt lgkmcnt(4)
  v_mfma_f32_16x16x32_bf16 v[58:61], v[50:53], a[56:59], v[58:61]
  v_mfma_f32_16x16x32_bf16 v[62:65], v[54:57], a[56:59], v[62:65]
  v_mfma_f32_16x16x32_bf16 v[66:69], v[50:53], a[136:139], v[66:69]
  v_mfma_f32_16x16x32_bf16 v[70:73], v[54:57], a[136:139], v[70:73]
  v_mfma_f32_16x16x32_bf16 v[74:77], v[50:53], a[216:219], v[74:77]
  v_mfma_f32_16x16x32_bf16 v[78:81], v[54:57], a[216:219], v[78:81]
  ds_read_b128 v[50:53], v13 offset:1024
  ds_read_b128 v[54:57], v13 offset:21504
  s_waitcnt lgkmcnt(4)
  v_mfma_f32_16x16x32_bf16 v[58:61], v[34:37], a[60:63], v[58:61]
  v_mfma_f32_16x16x32_bf16 v[62:65], v[38:41], a[60:63], v[62:65]
  v_mfma_f32_16x16x32_bf16 v[66:69], v[34:37], a[140:143], v[66:69]
  v_mfma_f32_16x16x32_bf16 v[70:73], v[38:41], a[140:143], v[70:73]
  v_mfma_f32_16x16x32_bf16 v[74:77], v[34:37], a[220:223], v[74:77]
  v_mfma_f32_16x16x32_bf16 v[78:81], v[38:41], a[220:223], v[78:81]
  ds_read_b128 v[34:37], v14 offset:1024
  ds_read_b128 v[38:41], v14 offset:21504
  s_waitcnt lgkmcnt(4)
  v_mfma_f32_16x16x32_bf16 v[58:61], v[42:45], a[64:67], v[58:61]
  v_mfma_f32_16x16x32_bf16 v[62:65], v[46:49], a[64:67], v[62:65]
  v_mfma_f32_16x16x32_bf16 v[66:69], v[42:45], a[144:147], v[66:69]
  v_mfma_f32_16x16x32_bf16 v[70:73], v[46:49], a[144:147], v[70:73]
  v_mfma_f32_16x16x32_bf16 v[74:77], v[42:45], a[224:227], v[74:77]
  v_mfma_f32_16x16x32_bf16 v[78:81], v[46:49], a[224:227], v[78:81]
  ds_read_b128 v[42:45], v15 offset:1024
  ds_read_b128 v[46:49], v15 offset:21504
  s_waitcnt lgkmcnt(4)
  v_mfma_f32_16x16x32_bf16 v[58:61], v[50:53], a[68:71], v[58:61]
  v_mfma_f32_16x16x32_bf16 v[62:65], v[54:57], a[68:71], v[62:65]
  v_mfma_f32_16x16x32_bf16 v[66:69], v[50:53], a[148:151], v[66:69]
  v_mfma_f32_16x16x32_bf16 v[70:73], v[54:57], a[148:151], v[70:73]
  v_mfma_f32_16x16x32_bf16 v[74:77], v[50:53], a[228:231], v[74:77]
  v_mfma_f32_16x16x32_bf16 v[78:81], v[54:57], a[228:231], v[78:81]
  s_waitcnt lgkmcnt(2)
  v_mfma_f32_16x16x32_bf16 v[58:61], v[34:37], a[72:75], v[58:61]
  v_mfma_f32_16x16x32_bf16 v[62:65], v[38:41], a[72:75], v[62:65]
  v_mfma_f32_16x16x32_bf16 v[66:69], v[34:37], a[152:155], v[66:69]
  v_mfma_f32_16x16x32_bf16 v[70:73], v[38:41], a[152:155], v[70:73]
  v_mfma_f32_16x16x32_bf16 v[74:77], v[34:37], a[232:235], v[74:77]
  v_mfma_f32_16x16x32_bf16 v[78:81], v[38:41], a[232:235], v[78:81]
  s_waitcnt lgkmcnt(0)
  v_mfma_f32_16x16x32_bf16 v[58:61], v[42:45], a[76:79], v[58:61]
  v_mfma_f32_16x16x32_bf16 v[62:65], v[46:49], a[76:79], v[62:65]
  v_mfma_f32_16x16x32_bf16 v[66:69], v[42:45], a[156:159], v[66:69]
  v_mfma_f32_16x16x32_bf16 v[70:73], v[46:49], a[156:159], v[70:73]
  v_mfma_f32_16x16x32_bf16 v[74:77], v[42:45], a[236:239], v[74:77]
  v_mfma_f32_16x16x32_bf16 v[78:81], v[46:49], a[236:239], v[78:81]
  s_add_u32 s30, s30, 40960
  s_add_u32 s29, s29, 1
  s_waitcnt vmcnt(0)
  s_branch L_v_odd
  s_waitcnt vmcnt(0)
L_v_loop:
  s_waitcnt vmcnt(3)
  s_barrier
  ds_read_b128 v[34:37], v12 offset:0
  ds_read_b128 v[38:41], v12 offset:20480
  ds_read_b128 v[42:45], v13 offset:0
  ds_read_b128 v[46:49], v13 offset:20480
  ds_read_b128 v[50:53], v14 offset:0
  ds_read_b128 v[54:57], v14 offset:20480
  s_waitcnt lgkmcnt(4)
  v_mfma_f32_16x16x32_bf16 v[58:61], v[34:37], a[0:3], 0
  v_mfma_f32_16x16x32_bf16 v[62:65], v[38:41], a[0:3], 0
  s_add_u32 m0, s32, 0
  s_nop 0
  buffer_load_dwordx4 v2, s[20:23], s30 offen lds
  v_mfma_f32_16x16x32_bf16 v[66:69], v[34:37], a[80:83], 0
  v_mfma_f32_16x16x32_bf16 v[70:73], v[38:41], a[80:83], 0
  v_mfma_f32_16x16x32_bf16 v[74:77], v[34:37], a[160:163], 0
  v_mfma_f32_16x16x32_bf16 v[78:81], v[38:41], a[160:163], 0
  s_add_u32 m0, s32, 1024
  s_nop 0
  buffer_load_dwordx4 v3, s[20:23], s30 offen lds
  ds_read_b128 v[34:37], v15 offset:0
  ds_read_b128 v[38:41], v15 offset:20480
  s_waitcnt lgkmcnt(4)
  v_mfma_f32_16x16x32_bf16 v[58:61], v[42:45], a[4:7], v[58:61]
  v_mfma_f32_16x16x32_bf16 v[62:65], v[46:49], a[4:7], v[62:65]
  s_add_u32 m0, s32, 2048
  s_nop 0
  buffer_load_dwordx4 v4, s[20:23], s30 offen lds
  v_mfma_f32_16x16x32_bf16 v[66:69], v[42:45], a[84:87], v[66:69]
  v_mfma_f32_16x16x32_bf16 v[70:73], v[46:49], a[84:87], v[70:73]
  v_mfma_f32_16x16x32_bf16 v[74:77], v[42:45], a[164:167], v[74:77]
  v_mfma_f32_16x16x32_bf16 v[78:81], v[46:49], a[164:167], v[78:81]
  s_add_u32 m0, s32, 3072
  s_nop 0
  buffer_load_dwordx4 v5, s[20:23], s30 offen lds
  ds_read_b128 v[42:45], v12 offset:256
  ds_read_b128 v[46:49], v12 offset:20736
  s_waitcnt lgkmcnt(4)
  v_mfma_f32_16x16x32_bf16 v[58:61], v[50:53], a[8:11], v[58:61]
  v_mfma_f32_16x16x32_bf16 v[62:65], v[54:57], a[8:11], v[62:65]
  s_add_u32 m0, s32, 4096
  s_nop 0
  buffer_load_dwordx4 v6, s[20:23], s30 offen lds
  v_mfma_f32_16x16x32_bf16 v[66:69], v[50:53], a[88:91], v[66:69]
  v_mfma_f32_16x16x32_bf16 v[70:73], v[54:57], a[88:91], v[70:73]
  v_mfma_f32_16x16x32_bf16 v[74:77], v[50:53], a[168:171], v[74:77]
  v_mfma_f32_16x16x32_bf16 v[78:81], v[54:57], a[168:171], v[78:81]
  s_add_u32 m0, s32, 5120
  s_nop 0
  buffer_load_dwordx4 v7, s[20:23], s30 offen lds
  ds_read_b128 v[50:53], v13 offset:256
  ds_read_b128 v[54:57], v13 offset:20736
  s_waitcnt lgkmcnt(4)
  v_mfma_f32_16x16x32_bf16 v[58:61], v[34:37], a[12:15], v[58:61]
  v_mfma_f32_16x16x32_bf16 v[62:65], v[38:41], a[12:15], v[62:65]
  s_add_u32 m0, s32, 6144
  s_nop 0
  buffer_load_dwordx4 v8, s[20:23], s30 offen lds
  v_mfma_f32_16x16x32_bf16 v[66:69], v[34:37], a[92:95], v[66:69]
  v_mfma_f32_16x16x32_bf16 v[70:73], v[38:41], a[92:95], v[70:73]
  v_mfma_f32_16x16x32_bf16 v[74:77], v[34:37], a[172:175], v[74:77]
  v_mfma_f32_16x16x32_bf16 v[78:81], v[38:41], a[172:175], v[78:81]
  s_add_u32 m0, s32, 7168
  s_nop 0
  buffer_load_dwordx4 v9, s[20:23], s30 offen lds
  ds_read_b128 v[34:37], v14 offset:256
  ds_read_b128 v[38:41], v14 offset:20736
  s_waitcnt lgkmcnt(4)
  v_mfma_f32_16x16x32_bf16 v[58:61], v[42:45], a[16:19], v[58:61]
  v_mfma_f32_16x16x32_bf16 v[62:65], v[46:49], a[16:19], v[62:65]
  s_add_u32 m0, s32, 8192
  s_nop 0
  buffer_load_dwordx4 v10, s[20:23], s30 offen lds
  v_mfma_f32_16x16x32_bf16 v[66:69], v[42:45], a[96:99], v[66:69]
  v_mfma_f32_16x16x32_bf16 v[70:73], v[46:49], a[96:99], v[70:73]
  v_mfma_f32_16x16x32_bf16 v[74:77], v[42:45], a[176:179], v[74:77]
  v_mfma_f32_16x16x32_bf16 v[78:81], v[46:49], a[176:179], v[78:81]
  s_add_u32 m0, s32, 9216
  s_nop 0
  buffer_load_dwordx4 v11, s[20:23], s30 offen lds
  s_waitcnt vmcnt(10)
  s_sub_u32 s38, s29, 1
  v_mov_b32 v26, s38
  s_mov_b64 exec, 1
  buffer_store_dword v26, v24, s[4:7], s35 offen sc1
  s_mov_b64 exec, -1
  ds_read_b128 v[42:45], v15 offset:256
  ds_read_b128 v[46:49], v15 offset:20736
  s_waitcnt lgkmcnt(4)
  v_mfma_f32_16x16x32_bf16 v[58:61], v[50:53], a[20:23], v[58:61]
  v_mfma_f32_16x16x32_bf16 v[62:65], v[54:57], a[20:23], v[62:65]
  v_cvt_pk_bf16_f32 v106, v82, v83
  v_cvt_pk_bf16_f32 v107, v84, v85
  v_mfma_f32_16x16x32_bf16 v[66:69], v[50:53], a[100:103], v[66:69]
  v_mfma_f32_16x16x32_bf16 v[70:73], v[54:57], a[100:103], v[70:73]
  v_cvt_pk_bf16_f32 v108, v86, v87
  v_cvt_pk_bf16_f32 v109, v88, v89
  v_mfma_f32_16x16x32_bf16 v[74:77], v[50:53], a[180:183], v[74:77]
  v_mfma_f32_16x16x32_bf16 v[78:81], v[54:57], a[180:183], v[78:81]
  buffer_store_dwordx4 v[106:109], v16, s[4:7], s33 offen offset:0 sc1
  ds_read_b128 v[50:53], v12 offset:512
  ds_read_b128 v[54:57], v12 offset:20992
  s_waitcnt lgkmcnt(4)
  v_mfma_f32_16x16x32_bf16 v[58:61], v[34:37], a[24:27], v[58:61]
  v_mfma_f32_16x16x32_bf16 v[62:65], v[38:41], a[24:27], v[62:65]
  v_cvt_pk_bf16_f32 v110, v90, v91
  v_cvt_pk_bf16_f32 v111, v92, v93
  v_mfma_f32_16x16x32_bf16 v[66:69], v[34:37], a[104:107], v[66:69]
  v_mfma_f32_16x16x32_bf16 v[70:73], v[38:41], a[104:107], v[70:73]
  v_cvt_pk_bf16_f32 v112, v94, v95
  v_cvt_pk_bf16_f32 v113, v96, v97
  v_mfma_f32_16x16x32_bf16 v[74:77], v[34:37], a[184:187], v[74:77]
  v_mfma_f32_16x16x32_bf16 v[78:81], v[38:41], a[184:187], v[78:81]
  buffer_store_dwordx4 v[110:113], v16, s[4:7], s33 offen offset:1024 sc1
  ds_read_b128 v[34:37], v13 offset:512
  ds_read_b128 v[38:41], v13 offset:20992
  s_waitcnt lgkmcnt(4)
  v_mfma_f32_16x16x32_bf16 v[58:61], v[42:45], a[28:31], v[58:61]
  v_mfma_f32_16x16x32_bf16 v[62:65], v[46:49], a[28:31], v[62:65]
  v_cvt_pk_bf16_f32 v114, v98, v99
  v_cvt_pk_bf16_f32 v115, v100, v101
  v_mfma_f32_16x16x32_bf16 v[66:69], v[42:45], a[108:111], v[66:69]
  v_mfma_f32_16x16x32_bf16 v[70:73], v[46:49], a[108:111], v[70:73]
  v_cvt_pk_bf16_f32 v116, v102, v103
  v_cvt_pk_bf16_f32 v117, v104, v105
  v_mfma_f32_16x16x32_bf16 v[74:77], v[42:45], a[188:191], v[74:77]
  v_mfma_f32_16x16x32_bf16 v[78:81], v[46:49], a[188:191], v[78:81]
  buffer_store_dwordx4 v[114:117], v16, s[4:7], s33 offen offset:2048 sc1
  s_add_u32 s33, s33, 393216
  ds_read_b128 v[42:45], v14 offset:512
  ds_read_b128 v[46:49], v14 offset:20992
  s_waitcnt lgkmcnt(4)
  v_mfma_f32_16x16x32_bf16 v[58:61], v[50:53], a[32:35], v[58:61]
  v_mfma_f32_16x16x32_bf16 v[62:65], v[54:57], a[32:35], v[62:65]
  v_mfma_f32_16x16x32_bf16 v[66:69], v[50:53], a[112:115], v[66:69]
  v_mfma_f32_16x16x32_bf16 v[70:73], v[54:57], a[112:115], v[70:73]
  v_mfma_f32_16x16x32_bf16 v[74:77], v[50:53], a[192:195], v[74:77]
  v_mfma_f32_16x16x32_bf16 v[78:81], v[54:57], a[192:195], v[78:81]
  ds_read_b128 v[50:53], v15 offset:512
  ds_read_b128 v[54:57], v15 offset:20992
  s_waitcnt lgkmcnt(4)
  v_mfma_f32_16x16x32_bf16 v[58:61], v[34:37], a[36:39], v[58:61]
  v_mfma_f32_16x16x32_bf16 v[62:65], v[38:41], a[36:39], v[62:65]
  v_mfma_f32_16x16x32_bf16 v[66:69], v[34:37], a[116:119], v[66:69]
  v_mfma_f32_16x16x32_bf16 v[70:73], v[38:41], a[116:119], v[70:73]
  v_mfma_f32_16x16x32_bf16 v[74:77], v[34:37], a[196:199], v[74:77]
  v_mfma_f32_16x16x32_bf16 v[78:81], v[38:41], a[196:199], v[78:81]
  ds_read_b128 v[34:37], v12 offset:768
  ds_read_b128 v[38:41], v12 offset:21248
  s_waitcnt lgkmcnt(4)
  v_mfma_f32_16x16x32_bf16 v[58:61], v[42:45], a[40:43], v[58:61]
  v_mfma_f32_16x16x32_bf16 v[62:65], v[46:49], a[40:43], v[62:65]
  v_mfma_f32_16x16x32_bf16 v[66:69], v[42:45], a[120:123], v[66:69]
  v_mfma_f32_16x16x32_bf16 v[70:73], v[46:49], a[120:123], v[70:73]
  v_mfma_f32_16x16x32_bf16 v[74:77], v[42:45], a[200:203], v[74:77]
  v_mfma_f32_16x16x32_bf16 v[78:81], v[46:49], a[200:203], v[78:81]
  ds_read_b128 v[42:45], v13 offset:768
  ds_read_b128 v[46:49], v13 offset:21248
  s_waitcnt lgkmcnt(4)
  v_mfma_f32_16x16x32_bf16 v[58:61], v[50:53], a[44:47], v[58:61]
  v_mfma_f32_16x16x32_bf16 v[62:65], v[54:57], a[44:47], v[62:65]
  v_mfma_f32_16x16x32_bf16 v[66:69], v[50:53], a[124:127], v[66:69]
  v_mfma_f32_16x16x32_bf16 v[70:73], v[54:57], a[124:127], v[70:73]
  v_mfma_f32_16x16x32_bf16 v[74:77], v[50:53], a[204:207], v[74:77]
  v_mfma_f32_16x16x32_bf16 v[78:81], v[54:57], a[204:207], v[78:81]
  ds_read_b128 v[50:53], v14 offset:768
  ds_read_b128 v[54:57], v14 offset:21248
  s_waitcnt lgkmcnt(4)
  v_mfma_f32_16x16x32_bf16 v[58:61], v[34:37], a[48:51], v[58:61]
  v_mfma_f32_16x16x32_bf16 v[62:65], v[38:41], a[48:51], v[62:65]
  v_mfma_f32_16x16x32_bf16 v[66:69], v[34:37], a[128:131], v[66:69]
  v_mfma_f32_16x16x32_bf16 v[70:73], v[38:41], a[128:131], v[70:73]
  v_mfma_f32_16x16x32_bf16 v[74:77], v[34:37], a[208:211], v[74:77]
  v_mfma_f32_16x16x32_bf16 v[78:81], v[38:41], a[208:211], v[78:81]
  ds_read_b128 v[34:37], v15 offset:768
  ds_read_b128 v[38:41], v15 offset:21248
  s_waitcnt lgkmcnt(4)
  v_mfma_f32_16x16x32_bf16 v[58:61], v[42:45], a[52:55], v[58:61]
  v_mfma_f32_16x16x32_bf16 v[62:65], v[46:49], a[52:55], v[62:65]
  v_mfma_f32_16x16x32_bf16 v[66:69], v[42:45], a[132:135], v[66:69]
  v_mfma_f32_16x16x32_bf16 v[70:73], v[46:49], a[132:135], v[70:73]
  v_mfma_f32_16x16x32_bf16 v[74:77], v[42:45], a[212:215], v[74:77]
  v_mfma_f32_16x16x32_bf16 v[78:81], v[46:49], a[212:215], v[78:81]
  ds_read_b128 v[42:45], v12 offset:1024
  ds_read_b128 v[46:49], v12 offset:21504
  s_waitcnt lgkmcnt(4)
  v_mfma_f32_16x16x32_bf16 v[58:61], v[50:53], a[56:59], v[58:61]
  v_mfma_f32_16x16x32_bf16 v[62:65], v[54:57], a[56:59], v[62:65]
  v_mfma_f32_16x16x32_bf16 v[66:69], v[50:53], a[136:139], v[66:69]
  v_mfma_f32_16x16x32_bf16 v[70:73], v[54:57], a[136:139], v[70:73]
  v_mfma_f32_16x16x32_bf16 v[74:77], v[50:53], a[216:219], v[74:77]
  v_mfma_f32_16x16x32_bf16 v[78:81], v[54:57], a[216:219], v[78:81]
  ds_read_b128 v[50:53], v13 offset:1024
  ds_read_b128 v[54:57], v13 offset:21504
  s_waitcnt lgkmcnt(4)
  v_mfma_f32_16x16x32_bf16 v[58:61], v[34:37], a[60:63], v[58:61]
  v_mfma_f32_16x16x32_bf16 v[62:65], v[38:41], a[60:63], v[62:65]
  v_mfma_f32_16x16x32_bf16 v[66:69], v[34:37], a[140:143], v[66:69]
  v_mfma_f32_16x16x32_bf16 v[70:73], v[38:41], a[140:143], v[70:73]
  v_mfma_f32_16x16x32_bf16 v[74:77], v[34:37], a[220:223], v[74:77]
  v_mfma_f32_16x16x32_bf16 v[78:81], v[38:41], a[220:223], v[78:81]
  ds_read_b128 v[34:37], v14 offset:1024
  ds_read_b128 v[38:41], v14 offset:21504
  s_waitcnt lgkmcnt(4)
  v_mfma_f32_16x16x32_bf16 v[58:61], v[42:45], a[64:67], v[58:61]
  v_mfma_f32_16x16x32_bf16 v[62:65], v[46:49], a[64:67], v[62:65]
  v_mfma_f32_16x16x32_bf16 v[66:69], v[42:45], a[144:147], v[66:69]
  v_mfma_f32_16x16x32_bf16 v[70:73], v[46:49], a[144:147], v[70:73]
  v_mfma_f32_16x16x32_bf16 v[74:77], v[42:45], a[224:227], v[74:77]
  v_mfma_f32_16x16x32_bf16 v[78:81], v[46:49], a[224:227], v[78:81]
  ds_read_b128 v[42:45], v15 offset:1024
  ds_read_b128 v[46:49], v15 offset:21504
  s_waitcnt lgkmcnt(4)
  v_mfma_f32_16x16x32_bf16 v[58:61], v[50:53], a[68:71], v[58:61]
  v_mfma_f32_16x16x32_bf16 v[62:65], v[54:57], a[68:71], v[62:65]
  v_mfma_f32_16x16x32_bf16 v[66:69], v[50:53], a[148:151], v[66:69]
  v_mfma_f32_16x16x32_bf16 v[70:73], v[54:57], a[148:151], v[70:73]
  v_mfma_f32_16x16x32_bf16 v[74:77], v[50:53], a[228:231], v[74:77]
  v_mfma_f32_16x16x32_bf16 v[78:81], v[54:57], a[228:231], v[78:81]
  s_waitcnt lgkmcnt(2)
  v_mfma_f32_16x16x32_bf16 v[58:61], v[34:37], a[72:75], v[58:61]
  v_mfma_f32_16x16x32_bf16 v[62:65], v[38:41], a[72:75], v[62:65]
  v_mfma_f32_16x16x32_bf16 v[66:69], v[34:37], a[152:155], v[66:69]
  v_mfma_f32_16x16x32_bf16 v[70:73], v[38:41], a[152:155], v[70:73]
  v_mfma_f32_16x16x32_bf16 v[74:77], v[34:37], a[232:235], v[74:77]
  v_mfma_f32_16x16x32_bf16 v[78:81], v[38:41], a[232:235], v[78:81]
  s_waitcnt lgkmcnt(0)
  v_mfma_f32_16x16x32_bf16 v[58:61], v[42:45], a[76:79], v[58:61]
  v_mfma_f32_16x16x32_bf16 v[62:65], v[46:49], a[76:79], v[62:65]
  v_mfma_f32_16x16x32_bf16 v[66:69], v[42:45], a[156:159], v[66:69]
  v_mfma_f32_16x16x32_bf16 v[70:73], v[46:49], a[156:159], v[70:73]
  v_mfma_f32_16x16x32_bf16 v[74:77], v[42:45], a[236:239], v[74:77]
  v_mfma_f32_16x16x32_bf16 v[78:81], v[46:49], a[236:239], v[78:81]
  s_add_u32 s30, s30, 40960
  s_add_u32 s29, s29, 1
L_v_odd:
  s_waitcnt vmcnt(3)
  s_barrier
  ds_read_b128 v[34:37], v12 offset:40960
  ds_read_b128 v[38:41], v12 offset:61440
  ds_read_b128 v[42:45], v13 offset:40960
  ds_read_b128 v[46:49], v13 offset:61440
  ds_read_b128 v[50:53], v14 offset:40960
  ds_read_b128 v[54:57], v14 offset:61440
  s_waitcnt lgkmcnt(4)
  v_mfma_f32_16x16x32_bf16 v[82:85], v[34:37], a[0:3], 0
  v_mfma_f32_16x16x32_bf16 v[86:89], v[38:41], a[0:3], 0
  s_add_u32 m0, s31, 0
  s_nop 0
  buffer_load_dwordx4 v2, s[20:23], s30 offen lds
  v_mfma_f32_16x16x32_bf16 v[90:93], v[34:37], a[80:83], 0
  v_mfma_f32_16x16x32_bf16 v[94:97], v[38:41], a[80:83], 0
  v_mfma_f32_16x16x32_bf16 v[98:101], v[34:37], a[160:163], 0
  v_mfma_f32_16x16x32_bf16 v[102:105], v[38:41], a[160:163], 0
  s_add_u32 m0, s31, 1024
  s_nop 0
  buffer_load_dwordx4 v3, s[20:23], s30 offen lds
  ds_read_b128 v[34:37], v15 offset:40960
  ds_read_b128 v[38:41], v15 offset:61440
  s_waitcnt lgkmcnt(4)
  v_mfma_f32_16x16x32_bf16 v[82:85], v[42:45], a[4:7], v[82:85]
  v_mfma_f32_16x16x32_bf16 v[86:89], v[46:49], a[4:7], v[86:89]
  s_add_u32 m0, s31, 2048
  s_nop 0
  buffer_load_dwordx4 v4, s[20:23], s30 offen lds
  v_mfma_f32_16x16x32_bf16 v[90:93], v[42:45], a[84:87], v[90:93]
  v_mfma_f32_16x16x32_bf16 v[94:97], v[46:49], a[84:87], v[94:97]
  v_mfma_f32_16x16x32_bf16 v[98:101], v[42:45], a[164:167], v[98:101]
  v_mfma_f32_16x16x32_bf16 v[102:105], v[46:49], a[164:167], v[102:105]
  s_add_u32 m0, s31, 3072
  s_nop 0
  buffer_load_dwordx4 v5, s[20:23], s30 offen lds
  ds_read_b128 v[42:45], v12 offset:41216
  ds_read_b128 v[46:49], v12 offset:61696
  s_waitcnt lgkmcnt(4)
  v_mfma_f32_16x16x32_bf16 v[82:85], v[50:53], a[8:11], v[82:85]
  v_mfma_f32_16x16x32_bf16 v[86:89], v[54:57], a[8:11], v[86:89]
  s_add_u32 m0, s31, 4096
  s_nop 0
  buffer_load_dwordx4 v6, s[20:23], s30 offen lds
  v_mfma_f32_16x16x32_bf16 v[90:93], v[50:53], a[88:91], v[90:93]
  v_mfma_f32_16x16x32_bf16 v[94:97], v[54:57], a[88:91], v[94:97]
  v_mfma_f32_16x16x32_bf16 v[98:101], v[50:53], a[168:171], v[98:101]
  v_mfma_f32_16x16x32_bf16 v[102:105], v[54:57], a[168:171], v[102:105]
  s_add_u32 m0, s31, 5120
  s_nop 0
  buffer_load_dwordx4 v7, s[20:23], s30 offen lds
  ds_read_b128 v[50:53], v13 offset:41216
  ds_read_b128 v[54:57], v13 offset:61696
  s_waitcnt lgkmcnt(4)
  v_mfma_f32_16x16x32_bf16 v[82:85], v[34:37], a[12:15], v[82:85]
  v_mfma_f32_16x16x32_bf16 v[86:89], v[38:41], a[12:15], v[86:89]
  s_add_u32 m0, s31, 6144
  s_nop 0
  buffer_load_dwordx4 v8, s[20:23], s30 offen lds
  v_mfma_f32_16x16x32_bf16 v[90:93], v[34:37], a[92:95], v[90:93]
  v_mfma_f32_16x16x32_bf16 v[94:97], v[38:41], a[92:95], v[94:97]
  v_mfma_f32_16x16x32_bf16 v[98:101], v[34:37], a[172:175], v[98:101]
  v_mfma_f32_16x16x32_bf16 v[102:105], v[38:41], a[172:175], v[102:105]
  s_add_u32 m0, s31, 7168
  s_nop 0
  buffer_load_dwordx4 v9, s[20:23], s30 offen lds
  ds_read_b128 v[34:37], v14 offset:41216
  ds_read_b128 v[38:41], v14 offset:61696
  s_waitcnt lgkmcnt(4)
  v_mfma_f32_16x16x32_bf16 v[82:85], v[42:45], a[16:19], v[82:85]
  v_mfma_f32_16x16x32_bf16 v[86:89], v[46:49], a[16:19], v[86:89]
  s_add_u32 m0, s31, 8192
  s_nop 0
  buffer_load_dwordx4 v10, s[20:23], s30 offen lds
  v_mfma_f32_16x16x32_bf16 v[90:93], v[42:45], a[96:99], v[90:93]
  v_mfma_f32_16x16x32_bf16 v[94:97], v[46:49], a[96:99], v[94:97]
  v_mfma_f32_16x16x32_bf16 v[98:101], v[42:45], a[176:179], v[98:101]
  v_mfma_f32_16x16x32_bf16 v[102:105], v[46:49], a[176:179], v[102:105]
  s_add_u32 m0, s31, 9216
  s_nop 0
  buffer_load_dwordx4 v11, s[20:23], s30 offen lds
  s_waitcnt vmcnt(10)
  s_sub_u32 s38, s29, 1
  v_mov_b32 v26, s38
  s_mov_b64 exec, 1
  buffer_store_dword v26, v24, s[4:7], s35 offen sc1
  s_mov_b64 exec, -1
  ds_read_b128 v[42:45], v15 offset:41216
  ds_read_b128 v[46:49], v15 offset:61696
  s_waitcnt lgkmcnt(4)
  v_mfma_f32_16x16x32_bf16 v[82:85], v[50:53], a[20:23], v[82:85]
  v_mfma_f32_16x16x32_bf16 v[86:89], v[54:57], a[20:23], v[86:89]
  v_cvt_pk_bf16_f32 v106, v58, v59
  v_cvt_pk_bf16_f32 v107, v60, v61
  v_mfma_f32_16x16x32_bf16 v[90:93], v[50:53], a[100:103], v[90:93]
  v_mfma_f32_16x16x32_bf16 v[94:97], v[54:57], a[100:103], v[94:97]
  v_cvt_pk_bf16_f32 v108, v62, v63
  v_cvt_pk_bf16_f32 v109, v64, v65
  v_mfma_f32_16x16x32_bf16 v[98:101], v[50:53], a[180:183], v[98:101]
  v_mfma_f32_16x16x32_bf16 v[102:105], v[54:57], a[180:183], v[102:105]
  buffer_store_dwordx4 v[106:109], v16, s[4:7], s33 offen offset:0 sc1
  ds_read_b128 v[50:53], v12 offset:41472
  ds_read_b128 v[54:57], v12 offset:61952
  s_waitcnt lgkmcnt(4)
  v_mfma_f32_16x16x32_bf16 v[82:85], v[34:37], a[24:27], v[82:85]
  v_mfma_f32_16x16x32_bf16 v[86:89], v[38:41], a[24:27], v[86:89]
  v_cvt_pk_bf16_f32 v110, v66, v67
  v_cvt_pk_bf16_f32 v111, v68, v69
  v_mfma_f32_16x16x32_bf16 v[90:93], v[34:37], a[104:107], v[90:93]
  v_mfma_f32_16x16x32_bf16 v[94:97], v[38:41], a[104:107], v[94:97]
  v_cvt_pk_bf16_f32 v112, v70, v71
  v_cvt_pk_bf16_f32 v113, v72, v73
  v_mfma_f32_16x16x32_bf16 v[98:101], v[34:37], a[184:187], v[98:101]
  v_mfma_f32_16x16x32_bf16 v[102:105], v[38:41], a[184:187], v[102:105]
  buffer_store_dwordx4 v[110:113], v16, s[4:7], s33 offen offset:1024 sc1
  ds_read_b128 v[34:37], v13 offset:41472
  ds_read_b128 v[38:41], v13 offset:61952
  s_waitcnt lgkmcnt(4)
  v_mfma_f32_16x16x32_bf16 v[82:85], v[42:45], a[28:31], v[82:85]
  v_mfma_f32_16x16x32_bf16 v[86:89], v[46:49], a[28:31], v[86:89]
  v_cvt_pk_bf16_f32 v114, v74, v75
  v_cvt_pk_bf16_f32 v115, v76, v77
  v_mfma_f32_16x16x32_bf16 v[90:93], v[42:45], a[108:111], v[90:93]
  v_mfma_f32_16x16x32_bf16 v[94:97], v[46:49], a[108:111], v[94:97]
  v_cvt_pk_bf16_f32 v116, v78, v79
  v_cvt_pk_bf16_f32 v117, v80, v81
  v_mfma_f32_16x16x32_bf16 v[98:101], v[42:45], a[188:191], v[98:101]
  v_mfma_f32_16x16x32_bf16 v[102:105], v[46:49], a[188:191], v[102:105]
  buffer_store_dwordx4 v[114:117], v16, s[4:7], s33 offen offset:2048 sc1
  s_add_u32 s33, s33, 393216
  ds_read_b128 v[42:45], v14 offset:41472
  ds_read_b128 v[46:49], v14 offset:61952
  s_waitcnt lgkmcnt(4)
  v_mfma_f32_16x16x32_bf16 v[82:85], v[50:53], a[32:35], v[82:85]
  v_mfma_f32_16x16x32_bf16 v[86:89], v[54:57], a[32:35], v[86:89]
  v_mfma_f32_16x16x32_bf16 v[90:93], v[50:53], a[112:115], v[90:93]
  v_mfma_f32_16x16x32_bf16 v[94:97], v[54:57], a[112:115], v[94:97]
  v_mfma_f32_16x16x32_bf16 v[98:101], v[50:53], a[192:195], v[98:101]
  v_mfma_f32_16x16x32_bf16 v[102:105], v[54:57], a[192:195], v[102:105]
  ds_read_b128 v[50:53], v15 offset:41472
  ds_read_b128 v[54:57], v15 offset:61952
  s_waitcnt lgkmcnt(4)
  v_mfma_f32_16x16x32_bf16 v[82:85], v[34:37], a[36:39], v[82:85]
  v_mfma_f32_16x16x32_bf16 v[86:89], v[38:41], a[36:39], v[86:89]
  v_mfma_f32_16x16x32_bf16 v[90:93], v[34:37], a[116:119], v[90:93]
  v_mfma_f32_16x16x32_bf16 v[94:97], v[38:41], a[116:119], v[94:97]
  v_mfma_f32_16x16x32_bf16 v[98:101], v[34:37], a[196:199], v[98:101]
  v_mfma_f32_16x16x32_bf16 v[102:105], v[38:41], a[196:199], v[102:105]
  ds_read_b128 v[34:37], v12 offset:41728
  ds_read_b128 v[38:41], v12 offset:62208
  s_waitcnt lgkmcnt(4)
  v_mfma_f32_16x16x32_bf16 v[82:85], v[42:45], a[40:43], v[82:85]
  v_mfma_f32_16x16x32_bf16 v[86:89], v[46:49], a[40:43], v[86:89]
  v_mfma_f32_16x16x32_bf16 v[90:93], v[42:45], a[120:123], v[90:93]
  v_mfma_f32_16x16x32_bf16 v[94:97], v[46:49], a[120:123], v[94:97]
  v_mfma_f32_16x16x32_bf16 v[98:101], v[42:45], a[200:203], v[98:101]
  v_mfma_f32_16x16x32_bf16 v[102:105], v[46:49], a[200:203], v[102:105]
  ds_read_b128 v[42:45], v13 offset:41728
  ds_read_b128 v[46:49], v13 offset:62208
  s_waitcnt lgkmcnt(4)
  v_mfma_f32_16x16x32_bf16 v[82:85], v[50:53], a[44:47], v[82:85]
  v_mfma_f32_16x16x32_bf16 v[86:89], v[54:57], a[44:47], v[86:89]
  v_mfma_f32_16x16x32_bf16 v[90:93], v[50:53], a[124:127], v[90:93]
  v_mfma_f32_16x16x32_bf16 v[94:97], v[54:57], a[124:127], v[94:97]
  v_mfma_f32_16x16x32_bf16 v[98:101], v[50:53], a[204:207], v[98:101]
  v_mfma_f32_16x16x32_bf16 v[102:105], v[54:57], a[204:207], v[102:105]
  ds_read_b128 v[50:53], v14 offset:41728
  ds_read_b128 v[54:57], v14 offset:62208
  s_waitcnt lgkmcnt(4)
  v_mfma_f32_16x16x32_bf16 v[82:85], v[34:37], a[48:51], v[82:85]
  v_mfma_f32_16x16x32_bf16 v[86:89], v[38:41], a[48:51], v[86:89]
  v_mfma_f32_16x16x32_bf16 v[90:93], v[34:37], a[128:131], v[90:93]
  v_mfma_f32_16x16x32_bf16 v[94:97], v[38:41], a[128:131], v[94:97]
  v_mfma_f32_16x16x32_bf16 v[98:101], v[34:37], a[208:211], v[98:101]
  v_mfma_f32_16x16x32_bf16 v[102:105], v[38:41], a[208:211], v[102:105]
  ds_read_b128 v[34:37], v15 offset:41728
  ds_read_b128 v[38:41], v15 offset:62208
  s_waitcnt lgkmcnt(4)
  v_mfma_f32_16x16x32_bf16 v[82:85], v[42:45], a[52:55], v[82:85]
  v_mfma_f32_16x16x32_bf16 v[86:89], v[46:49], a[52:55], v[86:89]
  v_mfma_f32_16x16x32_bf16 v[90:93], v[42:45], a[132:135], v[90:93]
  v_mfma_f32_16x16x32_bf16 v[94:97], v[46:49], a[132:135], v[94:97]
  v_mfma_f32_16x16x32_bf16 v[98:101], v[42:45], a[212:215], v[98:101]
  v_mfma_f32_16x16x32_bf16 v[102:105], v[46:49], a[212:215], v[102:105]
  ds_read_b128 v[42:45], v12 offset:41984
  ds_read_b128 v[46:49], v12 offset:62464
  s_waitcnt lgkmcnt(4)
  v_mfma_f32_16x16x32_bf16 v[82:85], v[50:53], a[56:59], v[82:85]
  v_mfma_f32_16x16x32_bf16 v[86:89], v[54:57], a[56:59], v[86:89]
  v_mfma_f32_16x16x32_bf16 v[90:93], v[50:53], a[136:139], v[90:93]
  v_mfma_f32_16x16x32_bf16 v[94:97], v[54:57], a[136:139], v[94:97]
  v_mfma_f32_16x16x32_bf16 v[98:101], v[50:53], a[216:219], v[98:101]
  v_mfma_f32_16x16x32_bf16 v[102:105], v[54:57], a[216:219], v[102:105]
  ds_read_b128 v[50:53], v13 offset:41984
  ds_read_b128 v[54:57], v13 offset:62464
  s_waitcnt lgkmcnt(4)
  v_mfma_f32_16x16x32_bf16 v[82:85], v[34:37], a[60:63], v[82:85]
  v_mfma_f32_16x16x32_bf16 v[86:89], v[38:41], a[60:63], v[86:89]
  v_mfma_f32_16x16x32_bf16 v[90:93], v[34:37], a[140:143], v[90:93]
  v_mfma_f32_16x16x32_bf16 v[94:97], v[38:41], a[140:143], v[94:97]
  v_mfma_f32_16x16x32_bf16 v[98:101], v[34:37], a[220:223], v[98:101]
  v_mfma_f32_16x16x32_bf16 v[102:105], v[38:41], a[220:223], v[102:105]
  ds_read_b128 v[34:37], v14 offset:41984
  ds_read_b128 v[38:41], v14 offset:62464
  s_waitcnt lgkmcnt(4)
  v_mfma_f32_16x16x32_bf16 v[82:85], v[42:45], a[64:67], v[82:85]
  v_mfma_f32_16x16x32_bf16 v[86:89], v[46:49], a[64:67], v[86:89]
  v_mfma_f32_16x16x32_bf16 v[90:93], v[42:45], a[144:147], v[90:93]
  v_mfma_f32_16x16x32_bf16 v[94:97], v[46:49], a[144:147], v[94:97]
  v_mfma_f32_16x16x32_bf16 v[98:101], v[42:45], a[224:227], v[98:101]
  v_mfma_f32_16x16x32_bf16 v[102:105], v[46:49], a[224:227], v[102:105]
  ds_read_b128 v[42:45], v15 offset:41984
  ds_read_b128 v[46:49], v15 offset:62464
  s_waitcnt lgkmcnt(4)
  v_mfma_f32_16x16x32_bf16 v[82:85], v[50:53], a[68:71], v[82:85]
  v_mfma_f32_16x16x32_bf16 v[86:89], v[54:57], a[68:71], v[86:89]
  v_mfma_f32_16x16x32_bf16 v[90:93], v[50:53], a[148:151], v[90:93]
  v_mfma_f32_16x16x32_bf16 v[94:97], v[54:57], a[148:151], v[94:97]
  v_mfma_f32_16x16x32_bf16 v[98:101], v[50:53], a[228:231], v[98:101]
  v_mfma_f32_16x16x32_bf16 v[102:105], v[54:57], a[228:231], v[102:105]
  s_waitcnt lgkmcnt(2)
  v_mfma_f32_16x16x32_bf16 v[82:85], v[34:37], a[72:75], v[82:85]
  v_mfma_f32_16x16x32_bf16 v[86:89], v[38:41], a[72:75], v[86:89]
  v_mfma_f32_16x16x32_bf16 v[90:93], v[34:37], a[152:155], v[90:93]
  v_mfma_f32_16x16x32_bf16 v[94:97], v[38:41], a[152:155], v[94:97]
  v_mfma_f32_16x16x32_bf16 v[98:101], v[34:37], a[232:235], v[98:101]
  v_mfma_f32_16x16x32_bf16 v[102:105], v[38:41], a[232:235], v[102:105]
  s_waitcnt lgkmcnt(0)
  v_mfma_f32_16x16x32_bf16 v[82:85], v[42:45], a[76:79], v[82:85]
  v_mfma_f32_16x16x32_bf16 v[86:89], v[46:49], a[76:79], v[86:89]
  v_mfma_f32_16x16x32_bf16 v[90:93], v[42:45], a[156:159], v[90:93]
  v_mfma_f32_16x16x32_bf16 v[94:97], v[46:49], a[156:159], v[94:97]
  v_mfma_f32_16x16x32_bf16 v[98:101], v[42:45], a[236:239], v[98:101]
  v_mfma_f32_16x16x32_bf16 v[102:105], v[46:49], a[236:239], v[102:105]
  s_add_u32 s30, s30, 40960
  s_add_u32 s29, s29, 1
  s_cmp_lt_u32 s29, 64
  s_cbranch_scc1 L_v_loop
  v_cvt_pk_bf16_f32 v106, v82, v83
  v_cvt_pk_bf16_f32 v107, v84, v85
  v_cvt_pk_bf16_f32 v108, v86, v87
  v_cvt_pk_bf16_f32 v109, v88, v89
  buffer_store_dwordx4 v[106:109], v16, s[4:7], s33 offen offset:0 sc1
  v_cvt_pk_bf16_f32 v110, v90, v91
  v_cvt_pk_bf16_f32 v111, v92, v93
  v_cvt_pk_bf16_f32 v112, v94, v95
  v_cvt_pk_bf16_f32 v113, v96, v97
  buffer_store_dwordx4 v[110:113], v16, s[4:7], s33 offen offset:1024 sc1
  v_cvt_pk_bf16_f32 v114, v98, v99
  v_cvt_pk_bf16_f32 v115, v100, v101
  v_cvt_pk_bf16_f32 v116, v102, v103
  v_cvt_pk_bf16_f32 v117, v104, v105
  buffer_store_dwordx4 v[114:117], v16, s[4:7], s33 offen offset:2048 sc1
  s_add_u32 s33, s33, 393216
  s_waitcnt vmcnt(0)
  v_mov_b32 v26, 64
  s_mov_b64 exec, 1
  buffer_store_dword v26, v24, s[4:7], s35 offen sc1
  s_mov_b64 exec, -1
  s_waitcnt vmcnt(0)
  s_branch L_post
L_post:
  s_mov_b32 s16, s13
  s_barrier
  s_cmp_ge_u32 s16, 40
  s_cbranch_scc1 L_post_g
  s_load_dwordx8 s[32:39], s[0:1], 64
  s_load_dwordx2 s[40:41], s[0:1], 96
  s_waitcnt lgkmcnt(0)
  s_mov_b32 s20, s32
  s_mov_b32 s21, s33
  s_mov_b32 s22, 2621440
  s_mov_b32 s23, 0x20000
  s_mov_b32 s24, s34
  s_mov_b32 s25, s35
  s_mov_b32 s26, 2621440
  s_mov_b32 s27, 0x20000
  s_mov_b32 s28, s36
  s_mov_b32 s29, s37
  s_mov_b32 s30, 5120
  s_mov_b32 s31, 0x20000
  v_and_b32 v1, 63, v0
  v_and_b32 v12, 1, v0
  s_lshl_b32 s49, s16, 7
  v_lshlrev_b32 v13, 6, v12
  buffer_load_dwordx4 v[52:55], v13, s[28:31], s49 offen offset:0
  buffer_load_dwordx4 v[56:59], v13, s[28:31], s49 offen offset:16
  buffer_load_dwordx4 v[60:63], v13, s[28:31], s49 offen offset:32
  buffer_load_dwordx4 v[64:67], v13, s[28:31], s49 offen offset:48
  v_mov_b32 v166, 0
  v_mov_b32 v167, 0
  v_mov_b32 v168, 0
  v_mov_b32 v169, 0
  v_and_b32 v14, 15, v0
  v_mul_u32_u24 v15, 5152, v14
  ds_write_b128 v15, v[166:169] offset:16
  v_mul_u32_u24 v15, 4160, v14
  v_bfe_u32 v14, v0, 4, 2
  v_lshl_add_u32 v15, v14, 4, v15
  v_add_u32 v15, 82464, v15
  ds_write_b128 v15, v[166:169]
  s_waitcnt vmcnt(0)
  v_lshlrev_b32 v20, 16, v52
  v_and_b32 v21, 0xffff0000, v52
  v_lshlrev_b32 v22, 16, v53
  v_and_b32 v23, 0xffff0000, v53
  v_lshlrev_b32 v24, 16, v54
  v_and_b32 v25, 0xffff0000, v54
  v_lshlrev_b32 v26, 16, v55
  v_and_b32 v27, 0xffff0000, v55
  v_lshlrev_b32 v28, 16, v56
  v_and_b32 v29, 0xffff0000, v56
  v_lshlrev_b32 v30, 16, v57
  v_and_b32 v31, 0xffff0000, v57
  v_lshlrev_b32 v32, 16, v58
  v_and_b32 v33, 0xffff0000, v58
  v_lshlrev_b32 v34, 16, v59
  v_and_b32 v35, 0xffff0000, v59
  v_lshlrev_b32 v36, 16, v60
  v_and_b32 v37, 0xffff0000, v60
  v_lshlrev_b32 v38, 16, v61
  v_and_b32 v39, 0xffff0000, v61
  v_lshlrev_b32 v40, 16, v62
  v_and_b32 v41, 0xffff0000, v62
  v_lshlrev_b32 v42, 16, v63
  v_and_b32 v43, 0xffff0000, v63
  v_lshlrev_b32 v44, 16, v64
  v_and_b32 v45, 0xffff0000, v64
  v_lshlrev_b32 v46, 16, v65
  v_and_b32 v47, 0xffff0000, v65
  v_lshlrev_b32 v48, 16, v66
  v_and_b32 v49, 0xffff0000, v66
  v_lshlrev_b32 v50, 16, v67
  v_and_b32 v51, 0xffff0000, v67
  s_mov_b32 s45, 0
L_cv_p1:
  s_lshl_b32 s49, s45, 2
  s_add_u32 s49, s49, s12
  s_lshl_b32 s49, s49, 5
  v_lshrrev_b32 v13, 1, v1
  v_add_u32 v13, s49, v13
  s_lshl_b32 s50, s16, 5
  v_mul_u32_u24 v2, 10240, v13
  v_lshl_add_u32 v2, v12, 4, v2
  v_add_u32 v2, s50, v2
  v_add_u32 v3, 5120, v2
  v_subrev_u32 v4, 3840, v2
  v_cmp_eq_u32 vcc, 0, v13
  v_mov_b32 v14, 2147483648
  s_nop 0
  v_cndmask_b32 v4, v4, v14, vcc
  buffer_load_dwordx4 v[52:55], v4, s[20:23], 0 offen offset:0
  s_waitcnt vmcnt(20)
  buffer_load_dwordx4 v[56:59], v4, s[20:23], 0 offen offset:1280
  s_waitcnt vmcnt(20)
  buffer_load_dwordx4 v[60:63], v4, s[20:23], 0 offen offset:2560
  s_waitcnt vmcnt(20)
  buffer_load_dwordx4 v[64:67], v2, s[20:23], 0 offen offset:0
  s_waitcnt vmcnt(20)
  buffer_load_dwordx4 v[68:71], v2, s[20:23], 0 offen offset:1280
  s_waitcnt vmcnt(20)
  buffer_load_dwordx4 v[72:75], v2, s[20:23], 0 offen offset:2560
  s_waitcnt vmcnt(20)
  buffer_load_dwordx4 v[76:79], v2, s[20:23], 0 offen offset:3840
  s_waitcnt vmcnt(20)
  buffer_load_dwordx4 v[80:83], v3, s[20:23], 0 offen offset:0
  s_waitcnt vmcnt(20)
  buffer_load_dwordx4 v[84:87], v3, s[20:23], 0 offen offset:1280
  s_waitcnt vmcnt(20)
  buffer_load_dwordx4 v[88:91], v3, s[20:23], 0 offen offset:2560
  s_waitcnt vmcnt(20)
  buffer_load_dwordx4 v[92:95], v3, s[20:23], 0 offen offset:3840
  s_waitcnt vmcnt(20)
  buffer_load_dwordx4 v[96:99], v2, s[24:27], 0 offen offset:0
  s_waitcnt vmcnt(20)
  buffer_load_dwordx4 v[100:103], v2, s[24:27], 0 offen offset:1280
  s_waitcnt vmcnt(20)
  buffer_load_dwordx4 v[104:107], v2, s[24:27], 0 offen offset:2560
  s_waitcnt vmcnt(20)
  buffer_load_dwordx4 v[108:111], v2, s[24:27], 0 offen offset:3840
  s_waitcnt vmcnt(20)
  buffer_load_dwordx4 v[112:115], v3, s[24:27], 0 offen offset:0
  s_waitcnt vmcnt(20)
  buffer_load_dwordx4 v[116:119], v3, s[24:27], 0 offen offset:1280
  s_waitcnt vmcnt(20)
  buffer_load_dwordx4 v[120:123], v3, s[24:27], 0 offen offset:2560
  s_waitcnt vmcnt(20)
  buffer_load_dwordx4 v[124:127], v3, s[24:27], 0 offen offset:3840
  s_waitcnt vmcnt(20)
  v_mul_u32_u24 v5, 41216, v12
  v_lshrrev_b32 v14, 3, v13
  v_mul_u32_u24 v14, 160, v14
  v_bfe_u32 v15, v13, 2, 1
  v_lshl_add_u32 v14, v15, 6, v14
  v_and_b32 v15, 3, v13
  v_xor_b32 v15, 3, v15
  v_lshl_add_u32 v14, v15, 4, v14
  v_add3_u32 v5, v5, v14, 32
  s_waitcnt vmcnt(0)
  v_lshlrev_b32 v128, 16, v52
  v_lshlrev_b32 v129, 16, v56
  v_lshlrev_b32 v130, 16, v60
  v_lshlrev_b32 v131, 16, v64
  v_lshlrev_b32 v132, 16, v68
  v_lshlrev_b32 v133, 16, v72
  v_lshlrev_b32 v134, 16, v76
  v_lshlrev_b32 v135, 16, v80
  v_lshlrev_b32 v136, 16, v84
  v_lshlrev_b32 v137, 16, v88
  v_lshlrev_b32 v138, 16, v92
  v_lshlrev_b32 v150, 16, v96
  v_lshlrev_b32 v151, 16, v100
  v_lshlrev_b32 v152, 16, v104
  v_lshlrev_b32 v153, 16, v108
  v_lshlrev_b32 v154, 16, v112
  v_lshlrev_b32 v155, 16, v116
  v_lshlrev_b32 v156, 16, v120
  v_lshlrev_b32 v157, 16, v124
  v_mul_f32 v158, v128, v23
  v_mul_f32 v159, v129, v23
  v_mul_f32 v160, v130, v23
  v_mul_f32 v161, v131, v23
  v_mul_f32 v162, v132, v23
  v_mul_f32 v163, v133, v23
  v_mul_f32 v164, v134, v23
  v_mul_f32 v165, v135, v23
  v_fmac_f32 v158, v129, v22
  v_fmac_f32 v159, v130, v22
  v_fmac_f32 v160, v131, v22
  v_fmac_f32 v161, v132, v22
  v_fmac_f32 v162, v133, v22
  v_fmac_f32 v163, v134, v22
  v_fmac_f32 v164, v135, v22
  v_fmac_f32 v165, v136, v22
  v_fmac_f32 v158, v130, v21
  v_fmac_f32 v159, v131, v21
  v_fmac_f32 v160, v132, v21
  v_fmac_f32 v161, v133, v21
  v_fmac_f32 v162, v134, v21
  v_fmac_f32 v163, v135, v21
  v_fmac_f32 v164, v136, v21
  v_fmac_f32 v165, v137, v21
  v_fmac_f32 v158, v131, v20
  v_fmac_f32 v159, v132, v20
  v_fmac_f32 v160, v133, v20
  v_fmac_f32 v161, v134, v20
  v_fmac_f32 v162, v135, v20
  v_fmac_f32 v163, v136, v20
  v_fmac_f32 v164, v137, v20
  v_fmac_f32 v165, v138, v20
  v_mul_f32 v150, v150, v158
  v_mul_f32 v151, v151, v159
  v_mul_f32 v152, v152, v160
  v_mul_f32 v153, v153, v161
  v_mul_f32 v154, v154, v162
  v_mul_f32 v155, v155, v163
  v_mul_f32 v156, v156, v164
  v_mul_f32 v157, v157, v165
  v_cvt_pk_bf16_f32 v166, v157, v156
  v_cvt_pk_bf16_f32 v167, v155, v154
  v_cvt_pk_bf16_f32 v168, v153, v152
  v_cvt_pk_bf16_f32 v169, v151, v150
  ds_write_b128 v5, v[166:169] offset:0
  v_and_b32 v128, 0xffff0000, v52
  v_and_b32 v129, 0xffff0000, v56
  v_and_b32 v130, 0xffff0000, v60
  v_and_b32 v131, 0xffff0000, v64
  v_and_b32 v132, 0xffff0000, v68
  v_and_b32 v133, 0xffff0000, v72
  v_and_b32 v134, 0xffff0000, v76
  v_and_b32 v135, 0xffff0000, v80
  v_and_b32 v136, 0xffff0000, v84
  v_and_b32 v137, 0xffff0000, v88
  v_and_b32 v138, 0xffff0000, v92
  v_and_b32 v150, 0xffff0000, v96
  v_and_b32 v151, 0xffff0000, v100
  v_and_b32 v152, 0xffff0000, v104
  v_and_b32 v153, 0xffff0000, v108
  v_and_b32 v154, 0xffff0000, v112
  v_and_b32 v155, 0xffff0000, v116
  v_and_b32 v156, 0xffff0000, v120
  v_and_b32 v157, 0xffff0000, v124
  v_mul_f32 v158, v128, v27
  v_mul_f32 v159, v129, v27
  v_mul_f32 v160, v130, v27
  v_mul_f32 v161, v131, v27
  v_mul_f32 v162, v132, v27
  v_mul_f32 v163, v133, v27
  v_mul_f32 v164, v134, v27
  v_mul_f32 v165, v135, v27
  v_fmac_f32 v158, v129, v26
  v_fmac_f32 v159, v130, v26
  v_fmac_f32 v160, v131, v26
  v_fmac_f32 v161, v132, v26
  v_fmac_f32 v162, v133, v26
  v_fmac_f32 v163, v134, v26
  v_fmac_f32 v164, v135, v26
  v_fmac_f32 v165, v136, v26
  v_fmac_f32 v158, v130, v25
  v_fmac_f32 v159, v131, v25
  v_fmac_f32 v160, v132, v25
  v_fmac_f32 v161, v133, v25
  v_fmac_f32 v162, v134, v25
  v_fmac_f32 v163, v135, v25
  v_fmac_f32 v164, v136, v25
  v_fmac_f32 v165, v137, v25
  v_fmac_f32 v158, v131, v24
  v_fmac_f32 v159, v132, v24
  v_fmac_f32 v160, v133, v24
  v_fmac_f32 v161, v134, v24
  v_fmac_f32 v162, v135, v24
  v_fmac_f32 v163, v136, v24
  v_fmac_f32 v164, v137, v24
  v_fmac_f32 v165, v138, v24
  v_mul_f32 v150, v150, v158
  v_mul_f32 v151, v151, v159
  v_mul_f32 v152, v152, v160
  v_mul_f32 v153, v153, v161
  v_mul_f32 v154, v154, v162
  v_mul_f32 v155, v155, v163
  v_mul_f32 v156, v156, v164
  v_mul_f32 v157, v157, v165
  v_cvt_pk_bf16_f32 v170, v157, v156
  v_cvt_pk_bf16_f32 v171, v155, v154
  v_cvt_pk_bf16_f32 v172, v153, v152
  v_cvt_pk_bf16_f32 v173, v151, v150
  ds_write_b128 v5, v[170:173] offset:5152
  v_lshlrev_b32 v128, 16, v53
  v_lshlrev_b32 v129, 16, v57
  v_lshlrev_b32 v130, 16, v61
  v_lshlrev_b32 v131, 16, v65
  v_lshlrev_b32 v132, 16, v69
  v_lshlrev_b32 v133, 16, v73
  v_lshlrev_b32 v134, 16, v77
  v_lshlrev_b32 v135, 16, v81
  v_lshlrev_b32 v136, 16, v85
  v_lshlrev_b32 v137, 16, v89
  v_lshlrev_b32 v138, 16, v93
  v_lshlrev_b32 v150, 16, v97
  v_lshlrev_b32 v151, 16, v101
  v_lshlrev_b32 v152, 16, v105
  v_lshlrev_b32 v153, 16, v109
  v_lshlrev_b32 v154, 16, v113
  v_lshlrev_b32 v155, 16, v117
  v_lshlrev_b32 v156, 16, v121
  v_lshlrev_b32 v157, 16, v125
  v_mul_f32 v158, v128, v31
  v_mul_f32 v159, v129, v31
  v_mul_f32 v160, v130, v31
  v_mul_f32 v161, v131, v31
  v_mul_f32 v162, v132, v31
  v_mul_f32 v163, v133, v31
  v_mul_f32 v164, v134, v31
  v_mul_f32 v165, v135, v31
  v_fmac_f32 v158, v129, v30
  v_fmac_f32 v159, v130, v30
  v_fmac_f32 v160, v131, v30
  v_fmac_f32 v161, v132, v30
  v_fmac_f32 v162, v133, v30
  v_fmac_f32 v163, v134, v30
  v_fmac_f32 v164, v135, v30
  v_fmac_f32 v165, v136, v30
  v_fmac_f32 v158, v130, v29
  v_fmac_f32 v159, v131, v29
  v_fmac_f32 v160, v132, v29
  v_fmac_f32 v161, v133, v29
  v_fmac_f32 v162, v134, v29
  v_fmac_f32 v163, v135, v29
  v_fmac_f32 v164, v136, v29
  v_fmac_f32 v165, v137, v29
  v_fmac_f32 v158, v131, v28
  v_fmac_f32 v159, v132, v28
  v_fmac_f32 v160, v133, v28
  v_fmac_f32 v161, v134, v28
  v_fmac_f32 v162, v135, v28
  v_fmac_f32 v163, v136, v28
  v_fmac_f32 v164, v137, v28
  v_fmac_f32 v165, v138, v28
  v_mul_f32 v150, v150, v158
  v_mul_f32 v151, v151, v159
  v_mul_f32 v152, v152, v160
  v_mul_f32 v153, v153, v161
  v_mul_f32 v154, v154, v162
  v_mul_f32 v155, v155, v163
  v_mul_f32 v156, v156, v164
  v_mul_f32 v157, v157, v165
  v_cvt_pk_bf16_f32 v166, v157, v156
  v_cvt_pk_bf16_f32 v167, v155, v154
  v_cvt_pk_bf16_f32 v168, v153, v152
  v_cvt_pk_bf16_f32 v169, v151, v150
  ds_write_b128 v5, v[166:169] offset:10304
  v_and_b32 v128, 0xffff0000, v53
  v_and_b32 v129, 0xffff0000, v57
  v_and_b32 v130, 0xffff0000, v61
  v_and_b32 v131, 0xffff0000, v65
  v_and_b32 v132, 0xffff0000, v69
  v_and_b32 v133, 0xffff0000, v73
  v_and_b32 v134, 0xffff0000, v77
  v_and_b32 v135, 0xffff0000, v81
  v_and_b32 v136, 0xffff0000, v85
  v_and_b32 v137, 0xffff0000, v89
  v_and_b32 v138, 0xffff0000, v93
  v_and_b32 v150, 0xffff0000, v97
  v_and_b32 v151, 0xffff0000, v101
  v_and_b32 v152, 0xffff0000, v105
  v_and_b32 v153, 0xffff0000, v109
  v_and_b32 v154, 0xffff0000, v113
  v_and_b32 v155, 0xffff0000, v117
  v_and_b32 v156, 0xffff0000, v121
  v_and_b32 v157, 0xffff0000, v125
  v_mul_f32 v158, v128, v35
  v_mul_f32 v159, v129, v35
  v_mul_f32 v160, v130, v35
  v_mul_f32 v161, v131, v35
  v_mul_f32 v162, v132, v35
  v_mul_f32 v163, v133, v35
  v_mul_f32 v164, v134, v35
  v_mul_f32 v165, v135, v35
  v_fmac_f32 v158, v129, v34
  v_fmac_f32 v159, v130, v34
  v_fmac_f32 v160, v131, v34
  v_fmac_f32 v161, v132, v34
  v_fmac_f32 v162, v133, v34
  v_fmac_f32 v163, v134, v34
  v_fmac_f32 v164, v135, v34
  v_fmac_f32 v165, v136, v34
  v_fmac_f32 v158, v130, v33
  v_fmac_f32 v159, v131, v33
  v_fmac_f32 v160, v132, v33
  v_fmac_f32 v161, v133, v33
  v_fmac_f32 v162, v134, v33
  v_fmac_f32 v163, v135, v33
  v_fmac_f32 v164, v136, v33
  v_fmac_f32 v165, v137, v33
  v_fmac_f32 v158, v131, v32
  v_fmac_f32 v159, v132, v32
  v_fmac_f32 v160, v133, v32
  v_fmac_f32 v161, v134, v32
  v_fmac_f32 v162, v135, v32
  v_fmac_f32 v163, v136, v32
  v_fmac_f32 v164, v137, v32
  v_fmac_f32 v165, v138, v32
  v_mul_f32 v150, v150, v158
  v_mul_f32 v151, v151, v159
  v_mul_f32 v152, v152, v160
  v_mul_f32 v153, v153, v161
  v_mul_f32 v154, v154, v162
  v_mul_f32 v155, v155, v163
  v_mul_f32 v156, v156, v164
  v_mul_f32 v157, v157, v165
  v_cvt_pk_bf16_f32 v170, v157, v156
  v_cvt_pk_bf16_f32 v171, v155, v154
  v_cvt_pk_bf16_f32 v172, v153, v152
  v_cvt_pk_bf16_f32 v173, v151, v150
  ds_write_b128 v5, v[170:173] offset:15456
  v_lshlrev_b32 v128, 16, v54
  v_lshlrev_b32 v129, 16, v58
  v_lshlrev_b32 v130, 16, v62
  v_lshlrev_b32 v131, 16, v66
  v_lshlrev_b32 v132, 16, v70
  v_lshlrev_b32 v133, 16, v74
  v_lshlrev_b32 v134, 16, v78
  v_lshlrev_b32 v135, 16, v82
  v_lshlrev_b32 v136, 16, v86
  v_lshlrev_b32 v137, 16, v90
  v_lshlrev_b32 v138, 16, v94
  v_lshlrev_b32 v150, 16, v98
  v_lshlrev_b32 v151, 16, v102
  v_lshlrev_b32 v152, 16, v106
  v_lshlrev_b32 v153, 16, v110
  v_lshlrev_b32 v154, 16, v114
  v_lshlrev_b32 v155, 16, v118
  v_lshlrev_b32 v156, 16, v122
  v_lshlrev_b32 v157, 16, v126
  v_mul_f32 v158, v128, v39
  v_mul_f32 v159, v129, v39
  v_mul_f32 v160, v130, v39
  v_mul_f32 v161, v131, v39
  v_mul_f32 v162, v132, v39
  v_mul_f32 v163, v133, v39
  v_mul_f32 v164, v134, v39
  v_mul_f32 v165, v135, v39
  v_fmac_f32 v158, v129, v38
  v_fmac_f32 v159, v130, v38
  v_fmac_f32 v160, v131, v38
  v_fmac_f32 v161, v132, v38
  v_fmac_f32 v162, v133, v38
  v_fmac_f32 v163, v134, v38
  v_fmac_f32 v164, v135, v38
  v_fmac_f32 v165, v136, v38
  v_fmac_f32 v158, v130, v37
  v_fmac_f32 v159, v131, v37
  v_fmac_f32 v160, v132, v37
  v_fmac_f32 v161, v133, v37
  v_fmac_f32 v162, v134, v37
  v_fmac_f32 v163, v135, v37
  v_fmac_f32 v164, v136, v37
  v_fmac_f32 v165, v137, v37
  v_fmac_f32 v158, v131, v36
  v_fmac_f32 v159, v132, v36
  v_fmac_f32 v160, v133, v36
  v_fmac_f32 v161, v134, v36
  v_fmac_f32 v162, v135, v36
  v_fmac_f32 v163, v136, v36
  v_fmac_f32 v164, v137, v36
  v_fmac_f32 v165, v138, v36
  v_mul_f32 v150, v150, v158
  v_mul_f32 v151, v151, v159
  v_mul_f32 v152, v152, v160
  v_mul_f32 v153, v153, v161
  v_mul_f32 v154, v154, v162
  v_mul_f32 v155, v155, v163
  v_mul_f32 v156, v156, v164
  v_mul_f32 v157, v157, v165
  v_cvt_pk_bf16_f32 v166, v157, v156
  v_cvt_pk_bf16_f32 v167, v155, v154
  v_cvt_pk_bf16_f32 v168, v153, v152
  v_cvt_pk_bf16_f32 v169, v151, v150
  ds_write_b128 v5, v[166:169] offset:20608
  v_and_b32 v128, 0xffff0000, v54
  v_and_b32 v129, 0xffff0000, v58
  v_and_b32 v130, 0xffff0000, v62
  v_and_b32 v131, 0xffff0000, v66
  v_and_b32 v132, 0xffff0000, v70
  v_and_b32 v133, 0xffff0000, v74
  v_and_b32 v134, 0xffff0000, v78
  v_and_b32 v135, 0xffff0000, v82
  v_and_b32 v136, 0xffff0000, v86
  v_and_b32 v137, 0xffff0000, v90
  v_and_b32 v138, 0xffff0000, v94
  v_and_b32 v150, 0xffff0000, v98
  v_and_b32 v151, 0xffff0000, v102
  v_and_b32 v152, 0xffff0000, v106
  v_and_b32 v153, 0xffff0000, v110
  v_and_b32 v154, 0xffff0000, v114
  v_and_b32 v155, 0xffff0000, v118
  v_and_b32 v156, 0xffff0000, v122
  v_and_b32 v157, 0xffff0000, v126
  v_mul_f32 v158, v128, v43
  v_mul_f32 v159, v129, v43
  v_mul_f32 v160, v130, v43
  v_mul_f32 v161, v131, v43
  v_mul_f32 v162, v132, v43
  v_mul_f32 v163, v133, v43
  v_mul_f32 v164, v134, v43
  v_mul_f32 v165, v135, v43
  v_fmac_f32 v158, v129, v42
  v_fmac_f32 v159, v130, v42
  v_fmac_f32 v160, v131, v42
  v_fmac_f32 v161, v132, v42
  v_fmac_f32 v162, v133, v42
  v_fmac_f32 v163, v134, v42
  v_fmac_f32 v164, v135, v42
  v_fmac_f32 v165, v136, v42
  v_fmac_f32 v158, v130, v41
  v_fmac_f32 v159, v131, v41
  v_fmac_f32 v160, v132, v41
  v_fmac_f32 v161, v133, v41
  v_fmac_f32 v162, v134, v41
  v_fmac_f32 v163, v135, v41
  v_fmac_f32 v164, v136, v41
  v_fmac_f32 v165, v137, v41
  v_fmac_f32 v158, v131, v40
  v_fmac_f32 v159, v132, v40
  v_fmac_f32 v160, v133, v40
  v_fmac_f32 v161, v134, v40
  v_fmac_f32 v162, v135, v40
  v_fmac_f32 v163, v136, v40
  v_fmac_f32 v164, v137, v40
  v_fmac_f32 v165, v138, v40
  v_mul_f32 v150, v150, v158
  v_mul_f32 v151, v151, v159
  v_mul_f32 v152, v152, v160
  v_mul_f32 v153, v153, v161
  v_mul_f32 v154, v154, v162
  v_mul_f32 v155, v155, v163
  v_mul_f32 v156, v156, v164
  v_mul_f32 v157, v157, v165
  v_cvt_pk_bf16_f32 v170, v157, v156
  v_cvt_pk_bf16_f32 v171, v155, v154
  v_cvt_pk_bf16_f32 v172, v153, v152
  v_cvt_pk_bf16_f32 v173, v151, v150
  ds_write_b128 v5, v[170:173] offset:25760
  v_lshlrev_b32 v128, 16, v55
  v_lshlrev_b32 v129, 16, v59
  v_lshlrev_b32 v130, 16, v63
  v_lshlrev_b32 v131, 16, v67
  v_lshlrev_b32 v132, 16, v71
  v_lshlrev_b32 v133, 16, v75
  v_lshlrev_b32 v134, 16, v79
  v_lshlrev_b32 v135, 16, v83
  v_lshlrev_b32 v136, 16, v87
  v_lshlrev_b32 v137, 16, v91
  v_lshlrev_b32 v138, 16, v95
  v_lshlrev_b32 v150, 16, v99
  v_lshlrev_b32 v151, 16, v103
  v_lshlrev_b32 v152, 16, v107
  v_lshlrev_b32 v153, 16, v111
  v_lshlrev_b32 v154, 16, v115
  v_lshlrev_b32 v155, 16, v119
  v_lshlrev_b32 v156, 16, v123
  v_lshlrev_b32 v157, 16, v127
  v_mul_f32 v158, v128, v47
  v_mul_f32 v159, v129, v47
  v_mul_f32 v160, v130, v47
  v_mul_f32 v161, v131, v47
  v_mul_f32 v162, v132, v47
  v_mul_f32 v163, v133, v47
  v_mul_f32 v164, v134, v47
  v_mul_f32 v165, v135, v47
  v_fmac_f32 v158, v129, v46
  v_fmac_f32 v159, v130, v46
  v_fmac_f32 v160, v131, v46
  v_fmac_f32 v161, v132, v46
  v_fmac_f32 v162, v133, v46
  v_fmac_f32 v163, v134, v46
  v_fmac_f32 v164, v135, v46
  v_fmac_f32 v165, v136, v46
  v_fmac_f32 v158, v130, v45
  v_fmac_f32 v159, v131, v45
  v_fmac_f32 v160, v132, v45
  v_fmac_f32 v161, v133, v45
  v_fmac_f32 v162, v134, v45
  v_fmac_f32 v163, v135, v45
  v_fmac_f32 v164, v136, v45
  v_fmac_f32 v165, v137, v45
  v_fmac_f32 v158, v131, v44
  v_fmac_f32 v159, v132, v44
  v_fmac_f32 v160, v133, v44
  v_fmac_f32 v161, v134, v44
  v_fmac_f32 v162, v135, v44
  v_fmac_f32 v163, v136, v44
  v_fmac_f32 v164, v137, v44
  v_fmac_f32 v165, v138, v44
  v_mul_f32 v150, v150, v158
  v_mul_f32 v151, v151, v159
  v_mul_f32 v152, v152, v160
  v_mul_f32 v153, v153, v161
  v_mul_f32 v154, v154, v162
  v_mul_f32 v155, v155, v163
  v_mul_f32 v156, v156, v164
  v_mul_f32 v157, v157, v165
  v_cvt_pk_bf16_f32 v166, v157, v156
  v_cvt_pk_bf16_f32 v167, v155, v154
  v_cvt_pk_bf16_f32 v168, v153, v152
  v_cvt_pk_bf16_f32 v169, v151, v150
  ds_write_b128 v5, v[166:169] offset:30912
  v_and_b32 v128, 0xffff0000, v55
  v_and_b32 v129, 0xffff0000, v59
  v_and_b32 v130, 0xffff0000, v63
  v_and_b32 v131, 0xffff0000, v67
  v_and_b32 v132, 0xffff0000, v71
  v_and_b32 v133, 0xffff0000, v75
  v_and_b32 v134, 0xffff0000, v79
  v_and_b32 v135, 0xffff0000, v83
  v_and_b32 v136, 0xffff0000, v87
  v_and_b32 v137, 0xffff0000, v91
  v_and_b32 v138, 0xffff0000, v95
  v_and_b32 v150, 0xffff0000, v99
  v_and_b32 v151, 0xffff0000, v103
  v_and_b32 v152, 0xffff0000, v107
  v_and_b32 v153, 0xffff0000, v111
  v_and_b32 v154, 0xffff0000, v115
  v_and_b32 v155, 0xffff0000, v119
  v_and_b32 v156, 0xffff0000, v123
  v_and_b32 v157, 0xffff0000, v127
  v_mul_f32 v158, v128, v51
  v_mul_f32 v159, v129, v51
  v_mul_f32 v160, v130, v51
  v_mul_f32 v161, v131, v51
  v_mul_f32 v162, v132, v51
  v_mul_f32 v163, v133, v51
  v_mul_f32 v164, v134, v51
  v_mul_f32 v165, v135, v51
  v_fmac_f32 v158, v129, v50
  v_fmac_f32 v159, v130, v50
  v_fmac_f32 v160, v131, v50
  v_fmac_f32 v161, v132, v50
  v_fmac_f32 v162, v133, v50
  v_fmac_f32 v163, v134, v50
  v_fmac_f32 v164, v135, v50
  v_fmac_f32 v165, v136, v50
  v_fmac_f32 v158, v130, v49
  v_fmac_f32 v159, v131, v49
  v_fmac_f32 v160, v132, v49
  v_fmac_f32 v161, v133, v49
  v_fmac_f32 v162, v134, v49
  v_fmac_f32 v163, v135, v49
  v_fmac_f32 v164, v136, v49
  v_fmac_f32 v165, v137, v49
  v_fmac_f32 v158, v131, v48
  v_fmac_f32 v159, v132, v48
  v_fmac_f32 v160, v133, v48
  v_fmac_f32 v161, v134, v48
  v_fmac_f32 v162, v135, v48
  v_fmac_f32 v163, v136, v48
  v_fmac_f32 v164, v137, v48
  v_fmac_f32 v165, v138, v48
  v_mul_f32 v150, v150, v158
  v_mul_f32 v151, v151, v159
  v_mul_f32 v152, v152, v160
  v_mul_f32 v153, v153, v161
  v_mul_f32 v154, v154, v162
  v_mul_f32 v155, v155, v163
  v_mul_f32 v156, v156, v164
  v_mul_f32 v157, v157, v165
  v_cvt_pk_bf16_f32 v170, v157, v156
  v_cvt_pk_bf16_f32 v171, v155, v154
  v_cvt_pk_bf16_f32 v172, v153, v152
  v_cvt_pk_bf16_f32 v173, v151, v150
  ds_write_b128 v5, v[170:173] offset:36064
  s_add_u32 s45, s45, 1
  s_cmp_lt_u32 s45, 2
  s_cbranch_scc1 L_cv_p1
  s_mov_b32 s20, s38
  s_mov_b32 s21, s39
  s_mov_b32 s22, 2621440
  s_mov_b32 s23, 0x20000
  s_mul_i32 s47, s12, 16640
  s_add_u32 s47, s47, 82464
  v_and_b32 v12, 15, v0
  v_bfe_u32 v13, v0, 4, 2
  v_add_u32 v14, 1, v12
  v_and_b32 v15, 3, v14
  v_sub_u32 v14, v14, v15
  v_lshl_add_u32 v14, v13, 3, v14
  v_lshlrev_b32 v14, 1, v14
  v_mul_u32_u24 v15, 4160, v15
  v_add3_u32 v6, v14, v15, s47
  v_mul_u32_u24 v10, 160, v12
  v_lshlrev_b32 v1, 4, v1
  s_mov_b32 s45, 0
  s_waitcnt lgkmcnt(0)
  s_barrier
L_cv_ch:
  s_lshl_b32 s44, s12, 2
  s_add_u32 s44, s44, s45
  s_lshl_b32 s49, s16, 4
  s_add_u32 s49, s49, s44
  s_lshl_b32 s48, s49, 12
  s_and_b32 s50, s49, 0xfffe
  s_lshl_b32 s50, s50, 1
  s_load_dword s46, s[40:41], s50
  v_mov_b32 v14, 0
  buffer_load_dwordx2 v[124:125], v14, s[20:23], s48 offen
  s_add_u32 m0, s47, 64
  s_add_u32 s50, s48, 0
  buffer_load_dwordx4 v1, s[20:23], s50 offen offset:0 lds
  buffer_load_dwordx4 v1, s[20:23], s50 offen offset:1024 lds
  buffer_load_dwordx4 v1, s[20:23], s50 offen offset:2048 lds
  buffer_load_dwordx4 v1, s[20:23], s50 offen offset:3072 lds
  s_waitcnt vmcnt(0)
  s_add_u32 m0, s47, 4224
  s_add_u32 s50, s48, 2
  buffer_load_dwordx4 v1, s[20:23], s50 offen offset:0 lds
  buffer_load_dwordx4 v1, s[20:23], s50 offen offset:1024 lds
  buffer_load_dwordx4 v1, s[20:23], s50 offen offset:2048 lds
  buffer_load_dwordx4 v1, s[20:23], s50 offen offset:3072 lds
  s_add_u32 m0, s47, 8384
  s_add_u32 s50, s48, 4
  buffer_load_dwordx4 v1, s[20:23], s50 offen offset:0 lds
  buffer_load_dwordx4 v1, s[20:23], s50 offen offset:1024 lds
  buffer_load_dwordx4 v1, s[20:23], s50 offen offset:2048 lds
  buffer_load_dwordx4 v1, s[20:23], s50 offen offset:3072 lds
  s_add_u32 m0, s47, 12544
  s_add_u32 s50, s48, 6
  buffer_load_dwordx4 v1, s[20:23], s50 offen offset:0 lds
  buffer_load_dwordx4 v1, s[20:23], s50 offen offset:1024 lds
  buffer_load_dwordx4 v1, s[20:23], s50 offen offset:2048 lds
  buffer_load_dwordx4 v1, s[20:23], s50 offen offset:3072 lds
  s_mul_i32 s51, s44, 5152
  s_add_u32 s51, s51, 32
  v_lshl_add_u32 v7, v13, 4, v10
  v_add_u32 v7, s51, v7
  s_sub_u32 s50, s51, 16
  v_mov_b32 v9, s50
  s_waitcnt lgkmcnt(0)
  s_and_b32 s49, s49, 1
  s_lshl_b32 s49, s49, 4
  s_lshr_b32 s46, s46, s49
  s_lshl_b32 s46, s46, 16
  v_and_b32 v14, 3, v0
  v_lshlrev_b32 v15, 4, v14
  v_sub_u32 v15, 48, v15
  v_lshlrev_b64 v[124:125], v15, v[124:125]
  v_lshlrev_b64 v[124:125], 16, v[124:125]
  v_mul_u32_u24 v14, 4160, v14
  v_add_u32 v14, s47, v14
  ds_write_b64 v14, v[124:125] offset:56
  s_waitcnt vmcnt(0)
  ds_read_b128 v[96:99], v7 offset:2624
  ds_read_b128 v[80:83], v7 offset:64
  ds_read_b64 v[52:53], v6 offset:0
  ds_read_b64 v[54:55], v6 offset:8
  ds_read_b64 v[56:57], v6 offset:32
  ds_read_b64 v[58:59], v6 offset:40
  ds_read_b128 v[92:95], v7 offset:2560
  ds_read_b128 v[76:79], v7 offset:0
  ds_read_b64 v[60:61], v6 offset:64
  ds_read_b64 v[62:63], v6 offset:72
  ds_read_b64 v[64:65], v6 offset:96
  ds_read_b64 v[66:67], v6 offset:104
  ds_read_b128 v[104:107], v7 offset:2464
  v_subrev_u32 v16, 96, v7
  v_max_i32 v16, v16, v9
  ds_read_b128 v[88:91], v16
  s_waitcnt lgkmcnt(6)
  v_mfma_f32_16x16x32_bf16 v[36:39], v[52:55], v[92:95], 0
  ds_read_b64 v[68:69], v6 offset:128
  v_mfma_f32_16x16x32_bf16 v[40:43], v[56:59], v[92:95], 0
  ds_read_b64 v[70:71], v6 offset:136
  v_mfma_f32_16x16x32_bf16 v[44:47], v[52:55], v[96:99], 0
  ds_read_b64 v[72:73], v6 offset:160
  v_mfma_f32_16x16x32_bf16 v[48:51], v[56:59], v[96:99], 0
  ds_read_b64 v[74:75], v6 offset:168
  v_mfma_f32_16x16x32_bf16 v[20:23], v[52:55], v[76:79], 0
  ds_read_b128 v[100:103], v7 offset:2400
  v_mfma_f32_16x16x32_bf16 v[24:27], v[56:59], v[76:79], 0
  v_subrev_u32 v16, 160, v7
  v_mfma_f32_16x16x32_bf16 v[28:31], v[52:55], v[80:83], 0
  v_max_i32 v16, v16, v9
  v_mfma_f32_16x16x32_bf16 v[32:35], v[56:59], v[80:83], 0
  ds_read_b128 v[84:87], v16
  s_waitcnt lgkmcnt(6)
  v_mfma_f32_16x16x32_bf16 v[36:39], v[60:63], v[104:107], v[36:39]
  ds_read_b64 v[52:53], v6 offset:192
  v_mfma_f32_16x16x32_bf16 v[40:43], v[64:67], v[104:107], v[40:43]
  ds_read_b64 v[54:55], v6 offset:200
  v_mfma_f32_16x16x32_bf16 v[44:47], v[60:63], v[92:95], v[44:47]
  ds_read_b64 v[56:57], v6 offset:224
  v_mfma_f32_16x16x32_bf16 v[48:51], v[64:67], v[92:95], v[48:51]
  ds_read_b64 v[58:59], v6 offset:232
  v_mfma_f32_16x16x32_bf16 v[20:23], v[60:63], v[88:91], v[20:23]
  ds_read_b128 v[96:99], v7 offset:2304
  v_mfma_f32_16x16x32_bf16 v[24:27], v[64:67], v[88:91], v[24:27]
  v_subrev_u32 v16, 256, v7
  v_mfma_f32_16x16x32_bf16 v[28:31], v[60:63], v[76:79], v[28:31]
  v_max_i32 v16, v16, v9
  v_mfma_f32_16x16x32_bf16 v[32:35], v[64:67], v[76:79], v[32:35]
  ds_read_b128 v[80:83], v16
  s_waitcnt lgkmcnt(6)
  v_mfma_f32_16x16x32_bf16 v[36:39], v[68:71], v[100:103], v[36:39]
  ds_read_b64 v[60:61], v6 offset:256
  v_mfma_f32_16x16x32_bf16 v[40:43], v[72:75], v[100:103], v[40:43]
  ds_read_b64 v[62:63], v6 offset:264
  v_mfma_f32_16x16x32_bf16 v[44:47], v[68:71], v[104:107], v[44:47]
  ds_read_b64 v[64:65], v6 offset:288
  v_mfma_f32_16x16x32_bf16 v[48:51], v[72:75], v[104:107], v[48:51]
  ds_read_b64 v[66:67], v6 offset:296
  v_mfma_f32_16x16x32_bf16 v[20:23], v[68:71], v[84:87], v[20:23]
  ds_read_b128 v[92:95], v7 offset:2240
  v_mfma_f32_16x16x32_bf16 v[24:27], v[72:75], v[84:87], v[24:27]
  v_subrev_u32 v16, 320, v7
  v_mfma_f32_16x16x32_bf16 v[28:31], v[68:71], v[88:91], v[28:31]
  v_max_i32 v16, v16, v9
  v_mfma_f32_16x16x32_bf16 v[32:35], v[72:75], v[88:91], v[32:35]
  ds_read_b128 v[76:79], v16
  s_waitcnt lgkmcnt(6)
  v_mfma_f32_16x16x32_bf16 v[36:39], v[52:55], v[96:99], v[36:39]
  ds_read_b64 v[68:69], v6 offset:320
  v_mfma_f32_16x16x32_bf16 v[40:43], v[56:59], v[96:99], v[40:43]
  ds_read_b64 v[70:71], v6 offset:328
  v_mfma_f32_16x16x32_bf16 v[44:47], v[52:55], v[100:103], v[44:47]
  ds_read_b64 v[72:73], v6 offset:352
  v_mfma_f32_16x16x32_bf16 v[48:51], v[56:59], v[100:103], v[48:51]
  ds_read_b64 v[74:75], v6 offset:360
  v_mfma_f32_16x16x32_bf16 v[20:23], v[52:55], v[80:83], v[20:23]
  ds_read_b128 v[104:107], v7 offset:2144
  v_mfma_f32_16x16x32_bf16 v[24:27], v[56:59], v[80:83], v[24:27]
  v_subrev_u32 v16, 416, v7
  v_mfma_f32_16x16x32_bf16 v[28:31], v[52:55], v[84:87], v[28:31]
  v_max_i32 v16, v16, v9
  v_mfma_f32_16x16x32_bf16 v[32:35], v[56:59], v[84:87], v[32:35]
  ds_read_b128 v[88:91], v16
  s_waitcnt lgkmcnt(6)
  v_mfma_f32_16x16x32_bf16 v[36:39], v[60:63], v[92:95], v[36:39]
  ds_read_b64 v[52:53], v6 offset:384
  v_mfma_f32_16x16x32_bf16 v[40:43], v[64:67], v[92:95], v[40:43]
  ds_read_b64 v[54:55], v6 offset:392
  v_mfma_f32_16x16x32_bf16 v[44:47], v[60:63], v[96:99], v[44:47]
  ds_read_b64 v[56:57], v6 offset:416
  v_mfma_f32_16x16x32_bf16 v[48:51], v[64:67], v[96:99], v[48:51]
  ds_read_b64 v[58:59], v6 offset:424
  v_mfma_f32_16x16x32_bf16 v[20:23], v[60:63], v[76:79], v[20:23]
  ds_read_b128 v[100:103], v7 offset:2080
  v_mfma_f32_16x16x32_bf16 v[24:27], v[64:67], v[76:79], v[24:27]
  v_subrev_u32 v16, 480, v7
  v_mfma_f32_16x16x32_bf16 v[28:31], v[60:63], v[80:83], v[28:31]
  v_max_i32 v16, v16, v9
  v_mfma_f32_16x16x32_bf16 v[32:35], v[64:67], v[80:83], v[32:35]
  ds_read_b128 v[84:87], v16
  s_waitcnt lgkmcnt(6)
  v_mfma_f32_16x16x32_bf16 v[36:39], v[68:71], v[104:107], v[36:39]
  ds_read_b64 v[60:61], v6 offset:448
  v_mfma_f32_16x16x32_bf16 v[40:43], v[72:75], v[104:107], v[40:43]
  ds_read_b64 v[62:63], v6 offset:456
  v_mfma_f32_16x16x32_bf16 v[44:47], v[68:71], v[92:95], v[44:47]
  ds_read_b64 v[64:65], v6 offset:480
  v_mfma_f32_16x16x32_bf16 v[48:51], v[72:75], v[92:95], v[48:51]
  ds_read_b64 v[66:67], v6 offset:488
  v_mfma_f32_16x16x32_bf16 v[20:23], v[68:71], v[88:91], v[20:23]
  ds_read_b128 v[96:99], v7 offset:1984
  v_mfma_f32_16x16x32_bf16 v[24:27], v[72:75], v[88:91], v[24:27]
  v_subrev_u32 v16, 576, v7
  v_mfma_f32_16x16x32_bf16 v[28:31], v[68:71], v[76:79], v[28:31]
  v_max_i32 v16, v16, v9
  v_mfma_f32_16x16x32_bf16 v[32:35], v[72:75], v[76:79], v[32:35]
  ds_read_b128 v[80:83], v16
  s_waitcnt lgkmcnt(6)
  v_mfma_f32_16x16x32_bf16 v[36:39], v[52:55], v[100:103], v[36:39]
  ds_read_b64 v[68:69], v6 offset:512
  v_mfma_f32_16x16x32_bf16 v[40:43], v[56:59], v[100:103], v[40:43]
  ds_read_b64 v[70:71], v6 offset:520
  v_mfma_f32_16x16x32_bf16 v[44:47], v[52:55], v[104:107], v[44:47]
  ds_read_b64 v[72:73], v6 offset:544
  v_mfma_f32_16x16x32_bf16 v[48:51], v[56:59], v[104:107], v[48:51]
  ds_read_b64 v[74:75], v6 offset:552
  v_mfma_f32_16x16x32_bf16 v[20:23], v[52:55], v[84:87], v[20:23]
  ds_read_b128 v[92:95], v7 offset:1920
  v_mfma_f32_16x16x32_bf16 v[24:27], v[56:59], v[84:87], v[24:27]
  v_subrev_u32 v16, 640, v7
  v_mfma_f32_16x16x32_bf16 v[28:31], v[52:55], v[88:91], v[28:31]
  v_max_i32 v16, v16, v9
  v_mfma_f32_16x16x32_bf16 v[32:35], v[56:59], v[88:91], v[32:35]
  ds_read_b128 v[76:79], v16
  s_waitcnt lgkmcnt(6)
  v_mfma_f32_16x16x32_bf16 v[36:39], v[60:63], v[96:99], v[36:39]
  ds_read_b64 v[52:53], v6 offset:576
  v_mfma_f32_16x16x32_bf16 v[40:43], v[64:67], v[96:99], v[40:43]
  ds_read_b64 v[54:55], v6 offset:584
  v_mfma_f32_16x16x32_bf16 v[44:47], v[60:63], v[100:103], v[44:47]
  ds_read_b64 v[56:57], v6 offset:608
  v_mfma_f32_16x16x32_bf16 v[48:51], v[64:67], v[100:103], v[48:51]
  ds_read_b64 v[58:59], v6 offset:616
  v_mfma_f32_16x16x32_bf16 v[20:23], v[60:63], v[80:83], v[20:23]
  ds_read_b128 v[104:107], v7 offset:1824
  v_mfma_f32_16x16x32_bf16 v[24:27], v[64:67], v[80:83], v[24:27]
  v_subrev_u32 v16, 736, v7
  v_mfma_f32_16x16x32_bf16 v[28:31], v[60:63], v[84:87], v[28:31]
  v_max_i32 v16, v16, v9
  v_mfma_f32_16x16x32_bf16 v[32:35], v[64:67], v[84:87], v[32:35]
  ds_read_b128 v[88:91], v16
  s_waitcnt lgkmcnt(6)
  v_mfma_f32_16x16x32_bf16 v[36:39], v[68:71], v[92:95], v[36:39]
  ds_read_b64 v[60:61], v6 offset:640
  v_mfma_f32_16x16x32_bf16 v[40:43], v[72:75], v[92:95], v[40:43]
  ds_read_b64 v[62:63], v6 offset:648
  v_mfma_f32_16x16x32_bf16 v[44:47], v[68:71], v[96:99], v[44:47]
  ds_read_b64 v[64:65], v6 offset:672
  v_mfma_f32_16x16x32_bf16 v[48:51], v[72:75], v[96:99], v[48:51]
  ds_read_b64 v[66:67], v6 offset:680
  v_mfma_f32_16x16x32_bf16 v[20:23], v[68:71], v[76:79], v[20:23]
  ds_read_b128 v[100:103], v7 offset:1760
  v_mfma_f32_16x16x32_bf16 v[24:27], v[72:75], v[76:79], v[24:27]
  v_subrev_u32 v16, 800, v7
  v_mfma_f32_16x16x32_bf16 v[28:31], v[68:71], v[80:83], v[28:31]
  v_max_i32 v16, v16, v9
  v_mfma_f32_16x16x32_bf16 v[32:35], v[72:75], v[80:83], v[32:35]
  ds_read_b128 v[84:87], v16
  s_waitcnt lgkmcnt(6)
  v_mfma_f32_16x16x32_bf16 v[36:39], v[52:55], v[104:107], v[36:39]
  ds_read_b64 v[68:69], v6 offset:704
  v_mfma_f32_16x16x32_bf16 v[40:43], v[56:59], v[104:107], v[40:43]
  ds_read_b64 v[70:71], v6 offset:712
  v_mfma_f32_16x16x32_bf16 v[44:47], v[52:55], v[92:95], v[44:47]
  ds_read_b64 v[72:73], v6 offset:736
  v_mfma_f32_16x16x32_bf16 v[48:51], v[56:59], v[92:95], v[48:51]
  ds_read_b64 v[74:75], v6 offset:744
  v_mfma_f32_16x16x32_bf16 v[20:23], v[52:55], v[88:91], v[20:23]
  ds_read_b128 v[96:99], v7 offset:1664
  v_mfma_f32_16x16x32_bf16 v[24:27], v[56:59], v[88:91], v[24:27]
  v_subrev_u32 v16, 896, v7
  v_mfma_f32_16x16x32_bf16 v[28:31], v[52:55], v[76:79], v[28:31]
  v_max_i32 v16, v16, v9
  v_mfma_f32_16x16x32_bf16 v[32:35], v[56:59], v[76:79], v[32:35]
  ds_read_b128 v[80:83], v16
  s_waitcnt lgkmcnt(6)
  v_mfma_f32_16x16x32_bf16 v[36:39], v[60:63], v[100:103], v[36:39]
  ds_read_b64 v[52:53], v6 offset:768
  v_mfma_f32_16x16x32_bf16 v[40:43], v[64:67], v[100:103], v[40:43]
  ds_read_b64 v[54:55], v6 offset:776
  v_mfma_f32_16x16x32_bf16 v[44:47], v[60:63], v[104:107], v[44:47]
  ds_read_b64 v[56:57], v6 offset:800
  v_mfma_f32_16x16x32_bf16 v[48:51], v[64:67], v[104:107], v[48:51]
  ds_read_b64 v[58:59], v6 offset:808
  v_mfma_f32_16x16x32_bf16 v[20:23], v[60:63], v[84:87], v[20:23]
  ds_read_b128 v[92:95], v7 offset:1600
  v_mfma_f32_16x16x32_bf16 v[24:27], v[64:67], v[84:87], v[24:27]
  v_subrev_u32 v16, 960, v7
  v_mfma_f32_16x16x32_bf16 v[28:31], v[60:63], v[88:91], v[28:31]
  v_max_i32 v16, v16, v9
  v_mfma_f32_16x16x32_bf16 v[32:35], v[64:67], v[88:91], v[32:35]
  ds_read_b128 v[76:79], v16
  s_waitcnt lgkmcnt(6)
  v_mfma_f32_16x16x32_bf16 v[36:39], v[68:71], v[96:99], v[36:39]
  ds_read_b64 v[60:61], v6 offset:832
  v_mfma_f32_16x16x32_bf16 v[40:43], v[72:75], v[96:99], v[40:43]
  ds_read_b64 v[62:63], v6 offset:840
  v_mfma_f32_16x16x32_bf16 v[44:47], v[68:71], v[100:103], v[44:47]
  ds_read_b64 v[64:65], v6 offset:864
  v_mfma_f32_16x16x32_bf16 v[48:51], v[72:75], v[100:103], v[48:51]
  ds_read_b64 v[66:67], v6 offset:872
  v_mfma_f32_16x16x32_bf16 v[20:23], v[68:71], v[80:83], v[20:23]
  ds_read_b128 v[104:107], v7 offset:1504
  v_mfma_f32_16x16x32_bf16 v[24:27], v[72:75], v[80:83], v[24:27]
  v_subrev_u32 v16, 1056, v7
  v_mfma_f32_16x16x32_bf16 v[28:31], v[68:71], v[84:87], v[28:31]
  v_max_i32 v16, v16, v9
  v_mfma_f32_16x16x32_bf16 v[32:35], v[72:75], v[84:87], v[32:35]
  ds_read_b128 v[88:91], v16
  s_waitcnt lgkmcnt(6)
  v_mfma_f32_16x16x32_bf16 v[36:39], v[52:55], v[92:95], v[36:39]
  ds_read_b64 v[68:69], v6 offset:896
  v_mfma_f32_16x16x32_bf16 v[40:43], v[56:59], v[92:95], v[40:43]
  ds_read_b64 v[70:71], v6 offset:904
  v_mfma_f32_16x16x32_bf16 v[44:47], v[52:55], v[96:99], v[44:47]
  ds_read_b64 v[72:73], v6 offset:928
  v_mfma_f32_16x16x32_bf16 v[48:51], v[56:59], v[96:99], v[48:51]
  ds_read_b64 v[74:75], v6 offset:936
  v_mfma_f32_16x16x32_bf16 v[20:23], v[52:55], v[76:79], v[20:23]
  ds_read_b128 v[100:103], v7 offset:1440
  v_mfma_f32_16x16x32_bf16 v[24:27], v[56:59], v[76:79], v[24:27]
  v_subrev_u32 v16, 1120, v7
  v_mfma_f32_16x16x32_bf16 v[28:31], v[52:55], v[80:83], v[28:31]
  v_max_i32 v16, v16, v9
  v_mfma_f32_16x16x32_bf16 v[32:35], v[56:59], v[80:83], v[32:35]
  ds_read_b128 v[84:87], v16
  s_waitcnt lgkmcnt(6)
  v_mfma_f32_16x16x32_bf16 v[36:39], v[60:63], v[104:107], v[36:39]
  ds_read_b64 v[52:53], v6 offset:960
  v_mfma_f32_16x16x32_bf16 v[40:43], v[64:67], v[104:107], v[40:43]
  ds_read_b64 v[54:55], v6 offset:968
  v_mfma_f32_16x16x32_bf16 v[44:47], v[60:63], v[92:95], v[44:47]
  ds_read_b64 v[56:57], v6 offset:992
  v_mfma_f32_16x16x32_bf16 v[48:51], v[64:67], v[92:95], v[48:51]
  ds_read_b64 v[58:59], v6 offset:1000
  v_mfma_f32_16x16x32_bf16 v[20:23], v[60:63], v[88:91], v[20:23]
  ds_read_b128 v[96:99], v7 offset:1344
  v_mfma_f32_16x16x32_bf16 v[24:27], v[64:67], v[88:91], v[24:27]
  v_subrev_u32 v16, 1216, v7
  v_mfma_f32_16x16x32_bf16 v[28:31], v[60:63], v[76:79], v[28:31]
  v_max_i32 v16, v16, v9
  v_mfma_f32_16x16x32_bf16 v[32:35], v[64:67], v[76:79], v[32:35]
  ds_read_b128 v[80:83], v16
  s_waitcnt lgkmcnt(6)
  v_mfma_f32_16x16x32_bf16 v[36:39], v[68:71], v[100:103], v[36:39]
  ds_read_b64 v[60:61], v6 offset:1024
  v_mfma_f32_16x16x32_bf16 v[40:43], v[72:75], v[100:103], v[40:43]
  ds_read_b64 v[62:63], v6 offset:1032
  v_mfma_f32_16x16x32_bf16 v[44:47], v[68:71], v[104:107], v[44:47]
  ds_read_b64 v[64:65], v6 offset:1056
  v_mfma_f32_16x16x32_bf16 v[48:51], v[72:75], v[104:107], v[48:51]
  ds_read_b64 v[66:67], v6 offset:1064
  v_mfma_f32_16x16x32_bf16 v[20:23], v[68:71], v[84:87], v[20:23]
  ds_read_b128 v[92:95], v7 offset:1280
  v_mfma_f32_16x16x32_bf16 v[24:27], v[72:75], v[84:87], v[24:27]
  v_subrev_u32 v16, 1280, v7
  v_mfma_f32_16x16x32_bf16 v[28:31], v[68:71], v[88:91], v[28:31]
  v_max_i32 v16, v16, v9
  v_mfma_f32_16x16x32_bf16 v[32:35], v[72:75], v[88:91], v[32:35]
  ds_read_b128 v[76:79], v16
  s_waitcnt lgkmcnt(6)
  v_mfma_f32_16x16x32_bf16 v[36:39], v[52:55], v[96:99], v[36:39]
  ds_read_b64 v[68:69], v6 offset:1088
  v_mfma_f32_16x16x32_bf16 v[40:43], v[56:59], v[96:99], v[40:43]
  ds_read_b64 v[70:71], v6 offset:1096
  v_mfma_f32_16x16x32_bf16 v[44:47], v[52:55], v[100:103], v[44:47]
  ds_read_b64 v[72:73], v6 offset:1120
  v_mfma_f32_16x16x32_bf16 v[48:51], v[56:59], v[100:103], v[48:51]
  ds_read_b64 v[74:75], v6 offset:1128
  v_mfma_f32_16x16x32_bf16 v[20:23], v[52:55], v[80:83], v[20:23]
  ds_read_b128 v[104:107], v7 offset:1184
  v_mfma_f32_16x16x32_bf16 v[24:27], v[56:59], v[80:83], v[24:27]
  v_subrev_u32 v16, 1376, v7
  v_mfma_f32_16x16x32_bf16 v[28:31], v[52:55], v[84:87], v[28:31]
  v_max_i32 v16, v16, v9
  v_mfma_f32_16x16x32_bf16 v[32:35], v[56:59], v[84:87], v[32:35]
  ds_read_b128 v[88:91], v16
  s_waitcnt lgkmcnt(6)
  v_mfma_f32_16x16x32_bf16 v[36:39], v[60:63], v[92:95], v[36:39]
  ds_read_b64 v[52:53], v6 offset:1152
  v_mfma_f32_16x16x32_bf16 v[40:43], v[64:67], v[92:95], v[40:43]
  ds_read_b64 v[54:55], v6 offset:1160
  v_mfma_f32_16x16x32_bf16 v[44:47], v[60:63], v[96:99], v[44:47]
  ds_read_b64 v[56:57], v6 offset:1184
  v_mfma_f32_16x16x32_bf16 v[48:51], v[64:67], v[96:99], v[48:51]
  ds_read_b64 v[58:59], v6 offset:1192
  v_mfma_f32_16x16x32_bf16 v[20:23], v[60:63], v[76:79], v[20:23]
  ds_read_b128 v[100:103], v7 offset:1120
  v_mfma_f32_16x16x32_bf16 v[24:27], v[64:67], v[76:79], v[24:27]
  v_subrev_u32 v16, 1440, v7
  v_mfma_f32_16x16x32_bf16 v[28:31], v[60:63], v[80:83], v[28:31]
  v_max_i32 v16, v16, v9
  v_mfma_f32_16x16x32_bf16 v[32:35], v[64:67], v[80:83], v[32:35]
  ds_read_b128 v[84:87], v16
  s_waitcnt lgkmcnt(6)
  v_mfma_f32_16x16x32_bf16 v[36:39], v[68:71], v[104:107], v[36:39]
  ds_read_b64 v[60:61], v6 offset:1216
  v_mfma_f32_16x16x32_bf16 v[40:43], v[72:75], v[104:107], v[40:43]
  ds_read_b64 v[62:63], v6 offset:1224
  v_mfma_f32_16x16x32_bf16 v[44:47], v[68:71], v[92:95], v[44:47]
  ds_read_b64 v[64:65], v6 offset:1248
  v_mfma_f32_16x16x32_bf16 v[48:51], v[72:75], v[92:95], v[48:51]
  ds_read_b64 v[66:67], v6 offset:1256
  v_mfma_f32_16x16x32_bf16 v[20:23], v[68:71], v[88:91], v[20:23]
  ds_read_b128 v[96:99], v7 offset:1024
  v_mfma_f32_16x16x32_bf16 v[24:27], v[72:75], v[88:91], v[24:27]
  v_subrev_u32 v16, 1536, v7
  v_mfma_f32_16x16x32_bf16 v[28:31], v[68:71], v[76:79], v[28:31]
  v_max_i32 v16, v16, v9
  v_mfma_f32_16x16x32_bf16 v[32:35], v[72:75], v[76:79], v[32:35]
  ds_read_b128 v[80:83], v16
  s_waitcnt lgkmcnt(6)
  v_mfma_f32_16x16x32_bf16 v[36:39], v[52:55], v[100:103], v[36:39]
  ds_read_b64 v[68:69], v6 offset:1280
  v_mfma_f32_16x16x32_bf16 v[40:43], v[56:59], v[100:103], v[40:43]
  ds_read_b64 v[70:71], v6 offset:1288
  v_mfma_f32_16x16x32_bf16 v[44:47], v[52:55], v[104:107], v[44:47]
  ds_read_b64 v[72:73], v6 offset:1312
  v_mfma_f32_16x16x32_bf16 v[48:51], v[56:59], v[104:107], v[48:51]
  ds_read_b64 v[74:75], v6 offset:1320
  v_mfma_f32_16x16x32_bf16 v[20:23], v[52:55], v[84:87], v[20:23]
  ds_read_b128 v[92:95], v7 offset:960
  v_mfma_f32_16x16x32_bf16 v[24:27], v[56:59], v[84:87], v[24:27]
  v_subrev_u32 v16, 1600, v7
  v_mfma_f32_16x16x32_bf16 v[28:31], v[52:55], v[88:91], v[28:31]
  v_max_i32 v16, v16, v9
  v_mfma_f32_16x16x32_bf16 v[32:35], v[56:59], v[88:91], v[32:35]
  ds_read_b128 v[76:79], v16
  s_waitcnt lgkmcnt(6)
  v_mfma_f32_16x16x32_bf16 v[36:39], v[60:63], v[96:99], v[36:39]
  ds_read_b64 v[52:53], v6 offset:1344
  v_mfma_f32_16x16x32_bf16 v[40:43], v[64:67], v[96:99], v[40:43]
  ds_read_b64 v[54:55], v6 offset:1352
  v_mfma_f32_16x16x32_bf16 v[44:47], v[60:63], v[100:103], v[44:47]
  ds_read_b64 v[56:57], v6 offset:1376
  v_mfma_f32_16x16x32_bf16 v[48:51], v[64:67], v[100:103], v[48:51]
  ds_read_b64 v[58:59], v6 offset:1384
  v_mfma_f32_16x16x32_bf16 v[20:23], v[60:63], v[80:83], v[20:23]
  ds_read_b128 v[104:107], v7 offset:864
  v_mfma_f32_16x16x32_bf16 v[24:27], v[64:67], v[80:83], v[24:27]
  v_subrev_u32 v16, 1696, v7
  v_mfma_f32_16x16x32_bf16 v[28:31], v[60:63], v[84:87], v[28:31]
  v_max_i32 v16, v16, v9
  v_mfma_f32_16x16x32_bf16 v[32:35], v[64:67], v[84:87], v[32:35]
  ds_read_b128 v[88:91], v16
  s_waitcnt lgkmcnt(6)
  v_mfma_f32_16x16x32_bf16 v[36:39], v[68:71], v[92:95], v[36:39]
  ds_read_b64 v[60:61], v6 offset:1408
  v_mfma_f32_16x16x32_bf16 v[40:43], v[72:75], v[92:95], v[40:43]
  ds_read_b64 v[62:63], v6 offset:1416
  v_mfma_f32_16x16x32_bf16 v[44:47], v[68:71], v[96:99], v[44:47]
  ds_read_b64 v[64:65], v6 offset:1440
  v_mfma_f32_16x16x32_bf16 v[48:51], v[72:75], v[96:99], v[48:51]
  ds_read_b64 v[66:67], v6 offset:1448
  v_mfma_f32_16x16x32_bf16 v[20:23], v[68:71], v[76:79], v[20:23]
  ds_read_b128 v[100:103], v7 offset:800
  v_mfma_f32_16x16x32_bf16 v[24:27], v[72:75], v[76:79], v[24:27]
  v_subrev_u32 v16, 1760, v7
  v_mfma_f32_16x16x32_bf16 v[28:31], v[68:71], v[80:83], v[28:31]
  v_max_i32 v16, v16, v9
  v_mfma_f32_16x16x32_bf16 v[32:35], v[72:75], v[80:83], v[32:35]
  ds_read_b128 v[84:87], v16
  s_waitcnt lgkmcnt(6)
  v_mfma_f32_16x16x32_bf16 v[36:39], v[52:55], v[104:107], v[36:39]
  ds_read_b64 v[68:69], v6 offset:1472
  v_mfma_f32_16x16x32_bf16 v[40:43], v[56:59], v[104:107], v[40:43]
  ds_read_b64 v[70:71], v6 offset:1480
  v_mfma_f32_16x16x32_bf16 v[44:47], v[52:55], v[92:95], v[44:47]
  ds_read_b64 v[72:73], v6 offset:1504
  v_mfma_f32_16x16x32_bf16 v[48:51], v[56:59], v[92:95], v[48:51]
  ds_read_b64 v[74:75], v6 offset:1512
  v_mfma_f32_16x16x32_bf16 v[20:23], v[52:55], v[88:91], v[20:23]
  ds_read_b128 v[96:99], v7 offset:704
  v_mfma_f32_16x16x32_bf16 v[24:27], v[56:59], v[88:91], v[24:27]
  v_subrev_u32 v16, 1856, v7
  v_mfma_f32_16x16x32_bf16 v[28:31], v[52:55], v[76:79], v[28:31]
  v_max_i32 v16, v16, v9
  v_mfma_f32_16x16x32_bf16 v[32:35], v[56:59], v[76:79], v[32:35]
  ds_read_b128 v[80:83], v16
  s_waitcnt lgkmcnt(6)
  v_mfma_f32_16x16x32_bf16 v[36:39], v[60:63], v[100:103], v[36:39]
  ds_read_b64 v[52:53], v6 offset:1536
  v_mfma_f32_16x16x32_bf16 v[40:43], v[64:67], v[100:103], v[40:43]
  ds_read_b64 v[54:55], v6 offset:1544
  v_mfma_f32_16x16x32_bf16 v[44:47], v[60:63], v[104:107], v[44:47]
  ds_read_b64 v[56:57], v6 offset:1568
  v_mfma_f32_16x16x32_bf16 v[48:51], v[64:67], v[104:107], v[48:51]
  ds_read_b64 v[58:59], v6 offset:1576
  v_mfma_f32_16x16x32_bf16 v[20:23], v[60:63], v[84:87], v[20:23]
  ds_read_b128 v[92:95], v7 offset:640
  v_mfma_f32_16x16x32_bf16 v[24:27], v[64:67], v[84:87], v[24:27]
  v_subrev_u32 v16, 1920, v7
  v_mfma_f32_16x16x32_bf16 v[28:31], v[60:63], v[88:91], v[28:31]
  v_max_i32 v16, v16, v9
  v_mfma_f32_16x16x32_bf16 v[32:35], v[64:67], v[88:91], v[32:35]
  ds_read_b128 v[76:79], v16
  s_waitcnt lgkmcnt(6)
  v_mfma_f32_16x16x32_bf16 v[36:39], v[68:71], v[96:99], v[36:39]
  ds_read_b64 v[60:61], v6 offset:1600
  v_mfma_f32_16x16x32_bf16 v[40:43], v[72:75], v[96:99], v[40:43]
  ds_read_b64 v[62:63], v6 offset:1608
  v_mfma_f32_16x16x32_bf16 v[44:47], v[68:71], v[100:103], v[44:47]
  ds_read_b64 v[64:65], v6 offset:1632
  v_mfma_f32_16x16x32_bf16 v[48:51], v[72:75], v[100:103], v[48:51]
  ds_read_b64 v[66:67], v6 offset:1640
  v_mfma_f32_16x16x32_bf16 v[20:23], v[68:71], v[80:83], v[20:23]
  ds_read_b128 v[104:107], v7 offset:544
  v_mfma_f32_16x16x32_bf16 v[24:27], v[72:75], v[80:83], v[24:27]
  v_subrev_u32 v16, 2016, v7
  v_mfma_f32_16x16x32_bf16 v[28:31], v[68:71], v[84:87], v[28:31]
  v_max_i32 v16, v16, v9
  v_mfma_f32_16x16x32_bf16 v[32:35], v[72:75], v[84:87], v[32:35]
  ds_read_b128 v[88:91], v16
  s_waitcnt lgkmcnt(6)
  v_mfma_f32_16x16x32_bf16 v[36:39], v[52:55], v[92:95], v[36:39]
  ds_read_b64 v[68:69], v6 offset:1664
  v_mfma_f32_16x16x32_bf16 v[40:43], v[56:59], v[92:95], v[40:43]
  ds_read_b64 v[70:71], v6 offset:1672
  v_mfma_f32_16x16x32_bf16 v[44:47], v[52:55], v[96:99], v[44:47]
  ds_read_b64 v[72:73], v6 offset:1696
  v_mfma_f32_16x16x32_bf16 v[48:51], v[56:59], v[96:99], v[48:51]
  ds_read_b64 v[74:75], v6 offset:1704
  v_mfma_f32_16x16x32_bf16 v[20:23], v[52:55], v[76:79], v[20:23]
  ds_read_b128 v[100:103], v7 offset:480
  v_mfma_f32_16x16x32_bf16 v[24:27], v[56:59], v[76:79], v[24:27]
  v_subrev_u32 v16, 2080, v7
  v_mfma_f32_16x16x32_bf16 v[28:31], v[52:55], v[80:83], v[28:31]
  v_max_i32 v16, v16, v9
  v_mfma_f32_16x16x32_bf16 v[32:35], v[56:59], v[80:83], v[32:35]
  ds_read_b128 v[84:87], v16
  s_waitcnt lgkmcnt(6)
  v_mfma_f32_16x16x32_bf16 v[36:39], v[60:63], v[104:107], v[36:39]
  ds_read_b64 v[52:53], v6 offset:1728
  v_mfma_f32_16x16x32_bf16 v[40:43], v[64:67], v[104:107], v[40:43]
  ds_read_b64 v[54:55], v6 offset:1736
  v_mfma_f32_16x16x32_bf16 v[44:47], v[60:63], v[92:95], v[44:47]
  ds_read_b64 v[56:57], v6 offset:1760
  v_mfma_f32_16x16x32_bf16 v[48:51], v[64:67], v[92:95], v[48:51]
  ds_read_b64 v[58:59], v6 offset:1768
  v_mfma_f32_16x16x32_bf16 v[20:23], v[60:63], v[88:91], v[20:23]
  ds_read_b128 v[96:99], v7 offset:384
  v_mfma_f32_16x16x32_bf16 v[24:27], v[64:67], v[88:91], v[24:27]
  v_subrev_u32 v16, 2176, v7
  v_mfma_f32_16x16x32_bf16 v[28:31], v[60:63], v[76:79], v[28:31]
  v_max_i32 v16, v16, v9
  v_mfma_f32_16x16x32_bf16 v[32:35], v[64:67], v[76:79], v[32:35]
  ds_read_b128 v[80:83], v16
  s_waitcnt lgkmcnt(6)
  v_mfma_f32_16x16x32_bf16 v[36:39], v[68:71], v[100:103], v[36:39]
  ds_read_b64 v[60:61], v6 offset:1792
  v_mfma_f32_16x16x32_bf16 v[40:43], v[72:75], v[100:103], v[40:43]
  ds_read_b64 v[62:63], v6 offset:1800
  v_mfma_f32_16x16x32_bf16 v[44:47], v[68:71], v[104:107], v[44:47]
  ds_read_b64 v[64:65], v6 offset:1824
  v_mfma_f32_16x16x32_bf16 v[48:51], v[72:75], v[104:107], v[48:51]
  ds_read_b64 v[66:67], v6 offset:1832
  v_mfma_f32_16x16x32_bf16 v[20:23], v[68:71], v[84:87], v[20:23]
  ds_read_b128 v[92:95], v7 offset:320
  v_mfma_f32_16x16x32_bf16 v[24:27], v[72:75], v[84:87], v[24:27]
  v_subrev_u32 v16, 2240, v7
  v_mfma_f32_16x16x32_bf16 v[28:31], v[68:71], v[88:91], v[28:31]
  v_max_i32 v16, v16, v9
  v_mfma_f32_16x16x32_bf16 v[32:35], v[72:75], v[88:91], v[32:35]
  ds_read_b128 v[76:79], v16
  s_waitcnt lgkmcnt(6)
  v_mfma_f32_16x16x32_bf16 v[36:39], v[52:55], v[96:99], v[36:39]
  ds_read_b64 v[68:69], v6 offset:1856
  v_mfma_f32_16x16x32_bf16 v[40:43], v[56:59], v[96:99], v[40:43]
  ds_read_b64 v[70:71], v6 offset:1864
  v_mfma_f32_16x16x32_bf16 v[44:47], v[52:55], v[100:103], v[44:47]
  ds_read_b64 v[72:73], v6 offset:1888
  v_mfma_f32_16x16x32_bf16 v[48:51], v[56:59], v[100:103], v[48:51]
  ds_read_b64 v[74:75], v6 offset:1896
  v_mfma_f32_16x16x32_bf16 v[20:23], v[52:55], v[80:83], v[20:23]
  ds_read_b128 v[104:107], v7 offset:224
  v_mfma_f32_16x16x32_bf16 v[24:27], v[56:59], v[80:83], v[24:27]
  v_subrev_u32 v16, 2336, v7
  v_mfma_f32_16x16x32_bf16 v[28:31], v[52:55], v[84:87], v[28:31]
  v_max_i32 v16, v16, v9
  v_mfma_f32_16x16x32_bf16 v[32:35], v[56:59], v[84:87], v[32:35]
  ds_read_b128 v[88:91], v16
  s_waitcnt lgkmcnt(6)
  v_mfma_f32_16x16x32_bf16 v[36:39], v[60:63], v[92:95], v[36:39]
  ds_read_b64 v[52:53], v6 offset:1920
  v_mfma_f32_16x16x32_bf16 v[40:43], v[64:67], v[92:95], v[40:43]
  ds_read_b64 v[54:55], v6 offset:1928
  v_mfma_f32_16x16x32_bf16 v[44:47], v[60:63], v[96:99], v[44:47]
  ds_read_b64 v[56:57], v6 offset:1952
  v_mfma_f32_16x16x32_bf16 v[48:51], v[64:67], v[96:99], v[48:51]
  ds_read_b64 v[58:59], v6 offset:1960
  v_mfma_f32_16x16x32_bf16 v[20:23], v[60:63], v[76:79], v[20:23]
  ds_read_b128 v[100:103], v7 offset:160
  v_mfma_f32_16x16x32_bf16 v[24:27], v[64:67], v[76:79], v[24:27]
  v_subrev_u32 v16, 2400, v7
  v_mfma_f32_16x16x32_bf16 v[28:31], v[60:63], v[80:83], v[28:31]
  v_max_i32 v16, v16, v9
  v_mfma_f32_16x16x32_bf16 v[32:35], v[64:67], v[80:83], v[32:35]
  ds_read_b128 v[84:87], v16
  s_waitcnt lgkmcnt(6)
  v_mfma_f32_16x16x32_bf16 v[36:39], v[68:71], v[104:107], v[36:39]
  ds_read_b64 v[60:61], v6 offset:1984
  v_mfma_f32_16x16x32_bf16 v[40:43], v[72:75], v[104:107], v[40:43]
  ds_read_b64 v[62:63], v6 offset:1992
  v_mfma_f32_16x16x32_bf16 v[44:47], v[68:71], v[92:95], v[44:47]
  ds_read_b64 v[64:65], v6 offset:2016
  v_mfma_f32_16x16x32_bf16 v[48:51], v[72:75], v[92:95], v[48:51]
  ds_read_b64 v[66:67], v6 offset:2024
  v_mfma_f32_16x16x32_bf16 v[20:23], v[68:71], v[88:91], v[20:23]
  ds_read_b128 v[96:99], v7 offset:64
  v_mfma_f32_16x16x32_bf16 v[24:27], v[72:75], v[88:91], v[24:27]
  v_subrev_u32 v16, 2496, v7
  v_mfma_f32_16x16x32_bf16 v[28:31], v[68:71], v[76:79], v[28:31]
  v_max_i32 v16, v16, v9
  v_mfma_f32_16x16x32_bf16 v[32:35], v[72:75], v[76:79], v[32:35]
  ds_read_b128 v[80:83], v16
  s_waitcnt lgkmcnt(6)
  v_mfma_f32_16x16x32_bf16 v[36:39], v[52:55], v[100:103], v[36:39]
  ds_read_b64 v[68:69], v6 offset:2048
  v_mfma_f32_16x16x32_bf16 v[40:43], v[56:59], v[100:103], v[40:43]
  ds_read_b64 v[70:71], v6 offset:2056
  v_mfma_f32_16x16x32_bf16 v[44:47], v[52:55], v[104:107], v[44:47]
  ds_read_b64 v[72:73], v6 offset:2080
  v_mfma_f32_16x16x32_bf16 v[48:51], v[56:59], v[104:107], v[48:51]
  ds_read_b64 v[74:75], v6 offset:2088
  v_mfma_f32_16x16x32_bf16 v[20:23], v[52:55], v[84:87], v[20:23]
  ds_read_b128 v[92:95], v7 offset:0
  v_mfma_f32_16x16x32_bf16 v[24:27], v[56:59], v[84:87], v[24:27]
  v_mfma_f32_16x16x32_bf16 v[28:31], v[52:55], v[88:91], v[28:31]
  v_mfma_f32_16x16x32_bf16 v[32:35], v[56:59], v[88:91], v[32:35]
  s_waitcnt lgkmcnt(5)
  v_mfma_f32_16x16x32_bf16 v[36:39], v[60:63], v[96:99], v[36:39]
  ds_read_b64 v[52:53], v6 offset:2112
  v_mfma_f32_16x16x32_bf16 v[40:43], v[64:67], v[96:99], v[40:43]
  ds_read_b64 v[54:55], v6 offset:2120
  v_mfma_f32_16x16x32_bf16 v[44:47], v[60:63], v[100:103], v[44:47]
  ds_read_b64 v[56:57], v6 offset:2144
  v_mfma_f32_16x16x32_bf16 v[48:51], v[64:67], v[100:103], v[48:51]
  ds_read_b64 v[58:59], v6 offset:2152
  v_mfma_f32_16x16x32_bf16 v[20:23], v[60:63], v[80:83], v[20:23]
  v_subrev_u32 v17, 96, v7
  v_mfma_f32_16x16x32_bf16 v[24:27], v[64:67], v[80:83], v[24:27]
  v_max_i32 v17, v17, v9
  v_mfma_f32_16x16x32_bf16 v[28:31], v[60:63], v[84:87], v[28:31]
  ds_read_b128 v[104:107], v17
  v_mfma_f32_16x16x32_bf16 v[32:35], v[64:67], v[84:87], v[32:35]
  s_waitcnt lgkmcnt(5)
  v_mfma_f32_16x16x32_bf16 v[36:39], v[68:71], v[92:95], v[36:39]
  ds_read_b64 v[60:61], v6 offset:2176
  ds_read_b64 v[62:63], v6 offset:2184
  v_mfma_f32_16x16x32_bf16 v[40:43], v[72:75], v[92:95], v[40:43]
  ds_read_b64 v[64:65], v6 offset:2208
  ds_read_b64 v[66:67], v6 offset:2216
  v_mfma_f32_16x16x32_bf16 v[44:47], v[68:71], v[96:99], v[44:47]
  v_subrev_u32 v17, 160, v7
  v_max_i32 v17, v17, v9
  v_mfma_f32_16x16x32_bf16 v[48:51], v[72:75], v[96:99], v[48:51]
  ds_read_b128 v[100:103], v17
  s_waitcnt lgkmcnt(5)
  v_mfma_f32_16x16x32_bf16 v[36:39], v[52:55], v[104:107], v[36:39]
  ds_read_b64 v[68:69], v6 offset:2240
  ds_read_b64 v[70:71], v6 offset:2248
  v_mfma_f32_16x16x32_bf16 v[40:43], v[56:59], v[104:107], v[40:43]
  ds_read_b64 v[72:73], v6 offset:2272
  ds_read_b64 v[74:75], v6 offset:2280
  v_mfma_f32_16x16x32_bf16 v[44:47], v[52:55], v[92:95], v[44:47]
  v_subrev_u32 v17, 256, v7
  v_max_i32 v17, v17, v9
  v_mfma_f32_16x16x32_bf16 v[48:51], v[56:59], v[92:95], v[48:51]
  ds_read_b128 v[96:99], v17
  s_waitcnt lgkmcnt(5)
  v_mfma_f32_16x16x32_bf16 v[36:39], v[60:63], v[100:103], v[36:39]
  ds_read_b64 v[52:53], v6 offset:2304
  ds_read_b64 v[54:55], v6 offset:2312
  v_mfma_f32_16x16x32_bf16 v[40:43], v[64:67], v[100:103], v[40:43]
  ds_read_b64 v[56:57], v6 offset:2336
  ds_read_b64 v[58:59], v6 offset:2344
  v_mfma_f32_16x16x32_bf16 v[44:47], v[60:63], v[104:107], v[44:47]
  v_subrev_u32 v17, 320, v7
  v_max_i32 v17, v17, v9
  v_mfma_f32_16x16x32_bf16 v[48:51], v[64:67], v[104:107], v[48:51]
  ds_read_b128 v[92:95], v17
  s_waitcnt lgkmcnt(5)
  v_mfma_f32_16x16x32_bf16 v[36:39], v[68:71], v[96:99], v[36:39]
  ds_read_b64 v[60:61], v6 offset:2368
  ds_read_b64 v[62:63], v6 offset:2376
  v_mfma_f32_16x16x32_bf16 v[40:43], v[72:75], v[96:99], v[40:43]
  ds_read_b64 v[64:65], v6 offset:2400
  ds_read_b64 v[66:67], v6 offset:2408
  v_mfma_f32_16x16x32_bf16 v[44:47], v[68:71], v[100:103], v[44:47]
  v_subrev_u32 v17, 416, v7
  v_max_i32 v17, v17, v9
  v_mfma_f32_16x16x32_bf16 v[48:51], v[72:75], v[100:103], v[48:51]
  ds_read_b128 v[104:107], v17
  s_waitcnt lgkmcnt(5)
  v_mfma_f32_16x16x32_bf16 v[36:39], v[52:55], v[92:95], v[36:39]
  ds_read_b64 v[68:69], v6 offset:2432
  ds_read_b64 v[70:71], v6 offset:2440
  v_mfma_f32_16x16x32_bf16 v[40:43], v[56:59], v[92:95], v[40:43]
  ds_read_b64 v[72:73], v6 offset:2464
  ds_read_b64 v[74:75], v6 offset:2472
  v_mfma_f32_16x16x32_bf16 v[44:47], v[52:55], v[96:99], v[44:47]
  v_subrev_u32 v17, 480, v7
  v_max_i32 v17, v17, v9
  v_mfma_f32_16x16x32_bf16 v[48:51], v[56:59], v[96:99], v[48:51]
  ds_read_b128 v[100:103], v17
  s_waitcnt lgkmcnt(5)
  v_mfma_f32_16x16x32_bf16 v[36:39], v[60:63], v[104:107], v[36:39]
  ds_read_b64 v[52:53], v6 offset:2496
  ds_read_b64 v[54:55], v6 offset:2504
  v_mfma_f32_16x16x32_bf16 v[40:43], v[64:67], v[104:107], v[40:43]
  ds_read_b64 v[56:57], v6 offset:2528
  ds_read_b64 v[58:59], v6 offset:2536
  v_mfma_f32_16x16x32_bf16 v[44:47], v[60:63], v[92:95], v[44:47]
  v_subrev_u32 v17, 576, v7
  v_max_i32 v17, v17, v9
  v_mfma_f32_16x16x32_bf16 v[48:51], v[64:67], v[92:95], v[48:51]
  ds_read_b128 v[96:99], v17
  s_waitcnt lgkmcnt(5)
  v_mfma_f32_16x16x32_bf16 v[36:39], v[68:71], v[100:103], v[36:39]
  ds_read_b64 v[60:61], v6 offset:2560
  ds_read_b64 v[62:63], v6 offset:2568
  v_mfma_f32_16x16x32_bf16 v[40:43], v[72:75], v[100:103], v[40:43]
  ds_read_b64 v[64:65], v6 offset:2592
  ds_read_b64 v[66:67], v6 offset:2600
  v_mfma_f32_16x16x32_bf16 v[44:47], v[68:71], v[104:107], v[44:47]
  v_subrev_u32 v17, 640, v7
  v_max_i32 v17, v17, v9
  v_mfma_f32_16x16x32_bf16 v[48:51], v[72:75], v[104:107], v[48:51]
  ds_read_b128 v[92:95], v17
  s_waitcnt lgkmcnt(5)
  v_mfma_f32_16x16x32_bf16 v[36:39], v[52:55], v[96:99], v[36:39]
  ds_read_b64 v[68:69], v6 offset:2624
  ds_read_b64 v[70:71], v6 offset:2632
  v_mfma_f32_16x16x32_bf16 v[40:43], v[56:59], v[96:99], v[40:43]
  ds_read_b64 v[72:73], v6 offset:2656
  ds_read_b64 v[74:75], v6 offset:2664
  v_mfma_f32_16x16x32_bf16 v[44:47], v[52:55], v[100:103], v[44:47]
  v_subrev_u32 v17, 736, v7
  v_max_i32 v17, v17, v9
  v_mfma_f32_16x16x32_bf16 v[48:51], v[56:59], v[100:103], v[48:51]
  ds_read_b128 v[104:107], v17
  s_waitcnt lgkmcnt(5)
  v_mfma_f32_16x16x32_bf16 v[36:39], v[60:63], v[92:95], v[36:39]
  ds_read_b64 v[52:53], v6 offset:2688
  ds_read_b64 v[54:55], v6 offset:2696
  v_mfma_f32_16x16x32_bf16 v[40:43], v[64:67], v[92:95], v[40:43]
  ds_read_b64 v[56:57], v6 offset:2720
  ds_read_b64 v[58:59], v6 offset:2728
  v_mfma_f32_16x16x32_bf16 v[44:47], v[60:63], v[96:99], v[44:47]
  v_subrev_u32 v17, 800, v7
  v_max_i32 v17, v17, v9
  v_mfma_f32_16x16x32_bf16 v[48:51], v[64:67], v[96:99], v[48:51]
  ds_read_b128 v[100:103], v17
  s_waitcnt lgkmcnt(5)
  v_mfma_f32_16x16x32_bf16 v[36:39], v[68:71], v[104:107], v[36:39]
  ds_read_b64 v[60:61], v6 offset:2752
  ds_read_b64 v[62:63], v6 offset:2760
  v_mfma_f32_16x16x32_bf16 v[40:43], v[72:75], v[104:107], v[40:43]
  ds_read_b64 v[64:65], v6 offset:2784
  ds_read_b64 v[66:67], v6 offset:2792
  v_mfma_f32_16x16x32_bf16 v[44:47], v[68:71], v[92:95], v[44:47]
  v_subrev_u32 v17, 896, v7
  v_max_i32 v17, v17, v9
  v_mfma_f32_16x16x32_bf16 v[48:51], v[72:75], v[92:95], v[48:51]
  ds_read_b128 v[96:99], v17
  s_waitcnt lgkmcnt(5)
  v_mfma_f32_16x16x32_bf16 v[36:39], v[52:55], v[100:103], v[36:39]
  ds_read_b64 v[68:69], v6 offset:2816
  ds_read_b64 v[70:71], v6 offset:2824
  v_mfma_f32_16x16x32_bf16 v[40:43], v[56:59], v[100:103], v[40:43]
  ds_read_b64 v[72:73], v6 offset:2848
  ds_read_b64 v[74:75], v6 offset:2856
  v_mfma_f32_16x16x32_bf16 v[44:47], v[52:55], v[104:107], v[44:47]
  v_subrev_u32 v17, 960, v7
  v_max_i32 v17, v17, v9
  v_mfma_f32_16x16x32_bf16 v[48:51], v[56:59], v[104:107], v[48:51]
  ds_read_b128 v[92:95], v17
  s_waitcnt lgkmcnt(5)
  v_mfma_f32_16x16x32_bf16 v[36:39], v[60:63], v[96:99], v[36:39]
  ds_read_b64 v[52:53], v6 offset:2880
  ds_read_b64 v[54:55], v6 offset:2888
  v_mfma_f32_16x16x32_bf16 v[40:43], v[64:67], v[96:99], v[40:43]
  ds_read_b64 v[56:57], v6 offset:2912
  ds_read_b64 v[58:59], v6 offset:2920
  v_mfma_f32_16x16x32_bf16 v[44:47], v[60:63], v[100:103], v[44:47]
  v_subrev_u32 v17, 1056, v7
  v_max_i32 v17, v17, v9
  v_mfma_f32_16x16x32_bf16 v[48:51], v[64:67], v[100:103], v[48:51]
  ds_read_b128 v[104:107], v17
  s_waitcnt lgkmcnt(5)
  v_mfma_f32_16x16x32_bf16 v[36:39], v[68:71], v[92:95], v[36:39]
  ds_read_b64 v[60:61], v6 offset:2944
  ds_read_b64 v[62:63], v6 offset:2952
  v_mfma_f32_16x16x32_bf16 v[40:43], v[72:75], v[92:95], v[40:43]
  ds_read_b64 v[64:65], v6 offset:2976
  ds_read_b64 v[66:67], v6 offset:2984
  v_mfma_f32_16x16x32_bf16 v[44:47], v[68:71], v[96:99], v[44:47]
  v_subrev_u32 v17, 1120, v7
  v_max_i32 v17, v17, v9
  v_mfma_f32_16x16x32_bf16 v[48:51], v[72:75], v[96:99], v[48:51]
  ds_read_b128 v[100:103], v17
  s_waitcnt lgkmcnt(5)
  v_mfma_f32_16x16x32_bf16 v[36:39], v[52:55], v[104:107], v[36:39]
  ds_read_b64 v[68:69], v6 offset:3008
  ds_read_b64 v[70:71], v6 offset:3016
  v_mfma_f32_16x16x32_bf16 v[40:43], v[56:59], v[104:107], v[40:43]
  ds_read_b64 v[72:73], v6 offset:3040
  ds_read_b64 v[74:75], v6 offset:3048
  v_mfma_f32_16x16x32_bf16 v[44:47], v[52:55], v[92:95], v[44:47]
  v_subrev_u32 v17, 1216, v7
  v_max_i32 v17, v17, v9
  v_mfma_f32_16x16x32_bf16 v[48:51], v[56:59], v[92:95], v[48:51]
  ds_read_b128 v[96:99], v17
  s_waitcnt lgkmcnt(5)
  v_mfma_f32_16x16x32_bf16 v[36:39], v[60:63], v[100:103], v[36:39]
  ds_read_b64 v[52:53], v6 offset:3072
  ds_read_b64 v[54:55], v6 offset:3080
  v_mfma_f32_16x16x32_bf16 v[40:43], v[64:67], v[100:103], v[40:43]
  ds_read_b64 v[56:57], v6 offset:3104
  ds_read_b64 v[58:59], v6 offset:3112
  v_mfma_f32_16x16x32_bf16 v[44:47], v[60:63], v[104:107], v[44:47]
  v_subrev_u32 v17, 1280, v7
  v_max_i32 v17, v17, v9
  v_mfma_f32_16x16x32_bf16 v[48:51], v[64:67], v[104:107], v[48:51]
  ds_read_b128 v[92:95], v17
  s_waitcnt lgkmcnt(5)
  v_mfma_f32_16x16x32_bf16 v[36:39], v[68:71], v[96:99], v[36:39]
  ds_read_b64 v[60:61], v6 offset:3136
  ds_read_b64 v[62:63], v6 offset:3144
  v_mfma_f32_16x16x32_bf16 v[40:43], v[72:75], v[96:99], v[40:43]
  ds_read_b64 v[64:65], v6 offset:3168
  ds_read_b64 v[66:67], v6 offset:3176
  v_mfma_f32_16x16x32_bf16 v[44:47], v[68:71], v[100:103], v[44:47]
  v_subrev_u32 v17, 1376, v7
  v_max_i32 v17, v17, v9
  v_mfma_f32_16x16x32_bf16 v[48:51], v[72:75], v[100:103], v[48:51]
  ds_read_b128 v[104:107], v17
  s_waitcnt lgkmcnt(5)
  v_mfma_f32_16x16x32_bf16 v[36:39], v[52:55], v[92:95], v[36:39]
  ds_read_b64 v[68:69], v6 offset:3200
  ds_read_b64 v[70:71], v6 offset:3208
  v_mfma_f32_16x16x32_bf16 v[40:43], v[56:59], v[92:95], v[40:43]
  ds_read_b64 v[72:73], v6 offset:3232
  ds_read_b64 v[74:75], v6 offset:3240
  v_mfma_f32_16x16x32_bf16 v[44:47], v[52:55], v[96:99], v[44:47]
  v_subrev_u32 v17, 1440, v7
  v_max_i32 v17, v17, v9
  v_mfma_f32_16x16x32_bf16 v[48:51], v[56:59], v[96:99], v[48:51]
  ds_read_b128 v[100:103], v17
  s_waitcnt lgkmcnt(5)
  v_mfma_f32_16x16x32_bf16 v[36:39], v[60:63], v[104:107], v[36:39]
  ds_read_b64 v[52:53], v6 offset:3264
  ds_read_b64 v[54:55], v6 offset:3272
  v_mfma_f32_16x16x32_bf16 v[40:43], v[64:67], v[104:107], v[40:43]
  ds_read_b64 v[56:57], v6 offset:3296
  ds_read_b64 v[58:59], v6 offset:3304
  v_mfma_f32_16x16x32_bf16 v[44:47], v[60:63], v[92:95], v[44:47]
  v_subrev_u32 v17, 1536, v7
  v_max_i32 v17, v17, v9
  v_mfma_f32_16x16x32_bf16 v[48:51], v[64:67], v[92:95], v[48:51]
  ds_read_b128 v[96:99], v17
  s_waitcnt lgkmcnt(5)
  v_mfma_f32_16x16x32_bf16 v[36:39], v[68:71], v[100:103], v[36:39]
  ds_read_b64 v[60:61], v6 offset:3328
  ds_read_b64 v[62:63], v6 offset:3336
  v_mfma_f32_16x16x32_bf16 v[40:43], v[72:75], v[100:103], v[40:43]
  ds_read_b64 v[64:65], v6 offset:3360
  ds_read_b64 v[66:67], v6 offset:3368
  v_mfma_f32_16x16x32_bf16 v[44:47], v[68:71], v[104:107], v[44:47]
  v_subrev_u32 v17, 1600, v7
  v_max_i32 v17, v17, v9
  v_mfma_f32_16x16x32_bf16 v[48:51], v[72:75], v[104:107], v[48:51]
  ds_read_b128 v[92:95], v17
  s_waitcnt lgkmcnt(5)
  v_mfma_f32_16x16x32_bf16 v[36:39], v[52:55], v[96:99], v[36:39]
  ds_read_b64 v[68:69], v6 offset:3392
  ds_read_b64 v[70:71], v6 offset:3400
  v_mfma_f32_16x16x32_bf16 v[40:43], v[56:59], v[96:99], v[40:43]
  ds_read_b64 v[72:73], v6 offset:3424
  ds_read_b64 v[74:75], v6 offset:3432
  v_mfma_f32_16x16x32_bf16 v[44:47], v[52:55], v[100:103], v[44:47]
  v_subrev_u32 v17, 1696, v7
  v_max_i32 v17, v17, v9
  v_mfma_f32_16x16x32_bf16 v[48:51], v[56:59], v[100:103], v[48:51]
  ds_read_b128 v[104:107], v17
  s_waitcnt lgkmcnt(5)
  v_mfma_f32_16x16x32_bf16 v[36:39], v[60:63], v[92:95], v[36:39]
  ds_read_b64 v[52:53], v6 offset:3456
  ds_read_b64 v[54:55], v6 offset:3464
  v_mfma_f32_16x16x32_bf16 v[40:43], v[64:67], v[92:95], v[40:43]
  ds_read_b64 v[56:57], v6 offset:3488
  ds_read_b64 v[58:59], v6 offset:3496
  v_mfma_f32_16x16x32_bf16 v[44:47], v[60:63], v[96:99], v[44:47]
  v_subrev_u32 v17, 1760, v7
  v_max_i32 v17, v17, v9
  v_mfma_f32_16x16x32_bf16 v[48:51], v[64:67], v[96:99], v[48:51]
  ds_read_b128 v[100:103], v17
  s_waitcnt lgkmcnt(5)
  v_mfma_f32_16x16x32_bf16 v[36:39], v[68:71], v[104:107], v[36:39]
  ds_read_b64 v[60:61], v6 offset:3520
  ds_read_b64 v[62:63], v6 offset:3528
  v_mfma_f32_16x16x32_bf16 v[40:43], v[72:75], v[104:107], v[40:43]
  ds_read_b64 v[64:65], v6 offset:3552
  ds_read_b64 v[66:67], v6 offset:3560
  v_mfma_f32_16x16x32_bf16 v[44:47], v[68:71], v[92:95], v[44:47]
  v_subrev_u32 v17, 1856, v7
  v_max_i32 v17, v17, v9
  v_mfma_f32_16x16x32_bf16 v[48:51], v[72:75], v[92:95], v[48:51]
  ds_read_b128 v[96:99], v17
  s_waitcnt lgkmcnt(5)
  v_mfma_f32_16x16x32_bf16 v[36:39], v[52:55], v[100:103], v[36:39]
  ds_read_b64 v[68:69], v6 offset:3584
  ds_read_b64 v[70:71], v6 offset:3592
  v_mfma_f32_16x16x32_bf16 v[40:43], v[56:59], v[100:103], v[40:43]
  ds_read_b64 v[72:73], v6 offset:3616
  ds_read_b64 v[74:75], v6 offset:3624
  v_mfma_f32_16x16x32_bf16 v[44:47], v[52:55], v[104:107], v[44:47]
  v_subrev_u32 v17, 1920, v7
  v_max_i32 v17, v17, v9
  v_mfma_f32_16x16x32_bf16 v[48:51], v[56:59], v[104:107], v[48:51]
  ds_read_b128 v[92:95], v17
  s_waitcnt lgkmcnt(5)
  v_mfma_f32_16x16x32_bf16 v[36:39], v[60:63], v[96:99], v[36:39]
  ds_read_b64 v[52:53], v6 offset:3648
  ds_read_b64 v[54:55], v6 offset:3656
  v_mfma_f32_16x16x32_bf16 v[40:43], v[64:67], v[96:99], v[40:43]
  ds_read_b64 v[56:57], v6 offset:3680
  ds_read_b64 v[58:59], v6 offset:3688
  v_mfma_f32_16x16x32_bf16 v[44:47], v[60:63], v[100:103], v[44:47]
  v_subrev_u32 v17, 2016, v7
  v_max_i32 v17, v17, v9
  v_mfma_f32_16x16x32_bf16 v[48:51], v[64:67], v[100:103], v[48:51]
  ds_read_b128 v[104:107], v17
  s_waitcnt lgkmcnt(5)
  v_mfma_f32_16x16x32_bf16 v[36:39], v[68:71], v[92:95], v[36:39]
  ds_read_b64 v[60:61], v6 offset:3712
  ds_read_b64 v[62:63], v6 offset:3720
  v_mfma_f32_16x16x32_bf16 v[40:43], v[72:75], v[92:95], v[40:43]
  ds_read_b64 v[64:65], v6 offset:3744
  ds_read_b64 v[66:67], v6 offset:3752
  v_mfma_f32_16x16x32_bf16 v[44:47], v[68:71], v[96:99], v[44:47]
  v_subrev_u32 v17, 2080, v7
  v_max_i32 v17, v17, v9
  v_mfma_f32_16x16x32_bf16 v[48:51], v[72:75], v[96:99], v[48:51]
  ds_read_b128 v[100:103], v17
  s_waitcnt lgkmcnt(5)
  v_mfma_f32_16x16x32_bf16 v[36:39], v[52:55], v[104:107], v[36:39]
  ds_read_b64 v[68:69], v6 offset:3776
  ds_read_b64 v[70:71], v6 offset:3784
  v_mfma_f32_16x16x32_bf16 v[40:43], v[56:59], v[104:107], v[40:43]
  ds_read_b64 v[72:73], v6 offset:3808
  ds_read_b64 v[74:75], v6 offset:3816
  v_mfma_f32_16x16x32_bf16 v[44:47], v[52:55], v[92:95], v[44:47]
  v_subrev_u32 v17, 2176, v7
  v_max_i32 v17, v17, v9
  v_mfma_f32_16x16x32_bf16 v[48:51], v[56:59], v[92:95], v[48:51]
  ds_read_b128 v[96:99], v17
  s_waitcnt lgkmcnt(5)
  v_mfma_f32_16x16x32_bf16 v[36:39], v[60:63], v[100:103], v[36:39]
  ds_read_b64 v[52:53], v6 offset:3840
  ds_read_b64 v[54:55], v6 offset:3848
  v_mfma_f32_16x16x32_bf16 v[40:43], v[64:67], v[100:103], v[40:43]
  ds_read_b64 v[56:57], v6 offset:3872
  ds_read_b64 v[58:59], v6 offset:3880
  v_mfma_f32_16x16x32_bf16 v[44:47], v[60:63], v[104:107], v[44:47]
  v_subrev_u32 v17, 2240, v7
  v_max_i32 v17, v17, v9
  v_mfma_f32_16x16x32_bf16 v[48:51], v[64:67], v[104:107], v[48:51]
  ds_read_b128 v[92:95], v17
  s_waitcnt lgkmcnt(5)
  v_mfma_f32_16x16x32_bf16 v[36:39], v[68:71], v[96:99], v[36:39]
  ds_read_b64 v[60:61], v6 offset:3904
  ds_read_b64 v[62:63], v6 offset:3912
  v_mfma_f32_16x16x32_bf16 v[40:43], v[72:75], v[96:99], v[40:43]
  ds_read_b64 v[64:65], v6 offset:3936
  ds_read_b64 v[66:67], v6 offset:3944
  v_mfma_f32_16x16x32_bf16 v[44:47], v[68:71], v[100:103], v[44:47]
  v_subrev_u32 v17, 2336, v7
  v_max_i32 v17, v17, v9
  v_mfma_f32_16x16x32_bf16 v[48:51], v[72:75], v[100:103], v[48:51]
  ds_read_b128 v[104:107], v17
  s_waitcnt lgkmcnt(5)
  v_mfma_f32_16x16x32_bf16 v[36:39], v[52:55], v[92:95], v[36:39]
  ds_read_b64 v[68:69], v6 offset:3968
  ds_read_b64 v[70:71], v6 offset:3976
  v_mfma_f32_16x16x32_bf16 v[40:43], v[56:59], v[92:95], v[40:43]
  ds_read_b64 v[72:73], v6 offset:4000
  ds_read_b64 v[74:75], v6 offset:4008
  v_mfma_f32_16x16x32_bf16 v[44:47], v[52:55], v[96:99], v[44:47]
  v_subrev_u32 v17, 2400, v7
  v_max_i32 v17, v17, v9
  v_mfma_f32_16x16x32_bf16 v[48:51], v[56:59], v[96:99], v[48:51]
  ds_read_b128 v[100:103], v17
  s_waitcnt lgkmcnt(5)
  v_mfma_f32_16x16x32_bf16 v[36:39], v[60:63], v[104:107], v[36:39]
  ds_read_b64 v[52:53], v6 offset:4032
  ds_read_b64 v[54:55], v6 offset:4040
  v_mfma_f32_16x16x32_bf16 v[40:43], v[64:67], v[104:107], v[40:43]
  ds_read_b64 v[56:57], v6 offset:4064
  ds_read_b64 v[58:59], v6 offset:4072
  v_mfma_f32_16x16x32_bf16 v[44:47], v[60:63], v[92:95], v[44:47]
  v_subrev_u32 v17, 2496, v7
  v_max_i32 v17, v17, v9
  v_mfma_f32_16x16x32_bf16 v[48:51], v[64:67], v[92:95], v[48:51]
  ds_read_b128 v[96:99], v17
  s_waitcnt lgkmcnt(5)
  v_mfma_f32_16x16x32_bf16 v[36:39], v[68:71], v[100:103], v[36:39]
  v_mfma_f32_16x16x32_bf16 v[40:43], v[72:75], v[100:103], v[40:43]
  v_mfma_f32_16x16x32_bf16 v[44:47], v[68:71], v[104:107], v[44:47]
  v_mfma_f32_16x16x32_bf16 v[48:51], v[72:75], v[104:107], v[48:51]
  s_waitcnt lgkmcnt(0)
  v_mfma_f32_16x16x32_bf16 v[36:39], v[52:55], v[96:99], v[36:39]
  v_mfma_f32_16x16x32_bf16 v[40:43], v[56:59], v[96:99], v[40:43]
  v_mfma_f32_16x16x32_bf16 v[44:47], v[52:55], v[100:103], v[44:47]
  v_mfma_f32_16x16x32_bf16 v[48:51], v[56:59], v[100:103], v[48:51]
  v_lshlrev_b32 v14, 3, v13
  v_add3_u32 v15, v10, v14, s51
  v_sub_u32 v14, v10, v14
  v_add_u32 v14, s51, v14
  ds_read_b64 v[108:109], v14 offset:56
  ds_read_b64 v[110:111], v14 offset:24
  ds_read_b64 v[112:113], v14 offset:120
  ds_read_b64 v[114:115], v14 offset:88
  ds_read_b64 v[116:117], v14 offset:2616
  ds_read_b64 v[118:119], v14 offset:2584
  ds_read_b64 v[120:121], v14 offset:2680
  ds_read_b64 v[122:123], v14 offset:2648
  s_waitcnt lgkmcnt(0)
  v_and_b32 v16, 0xffff0000, v109
  v_fmac_f32 v20, s46, v16
  v_lshlrev_b32 v17, 16, v109
  v_fmac_f32 v21, s46, v17
  v_and_b32 v16, 0xffff0000, v108
  v_fmac_f32 v22, s46, v16
  v_lshlrev_b32 v17, 16, v108
  v_fmac_f32 v23, s46, v17
  v_cvt_pk_bf16_f32 v20, v20, v21
  v_cvt_pk_bf16_f32 v21, v22, v23
  ds_write_b64 v15, v[20:21] offset:0
  v_and_b32 v16, 0xffff0000, v111
  v_fmac_f32 v24, s46, v16
  v_lshlrev_b32 v17, 16, v111
  v_fmac_f32 v25, s46, v17
  v_and_b32 v16, 0xffff0000, v110
  v_fmac_f32 v26, s46, v16
  v_lshlrev_b32 v17, 16, v110
  v_fmac_f32 v27, s46, v17
  v_cvt_pk_bf16_f32 v24, v24, v25
  v_cvt_pk_bf16_f32 v25, v26, v27
  ds_write_b64 v15, v[24:25] offset:32
  v_and_b32 v16, 0xffff0000, v113
  v_fmac_f32 v28, s46, v16
  v_lshlrev_b32 v17, 16, v113
  v_fmac_f32 v29, s46, v17
  v_and_b32 v16, 0xffff0000, v112
  v_fmac_f32 v30, s46, v16
  v_lshlrev_b32 v17, 16, v112
  v_fmac_f32 v31, s46, v17
  v_cvt_pk_bf16_f32 v28, v28, v29
  v_cvt_pk_bf16_f32 v29, v30, v31
  ds_write_b64 v15, v[28:29] offset:64
  v_and_b32 v16, 0xffff0000, v115
  v_fmac_f32 v32, s46, v16
  v_lshlrev_b32 v17, 16, v115
  v_fmac_f32 v33, s46, v17
  v_and_b32 v16, 0xffff0000, v114
  v_fmac_f32 v34, s46, v16
  v_lshlrev_b32 v17, 16, v114
  v_fmac_f32 v35, s46, v17
  v_cvt_pk_bf16_f32 v32, v32, v33
  v_cvt_pk_bf16_f32 v33, v34, v35
  ds_write_b64 v15, v[32:33] offset:96
  v_and_b32 v16, 0xffff0000, v117
  v_fmac_f32 v36, s46, v16
  v_lshlrev_b32 v17, 16, v117
  v_fmac_f32 v37, s46, v17
  v_and_b32 v16, 0xffff0000, v116
  v_fmac_f32 v38, s46, v16
  v_lshlrev_b32 v17, 16, v116
  v_fmac_f32 v39, s46, v17
  v_cvt_pk_bf16_f32 v36, v36, v37
  v_cvt_pk_bf16_f32 v37, v38, v39
  ds_write_b64 v15, v[36:37] offset:2560
  v_and_b32 v16, 0xffff0000, v119
  v_fmac_f32 v40, s46, v16
  v_lshlrev_b32 v17, 16, v119
  v_fmac_f32 v41, s46, v17
  v_and_b32 v16, 0xffff0000, v118
  v_fmac_f32 v42, s46, v16
  v_lshlrev_b32 v17, 16, v118
  v_fmac_f32 v43, s46, v17
  v_cvt_pk_bf16_f32 v40, v40, v41
  v_cvt_pk_bf16_f32 v41, v42, v43
  ds_write_b64 v15, v[40:41] offset:2592
  v_and_b32 v16, 0xffff0000, v121
  v_fmac_f32 v44, s46, v16
  v_lshlrev_b32 v17, 16, v121
  v_fmac_f32 v45, s46, v17
  v_and_b32 v16, 0xffff0000, v120
  v_fmac_f32 v46, s46, v16
  v_lshlrev_b32 v17, 16, v120
  v_fmac_f32 v47, s46, v17
  v_cvt_pk_bf16_f32 v44, v44, v45
  v_cvt_pk_bf16_f32 v45, v46, v47
  ds_write_b64 v15, v[44:45] offset:2624
  v_and_b32 v16, 0xffff0000, v123
  v_fmac_f32 v48, s46, v16
  v_lshlrev_b32 v17, 16, v123
  v_fmac_f32 v49, s46, v17
  v_and_b32 v16, 0xffff0000, v122
  v_fmac_f32 v50, s46, v16
  v_lshlrev_b32 v17, 16, v122
  v_fmac_f32 v51, s46, v17
  v_cvt_pk_bf16_f32 v48, v48, v49
  v_cvt_pk_bf16_f32 v49, v50, v51
  ds_write_b64 v15, v[48:49] offset:2656
  s_add_u32 s45, s45, 1
  s_cmp_lt_u32 s45, 4
  s_cbranch_scc1 L_cv_ch
  v_bfe_u32 v14, v0, 2, 4
  v_mul_u32_u24 v14, 5152, v14
  v_and_b32 v15, 3, v0
  v_lshl_add_u32 v14, v15, 3, v14
  s_lshr_b32 s49, s12, 1
  s_mul_i32 s49, s49, 160
  s_and_b32 s50, s12, 1
  s_lshl_b32 s50, s50, 6
  s_add_u32 s49, s49, s50
  s_add_u32 s49, s49, 32
  v_add_u32 v14, s49, v14
  s_lshl_b32 s48, s16, 16
  s_lshl_b32 s49, s12, 10
  s_add_u32 s48, s48, s49
  s_add_u32 s48, s48, 53477376
  s_waitcnt lgkmcnt(0)
  s_barrier
  ds_read_b64_tr_b16 v[20:21], v14 offset:0
  ds_read_b64_tr_b16 v[22:23], v14 offset:32
  ds_read_b64_tr_b16 v[24:25], v14 offset:320
  ds_read_b64_tr_b16 v[26:27], v14 offset:352
  ds_read_b64_tr_b16 v[28:29], v14 offset:640
  ds_read_b64_tr_b16 v[30:31], v14 offset:672
  ds_read_b64_tr_b16 v[32:33], v14 offset:960
  ds_read_b64_tr_b16 v[34:35], v14 offset:992
  ds_read_b64_tr_b16 v[36:37], v14 offset:1280
  ds_read_b64_tr_b16 v[38:39], v14 offset:1312
  ds_read_b64_tr_b16 v[40:41], v14 offset:1600
  ds_read_b64_tr_b16 v[42:43], v14 offset:1632
  s_waitcnt lgkmcnt(8)
  ds_read_b64_tr_b16 v[44:45], v14 offset:1920
  ds_read_b64_tr_b16 v[46:47], v14 offset:1952
  ds_read_b64_tr_b16 v[48:49], v14 offset:2240
  ds_read_b64_tr_b16 v[50:51], v14 offset:2272
  s_waitcnt lgkmcnt(8)
  buffer_store_dwordx4 v[20:23], v1, s[4:7], s48 offen sc1
  s_add_u32 s48, s48, 4096
  s_waitcnt lgkmcnt(8)
  buffer_store_dwordx4 v[24:27], v1, s[4:7], s48 offen sc1
  s_add_u32 s48, s48, 4096
  s_waitcnt lgkmcnt(8)
  buffer_store_dwordx4 v[28:31], v1, s[4:7], s48 offen sc1
  s_add_u32 s48, s48, 4096
  s_waitcnt lgkmcnt(8)
  buffer_store_dwordx4 v[32:35], v1, s[4:7], s48 offen sc1
  s_add_u32 s48, s48, 4096
  s_waitcnt lgkmcnt(6)
  buffer_store_dwordx4 v[36:39], v1, s[4:7], s48 offen sc1
  s_add_u32 s48, s48, 4096
  s_waitcnt lgkmcnt(4)
  buffer_store_dwordx4 v[40:43], v1, s[4:7], s48 offen sc1
  s_add_u32 s48, s48, 4096
  s_waitcnt lgkmcnt(2)
  buffer_store_dwordx4 v[44:47], v1, s[4:7], s48 offen sc1
  s_add_u32 s48, s48, 4096
  s_waitcnt lgkmcnt(0)
  buffer_store_dwordx4 v[48:51], v1, s[4:7], s48 offen sc1
  s_add_u32 s48, s48, 4096
  s_waitcnt vmcnt(0)
  ds_read_b64_tr_b16 v[20:21], v14 offset:2560
  ds_read_b64_tr_b16 v[22:23], v14 offset:2592
  ds_read_b64_tr_b16 v[24:25], v14 offset:2880
  ds_read_b64_tr_b16 v[26:27], v14 offset:2912
  ds_read_b64_tr_b16 v[28:29], v14 offset:3200
  ds_read_b64_tr_b16 v[30:31], v14 offset:3232
  ds_read_b64_tr_b16 v[32:33], v14 offset:3520
  ds_read_b64_tr_b16 v[34:35], v14 offset:3552
  ds_read_b64_tr_b16 v[36:37], v14 offset:3840
  ds_read_b64_tr_b16 v[38:39], v14 offset:3872
  ds_read_b64_tr_b16 v[40:41], v14 offset:4160
  ds_read_b64_tr_b16 v[42:43], v14 offset:4192
  s_waitcnt lgkmcnt(8)
  ds_read_b64_tr_b16 v[44:45], v14 offset:4480
  ds_read_b64_tr_b16 v[46:47], v14 offset:4512
  ds_read_b64_tr_b16 v[48:49], v14 offset:4800
  ds_read_b64_tr_b16 v[50:51], v14 offset:4832
  s_waitcnt lgkmcnt(8)
  buffer_store_dwordx4 v[20:23], v1, s[4:7], s48 offen sc1
  s_add_u32 s48, s48, 4096
  s_waitcnt lgkmcnt(8)
  buffer_store_dwordx4 v[24:27], v1, s[4:7], s48 offen sc1
  s_add_u32 s48, s48, 4096
  s_waitcnt lgkmcnt(8)
  buffer_store_dwordx4 v[28:31], v1, s[4:7], s48 offen sc1
  s_add_u32 s48, s48, 4096
  s_waitcnt lgkmcnt(8)
  buffer_store_dwordx4 v[32:35], v1, s[4:7], s48 offen sc1
  s_add_u32 s48, s48, 4096
  s_waitcnt lgkmcnt(6)
  buffer_store_dwordx4 v[36:39], v1, s[4:7], s48 offen sc1
  s_add_u32 s48, s48, 4096
  s_waitcnt lgkmcnt(4)
  buffer_store_dwordx4 v[40:43], v1, s[4:7], s48 offen sc1
  s_add_u32 s48, s48, 4096
  s_waitcnt lgkmcnt(2)
  buffer_store_dwordx4 v[44:47], v1, s[4:7], s48 offen sc1
  s_add_u32 s48, s48, 4096
  s_waitcnt lgkmcnt(0)
  buffer_store_dwordx4 v[48:51], v1, s[4:7], s48 offen sc1
  s_add_u32 s48, s48, 4096
  s_waitcnt vmcnt(0)
  s_barrier
  s_cmp_lg_u32 s12, 0
  s_cbranch_scc1 L_cv_end
  s_lshl_b32 s49, s16, 2
  s_add_u32 s49, s49, 52216064
  v_mov_b32 v14, 1
  v_mov_b32 v15, 0
  s_mov_b64 exec, 1
  buffer_store_dword v14, v15, s[4:7], s49 offen sc1
  s_mov_b64 exec, -1
L_cv_end:
  s_branch L_post_f
L_post_g:
  s_load_dwordx2 s[28:29], s[0:1], 0
  s_load_dwordx2 s[30:31], s[0:1], 104
  s_waitcnt lgkmcnt(0)
  s_mov_b32 s20, s28
  s_mov_b32 s21, s29
  s_mov_b32 s22, 2621440
  s_mov_b32 s23, 0x20000
  s_mov_b32 s24, s30
  s_mov_b32 s25, s31
  s_mov_b32 s26, 1280
  s_mov_b32 s27, 0x20000
  v_and_b32 v2, 3, v0
  v_lshlrev_b32 v2, 4, v2
  buffer_load_dwordx4 v[10:13], v2, s[24:27], 0 offen offset:0
  buffer_load_dwordx4 v[14:17], v2, s[24:27], 0 offen offset:64
  buffer_load_dwordx4 v[18:21], v2, s[24:27], 0 offen offset:128
  buffer_load_dwordx4 v[22:25], v2, s[24:27], 0 offen offset:192
  buffer_load_dwordx4 v[26:29], v2, s[24:27], 0 offen offset:256
  buffer_load_dwordx4 v[30:33], v2, s[24:27], 0 offen offset:320
  buffer_load_dwordx4 v[34:37], v2, s[24:27], 0 offen offset:384
  buffer_load_dwordx4 v[38:41], v2, s[24:27], 0 offen offset:448
  buffer_load_dwordx4 v[42:45], v2, s[24:27], 0 offen offset:512
  buffer_load_dwordx4 v[46:49], v2, s[24:27], 0 offen offset:576
  buffer_load_dwordx4 v[50:53], v2, s[24:27], 0 offen offset:640
  buffer_load_dwordx4 v[54:57], v2, s[24:27], 0 offen offset:704
  buffer_load_dwordx4 v[58:61], v2, s[24:27], 0 offen offset:768
  buffer_load_dwordx4 v[62:65], v2, s[24:27], 0 offen offset:832
  buffer_load_dwordx4 v[66:69], v2, s[24:27], 0 offen offset:896
  buffer_load_dwordx4 v[70:73], v2, s[24:27], 0 offen offset:960
  buffer_load_dwordx4 v[74:77], v2, s[24:27], 0 offen offset:1024
  buffer_load_dwordx4 v[78:81], v2, s[24:27], 0 offen offset:1088
  buffer_load_dwordx4 v[82:85], v2, s[24:27], 0 offen offset:1152
  buffer_load_dwordx4 v[86:89], v2, s[24:27], 0 offen offset:1216
  v_bfe_u32 v3, v0, 2, 4
  v_mul_u32_u24 v1, 1280, v3
  v_add_u32 v1, v1, v2
  v_lshlrev_b32 v3, 2, v3
  v_cmp_eq_u32 vcc, 0, v2
  v_mov_b32 v4, 2147483648
  s_nop 0
  v_cndmask_b32 v5, v4, v3, vcc
  s_sub_u32 s32, s16, 40
  s_lshl_b32 s32, s32, 2
  s_add_u32 s32, s32, s12
L_g_l:
  s_mul_i32 s33, s32, 20480
  buffer_load_dwordx4 v[90:93], v1, s[20:23], s33 offen offset:0
  buffer_load_dwordx4 v[94:97], v1, s[20:23], s33 offen offset:64
  buffer_load_dwordx4 v[98:101], v1, s[20:23], s33 offen offset:128
  buffer_load_dwordx4 v[102:105], v1, s[20:23], s33 offen offset:192
  buffer_load_dwordx4 v[106:109], v1, s[20:23], s33 offen offset:256
  buffer_load_dwordx4 v[110:113], v1, s[20:23], s33 offen offset:320
  buffer_load_dwordx4 v[114:117], v1, s[20:23], s33 offen offset:384
  buffer_load_dwordx4 v[118:121], v1, s[20:23], s33 offen offset:448
  buffer_load_dwordx4 v[122:125], v1, s[20:23], s33 offen offset:512
  buffer_load_dwordx4 v[126:129], v1, s[20:23], s33 offen offset:576
  buffer_load_dwordx4 v[130:133], v1, s[20:23], s33 offen offset:640
  buffer_load_dwordx4 v[134:137], v1, s[20:23], s33 offen offset:704
  buffer_load_dwordx4 v[138:141], v1, s[20:23], s33 offen offset:768
  buffer_load_dwordx4 v[142:145], v1, s[20:23], s33 offen offset:832
  buffer_load_dwordx4 v[146:149], v1, s[20:23], s33 offen offset:896
  buffer_load_dwordx4 v[150:153], v1, s[20:23], s33 offen offset:960
  buffer_load_dwordx4 v[154:157], v1, s[20:23], s33 offen offset:1024
  buffer_load_dwordx4 v[158:161], v1, s[20:23], s33 offen offset:1088
  buffer_load_dwordx4 v[162:165], v1, s[20:23], s33 offen offset:1152
  buffer_load_dwordx4 v[166:169], v1, s[20:23], s33 offen offset:1216
  v_mov_b32 v6, 0
  v_mov_b32 v7, 0
  v_mov_b32 v8, 0
  v_mov_b32 v9, 0
  s_waitcnt vmcnt(0)
  v_dot2_f32_bf16 v6, v90, v10, v6
  v_dot2_f32_bf16 v7, v91, v11, v7
  v_dot2_f32_bf16 v8, v92, v12, v8
  v_dot2_f32_bf16 v9, v93, v13, v9
  v_dot2_f32_bf16 v6, v94, v14, v6
  v_dot2_f32_bf16 v7, v95, v15, v7
  v_dot2_f32_bf16 v8, v96, v16, v8
  v_dot2_f32_bf16 v9, v97, v17, v9
  v_dot2_f32_bf16 v6, v98, v18, v6
  v_dot2_f32_bf16 v7, v99, v19, v7
  v_dot2_f32_bf16 v8, v100, v20, v8
  v_dot2_f32_bf16 v9, v101, v21, v9
  v_dot2_f32_bf16 v6, v102, v22, v6
  v_dot2_f32_bf16 v7, v103, v23, v7
  v_dot2_f32_bf16 v8, v104, v24, v8
  v_dot2_f32_bf16 v9, v105, v25, v9
  v_dot2_f32_bf16 v6, v106, v26, v6
  v_dot2_f32_bf16 v7, v107, v27, v7
  v_dot2_f32_bf16 v8, v108, v28, v8
  v_dot2_f32_bf16 v9, v109, v29, v9
  v_dot2_f32_bf16 v6, v110, v30, v6
  v_dot2_f32_bf16 v7, v111, v31, v7
  v_dot2_f32_bf16 v8, v112, v32, v8
  v_dot2_f32_bf16 v9, v113, v33, v9
  v_dot2_f32_bf16 v6, v114, v34, v6
  v_dot2_f32_bf16 v7, v115, v35, v7
  v_dot2_f32_bf16 v8, v116, v36, v8
  v_dot2_f32_bf16 v9, v117, v37, v9
  v_dot2_f32_bf16 v6, v118, v38, v6
  v_dot2_f32_bf16 v7, v119, v39, v7
  v_dot2_f32_bf16 v8, v120, v40, v8
  v_dot2_f32_bf16 v9, v121, v41, v9
  v_dot2_f32_bf16 v6, v122, v42, v6
  v_dot2_f32_bf16 v7, v123, v43, v7
  v_dot2_f32_bf16 v8, v124, v44, v8
  v_dot2_f32_bf16 v9, v125, v45, v9
  v_dot2_f32_bf16 v6, v126, v46, v6
  v_dot2_f32_bf16 v7, v127, v47, v7
  v_dot2_f32_bf16 v8, v128, v48, v8
  v_dot2_f32_bf16 v9, v129, v49, v9
  v_dot2_f32_bf16 v6, v130, v50, v6
  v_dot2_f32_bf16 v7, v131, v51, v7
  v_dot2_f32_bf16 v8, v132, v52, v8
  v_dot2_f32_bf16 v9, v133, v53, v9
  v_dot2_f32_bf16 v6, v134, v54, v6
  v_dot2_f32_bf16 v7, v135, v55, v7
  v_dot2_f32_bf16 v8, v136, v56, v8
  v_dot2_f32_bf16 v9, v137, v57, v9
  v_dot2_f32_bf16 v6, v138, v58, v6
  v_dot2_f32_bf16 v7, v139, v59, v7
  v_dot2_f32_bf16 v8, v140, v60, v8
  v_dot2_f32_bf16 v9, v141, v61, v9
  v_dot2_f32_bf16 v6, v142, v62, v6
  v_dot2_f32_bf16 v7, v143, v63, v7
  v_dot2_f32_bf16 v8, v144, v64, v8
  v_dot2_f32_bf16 v9, v145, v65, v9
  v_dot2_f32_bf16 v6, v146, v66, v6
  v_dot2_f32_bf16 v7, v147, v67, v7
  v_dot2_f32_bf16 v8, v148, v68, v8
  v_dot2_f32_bf16 v9, v149, v69, v9
  v_dot2_f32_bf16 v6, v150, v70, v6
  v_dot2_f32_bf16 v7, v151, v71, v7
  v_dot2_f32_bf16 v8, v152, v72, v8
  v_dot2_f32_bf16 v9, v153, v73, v9
  v_dot2_f32_bf16 v6, v154, v74, v6
  v_dot2_f32_bf16 v7, v155, v75, v7
  v_dot2_f32_bf16 v8, v156, v76, v8
  v_dot2_f32_bf16 v9, v157, v77, v9
  v_dot2_f32_bf16 v6, v158, v78, v6
  v_dot2_f32_bf16 v7, v159, v79, v7
  v_dot2_f32_bf16 v8, v160, v80, v8
  v_dot2_f32_bf16 v9, v161, v81, v9
  v_dot2_f32_bf16 v6, v162, v82, v6
  v_dot2_f32_bf16 v7, v163, v83, v7
  v_dot2_f32_bf16 v8, v164, v84, v8
  v_dot2_f32_bf16 v9, v165, v85, v9
  v_dot2_f32_bf16 v6, v166, v86, v6
  v_dot2_f32_bf16 v7, v167, v87, v7
  v_dot2_f32_bf16 v8, v168, v88, v8
  v_dot2_f32_bf16 v9, v169, v89, v9
  s_nop 3
  v_add_f32 v6, v6, v7
  v_add_f32 v8, v8, v9
  v_add_f32 v3, v6, v8
  s_nop 1
  v_add_f32_dpp v3, v3, v3 quad_perm:[1,0,3,2] row_mask:0xf bank_mask:0xf
  s_nop 1
  v_add_f32_dpp v3, v3, v3 quad_perm:[2,3,0,1] row_mask:0xf bank_mask:0xf
  v_mul_f32 v3, 0xbfb8aa3b, v3
  v_exp_f32 v3, v3
  s_nop 0
  v_add_f32 v3, 1.0, v3
  v_rcp_f32 v3, v3
  s_lshl_b32 s33, s32, 6
  s_add_u32 s33, s33, 52428800
  buffer_store_dword v3, v5, s[4:7], s33 offen sc1
  v_mov_b32 v3, 1
  v_mov_b32 v4, 52215936
  s_waitcnt vmcnt(0)
  s_mov_b64 exec, 1
  buffer_atomic_add v3, v4, s[4:7], 0 offen sc1
  s_mov_b64 exec, -1
  s_add_u32 s32, s32, 96
  s_cmp_lt_u32 s32, 128
  s_cbranch_scc1 L_g_l
L_post_f:
  s_load_dwordx2 s[28:29], s[0:1], 0
  s_load_dwordx2 s[30:31], s[0:1], 112
  s_lshl_b32 s48, s16, 2
  s_add_u32 s48, s48, s12
  s_mul_i32 s33, s48, 820
  s_lshr_b32 s33, s33, 16
  s_mul_i32 s49, s33, 80
  s_sub_u32 s32, s48, s49
  s_waitcnt vmcnt(0) lgkmcnt(0)
  s_cmp_ge_u32 s33, 3
  s_cbranch_scc1 L_exit
  s_mov_b32 s20, s28
  s_mov_b32 s21, s29
  s_mov_b32 s22, 2621440
  s_mov_b32 s23, 0x20000
  s_mov_b32 s24, s30
  s_mov_b32 s25, s31
  s_mov_b32 s26, 2621440
  s_mov_b32 s27, 0x20000
  s_mul_i32 s34, s32, 6554
  s_lshr_b32 s34, s34, 16
  s_mul_i32 s48, s34, 10
  s_sub_u32 s35, s32, s48
  s_cmp_ge_u32 s35, 5
  s_cselect_b32 s36, 1, 0
  s_mul_i32 s48, s36, 5
  s_sub_u32 s48, s35, s48
  s_mul_i32 s37, s34, 5
  s_add_u32 s37, s37, s48
  v_and_b32 v2, 63, v0
  v_lshlrev_b32 v1, 4, v2
  v_lshlrev_b32 v2, 2, v2
  v_and_b32 v5, 15, v0
  v_lshlrev_b32 v4, 2, v5
  v_mul_u32_u24 v3, 1280, v5
  v_bfe_u32 v5, v0, 4, 2
  v_lshl_add_u32 v3, v5, 3, v3
  s_lshl_b32 s45, s34, 9
  s_and_b32 s48, s35, 3
  s_lshl_b32 s48, s48, 7
  s_add_u32 s45, s45, s48
  s_add_u32 s45, s45, 52191232
  s_lshl_b32 s48, s14, 13
  s_xor_b32 s45, s45, s48
  s_mul_i32 s38, s33, 327680
  s_mul_i32 s48, s34, 40960
  s_add_u32 s38, s38, s48
  s_lshl_b32 s48, s35, 10
  s_add_u32 s38, s38, s48
  s_add_u32 s38, s38, 159383552
  s_lshl_b32 s42, s37, 16
  s_lshl_b32 s48, s33, 10
  s_add_u32 s42, s42, s48
  s_lshl_b32 s48, s36, 3
  s_add_u32 s42, s42, s48
  s_add_u32 s42, s42, 53477376
  s_lshl_b32 s48, s33, 1
  s_add_u32 s48, s48, s36
  s_lshl_b32 s44, s48, 6
  s_add_u32 s44, s44, 52428800
  s_mul_i32 s43, s48, 20480
  s_lshl_b32 s48, s37, 5
  s_add_u32 s43, s43, s48
  s_mov_b64 exec, 1
  s_lshl_b32 s48, s37, 2
  s_add_u32 s48, s48, 52216064
  s_mov_b32 s15, 0
L_f_z:
  buffer_load_dword v5, v2, s[4:7], s48 offen sc1
  s_waitcnt vmcnt(0)
  v_cmp_gt_u32 vcc, 1, v5
  s_cbranch_vccz L_f_z_ok
  s_sleep 8
  s_add_u32 s15, s15, 1
  s_cmp_lt_u32 s15, 262144
  s_cbranch_scc1 L_f_z
  s_branch L_fail
L_f_z_ok:
  s_mov_b32 s48, 52215936
  s_mov_b32 s49, 128
  s_mov_b32 s15, 0
L_f_g:
  buffer_load_dword v5, v2, s[4:7], s48 offen sc1
  s_waitcnt vmcnt(0)
  v_cmp_gt_u32 vcc, s49, v5
  s_cbranch_vccz L_f_g_ok
  s_sleep 8
  s_add_u32 s15, s15, 1
  s_cmp_lt_u32 s15, 262144
  s_cbranch_scc1 L_f_g
  s_branch L_fail
L_f_g_ok:
  s_mov_b64 exec, -1
  s_mov_b32 s46, 0
L_f_l:
  buffer_load_dwordx2 v[24:25], v1, s[4:7], s42 offen sc1
  buffer_load_dwordx2 v[26:27], v3, s[20:23], s43 offen
  buffer_load_dword v7, v4, s[4:7], s44 offen sc1
  s_add_u32 s47, s33, 1
  s_cmp_ge_u32 s46, s47
  s_cbranch_scc1 L_f_w_e
  s_mov_b64 exec, 15
  s_mov_b32 s15, 0
L_f_w:
  v_mov_b32 v5, 0
  buffer_atomic_add v5, v2, s[4:7], s45 offen sc0 sc1
  s_waitcnt vmcnt(0)
  v_cmp_gt_u32 vcc, s47, v5
  s_cbranch_vccz L_f_w_ok
  v_cmp_gt_u32 vcc, s33, v5
  s_sleep 3
  s_cbranch_vccz L_f_w_n
  s_sleep 48
L_f_w_n:
  s_add_u32 s15, s15, 1
  s_cmp_lt_u32 s15, 0x20000
  s_cbranch_scc1 L_f_w
  s_branch L_fail
L_f_w_ok:
  v_readlane_b32 s46, v5, 0
  v_readlane_b32 s48, v5, 1
  s_nop 0
  s_min_u32 s46, s46, s48
  v_readlane_b32 s48, v5, 2
  s_nop 0
  s_min_u32 s46, s46, s48
  v_readlane_b32 s48, v5, 3
  s_nop 0
  s_min_u32 s46, s46, s48
  s_mov_b64 exec, -1
L_f_w_e:
  s_add_u32 s39, s38, 10240
  s_add_u32 s40, s38, 20480
  s_add_u32 s41, s38, 30720
  buffer_load_dwordx4 v[8:11], v1, s[4:7], s38 offen sc1
  buffer_load_dwordx4 v[12:15], v1, s[4:7], s39 offen sc1
  buffer_load_dwordx4 v[16:19], v1, s[4:7], s40 offen sc1
  buffer_load_dwordx4 v[20:23], v1, s[4:7], s41 offen sc1
  s_waitcnt vmcnt(4)
  v_lshlrev_b32 v28, 16, v24
  v_and_b32 v29, 0xffff0000, v24
  v_lshlrev_b32 v32, 16, v26
  v_and_b32 v33, 0xffff0000, v26
  v_lshlrev_b32 v30, 16, v25
  v_and_b32 v31, 0xffff0000, v25
  v_lshlrev_b32 v34, 16, v27
  v_and_b32 v35, 0xffff0000, v27
  v_sub_f32 v6, 1.0, v7
  v_mul_f32 v28, v28, v32
  v_mul_f32 v29, v29, v33
  v_mul_f32 v30, v30, v34
  v_mul_f32 v31, v31, v35
  v_mul_f32 v28, v28, v6
  v_mul_f32 v29, v29, v6
  v_mul_f32 v30, v30, v6
  v_mul_f32 v31, v31, v6
  s_waitcnt vmcnt(0)
  v_add_f32 v8, v8, v12
  v_add_f32 v16, v16, v20
  v_add_f32 v9, v9, v13
  v_add_f32 v17, v17, v21
  v_add_f32 v10, v10, v14
  v_add_f32 v18, v18, v22
  v_add_f32 v11, v11, v15
  v_add_f32 v19, v19, v23
  v_add_f32 v8, v8, v16
  v_add_f32 v9, v9, v17
  v_add_f32 v10, v10, v18
  v_add_f32 v11, v11, v19
  v_fmac_f32 v28, v8, v7
  v_fmac_f32 v29, v9, v7
  v_fmac_f32 v30, v10, v7
  v_fmac_f32 v31, v11, v7
  v_cvt_pk_bf16_f32 v8, v28, v29
  v_cvt_pk_bf16_f32 v9, v30, v31
  buffer_store_dwordx2 v[8:9], v3, s[24:27], s43 offen
  s_add_u32 s38, s38, 983040
  s_add_u32 s42, s42, 3072
  s_add_u32 s44, s44, 384
  s_add_u32 s43, s43, 122880
  s_add_u32 s33, s33, 3
  s_cmp_lt_u32 s33, 64
  s_waitcnt vmcnt(0)
  s_cbranch_scc1 L_f_l
  s_branch L_exit
L_role_aux:
  s_lshl_b32 s13, s20, 3
  s_add_u32 s13, s13, s21
  s_mov_b32 s16, s13
  s_cmp_lg_u32 s12, 0
  s_cbranch_scc1 L_noprobe
  s_cmp_eq_u32 s13, 8
  s_cbranch_scc1 L_clear
  s_cmp_lg_u32 s13, 0
  s_cbranch_scc1 L_noprobe
  s_mov_b64 exec, 1
  s_mov_b32 s18, 0x100000
  s_mov_b32 s19, 0x100000
  s_mov_b32 s21, 0
L_probe:
  v_mov_b32 v1, 51904512
  v_mov_b32 v2, 0
  s_memtime s[22:23]
  s_waitcnt lgkmcnt(0)
  buffer_atomic_add v2, v1, s[4:7], 0 offen sc0 sc1
  s_waitcnt vmcnt(0)
  s_memtime s[24:25]
  s_waitcnt lgkmcnt(0)
  s_sub_u32 s20, s24, s22
  s_min_u32 s18, s18, s20
  v_mov_b32 v1, 51912704
  v_mov_b32 v2, 0
  s_memtime s[22:23]
  s_waitcnt lgkmcnt(0)
  buffer_atomic_add v2, v1, s[4:7], 0 offen sc0 sc1
  s_waitcnt vmcnt(0)
  s_memtime s[24:25]
  s_waitcnt lgkmcnt(0)
  s_sub_u32 s20, s24, s22
  s_min_u32 s19, s19, s20
  s_add_u32 s21, s21, 1
  s_cmp_lt_u32 s21, 3
  s_cbranch_scc1 L_probe
  s_min_u32 s17, s18, s19
  s_max_u32 s20, s18, s19
  s_cmp_gt_u32 s17, 720
  s_cselect_b32 s20, 0, s20
  s_mul_i32 s17, s17, 5
  s_lshl_b32 s20, s20, 2
  s_cmp_ge_u32 s20, s17
  s_cbranch_scc1 L_probed
  s_cmp_lt_u32 s21, 14
  s_cbranch_scc1 L_probe
L_probed:
  s_cmp_lt_u32 s18, s19
  s_cselect_b32 s17, 1, 2
  v_mov_b32 v2, s17
  v_mov_b32 v1, 240
  s_branch L_tell
L_clear:
  v_lshlrev_b32 v1, 4, v0
  v_mov_b32 v4, 0
  v_mov_b32 v5, 0
  v_mov_b32 v6, 0
  v_mov_b32 v7, 0
  s_mov_b32 s17, 52166656
  buffer_store_dwordx4 v[4:7], v1, s[4:7], s17 offen sc1
  s_mov_b32 s17, 52167680
  buffer_store_dwordx4 v[4:7], v1, s[4:7], s17 offen sc1
  s_mov_b32 s17, 52168704
  buffer_store_dwordx4 v[4:7], v1, s[4:7], s17 offen sc1
  s_mov_b32 s17, 52169728
  buffer_store_dwordx4 v[4:7], v1, s[4:7], s17 offen sc1
  s_mov_b32 s17, 52170752
  buffer_store_dwordx4 v[4:7], v1, s[4:7], s17 offen sc1
  s_mov_b32 s17, 52171776
  buffer_store_dwordx4 v[4:7], v1, s[4:7], s17 offen sc1
  s_mov_b32 s17, 52172800
  buffer_store_dwordx4 v[4:7], v1, s[4:7], s17 offen sc1
  s_mov_b32 s17, 52173824
  buffer_store_dwordx4 v[4:7], v1, s[4:7], s17 offen sc1
  s_mov_b32 s17, 52174848
  buffer_store_dwordx4 v[4:7], v1, s[4:7], s17 offen sc1
  s_mov_b32 s17, 52175872
  buffer_store_dwordx4 v[4:7], v1, s[4:7], s17 offen sc1
  s_mov_b32 s17, 52176896
  buffer_store_dwordx4 v[4:7], v1, s[4:7], s17 offen sc1
  s_mov_b32 s17, 52177920
  buffer_store_dwordx4 v[4:7], v1, s[4:7], s17 offen sc1
  s_mov_b32 s17, 52178944
  buffer_store_dwordx4 v[4:7], v1, s[4:7], s17 offen sc1
  s_mov_b32 s17, 52179968
  buffer_store_dwordx4 v[4:7], v1, s[4:7], s17 offen sc1
  s_mov_b32 s17, 52180992
  buffer_store_dwordx4 v[4:7], v1, s[4:7], s17 offen sc1
  s_mov_b32 s17, 52182016
  buffer_store_dwordx4 v[4:7], v1, s[4:7], s17 offen sc1
  s_mov_b32 s17, 52183040
  buffer_store_dwordx4 v[4:7], v1, s[4:7], s17 offen sc1
  s_mov_b32 s17, 52184064
  buffer_store_dwordx4 v[4:7], v1, s[4:7], s17 offen sc1
  s_mov_b32 s17, 52185088
  buffer_store_dwordx4 v[4:7], v1, s[4:7], s17 offen sc1
  s_mov_b32 s17, 52186112
  buffer_store_dwordx4 v[4:7], v1, s[4:7], s17 offen sc1
  s_mov_b32 s17, 52191232
  buffer_store_dwordx4 v[4:7], v1, s[4:7], s17 offen sc1
  s_mov_b32 s17, 52192256
  buffer_store_dwordx4 v[4:7], v1, s[4:7], s17 offen sc1
  s_mov_b32 s17, 52193280
  buffer_store_dwordx4 v[4:7], v1, s[4:7], s17 offen sc1
  s_mov_b32 s17, 52194304
  buffer_store_dwordx4 v[4:7], v1, s[4:7], s17 offen sc1
  s_mov_b32 s17, 52199424
  buffer_store_dwordx4 v[4:7], v1, s[4:7], s17 offen sc1
  s_mov_b32 s17, 52200448
  buffer_store_dwordx4 v[4:7], v1, s[4:7], s17 offen sc1
  s_mov_b32 s17, 52201472
  buffer_store_dwordx4 v[4:7], v1, s[4:7], s17 offen sc1
  s_mov_b32 s17, 52202496
  buffer_store_dwordx4 v[4:7], v1, s[4:7], s17 offen sc1
  s_mov_b32 s17, 52207616
  buffer_store_dwordx4 v[4:7], v1, s[4:7], s17 offen sc1
  s_mov_b32 s17, 52208640
  buffer_store_dwordx4 v[4:7], v1, s[4:7], s17 offen sc1
  s_mov_b32 s17, 52209664
  buffer_store_dwordx4 v[4:7], v1, s[4:7], s17 offen sc1
  s_mov_b32 s17, 52210688
  buffer_store_dwordx4 v[4:7], v1, s[4:7], s17 offen sc1
  s_mov_b32 s17, 52215808
  buffer_store_dwordx4 v[4:7], v1, s[4:7], s17 offen sc1
  s_mov_b64 exec, 1
  v_mov_b32 v2, 1
  v_mov_b32 v1, 48
  s_waitcnt vmcnt(0)
L_tell:
  buffer_store_dword v2, v1, s[8:11], 0 offen sc1
  s_mov_b64 exec, -1
L_noprobe:
  s_waitcnt vmcnt(0)
  s_branch L_exit
L_role_qa:
  s_mov_b32 s32, s13
  s_sleep 127
  s_sleep 127
  s_load_dwordx2 s[24:25], s[0:1], 16
  s_load_dwordx2 s[26:27], s[0:1], 0
  s_waitcnt lgkmcnt(0)
  s_mov_b32 s16, s24
  s_mov_b32 s17, s25
  s_mov_b32 s18, 7864320
  s_mov_b32 s19, 0x20000
  s_mov_b32 s20, s26
  s_mov_b32 s21, s27
  s_mov_b32 s22, 2621440
  s_mov_b32 s23, 0x20000
  v_and_b32 v170, 63, v0
  v_add_u32 v170, 0, v170
  v_mul_u32_u24 v171, 2731, v170
  v_lshrrev_b32 v171, 16, v171
  v_mul_u32_u24 v164, 24, v171
  v_sub_u32 v170, v170, v164
  v_mul_u32_u24 v164, 12288, v171
  v_and_b32 v171, 2, v171
  s_and_b32 s52, s12, 1
  s_lshl_b32 s52, s52, 2
  v_or_b32 v171, s52, v171
  v_xor_b32 v170, v170, v171
  v_lshl_add_u32 v164, v170, 4, v164
  v_and_b32 v170, 63, v0
  v_add_u32 v170, 64, v170
  v_mul_u32_u24 v171, 2731, v170
  v_lshrrev_b32 v171, 16, v171
  v_mul_u32_u24 v165, 24, v171
  v_sub_u32 v170, v170, v165
  v_mul_u32_u24 v165, 12288, v171
  v_and_b32 v171, 2, v171
  s_and_b32 s52, s12, 1
  s_lshl_b32 s52, s52, 2
  v_or_b32 v171, s52, v171
  v_xor_b32 v170, v170, v171
  v_lshl_add_u32 v165, v170, 4, v165
  v_and_b32 v170, 63, v0
  v_add_u32 v170, 128, v170
  v_mul_u32_u24 v171, 2731, v170
  v_lshrrev_b32 v171, 16, v171
  v_mul_u32_u24 v166, 24, v171
  v_sub_u32 v170, v170, v166
  v_mul_u32_u24 v166, 12288, v171
  v_and_b32 v171, 2, v171
  s_and_b32 s52, s12, 1
  s_lshl_b32 s52, s52, 2
  v_or_b32 v171, s52, v171
  v_xor_b32 v170, v170, v171
  v_lshl_add_u32 v166, v170, 4, v166
  v_bfe_u32 v170, v0, 3, 1
  v_bfe_u32 v171, v0, 4, 1
  v_lshl_or_b32 v170, v171, 1, v170
  s_mul_i32 s52, s12, 3
  s_add_u32 s52, s52, 0
  v_xor_b32 v167, s52, v170
  v_lshlrev_b32 v167, 5, v167
  s_mul_i32 s52, s12, 3
  s_add_u32 s52, s52, 1
  v_xor_b32 v168, s52, v170
  v_lshlrev_b32 v168, 5, v168
  s_mul_i32 s52, s12, 3
  s_add_u32 s52, s52, 2
  v_xor_b32 v169, s52, v170
  v_lshlrev_b32 v169, 5, v169
  v_bfe_u32 v170, v0, 4, 2
  v_bfe_u32 v171, v0, 2, 2
  v_lshl_add_u32 v170, v170, 3, v171
  v_mul_u32_u24 v170, 384, v170
  v_and_b32 v171, 3, v0
  v_lshl_add_u32 v170, v171, 3, v170
  v_add3_u32 v167, v167, v170, 0
  v_add3_u32 v168, v168, v170, 0
  v_add3_u32 v169, v169, v170, 0
  s_mul_i32 s52, s12, 98304
  s_mul_i32 s53, s32, 384
  s_add_u32 s52, s52, s53
  s_add_u32 s52, s52, 0
  s_mul_i32 s53, s12, 3072
  s_add_u32 s53, s53, 0
  s_add_u32 m0, s53, 0
  s_nop 0
  buffer_load_dwordx4 v164, s[16:19], s52 offen lds
  s_add_u32 m0, s53, 1024
  s_nop 0
  buffer_load_dwordx4 v165, s[16:19], s52 offen lds
  s_add_u32 m0, s53, 2048
  s_nop 0
  buffer_load_dwordx4 v166, s[16:19], s52 offen lds
  s_add_u32 s52, s52, 393216
  s_add_u32 m0, s53, 12288
  s_nop 0
  buffer_load_dwordx4 v164, s[16:19], s52 offen lds
  s_add_u32 m0, s53, 13312
  s_nop 0
  buffer_load_dwordx4 v165, s[16:19], s52 offen lds
  s_add_u32 m0, s53, 14336
  s_nop 0
  buffer_load_dwordx4 v166, s[16:19], s52 offen lds
  s_add_u32 s52, s52, 393216
  s_add_u32 m0, s53, 24576
  s_nop 0
  buffer_load_dwordx4 v164, s[16:19], s52 offen lds
  s_add_u32 m0, s53, 25600
  s_nop 0
  buffer_load_dwordx4 v165, s[16:19], s52 offen lds
  s_add_u32 m0, s53, 26624
  s_nop 0
  buffer_load_dwordx4 v166, s[16:19], s52 offen lds
  s_add_u32 s52, s52, 393216
  s_add_u32 m0, s53, 36864
  s_nop 0
  buffer_load_dwordx4 v164, s[16:19], s52 offen lds
  s_add_u32 m0, s53, 37888
  s_nop 0
  buffer_load_dwordx4 v165, s[16:19], s52 offen lds
  s_add_u32 m0, s53, 38912
  s_nop 0
  buffer_load_dwordx4 v166, s[16:19], s52 offen lds
  s_add_u32 s52, s52, 393216
  s_add_u32 m0, s53, 49152
  s_nop 0
  buffer_load_dwordx4 v164, s[16:19], s52 offen lds
  s_add_u32 m0, s53, 50176
  s_nop 0
  buffer_load_dwordx4 v165, s[16:19], s52 offen lds
  s_add_u32 m0, s53, 51200
  s_nop 0
  buffer_load_dwordx4 v166, s[16:19], s52 offen lds
  s_mul_i32 s52, s12, 98304
  s_mul_i32 s53, s32, 384
  s_add_u32 s52, s52, s53
  s_add_u32 s52, s52, 1966080
  s_mul_i32 s53, s12, 3072
  s_add_u32 s53, s53, 61440
  s_add_u32 m0, s53, 0
  s_nop 0
  buffer_load_dwordx4 v164, s[16:19], s52 offen lds
  s_add_u32 m0, s53, 1024
  s_nop 0
  buffer_load_dwordx4 v165, s[16:19], s52 offen lds
  s_add_u32 m0, s53, 2048
  s_nop 0
  buffer_load_dwordx4 v166, s[16:19], s52 offen lds
  s_add_u32 s52, s52, 393216
  s_add_u32 m0, s53, 12288
  s_nop 0
  buffer_load_dwordx4 v164, s[16:19], s52 offen lds
  s_add_u32 m0, s53, 13312
  s_nop 0
  buffer_load_dwordx4 v165, s[16:19], s52 offen lds
  s_add_u32 m0, s53, 14336
  s_nop 0
  buffer_load_dwordx4 v166, s[16:19], s52 offen lds
  s_add_u32 s52, s52, 393216
  s_add_u32 m0, s53, 24576
  s_nop 0
  buffer_load_dwordx4 v164, s[16:19], s52 offen lds
  s_add_u32 m0, s53, 25600
  s_nop 0
  buffer_load_dwordx4 v165, s[16:19], s52 offen lds
  s_add_u32 m0, s53, 26624
  s_nop 0
  buffer_load_dwordx4 v166, s[16:19], s52 offen lds
  s_add_u32 s52, s52, 393216
  s_add_u32 m0, s53, 36864
  s_nop 0
  buffer_load_dwordx4 v164, s[16:19], s52 offen lds
  s_add_u32 m0, s53, 37888
  s_nop 0
  buffer_load_dwordx4 v165, s[16:19], s52 offen lds
  s_add_u32 m0, s53, 38912
  s_nop 0
  buffer_load_dwordx4 v166, s[16:19], s52 offen lds
  s_add_u32 s52, s52, 393216
  s_add_u32 m0, s53, 49152
  s_nop 0
  buffer_load_dwordx4 v164, s[16:19], s52 offen lds
  s_add_u32 m0, s53, 50176
  s_nop 0
  buffer_load_dwordx4 v165, s[16:19], s52 offen lds
  s_add_u32 m0, s53, 51200
  s_nop 0
  buffer_load_dwordx4 v166, s[16:19], s52 offen lds
  s_waitcnt vmcnt(15)
  s_barrier
  ds_read_b64_tr_b16 a[0:1], v167 offset:0
  ds_read_b64_tr_b16 a[2:3], v167 offset:1536
  ds_read_b64_tr_b16 a[80:81], v168 offset:0
  ds_read_b64_tr_b16 a[82:83], v168 offset:1536
  ds_read_b64_tr_b16 a[160:161], v169 offset:0
  ds_read_b64_tr_b16 a[162:163], v169 offset:1536
  s_waitcnt lgkmcnt(6)
  ds_read_b64_tr_b16 a[4:5], v167 offset:12288
  ds_read_b64_tr_b16 a[6:7], v167 offset:13824
  ds_read_b64_tr_b16 a[84:85], v168 offset:12288
  ds_read_b64_tr_b16 a[86:87], v168 offset:13824
  ds_read_b64_tr_b16 a[164:165], v169 offset:12288
  ds_read_b64_tr_b16 a[166:167], v169 offset:13824
  s_waitcnt lgkmcnt(6)
  ds_read_b64_tr_b16 a[8:9], v167 offset:24576
  ds_read_b64_tr_b16 a[10:11], v167 offset:26112
  ds_read_b64_tr_b16 a[88:89], v168 offset:24576
  ds_read_b64_tr_b16 a[90:91], v168 offset:26112
  ds_read_b64_tr_b16 a[168:169], v169 offset:24576
  ds_read_b64_tr_b16 a[170:171], v169 offset:26112
  s_waitcnt lgkmcnt(6)
  ds_read_b64_tr_b16 a[12:13], v167 offset:36864
  ds_read_b64_tr_b16 a[14:15], v167 offset:38400
  ds_read_b64_tr_b16 a[92:93], v168 offset:36864
  ds_read_b64_tr_b16 a[94:95], v168 offset:38400
  ds_read_b64_tr_b16 a[172:173], v169 offset:36864
  ds_read_b64_tr_b16 a[174:175], v169 offset:38400
  s_waitcnt lgkmcnt(6)
  ds_read_b64_tr_b16 a[16:17], v167 offset:49152
  ds_read_b64_tr_b16 a[18:19], v167 offset:50688
  ds_read_b64_tr_b16 a[96:97], v168 offset:49152
  ds_read_b64_tr_b16 a[98:99], v168 offset:50688
  ds_read_b64_tr_b16 a[176:177], v169 offset:49152
  ds_read_b64_tr_b16 a[178:179], v169 offset:50688
  s_waitcnt lgkmcnt(6)
  v_add_u32 v167, 61440, v167
  v_add_u32 v168, 61440, v168
  v_add_u32 v169, 61440, v169
  s_waitcnt lgkmcnt(0)
  s_barrier
  s_mul_i32 s52, s12, 98304
  s_mul_i32 s53, s32, 384
  s_add_u32 s52, s52, s53
  s_add_u32 s52, s52, 3932160
  s_mul_i32 s53, s12, 3072
  s_add_u32 s53, s53, 0
  s_add_u32 m0, s53, 0
  s_nop 0
  buffer_load_dwordx4 v164, s[16:19], s52 offen lds
  s_add_u32 m0, s53, 1024
  s_nop 0
  buffer_load_dwordx4 v165, s[16:19], s52 offen lds
  s_add_u32 m0, s53, 2048
  s_nop 0
  buffer_load_dwordx4 v166, s[16:19], s52 offen lds
  s_add_u32 s52, s52, 393216
  s_add_u32 m0, s53, 12288
  s_nop 0
  buffer_load_dwordx4 v164, s[16:19], s52 offen lds
  s_add_u32 m0, s53, 13312
  s_nop 0
  buffer_load_dwordx4 v165, s[16:19], s52 offen lds
  s_add_u32 m0, s53, 14336
  s_nop 0
  buffer_load_dwordx4 v166, s[16:19], s52 offen lds
  s_add_u32 s52, s52, 393216
  s_add_u32 m0, s53, 24576
  s_nop 0
  buffer_load_dwordx4 v164, s[16:19], s52 offen lds
  s_add_u32 m0, s53, 25600
  s_nop 0
  buffer_load_dwordx4 v165, s[16:19], s52 offen lds
  s_add_u32 m0, s53, 26624
  s_nop 0
  buffer_load_dwordx4 v166, s[16:19], s52 offen lds
  s_add_u32 s52, s52, 393216
  s_add_u32 m0, s53, 36864
  s_nop 0
  buffer_load_dwordx4 v164, s[16:19], s52 offen lds
  s_add_u32 m0, s53, 37888
  s_nop 0
  buffer_load_dwordx4 v165, s[16:19], s52 offen lds
  s_add_u32 m0, s53, 38912
  s_nop 0
  buffer_load_dwordx4 v166, s[16:19], s52 offen lds
  s_add_u32 s52, s52, 393216
  s_add_u32 m0, s53, 49152
  s_nop 0
  buffer_load_dwordx4 v164, s[16:19], s52 offen lds
  s_add_u32 m0, s53, 50176
  s_nop 0
  buffer_load_dwordx4 v165, s[16:19], s52 offen lds
  s_add_u32 m0, s53, 51200
  s_nop 0
  buffer_load_dwordx4 v166, s[16:19], s52 offen lds
  s_waitcnt vmcnt(15)
  s_barrier
  ds_read_b64_tr_b16 a[20:21], v167 offset:0
  ds_read_b64_tr_b16 a[22:23], v167 offset:1536
  ds_read_b64_tr_b16 a[100:101], v168 offset:0
  ds_read_b64_tr_b16 a[102:103], v168 offset:1536
  ds_read_b64_tr_b16 a[180:181], v169 offset:0
  ds_read_b64_tr_b16 a[182:183], v169 offset:1536
  s_waitcnt lgkmcnt(6)
  ds_read_b64_tr_b16 a[24:25], v167 offset:12288
  ds_read_b64_tr_b16 a[26:27], v167 offset:13824
  ds_read_b64_tr_b16 a[104:105], v168 offset:12288
  ds_read_b64_tr_b16 a[106:107], v168 offset:13824
  ds_read_b64_tr_b16 a[184:185], v169 offset:12288
  ds_read_b64_tr_b16 a[186:187], v169 offset:13824
  s_waitcnt lgkmcnt(6)
  ds_read_b64_tr_b16 a[28:29], v167 offset:24576
  ds_read_b64_tr_b16 a[30:31], v167 offset:26112
  ds_read_b64_tr_b16 a[108:109], v168 offset:24576
  ds_read_b64_tr_b16 a[110:111], v168 offset:26112
  ds_read_b64_tr_b16 a[188:189], v169 offset:24576
  ds_read_b64_tr_b16 a[190:191], v169 offset:26112
  s_waitcnt lgkmcnt(6)
  ds_read_b64_tr_b16 a[32:33], v167 offset:36864
  ds_read_b64_tr_b16 a[34:35], v167 offset:38400
  ds_read_b64_tr_b16 a[112:113], v168 offset:36864
  ds_read_b64_tr_b16 a[114:115], v168 offset:38400
  ds_read_b64_tr_b16 a[192:193], v169 offset:36864
  ds_read_b64_tr_b16 a[194:195], v169 offset:38400
  s_waitcnt lgkmcnt(6)
  ds_read_b64_tr_b16 a[36:37], v167 offset:49152
  ds_read_b64_tr_b16 a[38:39], v167 offset:50688
  ds_read_b64_tr_b16 a[116:117], v168 offset:49152
  ds_read_b64_tr_b16 a[118:119], v168 offset:50688
  ds_read_b64_tr_b16 a[196:197], v169 offset:49152
  ds_read_b64_tr_b16 a[198:199], v169 offset:50688
  s_waitcnt lgkmcnt(6)
  v_subrev_u32 v167, 61440, v167
  v_subrev_u32 v168, 61440, v168
  v_subrev_u32 v169, 61440, v169
  s_waitcnt lgkmcnt(0)
  s_barrier
  s_mul_i32 s52, s12, 98304
  s_mul_i32 s53, s32, 384
  s_add_u32 s52, s52, s53
  s_add_u32 s52, s52, 5898240
  s_mul_i32 s53, s12, 3072
  s_add_u32 s53, s53, 61440
  s_add_u32 m0, s53, 0
  s_nop 0
  buffer_load_dwordx4 v164, s[16:19], s52 offen lds
  s_add_u32 m0, s53, 1024
  s_nop 0
  buffer_load_dwordx4 v165, s[16:19], s52 offen lds
  s_add_u32 m0, s53, 2048
  s_nop 0
  buffer_load_dwordx4 v166, s[16:19], s52 offen lds
  s_add_u32 s52, s52, 393216
  s_add_u32 m0, s53, 12288
  s_nop 0
  buffer_load_dwordx4 v164, s[16:19], s52 offen lds
  s_add_u32 m0, s53, 13312
  s_nop 0
  buffer_load_dwordx4 v165, s[16:19], s52 offen lds
  s_add_u32 m0, s53, 14336
  s_nop 0
  buffer_load_dwordx4 v166, s[16:19], s52 offen lds
  s_add_u32 s52, s52, 393216
  s_add_u32 m0, s53, 24576
  s_nop 0
  buffer_load_dwordx4 v164, s[16:19], s52 offen lds
  s_add_u32 m0, s53, 25600
  s_nop 0
  buffer_load_dwordx4 v165, s[16:19], s52 offen lds
  s_add_u32 m0, s53, 26624
  s_nop 0
  buffer_load_dwordx4 v166, s[16:19], s52 offen lds
  s_add_u32 s52, s52, 393216
  s_add_u32 m0, s53, 36864
  s_nop 0
  buffer_load_dwordx4 v164, s[16:19], s52 offen lds
  s_add_u32 m0, s53, 37888
  s_nop 0
  buffer_load_dwordx4 v165, s[16:19], s52 offen lds
  s_add_u32 m0, s53, 38912
  s_nop 0
  buffer_load_dwordx4 v166, s[16:19], s52 offen lds
  s_add_u32 s52, s52, 393216
  s_add_u32 m0, s53, 49152
  s_nop 0
  buffer_load_dwordx4 v164, s[16:19], s52 offen lds
  s_add_u32 m0, s53, 50176
  s_nop 0
  buffer_load_dwordx4 v165, s[16:19], s52 offen lds
  s_add_u32 m0, s53, 51200
  s_nop 0
  buffer_load_dwordx4 v166, s[16:19], s52 offen lds
  s_waitcnt vmcnt(15)
  s_barrier
  ds_read_b64_tr_b16 a[40:41], v167 offset:0
  ds_read_b64_tr_b16 a[42:43], v167 offset:1536
  ds_read_b64_tr_b16 a[120:121], v168 offset:0
  ds_read_b64_tr_b16 a[122:123], v168 offset:1536
  ds_read_b64_tr_b16 a[200:201], v169 offset:0
  ds_read_b64_tr_b16 a[202:203], v169 offset:1536
  s_waitcnt lgkmcnt(6)
  ds_read_b64_tr_b16 a[44:45], v167 offset:12288
  ds_read_b64_tr_b16 a[46:47], v167 offset:13824
  ds_read_b64_tr_b16 a[124:125], v168 offset:12288
  ds_read_b64_tr_b16 a[126:127], v168 offset:13824
  ds_read_b64_tr_b16 a[204:205], v169 offset:12288
  ds_read_b64_tr_b16 a[206:207], v169 offset:13824
  s_waitcnt lgkmcnt(6)
  ds_read_b64_tr_b16 a[48:49], v167 offset:24576
  ds_read_b64_tr_b16 a[50:51], v167 offset:26112
  ds_read_b64_tr_b16 a[128:129], v168 offset:24576
  ds_read_b64_tr_b16 a[130:131], v168 offset:26112
  ds_read_b64_tr_b16 a[208:209], v169 offset:24576
  ds_read_b64_tr_b16 a[210:211], v169 offset:26112
  s_waitcnt lgkmcnt(6)
  ds_read_b64_tr_b16 a[52:53], v167 offset:36864
  ds_read_b64_tr_b16 a[54:55], v167 offset:38400
  ds_read_b64_tr_b16 a[132:133], v168 offset:36864
  ds_read_b64_tr_b16 a[134:135], v168 offset:38400
  ds_read_b64_tr_b16 a[212:213], v169 offset:36864
  ds_read_b64_tr_b16 a[214:215], v169 offset:38400
  s_waitcnt lgkmcnt(6)
  ds_read_b64_tr_b16 a[56:57], v167 offset:49152
  ds_read_b64_tr_b16 a[58:59], v167 offset:50688
  ds_read_b64_tr_b16 a[136:137], v168 offset:49152
  ds_read_b64_tr_b16 a[138:139], v168 offset:50688
  ds_read_b64_tr_b16 a[216:217], v169 offset:49152
  ds_read_b64_tr_b16 a[218:219], v169 offset:50688
  s_waitcnt lgkmcnt(6)
  v_add_u32 v167, 61440, v167
  v_add_u32 v168, 61440, v168
  v_add_u32 v169, 61440, v169
  s_waitcnt lgkmcnt(0)
  s_barrier
  s_waitcnt vmcnt(0)
  s_barrier
  ds_read_b64_tr_b16 a[60:61], v167 offset:0
  ds_read_b64_tr_b16 a[62:63], v167 offset:1536
  ds_read_b64_tr_b16 a[140:141], v168 offset:0
  ds_read_b64_tr_b16 a[142:143], v168 offset:1536
  ds_read_b64_tr_b16 a[220:221], v169 offset:0
  ds_read_b64_tr_b16 a[222:223], v169 offset:1536
  s_waitcnt lgkmcnt(6)
  ds_read_b64_tr_b16 a[64:65], v167 offset:12288
  ds_read_b64_tr_b16 a[66:67], v167 offset:13824
  ds_read_b64_tr_b16 a[144:145], v168 offset:12288
  ds_read_b64_tr_b16 a[146:147], v168 offset:13824
  ds_read_b64_tr_b16 a[224:225], v169 offset:12288
  ds_read_b64_tr_b16 a[226:227], v169 offset:13824
  s_waitcnt lgkmcnt(6)
  ds_read_b64_tr_b16 a[68:69], v167 offset:24576
  ds_read_b64_tr_b16 a[70:71], v167 offset:26112
  ds_read_b64_tr_b16 a[148:149], v168 offset:24576
  ds_read_b64_tr_b16 a[150:151], v168 offset:26112
  ds_read_b64_tr_b16 a[228:229], v169 offset:24576
  ds_read_b64_tr_b16 a[230:231], v169 offset:26112
  s_waitcnt lgkmcnt(6)
  ds_read_b64_tr_b16 a[72:73], v167 offset:36864
  ds_read_b64_tr_b16 a[74:75], v167 offset:38400
  ds_read_b64_tr_b16 a[152:153], v168 offset:36864
  ds_read_b64_tr_b16 a[154:155], v168 offset:38400
  ds_read_b64_tr_b16 a[232:233], v169 offset:36864
  ds_read_b64_tr_b16 a[234:235], v169 offset:38400
  s_waitcnt lgkmcnt(6)
  ds_read_b64_tr_b16 a[76:77], v167 offset:49152
  ds_read_b64_tr_b16 a[78:79], v167 offset:50688
  ds_read_b64_tr_b16 a[156:157], v168 offset:49152
  ds_read_b64_tr_b16 a[158:159], v168 offset:50688
  ds_read_b64_tr_b16 a[236:237], v169 offset:49152
  ds_read_b64_tr_b16 a[238:239], v169 offset:50688
  s_waitcnt lgkmcnt(6)
  v_subrev_u32 v167, 61440, v167
  v_subrev_u32 v168, 61440, v168
  v_subrev_u32 v169, 61440, v169
  s_waitcnt lgkmcnt(0)
  s_barrier
  s_and_b32 s52, s12, 1
  s_lshl_b32 s52, s52, 3
  v_and_b32 v164, 63, v0
  v_add_u32 v164, 0, v164
  v_mul_u32_u24 v165, 820, v164
  v_lshrrev_b32 v165, 16, v165
  v_mul_u32_u24 v2, 80, v165
  v_sub_u32 v164, v164, v2
  v_mul_u32_u24 v2, 1280, v165
  v_or_b32 v165, s52, v165
  v_xor_b32 v164, v164, v165
  v_lshl_add_u32 v2, v164, 4, v2
  v_and_b32 v164, 63, v0
  v_add_u32 v164, 64, v164
  v_mul_u32_u24 v165, 820, v164
  v_lshrrev_b32 v165, 16, v165
  v_mul_u32_u24 v3, 80, v165
  v_sub_u32 v164, v164, v3
  v_mul_u32_u24 v3, 1280, v165
  v_or_b32 v165, s52, v165
  v_xor_b32 v164, v164, v165
  v_lshl_add_u32 v3, v164, 4, v3
  v_and_b32 v164, 63, v0
  v_add_u32 v164, 128, v164
  v_mul_u32_u24 v165, 820, v164
  v_lshrrev_b32 v165, 16, v165
  v_mul_u32_u24 v4, 80, v165
  v_sub_u32 v164, v164, v4
  v_mul_u32_u24 v4, 1280, v165
  v_or_b32 v165, s52, v165
  v_xor_b32 v164, v164, v165
  v_lshl_add_u32 v4, v164, 4, v4
  v_and_b32 v164, 63, v0
  v_add_u32 v164, 192, v164
  v_mul_u32_u24 v165, 820, v164
  v_lshrrev_b32 v165, 16, v165
  v_mul_u32_u24 v5, 80, v165
  v_sub_u32 v164, v164, v5
  v_mul_u32_u24 v5, 1280, v165
  v_or_b32 v165, s52, v165
  v_xor_b32 v164, v164, v165
  v_lshl_add_u32 v5, v164, 4, v5
  v_and_b32 v164, 63, v0
  v_add_u32 v164, 256, v164
  v_mul_u32_u24 v165, 820, v164
  v_lshrrev_b32 v165, 16, v165
  v_mul_u32_u24 v6, 80, v165
  v_sub_u32 v164, v164, v6
  v_mul_u32_u24 v6, 1280, v165
  v_or_b32 v165, s52, v165
  v_xor_b32 v164, v164, v165
  v_lshl_add_u32 v6, v164, 4, v6
  v_and_b32 v164, 63, v0
  v_add_u32 v164, 320, v164
  v_mul_u32_u24 v165, 820, v164
  v_lshrrev_b32 v165, 16, v165
  v_mul_u32_u24 v7, 80, v165
  v_sub_u32 v164, v164, v7
  v_mul_u32_u24 v7, 1280, v165
  v_or_b32 v165, s52, v165
  v_xor_b32 v164, v164, v165
  v_lshl_add_u32 v7, v164, 4, v7
  v_and_b32 v164, 63, v0
  v_add_u32 v164, 384, v164
  v_mul_u32_u24 v165, 820, v164
  v_lshrrev_b32 v165, 16, v165
  v_mul_u32_u24 v8, 80, v165
  v_sub_u32 v164, v164, v8
  v_mul_u32_u24 v8, 1280, v165
  v_or_b32 v165, s52, v165
  v_xor_b32 v164, v164, v165
  v_lshl_add_u32 v8, v164, 4, v8
  v_and_b32 v164, 63, v0
  v_add_u32 v164, 448, v164
  v_mul_u32_u24 v165, 820, v164
  v_lshrrev_b32 v165, 16, v165
  v_mul_u32_u24 v9, 80, v165
  v_sub_u32 v164, v164, v9
  v_mul_u32_u24 v9, 1280, v165
  v_or_b32 v165, s52, v165
  v_xor_b32 v164, v164, v165
  v_lshl_add_u32 v9, v164, 4, v9
  v_and_b32 v164, 63, v0
  v_add_u32 v164, 512, v164
  v_mul_u32_u24 v165, 820, v164
  v_lshrrev_b32 v165, 16, v165
  v_mul_u32_u24 v10, 80, v165
  v_sub_u32 v164, v164, v10
  v_mul_u32_u24 v10, 1280, v165
  v_or_b32 v165, s52, v165
  v_xor_b32 v164, v164, v165
  v_lshl_add_u32 v10, v164, 4, v10
  v_and_b32 v164, 63, v0
  v_add_u32 v164, 576, v164
  v_mul_u32_u24 v165, 820, v164
  v_lshrrev_b32 v165, 16, v165
  v_mul_u32_u24 v11, 80, v165
  v_sub_u32 v164, v164, v11
  v_mul_u32_u24 v11, 1280, v165
  v_or_b32 v165, s52, v165
  v_xor_b32 v164, v164, v165
  v_lshl_add_u32 v11, v164, 4, v11
  v_and_b32 v165, 15, v0
  v_bfe_u32 v164, v0, 4, 2
  v_add_u32 v164, 0, v164
  v_xor_b32 v164, v164, v165
  v_lshlrev_b32 v164, 4, v164
  v_mul_u32_u24 v12, 1280, v165
  v_add_u32 v12, v12, v164
  v_bfe_u32 v164, v0, 4, 2
  v_add_u32 v164, 4, v164
  v_xor_b32 v164, v164, v165
  v_lshlrev_b32 v164, 4, v164
  v_mul_u32_u24 v13, 1280, v165
  v_add_u32 v13, v13, v164
  v_bfe_u32 v164, v0, 4, 2
  v_add_u32 v164, 8, v164
  v_xor_b32 v164, v164, v165
  v_lshlrev_b32 v164, 4, v164
  v_mul_u32_u24 v14, 1280, v165
  v_add_u32 v14, v14, v164
  v_bfe_u32 v164, v0, 4, 2
  v_add_u32 v164, 12, v164
  v_xor_b32 v164, v164, v165
  v_lshlrev_b32 v164, 4, v164
  v_mul_u32_u24 v15, 1280, v165
  v_add_u32 v15, v15, v164
  s_mul_i32 s34, s12, 10240
  s_mov_b32 s35, s34
  s_add_u32 s36, s34, 40960
  s_add_u32 m0, s35, 0
  s_nop 0
  buffer_load_dwordx4 v2, s[20:23], s34 offen lds
  s_add_u32 m0, s35, 1024
  s_nop 0
  buffer_load_dwordx4 v3, s[20:23], s34 offen lds
  s_add_u32 m0, s35, 2048
  s_nop 0
  buffer_load_dwordx4 v4, s[20:23], s34 offen lds
  s_add_u32 m0, s35, 3072
  s_nop 0
  buffer_load_dwordx4 v5, s[20:23], s34 offen lds
  s_add_u32 m0, s35, 4096
  s_nop 0
  buffer_load_dwordx4 v6, s[20:23], s34 offen lds
  s_add_u32 m0, s35, 5120
  s_nop 0
  buffer_load_dwordx4 v7, s[20:23], s34 offen lds
  s_add_u32 m0, s35, 6144
  s_nop 0
  buffer_load_dwordx4 v8, s[20:23], s34 offen lds
  s_add_u32 m0, s35, 7168
  s_nop 0
  buffer_load_dwordx4 v9, s[20:23], s34 offen lds
  s_add_u32 m0, s35, 8192
  s_nop 0
  buffer_load_dwordx4 v10, s[20:23], s34 offen lds
  s_add_u32 m0, s35, 9216
  s_nop 0
  buffer_load_dwordx4 v11, s[20:23], s34 offen lds
  s_add_u32 s34, s34, 40960
  v_and_b32 v17, 63, v0
  v_lshlrev_b32 v16, 4, v17
  v_lshlrev_b32 v17, 2, v17
  v_mov_b32 v24, 0
  v_mov_b32 v25, 0xff7fffff
  v_mov_b32 v28, 0x3f803f80
  v_mov_b32 v230, 0
  v_mov_b32 v29, 0x3f803f80
  v_mov_b32 v231, 0
  v_mov_b32 v30, 0x3f803f80
  v_mov_b32 v232, 0
  v_mov_b32 v31, 0x3f803f80
  v_mov_b32 v233, 0
  v_mov_b32 v212, 0
  v_mov_b32 v213, 0
  v_mov_b32 v214, 0
  v_mov_b32 v215, 0
  v_mov_b32 v216, 0
  v_mov_b32 v217, 0
  v_mov_b32 v218, 0
  v_mov_b32 v219, 0
  v_mov_b32 v220, 0
  v_mov_b32 v221, 0
  v_mov_b32 v222, 0
  v_mov_b32 v223, 0
  v_mov_b32 v224, 0
  v_mov_b32 v225, 0
  s_mul_i32 s52, s12, 3072
  s_add_u32 s48, s52, 94208
  s_add_u32 s53, s52, 124928
  v_add_u32 v18, s53, v16
  s_mul_i32 s53, s32, 12288
  s_add_u32 s37, s53, s52
  s_add_u32 s37, s37, 0
  s_lshr_b32 s52, s12, 1
  s_and_b32 s54, s12, 1
  s_add_u32 s38, s37, 25165824
  s_mul_i32 s49, s52, 6144
  s_add_u32 s49, s49, 106496
  v_add_u32 v22, s49, v16
  s_mul_i32 s49, s52, 1536
  s_add_u32 s49, s49, 121856
  v_add_u32 v23, s49, v17
  s_mul_i32 s41, s52, 3072
  s_add_u32 s41, s41, s53
  s_mul_i32 s39, s54, 6144
  s_add_u32 s41, s41, s39
  s_add_u32 s41, s41, 134217728
  s_mul_i32 s39, s32, 3072
  s_min_u32 s49, s12, 2
  s_lshl_b32 s49, s49, 10
  s_add_u32 s39, s39, s49
  s_add_u32 s49, s49, 118784
  s_add_u32 s40, s39, 75497472
  s_add_u32 s39, s39, 67108864
  s_lshl_b32 s53, s54, 3
  s_add_u32 s53, s53, 124928
  v_add_u32 v19, s53, v16
  v_add_u32 v20, 94208, v16
  v_bfe_u32 v250, v0, 2, 2
  v_and_b32 v251, 1, v0
  v_lshl_add_u32 v250, v250, 1, v251
  v_lshlrev_b32 v250, 4, v250
  v_bfe_u32 v251, v0, 4, 2
  v_lshl_add_u32 v250, v251, 7, v250
  v_add_u32 v21, 118784, v250
  s_lshl_b32 s53, s54, 4
  v_and_b32 v250, 15, v0
  v_add_u32 v250, s53, v250
  v_lshlrev_b32 v251, 2, v251
  v_add_u32 v166, 0, v251
  v_cmp_le_u32 s[56:57], v166, v250
  v_add_u32 v166, 1, v251
  v_cmp_le_u32 s[58:59], v166, v250
  v_add_u32 v166, 2, v251
  v_cmp_le_u32 s[60:61], v166, v250
  v_add_u32 v166, 3, v251
  v_cmp_le_u32 s[62:63], v166, v250
  v_add_u32 v166, 16, v251
  v_cmp_le_u32 s[64:65], v166, v250
  v_add_u32 v166, 17, v251
  v_cmp_le_u32 s[66:67], v166, v250
  v_add_u32 v166, 18, v251
  v_cmp_le_u32 s[68:69], v166, v250
  v_add_u32 v166, 19, v251
  v_cmp_le_u32 s[70:71], v166, v250
  s_lshl_b32 s52, s32, 7
  s_lshl_b32 s42, s12, 2
  s_add_u32 s42, s42, s52
  s_add_u32 s42, s42, 52178944
  s_add_u32 s43, s52, 52174848
  s_add_u32 s44, s52, 52199424
  s_mov_b32 s45, 0
  s_mov_b32 s46, 0
  s_mov_b32 s50, 0x3dd53b95
  v_mov_b32 v164, 48
  s_mov_b32 s14, 240
  v_writelane_b32 v164, s14, 0
  s_mov_b32 s15, 0
L_q_go:
  buffer_load_dword v165, v164, s[8:11], 0 offen sc1
  s_waitcnt vmcnt(0)
  v_cmp_eq_u32 vcc, 0, v165
  s_cbranch_vccz L_q_go_ok
  s_sleep 2
  s_add_u32 s15, s15, 1
  s_cmp_lt_u32 s15, 262144
  s_cbranch_scc1 L_q_go
  s_branch L_fail
L_q_go_ok:
  v_readfirstlane_b32 s14, v165
  s_nop 0
  s_sub_u32 s14, s14, 1
  s_lshl_b32 s52, s14, 13
  s_xor_b32 s42, s42, s52
  s_xor_b32 s43, s43, s52
  s_xor_b32 s44, s44, s52
  s_mov_b32 s33, 0
  s_barrier
  ds_read_b128 v[32:35], v12 offset:0
  ds_read_b128 v[36:39], v12 offset:20480
  ds_read_b128 v[40:43], v13 offset:0
  ds_read_b128 v[44:47], v13 offset:20480
  ds_read_b128 v[48:51], v14 offset:0
  ds_read_b128 v[52:55], v14 offset:20480
  s_waitcnt lgkmcnt(4)
  v_mfma_f32_16x16x32_bf16 v[56:59], a[0:3], v[32:35], 0
  v_mfma_f32_16x16x32_bf16 v[60:63], a[0:3], v[36:39], 0
  s_add_u32 m0, s36, 0
  s_nop 0
  buffer_load_dwordx4 v2, s[20:23], s34 offen lds
  v_mfma_f32_16x16x32_bf16 v[64:67], a[80:83], v[32:35], 0
  v_mfma_f32_16x16x32_bf16 v[68:71], a[80:83], v[36:39], 0
  v_mfma_f32_16x16x32_bf16 v[72:75], a[160:163], v[32:35], 0
  v_mfma_f32_16x16x32_bf16 v[76:79], a[160:163], v[36:39], 0
  s_add_u32 m0, s36, 1024
  s_nop 0
  buffer_load_dwordx4 v3, s[20:23], s34 offen lds
  ds_read_b128 v[32:35], v15 offset:0
  ds_read_b128 v[36:39], v15 offset:20480
  s_waitcnt lgkmcnt(4)
  v_mfma_f32_16x16x32_bf16 v[56:59], a[4:7], v[40:43], v[56:59]
  v_mfma_f32_16x16x32_bf16 v[60:63], a[4:7], v[44:47], v[60:63]
  s_add_u32 m0, s36, 2048
  s_nop 0
  buffer_load_dwordx4 v4, s[20:23], s34 offen lds
  v_mfma_f32_16x16x32_bf16 v[64:67], a[84:87], v[40:43], v[64:67]
  v_mfma_f32_16x16x32_bf16 v[68:71], a[84:87], v[44:47], v[68:71]
  v_mfma_f32_16x16x32_bf16 v[72:75], a[164:167], v[40:43], v[72:75]
  v_mfma_f32_16x16x32_bf16 v[76:79], a[164:167], v[44:47], v[76:79]
  s_add_u32 m0, s36, 3072
  s_nop 0
  buffer_load_dwordx4 v5, s[20:23], s34 offen lds
  ds_read_b128 v[40:43], v12 offset:256
  ds_read_b128 v[44:47], v12 offset:20736
  s_waitcnt lgkmcnt(4)
  v_mfma_f32_16x16x32_bf16 v[56:59], a[8:11], v[48:51], v[56:59]
  v_mfma_f32_16x16x32_bf16 v[60:63], a[8:11], v[52:55], v[60:63]
  s_add_u32 m0, s36, 4096
  s_nop 0
  buffer_load_dwordx4 v6, s[20:23], s34 offen lds
  v_mfma_f32_16x16x32_bf16 v[64:67], a[88:91], v[48:51], v[64:67]
  v_mfma_f32_16x16x32_bf16 v[68:71], a[88:91], v[52:55], v[68:71]
  v_mfma_f32_16x16x32_bf16 v[72:75], a[168:171], v[48:51], v[72:75]
  v_mfma_f32_16x16x32_bf16 v[76:79], a[168:171], v[52:55], v[76:79]
  ds_read_b128 v[48:51], v13 offset:256
  ds_read_b128 v[52:55], v13 offset:20736
  s_waitcnt lgkmcnt(4)
  v_mfma_f32_16x16x32_bf16 v[56:59], a[12:15], v[32:35], v[56:59]
  v_mfma_f32_16x16x32_bf16 v[60:63], a[12:15], v[36:39], v[60:63]
  s_add_u32 m0, s36, 5120
  s_nop 0
  buffer_load_dwordx4 v7, s[20:23], s34 offen lds
  v_mfma_f32_16x16x32_bf16 v[64:67], a[92:95], v[32:35], v[64:67]
  v_mfma_f32_16x16x32_bf16 v[68:71], a[92:95], v[36:39], v[68:71]
  v_mfma_f32_16x16x32_bf16 v[72:75], a[172:175], v[32:35], v[72:75]
  v_mfma_f32_16x16x32_bf16 v[76:79], a[172:175], v[36:39], v[76:79]
  ds_read_b128 v[32:35], v14 offset:256
  ds_read_b128 v[36:39], v14 offset:20736
  s_waitcnt lgkmcnt(4)
  v_mfma_f32_16x16x32_bf16 v[56:59], a[16:19], v[40:43], v[56:59]
  v_mfma_f32_16x16x32_bf16 v[60:63], a[16:19], v[44:47], v[60:63]
  s_add_u32 m0, s36, 6144
  s_nop 0
  buffer_load_dwordx4 v8, s[20:23], s34 offen lds
  v_mfma_f32_16x16x32_bf16 v[64:67], a[96:99], v[40:43], v[64:67]
  v_mfma_f32_16x16x32_bf16 v[68:71], a[96:99], v[44:47], v[68:71]
  v_mfma_f32_16x16x32_bf16 v[72:75], a[176:179], v[40:43], v[72:75]
  v_mfma_f32_16x16x32_bf16 v[76:79], a[176:179], v[44:47], v[76:79]
  ds_read_b128 v[40:43], v15 offset:256
  ds_read_b128 v[44:47], v15 offset:20736
  s_waitcnt lgkmcnt(4)
  v_mfma_f32_16x16x32_bf16 v[56:59], a[20:23], v[48:51], v[56:59]
  v_mfma_f32_16x16x32_bf16 v[60:63], a[20:23], v[52:55], v[60:63]
  s_add_u32 m0, s36, 7168
  s_nop 0
  buffer_load_dwordx4 v9, s[20:23], s34 offen lds
  v_mfma_f32_16x16x32_bf16 v[64:67], a[100:103], v[48:51], v[64:67]
  v_mfma_f32_16x16x32_bf16 v[68:71], a[100:103], v[52:55], v[68:71]
  v_mfma_f32_16x16x32_bf16 v[72:75], a[180:183], v[48:51], v[72:75]
  v_mfma_f32_16x16x32_bf16 v[76:79], a[180:183], v[52:55], v[76:79]
  ds_read_b128 v[48:51], v12 offset:512
  ds_read_b128 v[52:55], v12 offset:20992
  s_waitcnt lgkmcnt(4)
  v_mfma_f32_16x16x32_bf16 v[56:59], a[24:27], v[32:35], v[56:59]
  v_mfma_f32_16x16x32_bf16 v[60:63], a[24:27], v[36:39], v[60:63]
  s_add_u32 m0, s36, 8192
  s_nop 0
  buffer_load_dwordx4 v10, s[20:23], s34 offen lds
  v_mfma_f32_16x16x32_bf16 v[64:67], a[104:107], v[32:35], v[64:67]
  v_mfma_f32_16x16x32_bf16 v[68:71], a[104:107], v[36:39], v[68:71]
  v_mfma_f32_16x16x32_bf16 v[72:75], a[184:187], v[32:35], v[72:75]
  v_mfma_f32_16x16x32_bf16 v[76:79], a[184:187], v[36:39], v[76:79]
  ds_read_b128 v[32:35], v13 offset:512
  ds_read_b128 v[36:39], v13 offset:20992
  s_waitcnt lgkmcnt(4)
  v_mfma_f32_16x16x32_bf16 v[56:59], a[28:31], v[40:43], v[56:59]
  v_mfma_f32_16x16x32_bf16 v[60:63], a[28:31], v[44:47], v[60:63]
  s_add_u32 m0, s36, 9216
  s_nop 0
  buffer_load_dwordx4 v11, s[20:23], s34 offen lds
  v_mfma_f32_16x16x32_bf16 v[64:67], a[108:111], v[40:43], v[64:67]
  v_mfma_f32_16x16x32_bf16 v[68:71], a[108:111], v[44:47], v[68:71]
  v_mfma_f32_16x16x32_bf16 v[72:75], a[188:191], v[40:43], v[72:75]
  v_mfma_f32_16x16x32_bf16 v[76:79], a[188:191], v[44:47], v[76:79]
  ds_read_b128 v[40:43], v14 offset:512
  ds_read_b128 v[44:47], v14 offset:20992
  s_waitcnt lgkmcnt(4)
  v_mfma_f32_16x16x32_bf16 v[56:59], a[32:35], v[48:51], v[56:59]
  v_mfma_f32_16x16x32_bf16 v[60:63], a[32:35], v[52:55], v[60:63]
  v_mfma_f32_16x16x32_bf16 v[64:67], a[112:115], v[48:51], v[64:67]
  v_mfma_f32_16x16x32_bf16 v[68:71], a[112:115], v[52:55], v[68:71]
  v_mfma_f32_16x16x32_bf16 v[72:75], a[192:195], v[48:51], v[72:75]
  v_mfma_f32_16x16x32_bf16 v[76:79], a[192:195], v[52:55], v[76:79]
  ds_read_b128 v[48:51], v15 offset:512
  ds_read_b128 v[52:55], v15 offset:20992
  s_waitcnt lgkmcnt(4)
  v_mfma_f32_16x16x32_bf16 v[56:59], a[36:39], v[32:35], v[56:59]
  v_mfma_f32_16x16x32_bf16 v[60:63], a[36:39], v[36:39], v[60:63]
  v_mfma_f32_16x16x32_bf16 v[64:67], a[116:119], v[32:35], v[64:67]
  v_mfma_f32_16x16x32_bf16 v[68:71], a[116:119], v[36:39], v[68:71]
  v_mfma_f32_16x16x32_bf16 v[72:75], a[196:199], v[32:35], v[72:75]
  v_mfma_f32_16x16x32_bf16 v[76:79], a[196:199], v[36:39], v[76:79]
  ds_read_b128 v[32:35], v12 offset:768
  ds_read_b128 v[36:39], v12 offset:21248
  s_waitcnt lgkmcnt(4)
  v_mfma_f32_16x16x32_bf16 v[56:59], a[40:43], v[40:43], v[56:59]
  v_mfma_f32_16x16x32_bf16 v[60:63], a[40:43], v[44:47], v[60:63]
  v_mfma_f32_16x16x32_bf16 v[64:67], a[120:123], v[40:43], v[64:67]
  v_mfma_f32_16x16x32_bf16 v[68:71], a[120:123], v[44:47], v[68:71]
  v_mfma_f32_16x16x32_bf16 v[72:75], a[200:203], v[40:43], v[72:75]
  v_mfma_f32_16x16x32_bf16 v[76:79], a[200:203], v[44:47], v[76:79]
  ds_read_b128 v[40:43], v13 offset:768
  ds_read_b128 v[44:47], v13 offset:21248
  s_waitcnt lgkmcnt(4)
  v_mfma_f32_16x16x32_bf16 v[56:59], a[44:47], v[48:51], v[56:59]
  v_mfma_f32_16x16x32_bf16 v[60:63], a[44:47], v[52:55], v[60:63]
  v_mfma_f32_16x16x32_bf16 v[64:67], a[124:127], v[48:51], v[64:67]
  v_mfma_f32_16x16x32_bf16 v[68:71], a[124:127], v[52:55], v[68:71]
  v_mfma_f32_16x16x32_bf16 v[72:75], a[204:207], v[48:51], v[72:75]
  v_mfma_f32_16x16x32_bf16 v[76:79], a[204:207], v[52:55], v[76:79]
  ds_read_b128 v[48:51], v14 offset:768
  ds_read_b128 v[52:55], v14 offset:21248
  s_waitcnt lgkmcnt(4)
  v_mfma_f32_16x16x32_bf16 v[56:59], a[48:51], v[32:35], v[56:59]
  v_mfma_f32_16x16x32_bf16 v[60:63], a[48:51], v[36:39], v[60:63]
  v_mfma_f32_16x16x32_bf16 v[64:67], a[128:131], v[32:35], v[64:67]
  v_mfma_f32_16x16x32_bf16 v[68:71], a[128:131], v[36:39], v[68:71]
  v_mfma_f32_16x16x32_bf16 v[72:75], a[208:211], v[32:35], v[72:75]
  v_mfma_f32_16x16x32_bf16 v[76:79], a[208:211], v[36:39], v[76:79]
  ds_read_b128 v[32:35], v15 offset:768
  ds_read_b128 v[36:39], v15 offset:21248
  s_waitcnt lgkmcnt(4)
  v_mfma_f32_16x16x32_bf16 v[56:59], a[52:55], v[40:43], v[56:59]
  v_mfma_f32_16x16x32_bf16 v[60:63], a[52:55], v[44:47], v[60:63]
  v_mfma_f32_16x16x32_bf16 v[64:67], a[132:135], v[40:43], v[64:67]
  v_mfma_f32_16x16x32_bf16 v[68:71], a[132:135], v[44:47], v[68:71]
  v_mfma_f32_16x16x32_bf16 v[72:75], a[212:215], v[40:43], v[72:75]
  v_mfma_f32_16x16x32_bf16 v[76:79], a[212:215], v[44:47], v[76:79]
  ds_read_b128 v[40:43], v12 offset:1024
  ds_read_b128 v[44:47], v12 offset:21504
  s_waitcnt lgkmcnt(4)
  v_mfma_f32_16x16x32_bf16 v[56:59], a[56:59], v[48:51], v[56:59]
  v_mfma_f32_16x16x32_bf16 v[60:63], a[56:59], v[52:55], v[60:63]
  v_mfma_f32_16x16x32_bf16 v[64:67], a[136:139], v[48:51], v[64:67]
  v_mfma_f32_16x16x32_bf16 v[68:71], a[136:139], v[52:55], v[68:71]
  v_mfma_f32_16x16x32_bf16 v[72:75], a[216:219], v[48:51], v[72:75]
  v_mfma_f32_16x16x32_bf16 v[76:79], a[216:219], v[52:55], v[76:79]
  ds_read_b128 v[48:51], v13 offset:1024
  ds_read_b128 v[52:55], v13 offset:21504
  s_waitcnt lgkmcnt(4)
  v_mfma_f32_16x16x32_bf16 v[56:59], a[60:63], v[32:35], v[56:59]
  v_mfma_f32_16x16x32_bf16 v[60:63], a[60:63], v[36:39], v[60:63]
  v_mfma_f32_16x16x32_bf16 v[64:67], a[140:143], v[32:35], v[64:67]
  v_mfma_f32_16x16x32_bf16 v[68:71], a[140:143], v[36:39], v[68:71]
  v_mfma_f32_16x16x32_bf16 v[72:75], a[220:223], v[32:35], v[72:75]
  v_mfma_f32_16x16x32_bf16 v[76:79], a[220:223], v[36:39], v[76:79]
  ds_read_b128 v[32:35], v14 offset:1024
  ds_read_b128 v[36:39], v14 offset:21504
  s_waitcnt lgkmcnt(4)
  v_mfma_f32_16x16x32_bf16 v[56:59], a[64:67], v[40:43], v[56:59]
  v_mfma_f32_16x16x32_bf16 v[60:63], a[64:67], v[44:47], v[60:63]
  v_mfma_f32_16x16x32_bf16 v[64:67], a[144:147], v[40:43], v[64:67]
  v_mfma_f32_16x16x32_bf16 v[68:71], a[144:147], v[44:47], v[68:71]
  v_mfma_f32_16x16x32_bf16 v[72:75], a[224:227], v[40:43], v[72:75]
  v_mfma_f32_16x16x32_bf16 v[76:79], a[224:227], v[44:47], v[76:79]
  ds_read_b128 v[40:43], v15 offset:1024
  ds_read_b128 v[44:47], v15 offset:21504
  s_waitcnt lgkmcnt(4)
  v_mfma_f32_16x16x32_bf16 v[56:59], a[68:71], v[48:51], v[56:59]
  v_mfma_f32_16x16x32_bf16 v[60:63], a[68:71], v[52:55], v[60:63]
  v_mfma_f32_16x16x32_bf16 v[64:67], a[148:151], v[48:51], v[64:67]
  v_mfma_f32_16x16x32_bf16 v[68:71], a[148:151], v[52:55], v[68:71]
  v_mfma_f32_16x16x32_bf16 v[72:75], a[228:231], v[48:51], v[72:75]
  v_mfma_f32_16x16x32_bf16 v[76:79], a[228:231], v[52:55], v[76:79]
  s_waitcnt lgkmcnt(2)
  v_mfma_f32_16x16x32_bf16 v[56:59], a[72:75], v[32:35], v[56:59]
  v_mfma_f32_16x16x32_bf16 v[60:63], a[72:75], v[36:39], v[60:63]
  v_mfma_f32_16x16x32_bf16 v[64:67], a[152:155], v[32:35], v[64:67]
  v_mfma_f32_16x16x32_bf16 v[68:71], a[152:155], v[36:39], v[68:71]
  v_mfma_f32_16x16x32_bf16 v[72:75], a[232:235], v[32:35], v[72:75]
  v_mfma_f32_16x16x32_bf16 v[76:79], a[232:235], v[36:39], v[76:79]
  s_waitcnt lgkmcnt(0)
  v_mfma_f32_16x16x32_bf16 v[56:59], a[76:79], v[40:43], v[56:59]
  v_mfma_f32_16x16x32_bf16 v[60:63], a[76:79], v[44:47], v[60:63]
  v_mfma_f32_16x16x32_bf16 v[64:67], a[156:159], v[40:43], v[64:67]
  v_mfma_f32_16x16x32_bf16 v[68:71], a[156:159], v[44:47], v[68:71]
  v_mfma_f32_16x16x32_bf16 v[72:75], a[236:239], v[40:43], v[72:75]
  v_mfma_f32_16x16x32_bf16 v[76:79], a[236:239], v[44:47], v[76:79]
  s_add_u32 s34, s34, 40960
  s_nop 1
  v_cvt_pk_bf16_f32 v80, v56, v57
  v_cvt_pk_bf16_f32 v81, v58, v59
  v_cvt_pk_bf16_f32 v82, v60, v61
  v_cvt_pk_bf16_f32 v83, v62, v63
  ds_write_b128 v18, v[80:83] offset:0
  v_cvt_pk_bf16_f32 v84, v64, v65
  v_cvt_pk_bf16_f32 v85, v66, v67
  v_cvt_pk_bf16_f32 v86, v68, v69
  v_cvt_pk_bf16_f32 v87, v70, v71
  ds_write_b128 v18, v[84:87] offset:1024
  v_cvt_pk_bf16_f32 v88, v72, v73
  v_cvt_pk_bf16_f32 v89, v74, v75
  v_cvt_pk_bf16_f32 v90, v76, v77
  v_cvt_pk_bf16_f32 v91, v78, v79
  ds_write_b128 v18, v[88:91] offset:2048
  s_waitcnt vmcnt(0) lgkmcnt(0)
  s_barrier
L_q_loop:
  ds_read_b128 v[32:35], v12 offset:40960
  ds_read_b128 v[36:39], v12 offset:61440
  ds_read_b128 v[40:43], v13 offset:40960
  ds_read_b128 v[44:47], v13 offset:61440
  s_add_u32 s47, s33, 1
  s_cmp_ge_u32 s45, s47
  s_cbranch_scc1 L_q_kv1_e
  s_mov_b64 exec, 255
  s_mov_b32 s15, 0
L_q_kv1:
  v_mov_b32 v250, 0
  buffer_atomic_add v250, v17, s[4:7], s43 offen sc0 sc1
  s_waitcnt vmcnt(0)
  v_cmp_gt_u32 vcc, s47, v250
  s_cbranch_vccz L_q_kv1_ok
  s_sleep 2
  s_add_u32 s15, s15, 1
  s_cmp_lt_u32 s15, 262144
  s_cbranch_scc1 L_q_kv1
  s_branch L_fail
L_q_kv1_ok:
  v_readlane_b32 s45, v250, 0
  v_readlane_b32 s52, v250, 1
  s_nop 0
  s_min_u32 s45, s45, s52
  v_readlane_b32 s52, v250, 2
  s_nop 0
  s_min_u32 s45, s45, s52
  v_readlane_b32 s52, v250, 3
  s_nop 0
  s_min_u32 s45, s45, s52
  v_readlane_b32 s52, v250, 4
  s_nop 0
  s_min_u32 s45, s45, s52
  v_readlane_b32 s52, v250, 5
  s_nop 0
  s_min_u32 s45, s45, s52
  v_readlane_b32 s52, v250, 6
  s_nop 0
  s_min_u32 s45, s45, s52
  v_readlane_b32 s52, v250, 7
  s_nop 0
  s_min_u32 s45, s45, s52
  s_mov_b64 exec, -1
L_q_kv1_e:
  ds_read_b128 v[48:51], v14 offset:40960
  ds_read_b128 v[52:55], v14 offset:61440
  s_waitcnt lgkmcnt(4)
  v_mfma_f32_16x16x32_bf16 v[56:59], a[0:3], v[32:35], 0
  v_mfma_f32_16x16x32_bf16 v[60:63], a[0:3], v[36:39], 0
  s_mov_b64 exec, 7
  v_mov_b32 v26, 0
  buffer_atomic_add v26, v17, s[4:7], s44 offen sc0 sc1
  s_mov_b64 exec, -1
  v_mfma_f32_16x16x32_bf16 v[64:67], a[80:83], v[32:35], 0
  v_mfma_f32_16x16x32_bf16 v[68:71], a[80:83], v[36:39], 0
  v_mfma_f32_16x16x32_bf16 v[72:75], a[160:163], v[32:35], 0
  v_mfma_f32_16x16x32_bf16 v[76:79], a[160:163], v[36:39], 0
  s_add_u32 m0, s48, 0
  s_nop 0
  buffer_load_dwordx4 v16, s[4:7], s37 offen offset:0 sc1 lds
  ds_read_b128 v[32:35], v15 offset:40960
  ds_read_b128 v[36:39], v15 offset:61440
  s_waitcnt lgkmcnt(4)
  v_mfma_f32_16x16x32_bf16 v[56:59], a[4:7], v[40:43], v[56:59]
  v_mfma_f32_16x16x32_bf16 v[60:63], a[4:7], v[44:47], v[60:63]
  buffer_load_dwordx4 v16, s[4:7], s37 offen offset:1024 sc1 lds
  v_mfma_f32_16x16x32_bf16 v[64:67], a[84:87], v[40:43], v[64:67]
  v_mfma_f32_16x16x32_bf16 v[68:71], a[84:87], v[44:47], v[68:71]
  v_mfma_f32_16x16x32_bf16 v[72:75], a[164:167], v[40:43], v[72:75]
  v_mfma_f32_16x16x32_bf16 v[76:79], a[164:167], v[44:47], v[76:79]
  buffer_load_dwordx4 v16, s[4:7], s37 offen offset:2048 sc1 lds
  ds_read_b128 v[40:43], v12 offset:41216
  ds_read_b128 v[44:47], v12 offset:61696
  s_waitcnt lgkmcnt(4)
  v_mfma_f32_16x16x32_bf16 v[56:59], a[8:11], v[48:51], v[56:59]
  v_mfma_f32_16x16x32_bf16 v[60:63], a[8:11], v[52:55], v[60:63]
  s_add_u32 m0, s35, 0
  s_nop 0
  buffer_load_dwordx4 v2, s[20:23], s34 offen lds
  v_mfma_f32_16x16x32_bf16 v[64:67], a[88:91], v[48:51], v[64:67]
  v_mfma_f32_16x16x32_bf16 v[68:71], a[88:91], v[52:55], v[68:71]
  v_mfma_f32_16x16x32_bf16 v[72:75], a[168:171], v[48:51], v[72:75]
  v_mfma_f32_16x16x32_bf16 v[76:79], a[168:171], v[52:55], v[76:79]
  ds_read_b128 v[48:51], v13 offset:41216
  ds_read_b128 v[52:55], v13 offset:61696
  s_waitcnt lgkmcnt(4)
  v_mfma_f32_16x16x32_bf16 v[56:59], a[12:15], v[32:35], v[56:59]
  v_mfma_f32_16x16x32_bf16 v[60:63], a[12:15], v[36:39], v[60:63]
  s_add_u32 m0, s35, 1024
  s_nop 0
  buffer_load_dwordx4 v3, s[20:23], s34 offen lds
  v_mfma_f32_16x16x32_bf16 v[64:67], a[92:95], v[32:35], v[64:67]
  v_mfma_f32_16x16x32_bf16 v[68:71], a[92:95], v[36:39], v[68:71]
  v_mfma_f32_16x16x32_bf16 v[72:75], a[172:175], v[32:35], v[72:75]
  v_mfma_f32_16x16x32_bf16 v[76:79], a[172:175], v[36:39], v[76:79]
  ds_read_b128 v[32:35], v14 offset:41216
  ds_read_b128 v[36:39], v14 offset:61696
  s_waitcnt lgkmcnt(4)
  v_mfma_f32_16x16x32_bf16 v[56:59], a[16:19], v[40:43], v[56:59]
  v_mfma_f32_16x16x32_bf16 v[60:63], a[16:19], v[44:47], v[60:63]
  s_add_u32 m0, s35, 2048
  s_nop 0
  buffer_load_dwordx4 v4, s[20:23], s34 offen lds
  v_mfma_f32_16x16x32_bf16 v[64:67], a[96:99], v[40:43], v[64:67]
  v_mfma_f32_16x16x32_bf16 v[68:71], a[96:99], v[44:47], v[68:71]
  v_mfma_f32_16x16x32_bf16 v[72:75], a[176:179], v[40:43], v[72:75]
  v_mfma_f32_16x16x32_bf16 v[76:79], a[176:179], v[44:47], v[76:79]
  ds_read_b128 v[40:43], v15 offset:41216
  ds_read_b128 v[44:47], v15 offset:61696
  s_waitcnt lgkmcnt(4)
  v_mfma_f32_16x16x32_bf16 v[56:59], a[20:23], v[48:51], v[56:59]
  v_mfma_f32_16x16x32_bf16 v[60:63], a[20:23], v[52:55], v[60:63]
  s_add_u32 m0, s35, 3072
  s_nop 0
  buffer_load_dwordx4 v5, s[20:23], s34 offen lds
  v_mfma_f32_16x16x32_bf16 v[64:67], a[100:103], v[48:51], v[64:67]
  v_mfma_f32_16x16x32_bf16 v[68:71], a[100:103], v[52:55], v[68:71]
  v_mfma_f32_16x16x32_bf16 v[72:75], a[180:183], v[48:51], v[72:75]
  v_mfma_f32_16x16x32_bf16 v[76:79], a[180:183], v[52:55], v[76:79]
  ds_read_b128 v[48:51], v12 offset:41472
  ds_read_b128 v[52:55], v12 offset:61952
  s_waitcnt lgkmcnt(4)
  v_mfma_f32_16x16x32_bf16 v[56:59], a[24:27], v[32:35], v[56:59]
  v_mfma_f32_16x16x32_bf16 v[60:63], a[24:27], v[36:39], v[60:63]
  s_add_u32 m0, s35, 4096
  s_nop 0
  buffer_load_dwordx4 v6, s[20:23], s34 offen lds
  v_mfma_f32_16x16x32_bf16 v[64:67], a[104:107], v[32:35], v[64:67]
  v_mfma_f32_16x16x32_bf16 v[68:71], a[104:107], v[36:39], v[68:71]
  v_mfma_f32_16x16x32_bf16 v[72:75], a[184:187], v[32:35], v[72:75]
  v_mfma_f32_16x16x32_bf16 v[76:79], a[184:187], v[36:39], v[76:79]
  ds_read_b128 v[32:35], v13 offset:41472
  ds_read_b128 v[36:39], v13 offset:61952
  s_waitcnt lgkmcnt(4)
  v_mfma_f32_16x16x32_bf16 v[56:59], a[28:31], v[40:43], v[56:59]
  v_mfma_f32_16x16x32_bf16 v[60:63], a[28:31], v[44:47], v[60:63]
  s_add_u32 m0, s35, 5120
  s_nop 0
  buffer_load_dwordx4 v7, s[20:23], s34 offen lds
  v_mfma_f32_16x16x32_bf16 v[64:67], a[108:111], v[40:43], v[64:67]
  v_mfma_f32_16x16x32_bf16 v[68:71], a[108:111], v[44:47], v[68:71]
  v_mfma_f32_16x16x32_bf16 v[72:75], a[188:191], v[40:43], v[72:75]
  v_mfma_f32_16x16x32_bf16 v[76:79], a[188:191], v[44:47], v[76:79]
  ds_read_b128 v[40:43], v14 offset:41472
  ds_read_b128 v[44:47], v14 offset:61952
  s_waitcnt lgkmcnt(4)
  v_mfma_f32_16x16x32_bf16 v[56:59], a[32:35], v[48:51], v[56:59]
  v_mfma_f32_16x16x32_bf16 v[60:63], a[32:35], v[52:55], v[60:63]
  s_add_u32 m0, s35, 6144
  s_nop 0
  buffer_load_dwordx4 v8, s[20:23], s34 offen lds
  v_mfma_f32_16x16x32_bf16 v[64:67], a[112:115], v[48:51], v[64:67]
  v_mfma_f32_16x16x32_bf16 v[68:71], a[112:115], v[52:55], v[68:71]
  v_mfma_f32_16x16x32_bf16 v[72:75], a[192:195], v[48:51], v[72:75]
  v_mfma_f32_16x16x32_bf16 v[76:79], a[192:195], v[52:55], v[76:79]
  s_waitcnt vmcnt(7)
  v_mov_b32 v250, s33
  s_mov_b64 exec, 1
  buffer_store_dword v250, v24, s[4:7], s42 offen sc1
  s_mov_b64 exec, -1
  v_readlane_b32 s52, v26, 0
  v_readlane_b32 s53, v26, 1
  v_readlane_b32 s54, v26, 2
  s_barrier
  s_min_u32 s52, s52, s53
  s_min_u32 s46, s52, s54
  s_cmp_ge_u32 s46, s47
  s_cselect_b32 s51, 1, 0
  s_cbranch_scc0 L_q_late1
  s_mov_b32 m0, s49
  s_nop 0
  buffer_load_dwordx4 v16, s[4:7], s39 offen sc1 lds
  s_add_u32 m0, s49, 3072
  s_add_u32 s39, s39, 98304
  buffer_load_dwordx4 v16, s[4:7], s40 offen sc1 lds
  s_add_u32 s40, s40, 98304
L_q_late1:
  ds_read_b128 v[48:51], v15 offset:41472
  ds_read_b128 v[52:55], v15 offset:61952
  s_waitcnt lgkmcnt(4)
  v_mfma_f32_16x16x32_bf16 v[56:59], a[36:39], v[32:35], v[56:59]
  v_mfma_f32_16x16x32_bf16 v[60:63], a[36:39], v[36:39], v[60:63]
  s_add_u32 m0, s48, 12288
  s_nop 0
  buffer_load_dwordx4 v16, s[4:7], s38 offen offset:0 sc1 lds
  v_mfma_f32_16x16x32_bf16 v[64:67], a[116:119], v[32:35], v[64:67]
  ds_read_b64 v[92:93], v19 offset:0
  v_mfma_f32_16x16x32_bf16 v[68:71], a[116:119], v[36:39], v[68:71]
  ds_read_b64 v[94:95], v19 offset:1024
  v_mfma_f32_16x16x32_bf16 v[72:75], a[196:199], v[32:35], v[72:75]
  ds_read_b64 v[96:97], v19 offset:2048
  v_mfma_f32_16x16x32_bf16 v[76:79], a[196:199], v[36:39], v[76:79]
  ds_read_b64 v[98:99], v19 offset:3072
  ds_read_b128 v[32:35], v12 offset:41728
  ds_read_b128 v[36:39], v12 offset:62208
  s_waitcnt lgkmcnt(8)
  v_mfma_f32_16x16x32_bf16 v[56:59], a[40:43], v[40:43], v[56:59]
  v_mfma_f32_16x16x32_bf16 v[60:63], a[40:43], v[44:47], v[60:63]
  buffer_load_dwordx4 v16, s[4:7], s38 offen offset:1024 sc1 lds
  v_mfma_f32_16x16x32_bf16 v[64:67], a[120:123], v[40:43], v[64:67]
  ds_read_b64 v[100:101], v19 offset:4096
  v_mfma_f32_16x16x32_bf16 v[68:71], a[120:123], v[44:47], v[68:71]
  ds_read_b64 v[102:103], v19 offset:5120
  v_mfma_f32_16x16x32_bf16 v[72:75], a[200:203], v[40:43], v[72:75]
  ds_read_b64 v[104:105], v19 offset:6144
  v_mfma_f32_16x16x32_bf16 v[76:79], a[200:203], v[44:47], v[76:79]
  ds_read_b64 v[106:107], v19 offset:7168
  ds_read_b128 v[40:43], v13 offset:41728
  ds_read_b128 v[44:47], v13 offset:62208
  s_waitcnt lgkmcnt(9)
  v_mfma_f32_16x16x32_bf16 v[56:59], a[44:47], v[48:51], v[56:59]
  v_mfma_f32_16x16x32_bf16 v[60:63], a[44:47], v[52:55], v[60:63]
  buffer_load_dwordx4 v16, s[4:7], s38 offen offset:2048 sc1 lds
  v_mfma_f32_16x16x32_bf16 v[64:67], a[124:127], v[48:51], v[64:67]
  ds_read_b64 v[108:109], v19 offset:8192
  v_mfma_f32_16x16x32_bf16 v[68:71], a[124:127], v[52:55], v[68:71]
  ds_read_b64 v[110:111], v19 offset:9216
  v_mfma_f32_16x16x32_bf16 v[72:75], a[204:207], v[48:51], v[72:75]
  ds_read_b64 v[112:113], v19 offset:10240
  v_mfma_f32_16x16x32_bf16 v[76:79], a[204:207], v[52:55], v[76:79]
  ds_read_b64 v[114:115], v19 offset:11264
  ds_read_b128 v[48:51], v14 offset:41728
  ds_read_b128 v[52:55], v14 offset:62208
  s_waitcnt lgkmcnt(9)
  v_mfma_f32_16x16x32_bf16 v[56:59], a[48:51], v[32:35], v[56:59]
  v_mfma_f32_16x16x32_bf16 v[60:63], a[48:51], v[36:39], v[60:63]
  s_add_u32 m0, s35, 7168
  s_nop 0
  buffer_load_dwordx4 v9, s[20:23], s34 offen lds
  v_mfma_f32_16x16x32_bf16 v[64:67], a[128:131], v[32:35], v[64:67]
  ds_read_b64 v[116:117], v20 offset:0
  v_mfma_f32_16x16x32_bf16 v[68:71], a[128:131], v[36:39], v[68:71]
  ds_read_b64 v[118:119], v20 offset:1024
  v_mfma_f32_16x16x32_bf16 v[72:75], a[208:211], v[32:35], v[72:75]
  ds_read_b64 v[120:121], v20 offset:2048
  v_mfma_f32_16x16x32_bf16 v[76:79], a[208:211], v[36:39], v[76:79]
  ds_read_b64 v[122:123], v20 offset:3072
  ds_read_b128 v[32:35], v15 offset:41728
  ds_read_b128 v[36:39], v15 offset:62208
  s_waitcnt lgkmcnt(9)
  v_mfma_f32_16x16x32_bf16 v[56:59], a[52:55], v[40:43], v[56:59]
  v_mfma_f32_16x16x32_bf16 v[60:63], a[52:55], v[44:47], v[60:63]
  s_add_u32 m0, s35, 8192
  s_nop 0
  buffer_load_dwordx4 v10, s[20:23], s34 offen lds
  v_mfma_f32_16x16x32_bf16 v[64:67], a[132:135], v[40:43], v[64:67]
  ds_read_b64 v[124:125], v20 offset:4096
  v_mfma_f32_16x16x32_bf16 v[68:71], a[132:135], v[44:47], v[68:71]
  ds_read_b64 v[126:127], v20 offset:5120
  v_mfma_f32_16x16x32_bf16 v[72:75], a[212:215], v[40:43], v[72:75]
  ds_read_b64 v[128:129], v20 offset:6144
  v_mfma_f32_16x16x32_bf16 v[76:79], a[212:215], v[44:47], v[76:79]
  ds_read_b64 v[130:131], v20 offset:7168
  ds_read_b128 v[40:43], v12 offset:41984
  ds_read_b128 v[44:47], v12 offset:62464
  s_waitcnt lgkmcnt(9)
  v_mfma_f32_16x16x32_bf16 v[56:59], a[56:59], v[48:51], v[56:59]
  v_mfma_f32_16x16x32_bf16 v[60:63], a[56:59], v[52:55], v[60:63]
  s_add_u32 m0, s35, 9216
  s_nop 0
  buffer_load_dwordx4 v11, s[20:23], s34 offen lds
  v_mfma_f32_16x16x32_bf16 v[64:67], a[136:139], v[48:51], v[64:67]
  ds_read_b64 v[132:133], v20 offset:8192
  v_mfma_f32_16x16x32_bf16 v[68:71], a[136:139], v[52:55], v[68:71]
  ds_read_b64 v[134:135], v20 offset:9216
  v_mfma_f32_16x16x32_bf16 v[72:75], a[216:219], v[48:51], v[72:75]
  ds_read_b64 v[136:137], v20 offset:10240
  v_mfma_f32_16x16x32_bf16 v[76:79], a[216:219], v[52:55], v[76:79]
  ds_read_b64 v[138:139], v20 offset:11264
  ds_read_b128 v[48:51], v13 offset:41984
  ds_read_b128 v[52:55], v13 offset:62464
  s_waitcnt lgkmcnt(9)
  v_mfma_f32_16x16x32_bf16 v[56:59], a[60:63], v[32:35], v[56:59]
  v_mfma_f32_16x16x32_bf16 v[60:63], a[60:63], v[36:39], v[60:63]
  v_mfma_f32_16x16x32_bf16 v[64:67], a[140:143], v[32:35], v[64:67]
  ds_read_b64 v[140:141], v20 offset:8
  v_mfma_f32_16x16x32_bf16 v[68:71], a[140:143], v[36:39], v[68:71]
  ds_read_b64 v[142:143], v20 offset:1032
  v_mfma_f32_16x16x32_bf16 v[72:75], a[220:223], v[32:35], v[72:75]
  ds_read_b64 v[144:145], v20 offset:2056
  v_mfma_f32_16x16x32_bf16 v[76:79], a[220:223], v[36:39], v[76:79]
  ds_read_b64 v[146:147], v20 offset:3080
  ds_read_b128 v[32:35], v14 offset:41984
  ds_read_b128 v[36:39], v14 offset:62464
  s_waitcnt lgkmcnt(9)
  v_mfma_f32_16x16x32_bf16 v[56:59], a[64:67], v[40:43], v[56:59]
  v_mfma_f32_16x16x32_bf16 v[60:63], a[64:67], v[44:47], v[60:63]
  v_mfma_f32_16x16x32_bf16 v[64:67], a[144:147], v[40:43], v[64:67]
  ds_read_b64 v[148:149], v20 offset:4104
  v_mfma_f32_16x16x32_bf16 v[68:71], a[144:147], v[44:47], v[68:71]
  ds_read_b64 v[150:151], v20 offset:5128
  v_mfma_f32_16x16x32_bf16 v[72:75], a[224:227], v[40:43], v[72:75]
  ds_read_b64 v[152:153], v20 offset:6152
  v_mfma_f32_16x16x32_bf16 v[76:79], a[224:227], v[44:47], v[76:79]
  ds_read_b64 v[154:155], v20 offset:7176
  ds_read_b128 v[40:43], v15 offset:41984
  ds_read_b128 v[44:47], v15 offset:62464
  s_waitcnt lgkmcnt(9)
  v_mfma_f32_16x16x32_bf16 v[56:59], a[68:71], v[48:51], v[56:59]
  v_mfma_f32_16x16x32_bf16 v[60:63], a[68:71], v[52:55], v[60:63]
  v_mfma_f32_16x16x32_bf16 v[64:67], a[148:151], v[48:51], v[64:67]
  ds_read_b64 v[156:157], v20 offset:8200
  v_mfma_f32_16x16x32_bf16 v[68:71], a[148:151], v[52:55], v[68:71]
  ds_read_b64 v[158:159], v20 offset:9224
  v_mfma_f32_16x16x32_bf16 v[72:75], a[228:231], v[48:51], v[72:75]
  ds_read_b64 v[160:161], v20 offset:10248
  v_mfma_f32_16x16x32_bf16 v[76:79], a[228:231], v[52:55], v[76:79]
  ds_read_b64 v[162:163], v20 offset:11272
  s_waitcnt lgkmcnt(9)
  v_mfma_f32_16x16x32_bf16 v[56:59], a[72:75], v[32:35], v[56:59]
  v_mfma_f32_16x16x32_bf16 v[60:63], a[72:75], v[36:39], v[60:63]
  v_mfma_f32_16x16x32_bf16 v[64:67], a[152:155], v[32:35], v[64:67]
  v_mfma_f32_16x16x32_bf16 v[68:71], a[152:155], v[36:39], v[68:71]
  v_mfma_f32_16x16x32_bf16 v[72:75], a[232:235], v[32:35], v[72:75]
  v_mfma_f32_16x16x32_bf16 v[76:79], a[232:235], v[36:39], v[76:79]
  s_waitcnt lgkmcnt(4)
  v_mfma_f32_16x16x32_bf16 v[56:59], a[76:79], v[40:43], v[56:59]
  v_mfma_f32_16x16x32_bf16 v[60:63], a[76:79], v[44:47], v[60:63]
  v_mfma_f32_16x16x32_bf16 v[64:67], a[156:159], v[40:43], v[64:67]
  v_mfma_f32_16x16x32_bf16 v[68:71], a[156:159], v[44:47], v[68:71]
  v_mfma_f32_16x16x32_bf16 v[72:75], a[236:239], v[40:43], v[72:75]
  v_mfma_f32_16x16x32_bf16 v[76:79], a[236:239], v[44:47], v[76:79]
  s_add_u32 s34, s34, 40960
  s_add_u32 s37, s37, 393216
  s_add_u32 s38, s38, 393216
  s_waitcnt lgkmcnt(0)
  v_mfma_f32_16x16x32_bf16 v[238:241], v[116:119], v[92:95], 0
  v_mfma_f32_16x16x32_bf16 v[242:245], v[140:143], v[92:95], 0
  v_mfma_f32_16x16x32_bf16 v[238:241], v[120:123], v[96:99], v[238:241]
  v_mfma_f32_16x16x32_bf16 v[242:245], v[144:147], v[96:99], v[242:245]
  v_cvt_pk_bf16_f32 v80, v56, v57
  v_cvt_pk_bf16_f32 v81, v58, v59
  v_mfma_f32_16x16x32_bf16 v[238:241], v[124:127], v[100:103], v[238:241]
  v_cvt_pk_bf16_f32 v82, v60, v61
  v_cvt_pk_bf16_f32 v83, v62, v63
  v_mfma_f32_16x16x32_bf16 v[242:245], v[148:151], v[100:103], v[242:245]
  ds_write_b128 v18, v[80:83] offset:12288
  v_cvt_pk_bf16_f32 v84, v64, v65
  v_mfma_f32_16x16x32_bf16 v[238:241], v[128:131], v[104:107], v[238:241]
  v_cvt_pk_bf16_f32 v85, v66, v67
  v_cvt_pk_bf16_f32 v86, v68, v69
  v_mfma_f32_16x16x32_bf16 v[242:245], v[152:155], v[104:107], v[242:245]
  v_cvt_pk_bf16_f32 v87, v70, v71
  ds_write_b128 v18, v[84:87] offset:13312
  v_mfma_f32_16x16x32_bf16 v[238:241], v[132:135], v[108:111], v[238:241]
  v_cvt_pk_bf16_f32 v88, v72, v73
  v_cvt_pk_bf16_f32 v89, v74, v75
  v_mfma_f32_16x16x32_bf16 v[242:245], v[156:159], v[108:111], v[242:245]
  v_cvt_pk_bf16_f32 v90, v76, v77
  v_cvt_pk_bf16_f32 v91, v78, v79
  v_mfma_f32_16x16x32_bf16 v[238:241], v[136:139], v[112:115], v[238:241]
  ds_write_b128 v18, v[88:91] offset:14336
  v_mfma_f32_16x16x32_bf16 v[242:245], v[160:163], v[112:115], v[242:245]
  s_cmp_lg_u32 s51, 0
  s_cbranch_scc1 L_q_have1
  s_cmp_ge_u32 s46, s47
  s_cbranch_scc1 L_q_ch1_e
  s_mov_b64 exec, 7
  s_mov_b32 s15, 0
L_q_ch1:
  v_mov_b32 v250, 0
  buffer_atomic_add v250, v17, s[4:7], s44 offen sc0 sc1
  s_waitcnt vmcnt(0)
  v_cmp_gt_u32 vcc, s47, v250
  s_cbranch_vccz L_q_ch1_ok
  s_sleep 2
  s_add_u32 s15, s15, 1
  s_cmp_lt_u32 s15, 262144
  s_cbranch_scc1 L_q_ch1
  s_branch L_fail
L_q_ch1_ok:
  v_readlane_b32 s46, v250, 0
  v_readlane_b32 s52, v250, 1
  s_nop 0
  s_min_u32 s46, s46, s52
  v_readlane_b32 s52, v250, 2
  s_nop 0
  s_min_u32 s46, s46, s52
  s_mov_b64 exec, -1
L_q_ch1_e:
  s_mov_b32 m0, s49
  s_nop 0
  buffer_load_dwordx4 v16, s[4:7], s39 offen sc1 lds
  s_add_u32 m0, s49, 3072
  s_add_u32 s39, s39, 98304
  buffer_load_dwordx4 v16, s[4:7], s40 offen sc1 lds
  s_add_u32 s40, s40, 98304
L_q_have1:
  s_waitcnt vmcnt(0) lgkmcnt(0)
  s_barrier
  ds_read_b128 v[164:167], v21 offset:0
  ds_read_b128 v[168:171], v21 offset:512
  ds_read_b128 v[172:175], v21 offset:1024
  ds_read_b128 v[176:179], v21 offset:1536
  ds_read_b128 v[180:183], v21 offset:2048
  ds_read_b128 v[184:187], v21 offset:2560
  s_waitcnt lgkmcnt(5)
  v_mfma_f32_16x16x32_bf16 v[234:237], v[164:167], v[92:95], 0
  ds_read_b128 v[188:191], v22 offset:0
  ds_read_b32 v212, v23 offset:0
  s_waitcnt lgkmcnt(6)
  v_mfma_f32_16x16x32_bf16 v[234:237], v[168:171], v[96:99], v[234:237]
  ds_read_b128 v[192:195], v22 offset:1024
  ds_read_b32 v214, v23 offset:256
  s_waitcnt lgkmcnt(7)
  v_mfma_f32_16x16x32_bf16 v[234:237], v[172:175], v[100:103], v[234:237]
  ds_read_b128 v[196:199], v22 offset:2048
  ds_read_b32 v216, v23 offset:512
  s_waitcnt lgkmcnt(8)
  v_mfma_f32_16x16x32_bf16 v[234:237], v[176:179], v[104:107], v[234:237]
  ds_read_b128 v[200:203], v22 offset:3072
  ds_read_b32 v218, v23 offset:768
  s_waitcnt lgkmcnt(9)
  v_mfma_f32_16x16x32_bf16 v[234:237], v[180:183], v[108:111], v[234:237]
  ds_read_b128 v[204:207], v22 offset:4096
  ds_read_b32 v220, v23 offset:1024
  s_waitcnt lgkmcnt(10)
  v_mfma_f32_16x16x32_bf16 v[234:237], v[184:187], v[112:115], v[234:237]
  ds_read_b128 v[208:211], v22 offset:5120
  ds_read_b32 v222, v23 offset:1280
  v_cndmask_b32 v238, v25, v238, s[56:57]
  v_cndmask_b32 v239, v25, v239, s[58:59]
  v_cndmask_b32 v240, v25, v240, s[60:61]
  v_cndmask_b32 v241, v25, v241, s[62:63]
  v_cndmask_b32 v242, v25, v242, s[64:65]
  v_cndmask_b32 v243, v25, v243, s[66:67]
  v_cndmask_b32 v244, v25, v244, s[68:69]
  v_cndmask_b32 v245, v25, v245, s[70:71]
  v_max3_f32 v250, v238, v239, v240
  v_max3_f32 v251, v241, v242, v243
  v_max3_f32 v250, v250, v244, v245
  v_max3_f32 v251, v251, v234, v235
  v_max_f32 v250, v250, v251
  v_mov_b32 v251, v250
  s_nop 1
  v_permlane16_swap_b32 v250, v251
  v_max_f32 v250, v250, v251
  v_mov_b32 v251, v250
  s_nop 1
  v_permlane32_swap_b32 v250, v251
  v_max_f32 v250, v250, v251
  v_mul_f32 v250, s50, v250
  v_fma_f32 v234, v234, s50, -v250
  v_fma_f32 v235, v235, s50, -v250
  v_fma_f32 v238, v238, s50, -v250
  v_fma_f32 v239, v239, s50, -v250
  v_fma_f32 v240, v240, s50, -v250
  v_fma_f32 v241, v241, s50, -v250
  v_fma_f32 v242, v242, s50, -v250
  v_fma_f32 v243, v243, s50, -v250
  v_fma_f32 v244, v244, s50, -v250
  v_fma_f32 v245, v245, s50, -v250
  v_exp_f32 v234, v234
  v_exp_f32 v235, v235
  v_exp_f32 v238, v238
  v_exp_f32 v239, v239
  v_exp_f32 v240, v240
  v_exp_f32 v241, v241
  v_exp_f32 v242, v242
  v_exp_f32 v243, v243
  v_exp_f32 v244, v244
  v_exp_f32 v245, v245
  v_cvt_pk_bf16_f32 v226, v238, v239
  v_cvt_pk_bf16_f32 v227, v240, v241
  v_cvt_pk_bf16_f32 v228, v242, v243
  v_cvt_pk_bf16_f32 v229, v244, v245
  v_cvt_pk_bf16_f32 v230, v234, v235
  s_nop 0
  v_mfma_f32_16x16x32_bf16 v[246:249], v[28:31], v[226:229], 0
  v_mfma_f32_16x16x32_bf16 v[246:249], v[28:31], v[230:233], v[246:249]
  s_waitcnt lgkmcnt(0)
  v_mfma_f32_16x16x32_bf16 v[56:59], v[188:191], v[226:229], 0
  v_mfma_f32_16x16x32_bf16 v[60:63], v[192:195], v[226:229], 0
  v_mfma_f32_16x16x32_bf16 v[64:67], v[196:199], v[226:229], 0
  v_mfma_f32_16x16x32_bf16 v[68:71], v[200:203], v[226:229], 0
  v_mfma_f32_16x16x32_bf16 v[72:75], v[204:207], v[226:229], 0
  v_mfma_f32_16x16x32_bf16 v[76:79], v[208:211], v[226:229], 0
  v_mfma_f32_16x16x32_bf16 v[56:59], v[212:215], v[230:233], v[56:59]
  v_mfma_f32_16x16x32_bf16 v[60:63], v[214:217], v[230:233], v[60:63]
  v_mfma_f32_16x16x32_bf16 v[64:67], v[216:219], v[230:233], v[64:67]
  v_mfma_f32_16x16x32_bf16 v[68:71], v[218:221], v[230:233], v[68:71]
  v_mfma_f32_16x16x32_bf16 v[72:75], v[220:223], v[230:233], v[72:75]
  v_mfma_f32_16x16x32_bf16 v[76:79], v[222:225], v[230:233], v[76:79]
  v_rcp_f32 v250, v246
  s_nop 1
  v_mul_f32 v56, v56, v250
  v_mul_f32 v57, v57, v250
  v_mul_f32 v58, v58, v250
  v_mul_f32 v59, v59, v250
  v_mul_f32 v60, v60, v250
  v_mul_f32 v61, v61, v250
  v_mul_f32 v62, v62, v250
  v_mul_f32 v63, v63, v250
  v_cvt_pk_bf16_f32 v80, v56, v57
  v_cvt_pk_bf16_f32 v81, v58, v59
  v_cvt_pk_bf16_f32 v82, v60, v61
  v_cvt_pk_bf16_f32 v83, v62, v63
  buffer_store_dwordx4 v[80:83], v16, s[4:7], s41 offen offset:0 sc1
  v_mul_f32 v64, v64, v250
  v_mul_f32 v65, v65, v250
  v_mul_f32 v66, v66, v250
  v_mul_f32 v67, v67, v250
  v_mul_f32 v68, v68, v250
  v_mul_f32 v69, v69, v250
  v_mul_f32 v70, v70, v250
  v_mul_f32 v71, v71, v250
  v_cvt_pk_bf16_f32 v84, v64, v65
  v_cvt_pk_bf16_f32 v85, v66, v67
  v_cvt_pk_bf16_f32 v86, v68, v69
  v_cvt_pk_bf16_f32 v87, v70, v71
  buffer_store_dwordx4 v[84:87], v16, s[4:7], s41 offen offset:1024 sc1
  v_mul_f32 v72, v72, v250
  v_mul_f32 v73, v73, v250
  v_mul_f32 v74, v74, v250
  v_mul_f32 v75, v75, v250
  v_mul_f32 v76, v76, v250
  v_mul_f32 v77, v77, v250
  v_mul_f32 v78, v78, v250
  v_mul_f32 v79, v79, v250
  v_cvt_pk_bf16_f32 v88, v72, v73
  v_cvt_pk_bf16_f32 v89, v74, v75
  v_cvt_pk_bf16_f32 v90, v76, v77
  v_cvt_pk_bf16_f32 v91, v78, v79
  buffer_store_dwordx4 v[88:91], v16, s[4:7], s41 offen offset:2048 sc1
  s_add_u32 s41, s41, 393216
  s_add_u32 s33, s33, 1
  s_cmp_ge_u32 s33, 63
  s_cbranch_scc1 L_q_last
  ds_read_b128 v[32:35], v12 offset:0
  ds_read_b128 v[36:39], v12 offset:20480
  ds_read_b128 v[40:43], v13 offset:0
  ds_read_b128 v[44:47], v13 offset:20480
  s_add_u32 s47, s33, 1
  s_cmp_ge_u32 s45, s47
  s_cbranch_scc1 L_q_kv0_e
  s_mov_b64 exec, 255
  s_mov_b32 s15, 0
L_q_kv0:
  v_mov_b32 v250, 0
  buffer_atomic_add v250, v17, s[4:7], s43 offen sc0 sc1
  s_waitcnt vmcnt(0)
  v_cmp_gt_u32 vcc, s47, v250
  s_cbranch_vccz L_q_kv0_ok
  s_sleep 2
  s_add_u32 s15, s15, 1
  s_cmp_lt_u32 s15, 262144
  s_cbranch_scc1 L_q_kv0
  s_branch L_fail
L_q_kv0_ok:
  v_readlane_b32 s45, v250, 0
  v_readlane_b32 s52, v250, 1
  s_nop 0
  s_min_u32 s45, s45, s52
  v_readlane_b32 s52, v250, 2
  s_nop 0
  s_min_u32 s45, s45, s52
  v_readlane_b32 s52, v250, 3
  s_nop 0
  s_min_u32 s45, s45, s52
  v_readlane_b32 s52, v250, 4
  s_nop 0
  s_min_u32 s45, s45, s52
  v_readlane_b32 s52, v250, 5
  s_nop 0
  s_min_u32 s45, s45, s52
  v_readlane_b32 s52, v250, 6
  s_nop 0
  s_min_u32 s45, s45, s52
  v_readlane_b32 s52, v250, 7
  s_nop 0
  s_min_u32 s45, s45, s52
  s_mov_b64 exec, -1
L_q_kv0_e:
  ds_read_b128 v[48:51], v14 offset:0
  ds_read_b128 v[52:55], v14 offset:20480
  s_waitcnt lgkmcnt(4)
  v_mfma_f32_16x16x32_bf16 v[56:59], a[0:3], v[32:35], 0
  v_mfma_f32_16x16x32_bf16 v[60:63], a[0:3], v[36:39], 0
  s_mov_b64 exec, 7
  v_mov_b32 v26, 0
  buffer_atomic_add v26, v17, s[4:7], s44 offen sc0 sc1
  s_mov_b64 exec, -1
  v_mfma_f32_16x16x32_bf16 v[64:67], a[80:83], v[32:35], 0
  v_mfma_f32_16x16x32_bf16 v[68:71], a[80:83], v[36:39], 0
  v_mfma_f32_16x16x32_bf16 v[72:75], a[160:163], v[32:35], 0
  v_mfma_f32_16x16x32_bf16 v[76:79], a[160:163], v[36:39], 0
  s_add_u32 m0, s48, 0
  s_nop 0
  buffer_load_dwordx4 v16, s[4:7], s37 offen offset:0 sc1 lds
  ds_read_b128 v[32:35], v15 offset:0
  ds_read_b128 v[36:39], v15 offset:20480
  s_waitcnt lgkmcnt(4)
  v_mfma_f32_16x16x32_bf16 v[56:59], a[4:7], v[40:43], v[56:59]
  v_mfma_f32_16x16x32_bf16 v[60:63], a[4:7], v[44:47], v[60:63]
  buffer_load_dwordx4 v16, s[4:7], s37 offen offset:1024 sc1 lds
  v_mfma_f32_16x16x32_bf16 v[64:67], a[84:87], v[40:43], v[64:67]
  v_mfma_f32_16x16x32_bf16 v[68:71], a[84:87], v[44:47], v[68:71]
  v_mfma_f32_16x16x32_bf16 v[72:75], a[164:167], v[40:43], v[72:75]
  v_mfma_f32_16x16x32_bf16 v[76:79], a[164:167], v[44:47], v[76:79]
  buffer_load_dwordx4 v16, s[4:7], s37 offen offset:2048 sc1 lds
  ds_read_b128 v[40:43], v12 offset:256
  ds_read_b128 v[44:47], v12 offset:20736
  s_waitcnt lgkmcnt(4)
  v_mfma_f32_16x16x32_bf16 v[56:59], a[8:11], v[48:51], v[56:59]
  v_mfma_f32_16x16x32_bf16 v[60:63], a[8:11], v[52:55], v[60:63]
  s_add_u32 m0, s36, 0
  s_nop 0
  buffer_load_dwordx4 v2, s[20:23], s34 offen lds
  v_mfma_f32_16x16x32_bf16 v[64:67], a[88:91], v[48:51], v[64:67]
  v_mfma_f32_16x16x32_bf16 v[68:71], a[88:91], v[52:55], v[68:71]
  v_mfma_f32_16x16x32_bf16 v[72:75], a[168:171], v[48:51], v[72:75]
  v_mfma_f32_16x16x32_bf16 v[76:79], a[168:171], v[52:55], v[76:79]
  ds_read_b128 v[48:51], v13 offset:256
  ds_read_b128 v[52:55], v13 offset:20736
  s_waitcnt lgkmcnt(4)
  v_mfma_f32_16x16x32_bf16 v[56:59], a[12:15], v[32:35], v[56:59]
  v_mfma_f32_16x16x32_bf16 v[60:63], a[12:15], v[36:39], v[60:63]
  s_add_u32 m0, s36, 1024
  s_nop 0
  buffer_load_dwordx4 v3, s[20:23], s34 offen lds
  v_mfma_f32_16x16x32_bf16 v[64:67], a[92:95], v[32:35], v[64:67]
  v_mfma_f32_16x16x32_bf16 v[68:71], a[92:95], v[36:39], v[68:71]
  v_mfma_f32_16x16x32_bf16 v[72:75], a[172:175], v[32:35], v[72:75]
  v_mfma_f32_16x16x32_bf16 v[76:79], a[172:175], v[36:39], v[76:79]
  ds_read_b128 v[32:35], v14 offset:256
  ds_read_b128 v[36:39], v14 offset:20736
  s_waitcnt lgkmcnt(4)
  v_mfma_f32_16x16x32_bf16 v[56:59], a[16:19], v[40:43], v[56:59]
  v_mfma_f32_16x16x32_bf16 v[60:63], a[16:19], v[44:47], v[60:63]
  s_add_u32 m0, s36, 2048
  s_nop 0
  buffer_load_dwordx4 v4, s[20:23], s34 offen lds
  v_mfma_f32_16x16x32_bf16 v[64:67], a[96:99], v[40:43], v[64:67]
  v_mfma_f32_16x16x32_bf16 v[68:71], a[96:99], v[44:47], v[68:71]
  v_mfma_f32_16x16x32_bf16 v[72:75], a[176:179], v[40:43], v[72:75]
  v_mfma_f32_16x16x32_bf16 v[76:79], a[176:179], v[44:47], v[76:79]
  ds_read_b128 v[40:43], v15 offset:256
  ds_read_b128 v[44:47], v15 offset:20736
  s_waitcnt lgkmcnt(4)
  v_mfma_f32_16x16x32_bf16 v[56:59], a[20:23], v[48:51], v[56:59]
  v_mfma_f32_16x16x32_bf16 v[60:63], a[20:23], v[52:55], v[60:63]
  s_add_u32 m0, s36, 3072
  s_nop 0
  buffer_load_dwordx4 v5, s[20:23], s34 offen lds
  v_mfma_f32_16x16x32_bf16 v[64:67], a[100:103], v[48:51], v[64:67]
  v_mfma_f32_16x16x32_bf16 v[68:71], a[100:103], v[52:55], v[68:71]
  v_mfma_f32_16x16x32_bf16 v[72:75], a[180:183], v[48:51], v[72:75]
  v_mfma_f32_16x16x32_bf16 v[76:79], a[180:183], v[52:55], v[76:79]
  ds_read_b128 v[48:51], v12 offset:512
  ds_read_b128 v[52:55], v12 offset:20992
  s_waitcnt lgkmcnt(4)
  v_mfma_f32_16x16x32_bf16 v[56:59], a[24:27], v[32:35], v[56:59]
  v_mfma_f32_16x16x32_bf16 v[60:63], a[24:27], v[36:39], v[60:63]
  s_add_u32 m0, s36, 4096
  s_nop 0
  buffer_load_dwordx4 v6, s[20:23], s34 offen lds
  v_mfma_f32_16x16x32_bf16 v[64:67], a[104:107], v[32:35], v[64:67]
  v_mfma_f32_16x16x32_bf16 v[68:71], a[104:107], v[36:39], v[68:71]
  v_mfma_f32_16x16x32_bf16 v[72:75], a[184:187], v[32:35], v[72:75]
  v_mfma_f32_16x16x32_bf16 v[76:79], a[184:187], v[36:39], v[76:79]
  ds_read_b128 v[32:35], v13 offset:512
  ds_read_b128 v[36:39], v13 offset:20992
  s_waitcnt lgkmcnt(4)
  v_mfma_f32_16x16x32_bf16 v[56:59], a[28:31], v[40:43], v[56:59]
  v_mfma_f32_16x16x32_bf16 v[60:63], a[28:31], v[44:47], v[60:63]
  s_add_u32 m0, s36, 5120
  s_nop 0
  buffer_load_dwordx4 v7, s[20:23], s34 offen lds
  v_mfma_f32_16x16x32_bf16 v[64:67], a[108:111], v[40:43], v[64:67]
  v_mfma_f32_16x16x32_bf16 v[68:71], a[108:111], v[44:47], v[68:71]
  v_mfma_f32_16x16x32_bf16 v[72:75], a[188:191], v[40:43], v[72:75]
  v_mfma_f32_16x16x32_bf16 v[76:79], a[188:191], v[44:47], v[76:79]
  ds_read_b128 v[40:43], v14 offset:512
  ds_read_b128 v[44:47], v14 offset:20992
  s_waitcnt lgkmcnt(4)
  v_mfma_f32_16x16x32_bf16 v[56:59], a[32:35], v[48:51], v[56:59]
  v_mfma_f32_16x16x32_bf16 v[60:63], a[32:35], v[52:55], v[60:63]
  s_add_u32 m0, s36, 6144
  s_nop 0
  buffer_load_dwordx4 v8, s[20:23], s34 offen lds
  v_mfma_f32_16x16x32_bf16 v[64:67], a[112:115], v[48:51], v[64:67]
  v_mfma_f32_16x16x32_bf16 v[68:71], a[112:115], v[52:55], v[68:71]
  v_mfma_f32_16x16x32_bf16 v[72:75], a[192:195], v[48:51], v[72:75]
  v_mfma_f32_16x16x32_bf16 v[76:79], a[192:195], v[52:55], v[76:79]
  s_waitcnt vmcnt(7)
  v_mov_b32 v250, s33
  s_mov_b64 exec, 1
  buffer_store_dword v250, v24, s[4:7], s42 offen sc1
  s_mov_b64 exec, -1
  v_readlane_b32 s52, v26, 0
  v_readlane_b32 s53, v26, 1
  v_readlane_b32 s54, v26, 2
  s_barrier
  s_min_u32 s52, s52, s53
  s_min_u32 s46, s52, s54
  s_cmp_ge_u32 s46, s47
  s_cselect_b32 s51, 1, 0
  s_cbranch_scc0 L_q_late0
  s_mov_b32 m0, s49
  s_nop 0
  buffer_load_dwordx4 v16, s[4:7], s39 offen sc1 lds
  s_add_u32 m0, s49, 3072
  s_add_u32 s39, s39, 98304
  buffer_load_dwordx4 v16, s[4:7], s40 offen sc1 lds
  s_add_u32 s40, s40, 98304
L_q_late0:
  ds_read_b128 v[48:51], v15 offset:512
  ds_read_b128 v[52:55], v15 offset:20992
  s_waitcnt lgkmcnt(4)
  v_mfma_f32_16x16x32_bf16 v[56:59], a[36:39], v[32:35], v[56:59]
  v_mfma_f32_16x16x32_bf16 v[60:63], a[36:39], v[36:39], v[60:63]
  s_add_u32 m0, s48, 12288
  s_nop 0
  buffer_load_dwordx4 v16, s[4:7], s38 offen offset:0 sc1 lds
  v_mfma_f32_16x16x32_bf16 v[64:67], a[116:119], v[32:35], v[64:67]
  ds_read_b64 v[92:93], v19 offset:12288
  v_mfma_f32_16x16x32_bf16 v[68:71], a[116:119], v[36:39], v[68:71]
  ds_read_b64 v[94:95], v19 offset:13312
  v_mfma_f32_16x16x32_bf16 v[72:75], a[196:199], v[32:35], v[72:75]
  ds_read_b64 v[96:97], v19 offset:14336
  v_mfma_f32_16x16x32_bf16 v[76:79], a[196:199], v[36:39], v[76:79]
  ds_read_b64 v[98:99], v19 offset:15360
  ds_read_b128 v[32:35], v12 offset:768
  ds_read_b128 v[36:39], v12 offset:21248
  s_waitcnt lgkmcnt(8)
  v_mfma_f32_16x16x32_bf16 v[56:59], a[40:43], v[40:43], v[56:59]
  v_mfma_f32_16x16x32_bf16 v[60:63], a[40:43], v[44:47], v[60:63]
  buffer_load_dwordx4 v16, s[4:7], s38 offen offset:1024 sc1 lds
  v_mfma_f32_16x16x32_bf16 v[64:67], a[120:123], v[40:43], v[64:67]
  ds_read_b64 v[100:101], v19 offset:16384
  v_mfma_f32_16x16x32_bf16 v[68:71], a[120:123], v[44:47], v[68:71]
  ds_read_b64 v[102:103], v19 offset:17408
  v_mfma_f32_16x16x32_bf16 v[72:75], a[200:203], v[40:43], v[72:75]
  ds_read_b64 v[104:105], v19 offset:18432
  v_mfma_f32_16x16x32_bf16 v[76:79], a[200:203], v[44:47], v[76:79]
  ds_read_b64 v[106:107], v19 offset:19456
  ds_read_b128 v[40:43], v13 offset:768
  ds_read_b128 v[44:47], v13 offset:21248
  s_waitcnt lgkmcnt(9)
  v_mfma_f32_16x16x32_bf16 v[56:59], a[44:47], v[48:51], v[56:59]
  v_mfma_f32_16x16x32_bf16 v[60:63], a[44:47], v[52:55], v[60:63]
  buffer_load_dwordx4 v16, s[4:7], s38 offen offset:2048 sc1 lds
  v_mfma_f32_16x16x32_bf16 v[64:67], a[124:127], v[48:51], v[64:67]
  ds_read_b64 v[108:109], v19 offset:20480
  v_mfma_f32_16x16x32_bf16 v[68:71], a[124:127], v[52:55], v[68:71]
  ds_read_b64 v[110:111], v19 offset:21504
  v_mfma_f32_16x16x32_bf16 v[72:75], a[204:207], v[48:51], v[72:75]
  ds_read_b64 v[112:113], v19 offset:22528
  v_mfma_f32_16x16x32_bf16 v[76:79], a[204:207], v[52:55], v[76:79]
  ds_read_b64 v[114:115], v19 offset:23552
  ds_read_b128 v[48:51], v14 offset:768
  ds_read_b128 v[52:55], v14 offset:21248
  s_waitcnt lgkmcnt(9)
  v_mfma_f32_16x16x32_bf16 v[56:59], a[48:51], v[32:35], v[56:59]
  v_mfma_f32_16x16x32_bf16 v[60:63], a[48:51], v[36:39], v[60:63]
  s_add_u32 m0, s36, 7168
  s_nop 0
  buffer_load_dwordx4 v9, s[20:23], s34 offen lds
  v_mfma_f32_16x16x32_bf16 v[64:67], a[128:131], v[32:35], v[64:67]
  ds_read_b64 v[116:117], v20 offset:0
  v_mfma_f32_16x16x32_bf16 v[68:71], a[128:131], v[36:39], v[68:71]
  ds_read_b64 v[118:119], v20 offset:1024
  v_mfma_f32_16x16x32_bf16 v[72:75], a[208:211], v[32:35], v[72:75]
  ds_read_b64 v[120:121], v20 offset:2048
  v_mfma_f32_16x16x32_bf16 v[76:79], a[208:211], v[36:39], v[76:79]
  ds_read_b64 v[122:123], v20 offset:3072
  ds_read_b128 v[32:35], v15 offset:768
  ds_read_b128 v[36:39], v15 offset:21248
  s_waitcnt lgkmcnt(9)
  v_mfma_f32_16x16x32_bf16 v[56:59], a[52:55], v[40:43], v[56:59]
  v_mfma_f32_16x16x32_bf16 v[60:63], a[52:55], v[44:47], v[60:63]
  s_add_u32 m0, s36, 8192
  s_nop 0
  buffer_load_dwordx4 v10, s[20:23], s34 offen lds
  v_mfma_f32_16x16x32_bf16 v[64:67], a[132:135], v[40:43], v[64:67]
  ds_read_b64 v[124:125], v20 offset:4096
  v_mfma_f32_16x16x32_bf16 v[68:71], a[132:135], v[44:47], v[68:71]
  ds_read_b64 v[126:127], v20 offset:5120
  v_mfma_f32_16x16x32_bf16 v[72:75], a[212:215], v[40:43], v[72:75]
  ds_read_b64 v[128:129], v20 offset:6144
  v_mfma_f32_16x16x32_bf16 v[76:79], a[212:215], v[44:47], v[76:79]
  ds_read_b64 v[130:131], v20 offset:7168
  ds_read_b128 v[40:43], v12 offset:1024
  ds_read_b128 v[44:47], v12 offset:21504
  s_waitcnt lgkmcnt(9)
  v_mfma_f32_16x16x32_bf16 v[56:59], a[56:59], v[48:51], v[56:59]
  v_mfma_f32_16x16x32_bf16 v[60:63], a[56:59], v[52:55], v[60:63]
  s_add_u32 m0, s36, 9216
  s_nop 0
  buffer_load_dwordx4 v11, s[20:23], s34 offen lds
  v_mfma_f32_16x16x32_bf16 v[64:67], a[136:139], v[48:51], v[64:67]
  ds_read_b64 v[132:133], v20 offset:8192
  v_mfma_f32_16x16x32_bf16 v[68:71], a[136:139], v[52:55], v[68:71]
  ds_read_b64 v[134:135], v20 offset:9216
  v_mfma_f32_16x16x32_bf16 v[72:75], a[216:219], v[48:51], v[72:75]
  ds_read_b64 v[136:137], v20 offset:10240
  v_mfma_f32_16x16x32_bf16 v[76:79], a[216:219], v[52:55], v[76:79]
  ds_read_b64 v[138:139], v20 offset:11264
  ds_read_b128 v[48:51], v13 offset:1024
  ds_read_b128 v[52:55], v13 offset:21504
  s_waitcnt lgkmcnt(9)
  v_mfma_f32_16x16x32_bf16 v[56:59], a[60:63], v[32:35], v[56:59]
  v_mfma_f32_16x16x32_bf16 v[60:63], a[60:63], v[36:39], v[60:63]
  v_mfma_f32_16x16x32_bf16 v[64:67], a[140:143], v[32:35], v[64:67]
  ds_read_b64 v[140:141], v20 offset:8
  v_mfma_f32_16x16x32_bf16 v[68:71], a[140:143], v[36:39], v[68:71]
  ds_read_b64 v[142:143], v20 offset:1032
  v_mfma_f32_16x16x32_bf16 v[72:75], a[220:223], v[32:35], v[72:75]
  ds_read_b64 v[144:145], v20 offset:2056
  v_mfma_f32_16x16x32_bf16 v[76:79], a[220:223], v[36:39], v[76:79]
  ds_read_b64 v[146:147], v20 offset:3080
  ds_read_b128 v[32:35], v14 offset:1024
  ds_read_b128 v[36:39], v14 offset:21504
  s_waitcnt lgkmcnt(9)
  v_mfma_f32_16x16x32_bf16 v[56:59], a[64:67], v[40:43], v[56:59]
  v_mfma_f32_16x16x32_bf16 v[60:63], a[64:67], v[44:47], v[60:63]
  v_mfma_f32_16x16x32_bf16 v[64:67], a[144:147], v[40:43], v[64:67]
  ds_read_b64 v[148:149], v20 offset:4104
  v_mfma_f32_16x16x32_bf16 v[68:71], a[144:147], v[44:47], v[68:71]
  ds_read_b64 v[150:151], v20 offset:5128
  v_mfma_f32_16x16x32_bf16 v[72:75], a[224:227], v[40:43], v[72:75]
  ds_read_b64 v[152:153], v20 offset:6152
  v_mfma_f32_16x16x32_bf16 v[76:79], a[224:227], v[44:47], v[76:79]
  ds_read_b64 v[154:155], v20 offset:7176
  ds_read_b128 v[40:43], v15 offset:1024
  ds_read_b128 v[44:47], v15 offset:21504
  s_waitcnt lgkmcnt(9)
  v_mfma_f32_16x16x32_bf16 v[56:59], a[68:71], v[48:51], v[56:59]
  v_mfma_f32_16x16x32_bf16 v[60:63], a[68:71], v[52:55], v[60:63]
  v_mfma_f32_16x16x32_bf16 v[64:67], a[148:151], v[48:51], v[64:67]
  ds_read_b64 v[156:157], v20 offset:8200
  v_mfma_f32_16x16x32_bf16 v[68:71], a[148:151], v[52:55], v[68:71]
  ds_read_b64 v[158:159], v20 offset:9224
  v_mfma_f32_16x16x32_bf16 v[72:75], a[228:231], v[48:51], v[72:75]
  ds_read_b64 v[160:161], v20 offset:10248
  v_mfma_f32_16x16x32_bf16 v[76:79], a[228:231], v[52:55], v[76:79]
  ds_read_b64 v[162:163], v20 offset:11272
  s_waitcnt lgkmcnt(9)
  v_mfma_f32_16x16x32_bf16 v[56:59], a[72:75], v[32:35], v[56:59]
  v_mfma_f32_16x16x32_bf16 v[60:63], a[72:75], v[36:39], v[60:63]
  v_mfma_f32_16x16x32_bf16 v[64:67], a[152:155], v[32:35], v[64:67]
  v_mfma_f32_16x16x32_bf16 v[68:71], a[152:155], v[36:39], v[68:71]
  v_mfma_f32_16x16x32_bf16 v[72:75], a[232:235], v[32:35], v[72:75]
  v_mfma_f32_16x16x32_bf16 v[76:79], a[232:235], v[36:39], v[76:79]
  s_waitcnt lgkmcnt(4)
  v_mfma_f32_16x16x32_bf16 v[56:59], a[76:79], v[40:43], v[56:59]
  v_mfma_f32_16x16x32_bf16 v[60:63], a[76:79], v[44:47], v[60:63]
  v_mfma_f32_16x16x32_bf16 v[64:67], a[156:159], v[40:43], v[64:67]
  v_mfma_f32_16x16x32_bf16 v[68:71], a[156:159], v[44:47], v[68:71]
  v_mfma_f32_16x16x32_bf16 v[72:75], a[236:239], v[40:43], v[72:75]
  v_mfma_f32_16x16x32_bf16 v[76:79], a[236:239], v[44:47], v[76:79]
  s_add_u32 s34, s34, 40960
  s_add_u32 s37, s37, 393216
  s_add_u32 s38, s38, 393216
  s_waitcnt lgkmcnt(0)
  v_mfma_f32_16x16x32_bf16 v[238:241], v[116:119], v[92:95], 0
  v_mfma_f32_16x16x32_bf16 v[242:245], v[140:143], v[92:95], 0
  v_mfma_f32_16x16x32_bf16 v[238:241], v[120:123], v[96:99], v[238:241]
  v_mfma_f32_16x16x32_bf16 v[242:245], v[144:147], v[96:99], v[242:245]
  v_cvt_pk_bf16_f32 v80, v56, v57
  v_cvt_pk_bf16_f32 v81, v58, v59
  v_mfma_f32_16x16x32_bf16 v[238:241], v[124:127], v[100:103], v[238:241]
  v_cvt_pk_bf16_f32 v82, v60, v61
  v_cvt_pk_bf16_f32 v83, v62, v63
  v_mfma_f32_16x16x32_bf16 v[242:245], v[148:151], v[100:103], v[242:245]
  ds_write_b128 v18, v[80:83] offset:0
  v_cvt_pk_bf16_f32 v84, v64, v65
  v_mfma_f32_16x16x32_bf16 v[238:241], v[128:131], v[104:107], v[238:241]
  v_cvt_pk_bf16_f32 v85, v66, v67
  v_cvt_pk_bf16_f32 v86, v68, v69
  v_mfma_f32_16x16x32_bf16 v[242:245], v[152:155], v[104:107], v[242:245]
  v_cvt_pk_bf16_f32 v87, v70, v71
  ds_write_b128 v18, v[84:87] offset:1024
  v_mfma_f32_16x16x32_bf16 v[238:241], v[132:135], v[108:111], v[238:241]
  v_cvt_pk_bf16_f32 v88, v72, v73
  v_cvt_pk_bf16_f32 v89, v74, v75
  v_mfma_f32_16x16x32_bf16 v[242:245], v[156:159], v[108:111], v[242:245]
  v_cvt_pk_bf16_f32 v90, v76, v77
  v_cvt_pk_bf16_f32 v91, v78, v79
  v_mfma_f32_16x16x32_bf16 v[238:241], v[136:139], v[112:115], v[238:241]
  ds_write_b128 v18, v[88:91] offset:2048
  v_mfma_f32_16x16x32_bf16 v[242:245], v[160:163], v[112:115], v[242:245]
  s_cmp_lg_u32 s51, 0
  s_cbranch_scc1 L_q_have0
  s_cmp_ge_u32 s46, s47
  s_cbranch_scc1 L_q_ch0_e
  s_mov_b64 exec, 7
  s_mov_b32 s15, 0
L_q_ch0:
  v_mov_b32 v250, 0
  buffer_atomic_add v250, v17, s[4:7], s44 offen sc0 sc1
  s_waitcnt vmcnt(0)
  v_cmp_gt_u32 vcc, s47, v250
  s_cbranch_vccz L_q_ch0_ok
  s_sleep 2
  s_add_u32 s15, s15, 1
  s_cmp_lt_u32 s15, 262144
  s_cbranch_scc1 L_q_ch0
  s_branch L_fail
L_q_ch0_ok:
  v_readlane_b32 s46, v250, 0
  v_readlane_b32 s52, v250, 1
  s_nop 0
  s_min_u32 s46, s46, s52
  v_readlane_b32 s52, v250, 2
  s_nop 0
  s_min_u32 s46, s46, s52
  s_mov_b64 exec, -1
L_q_ch0_e:
  s_mov_b32 m0, s49
  s_nop 0
  buffer_load_dwordx4 v16, s[4:7], s39 offen sc1 lds
  s_add_u32 m0, s49, 3072
  s_add_u32 s39, s39, 98304
  buffer_load_dwordx4 v16, s[4:7], s40 offen sc1 lds
  s_add_u32 s40, s40, 98304
L_q_have0:
  s_waitcnt vmcnt(0) lgkmcnt(0)
  s_barrier
  ds_read_b128 v[164:167], v21 offset:0
  ds_read_b128 v[168:171], v21 offset:512
  ds_read_b128 v[172:175], v21 offset:1024
  ds_read_b128 v[176:179], v21 offset:1536
  ds_read_b128 v[180:183], v21 offset:2048
  ds_read_b128 v[184:187], v21 offset:2560
  s_waitcnt lgkmcnt(5)
  v_mfma_f32_16x16x32_bf16 v[234:237], v[164:167], v[92:95], 0
  ds_read_b128 v[188:191], v22 offset:0
  ds_read_b32 v212, v23 offset:0
  s_waitcnt lgkmcnt(6)
  v_mfma_f32_16x16x32_bf16 v[234:237], v[168:171], v[96:99], v[234:237]
  ds_read_b128 v[192:195], v22 offset:1024
  ds_read_b32 v214, v23 offset:256
  s_waitcnt lgkmcnt(7)
  v_mfma_f32_16x16x32_bf16 v[234:237], v[172:175], v[100:103], v[234:237]
  ds_read_b128 v[196:199], v22 offset:2048
  ds_read_b32 v216, v23 offset:512
  s_waitcnt lgkmcnt(8)
  v_mfma_f32_16x16x32_bf16 v[234:237], v[176:179], v[104:107], v[234:237]
  ds_read_b128 v[200:203], v22 offset:3072
  ds_read_b32 v218, v23 offset:768
  s_waitcnt lgkmcnt(9)
  v_mfma_f32_16x16x32_bf16 v[234:237], v[180:183], v[108:111], v[234:237]
  ds_read_b128 v[204:207], v22 offset:4096
  ds_read_b32 v220, v23 offset:1024
  s_waitcnt lgkmcnt(10)
  v_mfma_f32_16x16x32_bf16 v[234:237], v[184:187], v[112:115], v[234:237]
  ds_read_b128 v[208:211], v22 offset:5120
  ds_read_b32 v222, v23 offset:1280
  v_cndmask_b32 v238, v25, v238, s[56:57]
  v_cndmask_b32 v239, v25, v239, s[58:59]
  v_cndmask_b32 v240, v25, v240, s[60:61]
  v_cndmask_b32 v241, v25, v241, s[62:63]
  v_cndmask_b32 v242, v25, v242, s[64:65]
  v_cndmask_b32 v243, v25, v243, s[66:67]
  v_cndmask_b32 v244, v25, v244, s[68:69]
  v_cndmask_b32 v245, v25, v245, s[70:71]
  v_max3_f32 v250, v238, v239, v240
  v_max3_f32 v251, v241, v242, v243
  v_max3_f32 v250, v250, v244, v245
  v_max3_f32 v251, v251, v234, v235
  v_max_f32 v250, v250, v251
  v_mov_b32 v251, v250
  s_nop 1
  v_permlane16_swap_b32 v250, v251
  v_max_f32 v250, v250, v251
  v_mov_b32 v251, v250
  s_nop 1
  v_permlane32_swap_b32 v250, v251
  v_max_f32 v250, v250, v251
  v_mul_f32 v250, s50, v250
  v_fma_f32 v234, v234, s50, -v250
  v_fma_f32 v235, v235, s50, -v250
  v_fma_f32 v238, v238, s50, -v250
  v_fma_f32 v239, v239, s50, -v250
  v_fma_f32 v240, v240, s50, -v250
  v_fma_f32 v241, v241, s50, -v250
  v_fma_f32 v242, v242, s50, -v250
  v_fma_f32 v243, v243, s50, -v250
  v_fma_f32 v244, v244, s50, -v250
  v_fma_f32 v245, v245, s50, -v250
  v_exp_f32 v234, v234
  v_exp_f32 v235, v235
  v_exp_f32 v238, v238
  v_exp_f32 v239, v239
  v_exp_f32 v240, v240
  v_exp_f32 v241, v241
  v_exp_f32 v242, v242
  v_exp_f32 v243, v243
  v_exp_f32 v244, v244
  v_exp_f32 v245, v245
  v_cvt_pk_bf16_f32 v226, v238, v239
  v_cvt_pk_bf16_f32 v227, v240, v241
  v_cvt_pk_bf16_f32 v228, v242, v243
  v_cvt_pk_bf16_f32 v229, v244, v245
  v_cvt_pk_bf16_f32 v230, v234, v235
  s_nop 0
  v_mfma_f32_16x16x32_bf16 v[246:249], v[28:31], v[226:229], 0
  v_mfma_f32_16x16x32_bf16 v[246:249], v[28:31], v[230:233], v[246:249]
  s_waitcnt lgkmcnt(0)
  v_mfma_f32_16x16x32_bf16 v[56:59], v[188:191], v[226:229], 0
  v_mfma_f32_16x16x32_bf16 v[60:63], v[192:195], v[226:229], 0
  v_mfma_f32_16x16x32_bf16 v[64:67], v[196:199], v[226:229], 0
  v_mfma_f32_16x16x32_bf16 v[68:71], v[200:203], v[226:229], 0
  v_mfma_f32_16x16x32_bf16 v[72:75], v[204:207], v[226:229], 0
  v_mfma_f32_16x16x32_bf16 v[76:79], v[208:211], v[226:229], 0
  v_mfma_f32_16x16x32_bf16 v[56:59], v[212:215], v[230:233], v[56:59]
  v_mfma_f32_16x16x32_bf16 v[60:63], v[214:217], v[230:233], v[60:63]
  v_mfma_f32_16x16x32_bf16 v[64:67], v[216:219], v[230:233], v[64:67]
  v_mfma_f32_16x16x32_bf16 v[68:71], v[218:221], v[230:233], v[68:71]
  v_mfma_f32_16x16x32_bf16 v[72:75], v[220:223], v[230:233], v[72:75]
  v_mfma_f32_16x16x32_bf16 v[76:79], v[222:225], v[230:233], v[76:79]
  v_rcp_f32 v250, v246
  s_nop 1
  v_mul_f32 v56, v56, v250
  v_mul_f32 v57, v57, v250
  v_mul_f32 v58, v58, v250
  v_mul_f32 v59, v59, v250
  v_mul_f32 v60, v60, v250
  v_mul_f32 v61, v61, v250
  v_mul_f32 v62, v62, v250
  v_mul_f32 v63, v63, v250
  v_cvt_pk_bf16_f32 v80, v56, v57
  v_cvt_pk_bf16_f32 v81, v58, v59
  v_cvt_pk_bf16_f32 v82, v60, v61
  v_cvt_pk_bf16_f32 v83, v62, v63
  buffer_store_dwordx4 v[80:83], v16, s[4:7], s41 offen offset:0 sc1
  v_mul_f32 v64, v64, v250
  v_mul_f32 v65, v65, v250
  v_mul_f32 v66, v66, v250
  v_mul_f32 v67, v67, v250
  v_mul_f32 v68, v68, v250
  v_mul_f32 v69, v69, v250
  v_mul_f32 v70, v70, v250
  v_mul_f32 v71, v71, v250
  v_cvt_pk_bf16_f32 v84, v64, v65
  v_cvt_pk_bf16_f32 v85, v66, v67
  v_cvt_pk_bf16_f32 v86, v68, v69
  v_cvt_pk_bf16_f32 v87, v70, v71
  buffer_store_dwordx4 v[84:87], v16, s[4:7], s41 offen offset:1024 sc1
  v_mul_f32 v72, v72, v250
  v_mul_f32 v73, v73, v250
  v_mul_f32 v74, v74, v250
  v_mul_f32 v75, v75, v250
  v_mul_f32 v76, v76, v250
  v_mul_f32 v77, v77, v250
  v_mul_f32 v78, v78, v250
  v_mul_f32 v79, v79, v250
  v_cvt_pk_bf16_f32 v88, v72, v73
  v_cvt_pk_bf16_f32 v89, v74, v75
  v_cvt_pk_bf16_f32 v90, v76, v77
  v_cvt_pk_bf16_f32 v91, v78, v79
  buffer_store_dwordx4 v[88:91], v16, s[4:7], s41 offen offset:2048 sc1
  s_add_u32 s41, s41, 393216
  s_add_u32 s33, s33, 1
  s_branch L_q_loop
L_q_last:
  s_add_u32 s47, s33, 1
  s_cmp_ge_u32 s45, s47
  s_cbranch_scc1 L_q_kvl_e
  s_mov_b64 exec, 255
  s_mov_b32 s15, 0
L_q_kvl:
  v_mov_b32 v250, 0
  buffer_atomic_add v250, v17, s[4:7], s43 offen sc0 sc1
  s_waitcnt vmcnt(0)
  v_cmp_gt_u32 vcc, s47, v250
  s_cbranch_vccz L_q_kvl_ok
  s_sleep 2
  s_add_u32 s15, s15, 1
  s_cmp_lt_u32 s15, 262144
  s_cbranch_scc1 L_q_kvl
  s_branch L_fail
L_q_kvl_ok:
  v_readlane_b32 s45, v250, 0
  v_readlane_b32 s52, v250, 1
  s_nop 0
  s_min_u32 s45, s45, s52
  v_readlane_b32 s52, v250, 2
  s_nop 0
  s_min_u32 s45, s45, s52
  v_readlane_b32 s52, v250, 3
  s_nop 0
  s_min_u32 s45, s45, s52
  v_readlane_b32 s52, v250, 4
  s_nop 0
  s_min_u32 s45, s45, s52
  v_readlane_b32 s52, v250, 5
  s_nop 0
  s_min_u32 s45, s45, s52
  v_readlane_b32 s52, v250, 6
  s_nop 0
  s_min_u32 s45, s45, s52
  v_readlane_b32 s52, v250, 7
  s_nop 0
  s_min_u32 s45, s45, s52
  s_mov_b64 exec, -1
L_q_kvl_e:
  s_add_u32 m0, s48, 0
  s_nop 0
  buffer_load_dwordx4 v16, s[4:7], s37 offen offset:0 sc1 lds
  buffer_load_dwordx4 v16, s[4:7], s37 offen offset:1024 sc1 lds
  buffer_load_dwordx4 v16, s[4:7], s37 offen offset:2048 sc1 lds
  s_barrier
  s_add_u32 m0, s48, 12288
  s_nop 0
  buffer_load_dwordx4 v16, s[4:7], s38 offen offset:0 sc1 lds
  buffer_load_dwordx4 v16, s[4:7], s38 offen offset:1024 sc1 lds
  buffer_load_dwordx4 v16, s[4:7], s38 offen offset:2048 sc1 lds
  s_waitcnt vmcnt(6)
  v_mov_b32 v250, s33
  s_mov_b64 exec, 1
  buffer_store_dword v250, v24, s[4:7], s42 offen sc1
  s_mov_b64 exec, -1
  s_mov_b32 s51, 0
  s_waitcnt vmcnt(4)
  s_barrier
  ds_read_b64 v[92:93], v19 offset:12288
  ds_read_b64 v[94:95], v19 offset:13312
  ds_read_b64 v[96:97], v19 offset:14336
  ds_read_b64 v[98:99], v19 offset:15360
  ds_read_b64 v[100:101], v19 offset:16384
  ds_read_b64 v[102:103], v19 offset:17408
  ds_read_b64 v[104:105], v19 offset:18432
  ds_read_b64 v[106:107], v19 offset:19456
  ds_read_b64 v[108:109], v19 offset:20480
  ds_read_b64 v[110:111], v19 offset:21504
  ds_read_b64 v[112:113], v19 offset:22528
  ds_read_b64 v[114:115], v19 offset:23552
  s_waitcnt lgkmcnt(2)
  ds_read_b64 v[116:117], v20 offset:0
  ds_read_b64 v[118:119], v20 offset:1024
  ds_read_b64 v[120:121], v20 offset:2048
  ds_read_b64 v[122:123], v20 offset:3072
  ds_read_b64 v[124:125], v20 offset:4096
  ds_read_b64 v[126:127], v20 offset:5120
  ds_read_b64 v[128:129], v20 offset:6144
  ds_read_b64 v[130:131], v20 offset:7168
  ds_read_b64 v[132:133], v20 offset:8192
  ds_read_b64 v[134:135], v20 offset:9216
  ds_read_b64 v[136:137], v20 offset:10240
  ds_read_b64 v[138:139], v20 offset:11264
  s_waitcnt lgkmcnt(2)
  ds_read_b64 v[140:141], v20 offset:8
  ds_read_b64 v[142:143], v20 offset:1032
  ds_read_b64 v[144:145], v20 offset:2056
  ds_read_b64 v[146:147], v20 offset:3080
  ds_read_b64 v[148:149], v20 offset:4104
  ds_read_b64 v[150:151], v20 offset:5128
  ds_read_b64 v[152:153], v20 offset:6152
  ds_read_b64 v[154:155], v20 offset:7176
  ds_read_b64 v[156:157], v20 offset:8200
  ds_read_b64 v[158:159], v20 offset:9224
  ds_read_b64 v[160:161], v20 offset:10248
  ds_read_b64 v[162:163], v20 offset:11272
  s_waitcnt lgkmcnt(2)
  s_add_u32 s37, s37, 393216
  s_add_u32 s38, s38, 393216
  s_waitcnt lgkmcnt(0)
  v_mfma_f32_16x16x32_bf16 v[238:241], v[116:119], v[92:95], 0
  v_mfma_f32_16x16x32_bf16 v[242:245], v[140:143], v[92:95], 0
  v_mfma_f32_16x16x32_bf16 v[238:241], v[120:123], v[96:99], v[238:241]
  v_mfma_f32_16x16x32_bf16 v[242:245], v[144:147], v[96:99], v[242:245]
  v_mfma_f32_16x16x32_bf16 v[238:241], v[124:127], v[100:103], v[238:241]
  v_mfma_f32_16x16x32_bf16 v[242:245], v[148:151], v[100:103], v[242:245]
  v_mfma_f32_16x16x32_bf16 v[238:241], v[128:131], v[104:107], v[238:241]
  v_mfma_f32_16x16x32_bf16 v[242:245], v[152:155], v[104:107], v[242:245]
  v_mfma_f32_16x16x32_bf16 v[238:241], v[132:135], v[108:111], v[238:241]
  v_mfma_f32_16x16x32_bf16 v[242:245], v[156:159], v[108:111], v[242:245]
  v_mfma_f32_16x16x32_bf16 v[238:241], v[136:139], v[112:115], v[238:241]
  v_mfma_f32_16x16x32_bf16 v[242:245], v[160:163], v[112:115], v[242:245]
  s_cmp_lg_u32 s51, 0
  s_cbranch_scc1 L_q_havel
  s_cmp_ge_u32 s46, s47
  s_cbranch_scc1 L_q_chl_e
  s_mov_b64 exec, 7
  s_mov_b32 s15, 0
L_q_chl:
  v_mov_b32 v250, 0
  buffer_atomic_add v250, v17, s[4:7], s44 offen sc0 sc1
  s_waitcnt vmcnt(0)
  v_cmp_gt_u32 vcc, s47, v250
  s_cbranch_vccz L_q_chl_ok
  s_sleep 2
  s_add_u32 s15, s15, 1
  s_cmp_lt_u32 s15, 262144
  s_cbranch_scc1 L_q_chl
  s_branch L_fail
L_q_chl_ok:
  v_readlane_b32 s46, v250, 0
  v_readlane_b32 s52, v250, 1
  s_nop 0
  s_min_u32 s46, s46, s52
  v_readlane_b32 s52, v250, 2
  s_nop 0
  s_min_u32 s46, s46, s52
  s_mov_b64 exec, -1
L_q_chl_e:
  s_mov_b32 m0, s49
  s_nop 0
  buffer_load_dwordx4 v16, s[4:7], s39 offen sc1 lds
  s_add_u32 m0, s49, 3072
  s_add_u32 s39, s39, 98304
  buffer_load_dwordx4 v16, s[4:7], s40 offen sc1 lds
  s_add_u32 s40, s40, 98304
L_q_havel:
  s_waitcnt vmcnt(0) lgkmcnt(0)
  s_barrier
  ds_read_b128 v[164:167], v21 offset:0
  ds_read_b128 v[168:171], v21 offset:512
  ds_read_b128 v[172:175], v21 offset:1024
  ds_read_b128 v[176:179], v21 offset:1536
  ds_read_b128 v[180:183], v21 offset:2048
  ds_read_b128 v[184:187], v21 offset:2560
  s_waitcnt lgkmcnt(5)
  v_mfma_f32_16x16x32_bf16 v[234:237], v[164:167], v[92:95], 0
  ds_read_b128 v[188:191], v22 offset:0
  ds_read_b32 v212, v23 offset:0
  s_waitcnt lgkmcnt(6)
  v_mfma_f32_16x16x32_bf16 v[234:237], v[168:171], v[96:99], v[234:237]
  ds_read_b128 v[192:195], v22 offset:1024
  ds_read_b32 v214, v23 offset:256
  s_waitcnt lgkmcnt(7)
  v_mfma_f32_16x16x32_bf16 v[234:237], v[172:175], v[100:103], v[234:237]
  ds_read_b128 v[196:199], v22 offset:2048
  ds_read_b32 v216, v23 offset:512
  s_waitcnt lgkmcnt(8)
  v_mfma_f32_16x16x32_bf16 v[234:237], v[176:179], v[104:107], v[234:237]
  ds_read_b128 v[200:203], v22 offset:3072
  ds_read_b32 v218, v23 offset:768
  s_waitcnt lgkmcnt(9)
  v_mfma_f32_16x16x32_bf16 v[234:237], v[180:183], v[108:111], v[234:237]
  ds_read_b128 v[204:207], v22 offset:4096
  ds_read_b32 v220, v23 offset:1024
  s_waitcnt lgkmcnt(10)
  v_mfma_f32_16x16x32_bf16 v[234:237], v[184:187], v[112:115], v[234:237]
  ds_read_b128 v[208:211], v22 offset:5120
  ds_read_b32 v222, v23 offset:1280
  v_cndmask_b32 v238, v25, v238, s[56:57]
  v_cndmask_b32 v239, v25, v239, s[58:59]
  v_cndmask_b32 v240, v25, v240, s[60:61]
  v_cndmask_b32 v241, v25, v241, s[62:63]
  v_cndmask_b32 v242, v25, v242, s[64:65]
  v_cndmask_b32 v243, v25, v243, s[66:67]
  v_cndmask_b32 v244, v25, v244, s[68:69]
  v_cndmask_b32 v245, v25, v245, s[70:71]
  v_max3_f32 v250, v238, v239, v240
  v_max3_f32 v251, v241, v242, v243
  v_max3_f32 v250, v250, v244, v245
  v_max3_f32 v251, v251, v234, v235
  v_max_f32 v250, v250, v251
  v_mov_b32 v251, v250
  s_nop 1
  v_permlane16_swap_b32 v250, v251
  v_max_f32 v250, v250, v251
  v_mov_b32 v251, v250
  s_nop 1
  v_permlane32_swap_b32 v250, v251
  v_max_f32 v250, v250, v251
  v_mul_f32 v250, s50, v250
  v_fma_f32 v234, v234, s50, -v250
  v_fma_f32 v235, v235, s50, -v250
  v_fma_f32 v238, v238, s50, -v250
  v_fma_f32 v239, v239, s50, -v250
  v_fma_f32 v240, v240, s50, -v250
  v_fma_f32 v241, v241, s50, -v250
  v_fma_f32 v242, v242, s50, -v250
  v_fma_f32 v243, v243, s50, -v250
  v_fma_f32 v244, v244, s50, -v250
  v_fma_f32 v245, v245, s50, -v250
  v_exp_f32 v234, v234
  v_exp_f32 v235, v235
  v_exp_f32 v238, v238
  v_exp_f32 v239, v239
  v_exp_f32 v240, v240
  v_exp_f32 v241, v241
  v_exp_f32 v242, v242
  v_exp_f32 v243, v243
  v_exp_f32 v244, v244
  v_exp_f32 v245, v245
  v_cvt_pk_bf16_f32 v226, v238, v239
  v_cvt_pk_bf16_f32 v227, v240, v241
  v_cvt_pk_bf16_f32 v228, v242, v243
  v_cvt_pk_bf16_f32 v229, v244, v245
  v_cvt_pk_bf16_f32 v230, v234, v235
  s_nop 0
  v_mfma_f32_16x16x32_bf16 v[246:249], v[28:31], v[226:229], 0
  v_mfma_f32_16x16x32_bf16 v[246:249], v[28:31], v[230:233], v[246:249]
  s_waitcnt lgkmcnt(0)
  v_mfma_f32_16x16x32_bf16 v[56:59], v[188:191], v[226:229], 0
  v_mfma_f32_16x16x32_bf16 v[60:63], v[192:195], v[226:229], 0
  v_mfma_f32_16x16x32_bf16 v[64:67], v[196:199], v[226:229], 0
  v_mfma_f32_16x16x32_bf16 v[68:71], v[200:203], v[226:229], 0
  v_mfma_f32_16x16x32_bf16 v[72:75], v[204:207], v[226:229], 0
  v_mfma_f32_16x16x32_bf16 v[76:79], v[208:211], v[226:229], 0
  v_mfma_f32_16x16x32_bf16 v[56:59], v[212:215], v[230:233], v[56:59]
  v_mfma_f32_16x16x32_bf16 v[60:63], v[214:217], v[230:233], v[60:63]
  v_mfma_f32_16x16x32_bf16 v[64:67], v[216:219], v[230:233], v[64:67]
  v_mfma_f32_16x16x32_bf16 v[68:71], v[218:221], v[230:233], v[68:71]
  v_mfma_f32_16x16x32_bf16 v[72:75], v[220:223], v[230:233], v[72:75]
  v_mfma_f32_16x16x32_bf16 v[76:79], v[222:225], v[230:233], v[76:79]
  v_rcp_f32 v250, v246
  s_nop 1
  v_mul_f32 v56, v56, v250
  v_mul_f32 v57, v57, v250
  v_mul_f32 v58, v58, v250
  v_mul_f32 v59, v59, v250
  v_mul_f32 v60, v60, v250
  v_mul_f32 v61, v61, v250
  v_mul_f32 v62, v62, v250
  v_mul_f32 v63, v63, v250
  v_cvt_pk_bf16_f32 v80, v56, v57
  v_cvt_pk_bf16_f32 v81, v58, v59
  v_cvt_pk_bf16_f32 v82, v60, v61
  v_cvt_pk_bf16_f32 v83, v62, v63
  buffer_store_dwordx4 v[80:83], v16, s[4:7], s41 offen offset:0 sc1
  v_mul_f32 v64, v64, v250
  v_mul_f32 v65, v65, v250
  v_mul_f32 v66, v66, v250
  v_mul_f32 v67, v67, v250
  v_mul_f32 v68, v68, v250
  v_mul_f32 v69, v69, v250
  v_mul_f32 v70, v70, v250
  v_mul_f32 v71, v71, v250
  v_cvt_pk_bf16_f32 v84, v64, v65
  v_cvt_pk_bf16_f32 v85, v66, v67
  v_cvt_pk_bf16_f32 v86, v68, v69
  v_cvt_pk_bf16_f32 v87, v70, v71
  buffer_store_dwordx4 v[84:87], v16, s[4:7], s41 offen offset:1024 sc1
  v_mul_f32 v72, v72, v250
  v_mul_f32 v73, v73, v250
  v_mul_f32 v74, v74, v250
  v_mul_f32 v75, v75, v250
  v_mul_f32 v76, v76, v250
  v_mul_f32 v77, v77, v250
  v_mul_f32 v78, v78, v250
  v_mul_f32 v79, v79, v250
  v_cvt_pk_bf16_f32 v88, v72, v73
  v_cvt_pk_bf16_f32 v89, v74, v75
  v_cvt_pk_bf16_f32 v90, v76, v77
  v_cvt_pk_bf16_f32 v91, v78, v79
  buffer_store_dwordx4 v[88:91], v16, s[4:7], s41 offen offset:2048 sc1
  s_add_u32 s41, s41, 393216
  s_add_u32 s33, s33, 1
  s_waitcnt vmcnt(0)
  v_mov_b32 v250, s33
  s_mov_b64 exec, 1
  buffer_store_dword v250, v24, s[4:7], s42 offen sc1
  s_mov_b64 exec, -1
  s_waitcnt vmcnt(0)
  s_branch L_exit
L_role_wo:
  s_lshr_b32 s30, s13, 3
  s_and_b32 s31, s13, 7
  s_sleep 127
  s_sleep 127
  s_load_dwordx2 s[28:29], s[0:1], 40
  s_waitcnt lgkmcnt(0)
  s_mov_b32 s16, s28
  s_mov_b32 s17, s29
  s_mov_b32 s18, 7864320
  s_mov_b32 s19, 0x20000
  v_and_b32 v1, 63, v0
  v_mul_u32_u24 v8, 6554, v1
  v_lshrrev_b32 v8, 16, v8
  v_mul_u32_u24 v9, 10, v8
  v_sub_u32 v9, v1, v9
  v_mul_u32_u24 v8, 1280, v8
  v_lshl_add_u32 v8, v9, 4, v8
  v_cmp_gt_u32 vcc, 60, v1
  v_mov_b32 v9, 2147483648
  s_nop 0
  v_cndmask_b32 v10, v9, v8, vcc
  s_lshl_b32 s50, s12, 15
  v_bfe_u32 v8, v0, 2, 4
  v_add_u32 v8, 0, v8
  v_mul_u32_u24 v9, 10923, v8
  v_lshrrev_b32 v9, 16, v9
  v_mul_u32_u24 v8, 160, v8
  v_lshl_add_u32 v8, v9, 6, v8
  v_and_b32 v9, 3, v0
  v_lshl_add_u32 v8, v9, 3, v8
  v_add_u32 v11, s50, v8
  v_bfe_u32 v8, v0, 2, 4
  v_add_u32 v8, 16, v8
  v_mul_u32_u24 v9, 10923, v8
  v_lshrrev_b32 v9, 16, v9
  v_mul_u32_u24 v8, 160, v8
  v_lshl_add_u32 v8, v9, 6, v8
  v_and_b32 v9, 3, v0
  v_lshl_add_u32 v8, v9, 3, v8
  v_add_u32 v12, s50, v8
  v_bfe_u32 v8, v0, 2, 4
  v_add_u32 v8, 32, v8
  v_mul_u32_u24 v9, 10923, v8
  v_lshrrev_b32 v9, 16, v9
  v_mul_u32_u24 v8, 160, v8
  v_lshl_add_u32 v8, v9, 6, v8
  v_and_b32 v9, 3, v0
  v_lshl_add_u32 v8, v9, 3, v8
  v_add_u32 v13, s50, v8
  v_bfe_u32 v8, v0, 2, 4
  v_add_u32 v8, 48, v8
  v_mul_u32_u24 v9, 10923, v8
  v_lshrrev_b32 v9, 16, v9
  v_mul_u32_u24 v8, 160, v8
  v_lshl_add_u32 v8, v9, 6, v8
  v_and_b32 v9, 3, v0
  v_lshl_add_u32 v8, v9, 3, v8
  v_add_u32 v14, s50, v8
  v_bfe_u32 v8, v0, 2, 4
  v_add_u32 v8, 64, v8
  v_mul_u32_u24 v9, 10923, v8
  v_lshrrev_b32 v9, 16, v9
  v_mul_u32_u24 v8, 160, v8
  v_lshl_add_u32 v8, v9, 6, v8
  v_and_b32 v9, 3, v0
  v_lshl_add_u32 v8, v9, 3, v8
  v_add_u32 v15, s50, v8
  v_bfe_u32 v8, v0, 2, 4
  v_add_u32 v8, 80, v8
  v_mul_u32_u24 v9, 10923, v8
  v_lshrrev_b32 v9, 16, v9
  v_mul_u32_u24 v8, 160, v8
  v_lshl_add_u32 v8, v9, 6, v8
  v_and_b32 v9, 3, v0
  v_lshl_add_u32 v8, v9, 3, v8
  v_add_u32 v16, s50, v8
  v_lshlrev_b32 v1, 4, v1
  s_lshl_b32 s48, s30, 2
  s_add_u32 s48, s48, s12
  s_mul_i32 s34, s48, 24576
  s_lshl_b32 s40, s48, 8
  s_mul_i32 s48, s48, 491520
  s_mul_i32 s49, s31, 160
  s_add_u32 s48, s48, s49
  s_add_u32 m0, s50, 0
  s_nop 0
  buffer_load_dwordx4 v10, s[16:19], s48 offen lds
  s_add_u32 s48, s48, 7680
  s_add_u32 m0, s50, 1024
  s_nop 0
  buffer_load_dwordx4 v10, s[16:19], s48 offen lds
  s_add_u32 s48, s48, 7680
  s_add_u32 m0, s50, 2048
  s_nop 0
  buffer_load_dwordx4 v10, s[16:19], s48 offen lds
  s_add_u32 s48, s48, 7680
  s_add_u32 m0, s50, 3072
  s_nop 0
  buffer_load_dwordx4 v10, s[16:19], s48 offen lds
  s_add_u32 s48, s48, 7680
  s_add_u32 m0, s50, 4096
  s_nop 0
  buffer_load_dwordx4 v10, s[16:19], s48 offen lds
  s_add_u32 s48, s48, 7680
  s_add_u32 m0, s50, 5120
  s_nop 0
  buffer_load_dwordx4 v10, s[16:19], s48 offen lds
  s_add_u32 s48, s48, 7680
  s_add_u32 m0, s50, 6144
  s_nop 0
  buffer_load_dwordx4 v10, s[16:19], s48 offen lds
  s_add_u32 s48, s48, 7680
  s_add_u32 m0, s50, 7168
  s_nop 0
  buffer_load_dwordx4 v10, s[16:19], s48 offen lds
  s_add_u32 s48, s48, 7680
  s_add_u32 m0, s50, 8192
  s_nop 0
  buffer_load_dwordx4 v10, s[16:19], s48 offen lds
  s_add_u32 s48, s48, 7680
  s_add_u32 m0, s50, 9216
  s_nop 0
  buffer_load_dwordx4 v10, s[16:19], s48 offen lds
  s_add_u32 s48, s48, 7680
  s_add_u32 m0, s50, 10240
  s_nop 0
  buffer_load_dwordx4 v10, s[16:19], s48 offen lds
  s_add_u32 s48, s48, 7680
  s_add_u32 m0, s50, 11264
  s_nop 0
  buffer_load_dwordx4 v10, s[16:19], s48 offen lds
  s_add_u32 s48, s48, 7680
  s_add_u32 m0, s50, 12288
  s_nop 0
  buffer_load_dwordx4 v10, s[16:19], s48 offen lds
  s_add_u32 s48, s48, 7680
  s_add_u32 m0, s50, 13312
  s_nop 0
  buffer_load_dwordx4 v10, s[16:19], s48 offen lds
  s_add_u32 s48, s48, 7680
  s_add_u32 m0, s50, 14336
  s_nop 0
  buffer_load_dwordx4 v10, s[16:19], s48 offen lds
  s_add_u32 s48, s48, 7680
  s_add_u32 m0, s50, 15360
  s_nop 0
  buffer_load_dwordx4 v10, s[16:19], s48 offen lds
  s_add_u32 s48, s48, 7680
  s_add_u32 m0, s50, 16384
  s_nop 0
  buffer_load_dwordx4 v10, s[16:19], s48 offen lds
  s_add_u32 s48, s48, 7680
  s_add_u32 m0, s50, 17408
  s_nop 0
  buffer_load_dwordx4 v10, s[16:19], s48 offen lds
  s_add_u32 s48, s48, 7680
  s_add_u32 m0, s50, 18432
  s_nop 0
  buffer_load_dwordx4 v10, s[16:19], s48 offen lds
  s_add_u32 s48, s48, 7680
  s_add_u32 m0, s50, 19456
  s_nop 0
  buffer_load_dwordx4 v10, s[16:19], s48 offen lds
  s_add_u32 s48, s48, 7680
  s_add_u32 m0, s50, 20480
  s_nop 0
  buffer_load_dwordx4 v10, s[16:19], s48 offen lds
  s_add_u32 s48, s48, 7680
  s_add_u32 m0, s50, 21504
  s_nop 0
  buffer_load_dwordx4 v10, s[16:19], s48 offen lds
  s_add_u32 s48, s48, 7680
  s_add_u32 m0, s50, 22528
  s_nop 0
  buffer_load_dwordx4 v10, s[16:19], s48 offen lds
  s_add_u32 s48, s48, 7680
  s_add_u32 m0, s50, 23552
  s_nop 0
  buffer_load_dwordx4 v10, s[16:19], s48 offen lds
  s_add_u32 s48, s48, 7680
  s_add_u32 m0, s50, 24576
  s_nop 0
  buffer_load_dwordx4 v10, s[16:19], s48 offen lds
  s_add_u32 s48, s48, 7680
  s_add_u32 m0, s50, 25600
  s_nop 0
  buffer_load_dwordx4 v10, s[16:19], s48 offen lds
  s_add_u32 s48, s48, 7680
  s_add_u32 m0, s50, 26624
  s_nop 0
  buffer_load_dwordx4 v10, s[16:19], s48 offen lds
  s_add_u32 s48, s48, 7680
  s_add_u32 m0, s50, 27648
  s_nop 0
  buffer_load_dwordx4 v10, s[16:19], s48 offen lds
  s_add_u32 s48, s48, 7680
  s_add_u32 m0, s50, 28672
  s_nop 0
  buffer_load_dwordx4 v10, s[16:19], s48 offen lds
  s_add_u32 s48, s48, 7680
  s_add_u32 m0, s50, 29696
  s_nop 0
  buffer_load_dwordx4 v10, s[16:19], s48 offen lds
  s_add_u32 s48, s48, 7680
  s_add_u32 m0, s50, 30720
  s_nop 0
  buffer_load_dwordx4 v10, s[16:19], s48 offen lds
  s_add_u32 s48, s48, 7680
  s_add_u32 m0, s50, 31744
  s_nop 0
  buffer_load_dwordx4 v10, s[16:19], s48 offen lds
  s_add_u32 s48, s48, 7680
  s_waitcnt vmcnt(16)
  ds_read_b64_tr_b16 a[0:1], v11 offset:0
  ds_read_b64_tr_b16 a[48:49], v11 offset:32
  ds_read_b64_tr_b16 a[96:97], v11 offset:64
  ds_read_b64_tr_b16 a[144:145], v11 offset:96
  ds_read_b64_tr_b16 a[192:193], v11 offset:128
  s_waitcnt lgkmcnt(5)
  ds_read_b64_tr_b16 a[2:3], v12 offset:0
  ds_read_b64_tr_b16 a[50:51], v12 offset:32
  ds_read_b64_tr_b16 a[98:99], v12 offset:64
  ds_read_b64_tr_b16 a[146:147], v12 offset:96
  ds_read_b64_tr_b16 a[194:195], v12 offset:128
  s_waitcnt lgkmcnt(5)
  ds_read_b64_tr_b16 a[4:5], v13 offset:0
  ds_read_b64_tr_b16 a[52:53], v13 offset:32
  ds_read_b64_tr_b16 a[100:101], v13 offset:64
  ds_read_b64_tr_b16 a[148:149], v13 offset:96
  ds_read_b64_tr_b16 a[196:197], v13 offset:128
  s_waitcnt lgkmcnt(5)
  ds_read_b64_tr_b16 a[6:7], v14 offset:0
  ds_read_b64_tr_b16 a[54:55], v14 offset:32
  ds_read_b64_tr_b16 a[102:103], v14 offset:64
  ds_read_b64_tr_b16 a[150:151], v14 offset:96
  ds_read_b64_tr_b16 a[198:199], v14 offset:128
  s_waitcnt lgkmcnt(5)
  ds_read_b64_tr_b16 a[8:9], v15 offset:0
  ds_read_b64_tr_b16 a[56:57], v15 offset:32
  ds_read_b64_tr_b16 a[104:105], v15 offset:64
  ds_read_b64_tr_b16 a[152:153], v15 offset:96
  ds_read_b64_tr_b16 a[200:201], v15 offset:128
  s_waitcnt lgkmcnt(5)
  ds_read_b64_tr_b16 a[10:11], v16 offset:0
  ds_read_b64_tr_b16 a[58:59], v16 offset:32
  ds_read_b64_tr_b16 a[106:107], v16 offset:64
  ds_read_b64_tr_b16 a[154:155], v16 offset:96
  ds_read_b64_tr_b16 a[202:203], v16 offset:128
  s_waitcnt lgkmcnt(5)
  s_waitcnt lgkmcnt(0)
  s_add_u32 m0, s50, 0
  s_nop 0
  buffer_load_dwordx4 v10, s[16:19], s48 offen lds
  s_add_u32 s48, s48, 7680
  s_add_u32 m0, s50, 1024
  s_nop 0
  buffer_load_dwordx4 v10, s[16:19], s48 offen lds
  s_add_u32 s48, s48, 7680
  s_add_u32 m0, s50, 2048
  s_nop 0
  buffer_load_dwordx4 v10, s[16:19], s48 offen lds
  s_add_u32 s48, s48, 7680
  s_add_u32 m0, s50, 3072
  s_nop 0
  buffer_load_dwordx4 v10, s[16:19], s48 offen lds
  s_add_u32 s48, s48, 7680
  s_add_u32 m0, s50, 4096
  s_nop 0
  buffer_load_dwordx4 v10, s[16:19], s48 offen lds
  s_add_u32 s48, s48, 7680
  s_add_u32 m0, s50, 5120
  s_nop 0
  buffer_load_dwordx4 v10, s[16:19], s48 offen lds
  s_add_u32 s48, s48, 7680
  s_add_u32 m0, s50, 6144
  s_nop 0
  buffer_load_dwordx4 v10, s[16:19], s48 offen lds
  s_add_u32 s48, s48, 7680
  s_add_u32 m0, s50, 7168
  s_nop 0
  buffer_load_dwordx4 v10, s[16:19], s48 offen lds
  s_add_u32 s48, s48, 7680
  s_add_u32 m0, s50, 8192
  s_nop 0
  buffer_load_dwordx4 v10, s[16:19], s48 offen lds
  s_add_u32 s48, s48, 7680
  s_add_u32 m0, s50, 9216
  s_nop 0
  buffer_load_dwordx4 v10, s[16:19], s48 offen lds
  s_add_u32 s48, s48, 7680
  s_add_u32 m0, s50, 10240
  s_nop 0
  buffer_load_dwordx4 v10, s[16:19], s48 offen lds
  s_add_u32 s48, s48, 7680
  s_add_u32 m0, s50, 11264
  s_nop 0
  buffer_load_dwordx4 v10, s[16:19], s48 offen lds
  s_add_u32 s48, s48, 7680
  s_add_u32 m0, s50, 12288
  s_nop 0
  buffer_load_dwordx4 v10, s[16:19], s48 offen lds
  s_add_u32 s48, s48, 7680
  s_add_u32 m0, s50, 13312
  s_nop 0
  buffer_load_dwordx4 v10, s[16:19], s48 offen lds
  s_add_u32 s48, s48, 7680
  s_add_u32 m0, s50, 14336
  s_nop 0
  buffer_load_dwordx4 v10, s[16:19], s48 offen lds
  s_add_u32 s48, s48, 7680
  s_add_u32 m0, s50, 15360
  s_nop 0
  buffer_load_dwordx4 v10, s[16:19], s48 offen lds
  s_add_u32 s48, s48, 7680
  s_waitcnt vmcnt(16)
  ds_read_b64_tr_b16 a[12:13], v11 offset:16384
  ds_read_b64_tr_b16 a[60:61], v11 offset:16416
  ds_read_b64_tr_b16 a[108:109], v11 offset:16448
  ds_read_b64_tr_b16 a[156:157], v11 offset:16480
  ds_read_b64_tr_b16 a[204:205], v11 offset:16512
  s_waitcnt lgkmcnt(5)
  ds_read_b64_tr_b16 a[14:15], v12 offset:16384
  ds_read_b64_tr_b16 a[62:63], v12 offset:16416
  ds_read_b64_tr_b16 a[110:111], v12 offset:16448
  ds_read_b64_tr_b16 a[158:159], v12 offset:16480
  ds_read_b64_tr_b16 a[206:207], v12 offset:16512
  s_waitcnt lgkmcnt(5)
  ds_read_b64_tr_b16 a[16:17], v13 offset:16384
  ds_read_b64_tr_b16 a[64:65], v13 offset:16416
  ds_read_b64_tr_b16 a[112:113], v13 offset:16448
  ds_read_b64_tr_b16 a[160:161], v13 offset:16480
  ds_read_b64_tr_b16 a[208:209], v13 offset:16512
  s_waitcnt lgkmcnt(5)
  ds_read_b64_tr_b16 a[18:19], v14 offset:16384
  ds_read_b64_tr_b16 a[66:67], v14 offset:16416
  ds_read_b64_tr_b16 a[114:115], v14 offset:16448
  ds_read_b64_tr_b16 a[162:163], v14 offset:16480
  ds_read_b64_tr_b16 a[210:211], v14 offset:16512
  s_waitcnt lgkmcnt(5)
  ds_read_b64_tr_b16 a[20:21], v15 offset:16384
  ds_read_b64_tr_b16 a[68:69], v15 offset:16416
  ds_read_b64_tr_b16 a[116:117], v15 offset:16448
  ds_read_b64_tr_b16 a[164:165], v15 offset:16480
  ds_read_b64_tr_b16 a[212:213], v15 offset:16512
  s_waitcnt lgkmcnt(5)
  ds_read_b64_tr_b16 a[22:23], v16 offset:16384
  ds_read_b64_tr_b16 a[70:71], v16 offset:16416
  ds_read_b64_tr_b16 a[118:119], v16 offset:16448
  ds_read_b64_tr_b16 a[166:167], v16 offset:16480
  ds_read_b64_tr_b16 a[214:215], v16 offset:16512
  s_waitcnt lgkmcnt(5)
  s_waitcnt lgkmcnt(0)
  s_add_u32 m0, s50, 16384
  s_nop 0
  buffer_load_dwordx4 v10, s[16:19], s48 offen lds
  s_add_u32 s48, s48, 7680
  s_add_u32 m0, s50, 17408
  s_nop 0
  buffer_load_dwordx4 v10, s[16:19], s48 offen lds
  s_add_u32 s48, s48, 7680
  s_add_u32 m0, s50, 18432
  s_nop 0
  buffer_load_dwordx4 v10, s[16:19], s48 offen lds
  s_add_u32 s48, s48, 7680
  s_add_u32 m0, s50, 19456
  s_nop 0
  buffer_load_dwordx4 v10, s[16:19], s48 offen lds
  s_add_u32 s48, s48, 7680
  s_add_u32 m0, s50, 20480
  s_nop 0
  buffer_load_dwordx4 v10, s[16:19], s48 offen lds
  s_add_u32 s48, s48, 7680
  s_add_u32 m0, s50, 21504
  s_nop 0
  buffer_load_dwordx4 v10, s[16:19], s48 offen lds
  s_add_u32 s48, s48, 7680
  s_add_u32 m0, s50, 22528
  s_nop 0
  buffer_load_dwordx4 v10, s[16:19], s48 offen lds
  s_add_u32 s48, s48, 7680
  s_add_u32 m0, s50, 23552
  s_nop 0
  buffer_load_dwordx4 v10, s[16:19], s48 offen lds
  s_add_u32 s48, s48, 7680
  s_add_u32 m0, s50, 24576
  s_nop 0
  buffer_load_dwordx4 v10, s[16:19], s48 offen lds
  s_add_u32 s48, s48, 7680
  s_add_u32 m0, s50, 25600
  s_nop 0
  buffer_load_dwordx4 v10, s[16:19], s48 offen lds
  s_add_u32 s48, s48, 7680
  s_add_u32 m0, s50, 26624
  s_nop 0
  buffer_load_dwordx4 v10, s[16:19], s48 offen lds
  s_add_u32 s48, s48, 7680
  s_add_u32 m0, s50, 27648
  s_nop 0
  buffer_load_dwordx4 v10, s[16:19], s48 offen lds
  s_add_u32 s48, s48, 7680
  s_add_u32 m0, s50, 28672
  s_nop 0
  buffer_load_dwordx4 v10, s[16:19], s48 offen lds
  s_add_u32 s48, s48, 7680
  s_add_u32 m0, s50, 29696
  s_nop 0
  buffer_load_dwordx4 v10, s[16:19], s48 offen lds
  s_add_u32 s48, s48, 7680
  s_add_u32 m0, s50, 30720
  s_nop 0
  buffer_load_dwordx4 v10, s[16:19], s48 offen lds
  s_add_u32 s48, s48, 7680
  s_add_u32 m0, s50, 31744
  s_nop 0
  buffer_load_dwordx4 v10, s[16:19], s48 offen lds
  s_add_u32 s48, s48, 7680
  s_waitcnt vmcnt(16)
  ds_read_b64_tr_b16 a[24:25], v11 offset:0
  ds_read_b64_tr_b16 a[72:73], v11 offset:32
  ds_read_b64_tr_b16 a[120:121], v11 offset:64
  ds_read_b64_tr_b16 a[168:169], v11 offset:96
  ds_read_b64_tr_b16 a[216:217], v11 offset:128
  s_waitcnt lgkmcnt(5)
  ds_read_b64_tr_b16 a[26:27], v12 offset:0
  ds_read_b64_tr_b16 a[74:75], v12 offset:32
  ds_read_b64_tr_b16 a[122:123], v12 offset:64
  ds_read_b64_tr_b16 a[170:171], v12 offset:96
  ds_read_b64_tr_b16 a[218:219], v12 offset:128
  s_waitcnt lgkmcnt(5)
  ds_read_b64_tr_b16 a[28:29], v13 offset:0
  ds_read_b64_tr_b16 a[76:77], v13 offset:32
  ds_read_b64_tr_b16 a[124:125], v13 offset:64
  ds_read_b64_tr_b16 a[172:173], v13 offset:96
  ds_read_b64_tr_b16 a[220:221], v13 offset:128
  s_waitcnt lgkmcnt(5)
  ds_read_b64_tr_b16 a[30:31], v14 offset:0
  ds_read_b64_tr_b16 a[78:79], v14 offset:32
  ds_read_b64_tr_b16 a[126:127], v14 offset:64
  ds_read_b64_tr_b16 a[174:175], v14 offset:96
  ds_read_b64_tr_b16 a[222:223], v14 offset:128
  s_waitcnt lgkmcnt(5)
  ds_read_b64_tr_b16 a[32:33], v15 offset:0
  ds_read_b64_tr_b16 a[80:81], v15 offset:32
  ds_read_b64_tr_b16 a[128:129], v15 offset:64
  ds_read_b64_tr_b16 a[176:177], v15 offset:96
  ds_read_b64_tr_b16 a[224:225], v15 offset:128
  s_waitcnt lgkmcnt(5)
  ds_read_b64_tr_b16 a[34:35], v16 offset:0
  ds_read_b64_tr_b16 a[82:83], v16 offset:32
  ds_read_b64_tr_b16 a[130:131], v16 offset:64
  ds_read_b64_tr_b16 a[178:179], v16 offset:96
  ds_read_b64_tr_b16 a[226:227], v16 offset:128
  s_waitcnt lgkmcnt(5)
  s_waitcnt lgkmcnt(0)
  s_waitcnt vmcnt(0)
  ds_read_b64_tr_b16 a[36:37], v11 offset:16384
  ds_read_b64_tr_b16 a[84:85], v11 offset:16416
  ds_read_b64_tr_b16 a[132:133], v11 offset:16448
  ds_read_b64_tr_b16 a[180:181], v11 offset:16480
  ds_read_b64_tr_b16 a[228:229], v11 offset:16512
  s_waitcnt lgkmcnt(5)
  ds_read_b64_tr_b16 a[38:39], v12 offset:16384
  ds_read_b64_tr_b16 a[86:87], v12 offset:16416
  ds_read_b64_tr_b16 a[134:135], v12 offset:16448
  ds_read_b64_tr_b16 a[182:183], v12 offset:16480
  ds_read_b64_tr_b16 a[230:231], v12 offset:16512
  s_waitcnt lgkmcnt(5)
  ds_read_b64_tr_b16 a[40:41], v13 offset:16384
  ds_read_b64_tr_b16 a[88:89], v13 offset:16416
  ds_read_b64_tr_b16 a[136:137], v13 offset:16448
  ds_read_b64_tr_b16 a[184:185], v13 offset:16480
  ds_read_b64_tr_b16 a[232:233], v13 offset:16512
  s_waitcnt lgkmcnt(5)
  ds_read_b64_tr_b16 a[42:43], v14 offset:16384
  ds_read_b64_tr_b16 a[90:91], v14 offset:16416
  ds_read_b64_tr_b16 a[138:139], v14 offset:16448
  ds_read_b64_tr_b16 a[186:187], v14 offset:16480
  ds_read_b64_tr_b16 a[234:235], v14 offset:16512
  s_waitcnt lgkmcnt(5)
  ds_read_b64_tr_b16 a[44:45], v15 offset:16384
  ds_read_b64_tr_b16 a[92:93], v15 offset:16416
  ds_read_b64_tr_b16 a[140:141], v15 offset:16448
  ds_read_b64_tr_b16 a[188:189], v15 offset:16480
  ds_read_b64_tr_b16 a[236:237], v15 offset:16512
  s_waitcnt lgkmcnt(5)
  ds_read_b64_tr_b16 a[46:47], v16 offset:16384
  ds_read_b64_tr_b16 a[94:95], v16 offset:16416
  ds_read_b64_tr_b16 a[142:143], v16 offset:16448
  ds_read_b64_tr_b16 a[190:191], v16 offset:16480
  ds_read_b64_tr_b16 a[238:239], v16 offset:16512
  s_waitcnt lgkmcnt(5)
  s_waitcnt lgkmcnt(0)
  s_add_u32 s34, s34, 134217728
  s_add_u32 s40, s40, 52178944
  v_bfe_u32 v8, v0, 2, 1
  v_and_b32 v9, 3, v0
  v_lshlrev_b32 v9, 2, v9
  v_lshl_add_u32 v3, v8, 7, v9
  v_mov_b32 v2, 0
  s_lshl_b32 s38, s31, 2
  s_add_u32 s38, s38, s30
  s_mul_i32 s38, s38, 10240
  s_lshl_b32 s48, s12, 10
  s_add_u32 s38, s38, s48
  s_add_u32 s38, s38, 159383552
  v_add_u32 v5, s48, v1
  s_mul_i32 s48, s12, 10240
  v_add_u32 v4, s48, v1
  v_add_u32 v8, 8192, v1
  v_mov_b32 v9, 2147483648
  s_cmp_lt_u32 s12, 2
  s_cselect_b64 vcc, -1, 0
  v_cndmask_b32 v6, v9, v8, vcc
  s_lshl_b32 s39, s31, 9
  s_lshl_b32 s48, s12, 7
  s_add_u32 s39, s39, s48
  s_lshl_b32 s48, s30, 2
  s_add_u32 s39, s39, s48
  s_add_u32 s39, s39, 52191232
  s_mov_b32 s41, 0
  s_load_dwordx4 s[20:23], s[0:1], 64
  s_load_dwordx2 s[24:25], s[0:1], 0
  s_load_dwordx2 s[28:29], s[0:1], 88
  s_lshl_b32 s48, s13, 2
  s_add_u32 s48, s48, s12
  s_mul_i32 s48, s48, 20480
  s_waitcnt lgkmcnt(0)
  s_mov_b32 s16, s24
  s_mov_b32 s17, s25
  s_mov_b32 s18, 2621440
  s_mov_b32 s19, 0x20000
  s_mov_b32 s49, s48
  buffer_load_dwordx4 v[18:21], v1, s[16:19], s49 offen offset:0
  buffer_load_dwordx4 v[22:25], v1, s[16:19], s49 offen offset:1024
  buffer_load_dwordx4 v[26:29], v1, s[16:19], s49 offen offset:2048
  buffer_load_dwordx4 v[30:33], v1, s[16:19], s49 offen offset:3072
  s_add_u32 s49, s49, 4096
  buffer_load_dwordx4 v[34:37], v1, s[16:19], s49 offen offset:0
  buffer_load_dwordx4 v[38:41], v1, s[16:19], s49 offen offset:1024
  buffer_load_dwordx4 v[42:45], v1, s[16:19], s49 offen offset:2048
  buffer_load_dwordx4 v[46:49], v1, s[16:19], s49 offen offset:3072
  s_add_u32 s49, s49, 4096
  buffer_load_dwordx4 v[50:53], v1, s[16:19], s49 offen offset:0
  buffer_load_dwordx4 v[54:57], v1, s[16:19], s49 offen offset:1024
  buffer_load_dwordx4 v[58:61], v1, s[16:19], s49 offen offset:2048
  buffer_load_dwordx4 v[62:65], v1, s[16:19], s49 offen offset:3072
  s_add_u32 s49, s49, 4096
  buffer_load_dwordx4 v[66:69], v1, s[16:19], s49 offen offset:0
  buffer_load_dwordx4 v[70:73], v1, s[16:19], s49 offen offset:1024
  buffer_load_dwordx4 v[74:77], v1, s[16:19], s49 offen offset:2048
  buffer_load_dwordx4 v[78:81], v1, s[16:19], s49 offen offset:3072
  s_add_u32 s49, s49, 4096
  buffer_load_dwordx4 v[82:85], v1, s[16:19], s49 offen offset:0
  buffer_load_dwordx4 v[86:89], v1, s[16:19], s49 offen offset:1024
  buffer_load_dwordx4 v[90:93], v1, s[16:19], s49 offen offset:2048
  buffer_load_dwordx4 v[94:97], v1, s[16:19], s49 offen offset:3072
  s_add_u32 s49, s49, 4096
  s_waitcnt vmcnt(0)
  s_mov_b32 s16, s20
  s_mov_b32 s17, s21
  s_mov_b32 s18, 2621440
  s_mov_b32 s19, 0x20000
  s_mov_b32 s49, s48
  buffer_load_dwordx4 v[18:21], v1, s[16:19], s49 offen offset:0
  buffer_load_dwordx4 v[22:25], v1, s[16:19], s49 offen offset:1024
  buffer_load_dwordx4 v[26:29], v1, s[16:19], s49 offen offset:2048
  buffer_load_dwordx4 v[30:33], v1, s[16:19], s49 offen offset:3072
  s_add_u32 s49, s49, 4096
  buffer_load_dwordx4 v[34:37], v1, s[16:19], s49 offen offset:0
  buffer_load_dwordx4 v[38:41], v1, s[16:19], s49 offen offset:1024
  buffer_load_dwordx4 v[42:45], v1, s[16:19], s49 offen offset:2048
  buffer_load_dwordx4 v[46:49], v1, s[16:19], s49 offen offset:3072
  s_add_u32 s49, s49, 4096
  buffer_load_dwordx4 v[50:53], v1, s[16:19], s49 offen offset:0
  buffer_load_dwordx4 v[54:57], v1, s[16:19], s49 offen offset:1024
  buffer_load_dwordx4 v[58:61], v1, s[16:19], s49 offen offset:2048
  buffer_load_dwordx4 v[62:65], v1, s[16:19], s49 offen offset:3072
  s_add_u32 s49, s49, 4096
  buffer_load_dwordx4 v[66:69], v1, s[16:19], s49 offen offset:0
  buffer_load_dwordx4 v[70:73], v1, s[16:19], s49 offen offset:1024
  buffer_load_dwordx4 v[74:77], v1, s[16:19], s49 offen offset:2048
  buffer_load_dwordx4 v[78:81], v1, s[16:19], s49 offen offset:3072
  s_add_u32 s49, s49, 4096
  buffer_load_dwordx4 v[82:85], v1, s[16:19], s49 offen offset:0
  buffer_load_dwordx4 v[86:89], v1, s[16:19], s49 offen offset:1024
  buffer_load_dwordx4 v[90:93], v1, s[16:19], s49 offen offset:2048
  buffer_load_dwordx4 v[94:97], v1, s[16:19], s49 offen offset:3072
  s_add_u32 s49, s49, 4096
  s_waitcnt vmcnt(0)
  s_mov_b32 s16, s22
  s_mov_b32 s17, s23
  s_mov_b32 s18, 2621440
  s_mov_b32 s19, 0x20000
  s_mov_b32 s49, s48
  buffer_load_dwordx4 v[18:21], v1, s[16:19], s49 offen offset:0
  buffer_load_dwordx4 v[22:25], v1, s[16:19], s49 offen offset:1024
  buffer_load_dwordx4 v[26:29], v1, s[16:19], s49 offen offset:2048
  buffer_load_dwordx4 v[30:33], v1, s[16:19], s49 offen offset:3072
  s_add_u32 s49, s49, 4096
  buffer_load_dwordx4 v[34:37], v1, s[16:19], s49 offen offset:0
  buffer_load_dwordx4 v[38:41], v1, s[16:19], s49 offen offset:1024
  buffer_load_dwordx4 v[42:45], v1, s[16:19], s49 offen offset:2048
  buffer_load_dwordx4 v[46:49], v1, s[16:19], s49 offen offset:3072
  s_add_u32 s49, s49, 4096
  buffer_load_dwordx4 v[50:53], v1, s[16:19], s49 offen offset:0
  buffer_load_dwordx4 v[54:57], v1, s[16:19], s49 offen offset:1024
  buffer_load_dwordx4 v[58:61], v1, s[16:19], s49 offen offset:2048
  buffer_load_dwordx4 v[62:65], v1, s[16:19], s49 offen offset:3072
  s_add_u32 s49, s49, 4096
  buffer_load_dwordx4 v[66:69], v1, s[16:19], s49 offen offset:0
  buffer_load_dwordx4 v[70:73], v1, s[16:19], s49 offen offset:1024
  buffer_load_dwordx4 v[74:77], v1, s[16:19], s49 offen offset:2048
  buffer_load_dwordx4 v[78:81], v1, s[16:19], s49 offen offset:3072
  s_add_u32 s49, s49, 4096
  buffer_load_dwordx4 v[82:85], v1, s[16:19], s49 offen offset:0
  buffer_load_dwordx4 v[86:89], v1, s[16:19], s49 offen offset:1024
  buffer_load_dwordx4 v[90:93], v1, s[16:19], s49 offen offset:2048
  buffer_load_dwordx4 v[94:97], v1, s[16:19], s49 offen offset:3072
  s_add_u32 s49, s49, 4096
  s_waitcnt vmcnt(0)
  s_mov_b32 s16, s28
  s_mov_b32 s17, s29
  s_mov_b32 s18, 2621440
  s_mov_b32 s19, 0x20000
  s_mov_b32 s49, s48
  buffer_load_dwordx4 v[18:21], v1, s[16:19], s49 offen offset:0
  buffer_load_dwordx4 v[22:25], v1, s[16:19], s49 offen offset:1024
  buffer_load_dwordx4 v[26:29], v1, s[16:19], s49 offen offset:2048
  buffer_load_dwordx4 v[30:33], v1, s[16:19], s49 offen offset:3072
  s_add_u32 s49, s49, 4096
  buffer_load_dwordx4 v[34:37], v1, s[16:19], s49 offen offset:0
  buffer_load_dwordx4 v[38:41], v1, s[16:19], s49 offen offset:1024
  buffer_load_dwordx4 v[42:45], v1, s[16:19], s49 offen offset:2048
  buffer_load_dwordx4 v[46:49], v1, s[16:19], s49 offen offset:3072
  s_add_u32 s49, s49, 4096
  buffer_load_dwordx4 v[50:53], v1, s[16:19], s49 offen offset:0
  buffer_load_dwordx4 v[54:57], v1, s[16:19], s49 offen offset:1024
  buffer_load_dwordx4 v[58:61], v1, s[16:19], s49 offen offset:2048
  buffer_load_dwordx4 v[62:65], v1, s[16:19], s49 offen offset:3072
  s_add_u32 s49, s49, 4096
  buffer_load_dwordx4 v[66:69], v1, s[16:19], s49 offen offset:0
  buffer_load_dwordx4 v[70:73], v1, s[16:19], s49 offen offset:1024
  buffer_load_dwordx4 v[74:77], v1, s[16:19], s49 offen offset:2048
  buffer_load_dwordx4 v[78:81], v1, s[16:19], s49 offen offset:3072
  s_add_u32 s49, s49, 4096
  buffer_load_dwordx4 v[82:85], v1, s[16:19], s49 offen offset:0
  buffer_load_dwordx4 v[86:89], v1, s[16:19], s49 offen offset:1024
  buffer_load_dwordx4 v[90:93], v1, s[16:19], s49 offen offset:2048
  buffer_load_dwordx4 v[94:97], v1, s[16:19], s49 offen offset:3072
  s_add_u32 s49, s49, 4096
  s_waitcnt vmcnt(0)
  v_mov_b32 v8, 48
  s_mov_b32 s14, 240
  v_writelane_b32 v8, s14, 0
  s_mov_b32 s15, 0
L_o_go:
  buffer_load_dword v9, v8, s[8:11], 0 offen sc1
  s_waitcnt vmcnt(0)
  v_cmp_eq_u32 vcc, 0, v9
  s_cbranch_vccz L_o_go_ok
  s_sleep 2
  s_add_u32 s15, s15, 1
  s_cmp_lt_u32 s15, 262144
  s_cbranch_scc1 L_o_go
  s_branch L_fail
L_o_go_ok:
  v_readfirstlane_b32 s14, v9
  s_nop 0
  s_sub_u32 s14, s14, 1
  s_lshl_b32 s48, s14, 13
  s_xor_b32 s39, s39, s48
  s_xor_b32 s40, s40, s48
  s_barrier
  s_mov_b32 s32, 0
  s_mov_b32 s43, 0
  v_mov_b32 v7, 0
  s_add_u32 s44, s34, 4096
  s_add_u32 s35, s34, 6144
  s_add_u32 s45, s34, 10240
  s_add_u32 s36, s34, 12288
  s_add_u32 s46, s34, 16384
  s_add_u32 s37, s34, 18432
  s_add_u32 s47, s34, 22528
L_o_seg0:
  s_add_u32 s42, s32, 1
  s_add_u32 s41, s32, 2
  s_cmp_lg_u32 s43, 0
  s_waitcnt vmcnt(3)
  s_cbranch_scc1 L_o_pre0
  v_cmp_gt_u32 vcc, s42, v7
  s_nop 0
  s_and_b64 vcc, vcc, 0xff
  s_cbranch_scc0 L_o_go0
  s_waitcnt vmcnt(0)
  v_mov_b32 v8, s32
  s_mov_b64 exec, 1
  buffer_store_dword v8, v2, s[4:7], s39 offen sc1
  s_mov_b64 exec, -1
  s_mov_b64 exec, 0xff
  s_mov_b32 s15, 0
L_o_qa0:
  v_mov_b32 v7, 0
  buffer_atomic_add v7, v3, s[4:7], s40 offen sc0 sc1
  s_waitcnt vmcnt(0)
  v_cmp_gt_u32 vcc, s42, v7
  s_cbranch_vccz L_o_qa0_ok
  s_sleep 2
  s_add_u32 s15, s15, 1
  s_cmp_lt_u32 s15, 262144
  s_cbranch_scc1 L_o_qa0
  s_branch L_fail
L_o_qa0_ok:
  s_mov_b64 exec, -1
L_o_go0:
  buffer_load_dwordx4 v[18:21], v1, s[4:7], s34 offen offset:0 sc1
  buffer_load_dwordx4 v[22:25], v1, s[4:7], s35 offen offset:0 sc1
  buffer_load_dwordx4 v[26:29], v1, s[4:7], s34 offen offset:1024 sc1
  buffer_load_dwordx4 v[30:33], v1, s[4:7], s35 offen offset:1024 sc1
  v_cmp_gt_u32 vcc, s41, v7
  s_nop 0
  s_and_b64 vcc, vcc, 0xff
  s_cselect_b32 s43, 0, 1
  s_nop 15
  s_nop 15
  s_nop 7
  buffer_load_dwordx4 v[34:37], v1, s[4:7], s34 offen offset:2048 sc1
  buffer_load_dwordx4 v[38:41], v1, s[4:7], s35 offen offset:2048 sc1
  buffer_load_dwordx4 v[42:45], v1, s[4:7], s34 offen offset:3072 sc1
  buffer_load_dwordx4 v[46:49], v1, s[4:7], s35 offen offset:3072 sc1
  buffer_load_dwordx4 v[50:53], v1, s[4:7], s44 offen offset:0 sc1
  buffer_load_dwordx4 v[54:57], v1, s[4:7], s45 offen offset:0 sc1
  buffer_load_dwordx4 v[58:61], v1, s[4:7], s44 offen offset:1024 sc1
  buffer_load_dwordx4 v[62:65], v1, s[4:7], s45 offen offset:1024 sc1
  s_waitcnt vmcnt(11)
  v_mfma_f32_16x16x32_bf16 v[114:117], a[0:3], v[18:21], 0
  v_mfma_f32_16x16x32_bf16 v[118:121], a[48:51], v[18:21], 0
  v_mfma_f32_16x16x32_bf16 v[122:125], a[96:99], v[18:21], 0
  v_mfma_f32_16x16x32_bf16 v[126:129], a[144:147], v[18:21], 0
  v_mfma_f32_16x16x32_bf16 v[130:133], a[192:195], v[18:21], 0
  buffer_load_dwordx4 v[66:69], v1, s[4:7], s36 offen offset:0 sc1
  s_waitcnt vmcnt(11)
  v_mfma_f32_16x16x32_bf16 v[134:137], a[0:3], v[22:25], 0
  v_mfma_f32_16x16x32_bf16 v[138:141], a[48:51], v[22:25], 0
  v_mfma_f32_16x16x32_bf16 v[142:145], a[96:99], v[22:25], 0
  v_mfma_f32_16x16x32_bf16 v[146:149], a[144:147], v[22:25], 0
  v_mfma_f32_16x16x32_bf16 v[150:153], a[192:195], v[22:25], 0
  buffer_load_dwordx4 v[70:73], v1, s[4:7], s37 offen offset:0 sc1
  s_waitcnt vmcnt(11)
  v_mfma_f32_16x16x32_bf16 v[114:117], a[4:7], v[26:29], v[114:117]
  v_mfma_f32_16x16x32_bf16 v[118:121], a[52:55], v[26:29], v[118:121]
  v_mfma_f32_16x16x32_bf16 v[122:125], a[100:103], v[26:29], v[122:125]
  v_mfma_f32_16x16x32_bf16 v[126:129], a[148:151], v[26:29], v[126:129]
  v_mfma_f32_16x16x32_bf16 v[130:133], a[196:199], v[26:29], v[130:133]
  buffer_load_dwordx4 v[74:77], v1, s[4:7], s36 offen offset:1024 sc1
  s_waitcnt vmcnt(11)
  v_mfma_f32_16x16x32_bf16 v[134:137], a[4:7], v[30:33], v[134:137]
  v_mfma_f32_16x16x32_bf16 v[138:141], a[52:55], v[30:33], v[138:141]
  v_mfma_f32_16x16x32_bf16 v[142:145], a[100:103], v[30:33], v[142:145]
  v_mfma_f32_16x16x32_bf16 v[146:149], a[148:151], v[30:33], v[146:149]
  v_mfma_f32_16x16x32_bf16 v[150:153], a[196:199], v[30:33], v[150:153]
  buffer_load_dwordx4 v[78:81], v1, s[4:7], s37 offen offset:1024 sc1
  s_waitcnt vmcnt(11)
  v_mfma_f32_16x16x32_bf16 v[114:117], a[8:11], v[34:37], v[114:117]
  v_mfma_f32_16x16x32_bf16 v[118:121], a[56:59], v[34:37], v[118:121]
  v_mfma_f32_16x16x32_bf16 v[122:125], a[104:107], v[34:37], v[122:125]
  v_mfma_f32_16x16x32_bf16 v[126:129], a[152:155], v[34:37], v[126:129]
  v_mfma_f32_16x16x32_bf16 v[130:133], a[200:203], v[34:37], v[130:133]
  buffer_load_dwordx4 v[82:85], v1, s[4:7], s36 offen offset:2048 sc1
  s_waitcnt vmcnt(11)
  v_mfma_f32_16x16x32_bf16 v[134:137], a[8:11], v[38:41], v[134:137]
  v_mfma_f32_16x16x32_bf16 v[138:141], a[56:59], v[38:41], v[138:141]
  v_mfma_f32_16x16x32_bf16 v[142:145], a[104:107], v[38:41], v[142:145]
  v_mfma_f32_16x16x32_bf16 v[146:149], a[152:155], v[38:41], v[146:149]
  v_mfma_f32_16x16x32_bf16 v[150:153], a[200:203], v[38:41], v[150:153]
  buffer_load_dwordx4 v[86:89], v1, s[4:7], s37 offen offset:2048 sc1
  s_waitcnt vmcnt(11)
  v_mfma_f32_16x16x32_bf16 v[114:117], a[12:15], v[42:45], v[114:117]
  v_mfma_f32_16x16x32_bf16 v[118:121], a[60:63], v[42:45], v[118:121]
  v_mfma_f32_16x16x32_bf16 v[122:125], a[108:111], v[42:45], v[122:125]
  v_mfma_f32_16x16x32_bf16 v[126:129], a[156:159], v[42:45], v[126:129]
  v_mfma_f32_16x16x32_bf16 v[130:133], a[204:207], v[42:45], v[130:133]
  buffer_load_dwordx4 v[90:93], v1, s[4:7], s36 offen offset:3072 sc1
  s_waitcnt vmcnt(11)
  v_mfma_f32_16x16x32_bf16 v[134:137], a[12:15], v[46:49], v[134:137]
  v_mfma_f32_16x16x32_bf16 v[138:141], a[60:63], v[46:49], v[138:141]
  v_mfma_f32_16x16x32_bf16 v[142:145], a[108:111], v[46:49], v[142:145]
  v_mfma_f32_16x16x32_bf16 v[146:149], a[156:159], v[46:49], v[146:149]
  v_mfma_f32_16x16x32_bf16 v[150:153], a[204:207], v[46:49], v[150:153]
  buffer_load_dwordx4 v[94:97], v1, s[4:7], s37 offen offset:3072 sc1
  s_waitcnt vmcnt(11)
  v_mfma_f32_16x16x32_bf16 v[114:117], a[16:19], v[50:53], v[114:117]
  v_mfma_f32_16x16x32_bf16 v[118:121], a[64:67], v[50:53], v[118:121]
  v_mfma_f32_16x16x32_bf16 v[122:125], a[112:115], v[50:53], v[122:125]
  v_mfma_f32_16x16x32_bf16 v[126:129], a[160:163], v[50:53], v[126:129]
  v_mfma_f32_16x16x32_bf16 v[130:133], a[208:211], v[50:53], v[130:133]
  buffer_load_dwordx4 v[98:101], v1, s[4:7], s46 offen offset:0 sc1
  s_waitcnt vmcnt(11)
  v_mfma_f32_16x16x32_bf16 v[134:137], a[16:19], v[54:57], v[134:137]
  v_mfma_f32_16x16x32_bf16 v[138:141], a[64:67], v[54:57], v[138:141]
  v_mfma_f32_16x16x32_bf16 v[142:145], a[112:115], v[54:57], v[142:145]
  v_mfma_f32_16x16x32_bf16 v[146:149], a[160:163], v[54:57], v[146:149]
  v_mfma_f32_16x16x32_bf16 v[150:153], a[208:211], v[54:57], v[150:153]
  buffer_load_dwordx4 v[102:105], v1, s[4:7], s47 offen offset:0 sc1
  s_waitcnt vmcnt(11)
  v_mfma_f32_16x16x32_bf16 v[114:117], a[20:23], v[58:61], v[114:117]
  v_mfma_f32_16x16x32_bf16 v[118:121], a[68:71], v[58:61], v[118:121]
  v_mfma_f32_16x16x32_bf16 v[122:125], a[116:119], v[58:61], v[122:125]
  v_mfma_f32_16x16x32_bf16 v[126:129], a[164:167], v[58:61], v[126:129]
  v_mfma_f32_16x16x32_bf16 v[130:133], a[212:215], v[58:61], v[130:133]
  buffer_load_dwordx4 v[106:109], v1, s[4:7], s46 offen offset:1024 sc1
  s_waitcnt vmcnt(11)
  v_mfma_f32_16x16x32_bf16 v[134:137], a[20:23], v[62:65], v[134:137]
  v_mfma_f32_16x16x32_bf16 v[138:141], a[68:71], v[62:65], v[138:141]
  v_mfma_f32_16x16x32_bf16 v[142:145], a[116:119], v[62:65], v[142:145]
  v_mfma_f32_16x16x32_bf16 v[146:149], a[164:167], v[62:65], v[146:149]
  v_mfma_f32_16x16x32_bf16 v[150:153], a[212:215], v[62:65], v[150:153]
  buffer_load_dwordx4 v[110:113], v1, s[4:7], s47 offen offset:1024 sc1
  s_waitcnt vmcnt(11)
  v_mov_b32 v8, s32
  s_mov_b64 exec, 1
  buffer_store_dword v8, v2, s[4:7], s39 offen sc1
  s_mov_b64 exec, -1
  v_mfma_f32_16x16x32_bf16 v[114:117], a[24:27], v[66:69], v[114:117]
  v_mfma_f32_16x16x32_bf16 v[118:121], a[72:75], v[66:69], v[118:121]
  v_mfma_f32_16x16x32_bf16 v[122:125], a[120:123], v[66:69], v[122:125]
  v_mfma_f32_16x16x32_bf16 v[126:129], a[168:171], v[66:69], v[126:129]
  v_mfma_f32_16x16x32_bf16 v[130:133], a[216:219], v[66:69], v[130:133]
  s_waitcnt vmcnt(11)
  v_mfma_f32_16x16x32_bf16 v[134:137], a[24:27], v[70:73], v[134:137]
  v_mfma_f32_16x16x32_bf16 v[138:141], a[72:75], v[70:73], v[138:141]
  v_mfma_f32_16x16x32_bf16 v[142:145], a[120:123], v[70:73], v[142:145]
  v_mfma_f32_16x16x32_bf16 v[146:149], a[168:171], v[70:73], v[146:149]
  v_mfma_f32_16x16x32_bf16 v[150:153], a[216:219], v[70:73], v[150:153]
  s_waitcnt vmcnt(10)
  v_mfma_f32_16x16x32_bf16 v[114:117], a[28:31], v[74:77], v[114:117]
  v_mfma_f32_16x16x32_bf16 v[118:121], a[76:79], v[74:77], v[118:121]
  v_mfma_f32_16x16x32_bf16 v[122:125], a[124:127], v[74:77], v[122:125]
  v_mfma_f32_16x16x32_bf16 v[126:129], a[172:175], v[74:77], v[126:129]
  v_mfma_f32_16x16x32_bf16 v[130:133], a[220:223], v[74:77], v[130:133]
  s_waitcnt vmcnt(9)
  v_mfma_f32_16x16x32_bf16 v[134:137], a[28:31], v[78:81], v[134:137]
  v_mfma_f32_16x16x32_bf16 v[138:141], a[76:79], v[78:81], v[138:141]
  v_mfma_f32_16x16x32_bf16 v[142:145], a[124:127], v[78:81], v[142:145]
  v_mfma_f32_16x16x32_bf16 v[146:149], a[172:175], v[78:81], v[146:149]
  v_mfma_f32_16x16x32_bf16 v[150:153], a[220:223], v[78:81], v[150:153]
  s_waitcnt vmcnt(8)
  v_mfma_f32_16x16x32_bf16 v[114:117], a[32:35], v[82:85], v[114:117]
  v_mfma_f32_16x16x32_bf16 v[118:121], a[80:83], v[82:85], v[118:121]
  v_mfma_f32_16x16x32_bf16 v[122:125], a[128:131], v[82:85], v[122:125]
  v_mfma_f32_16x16x32_bf16 v[126:129], a[176:179], v[82:85], v[126:129]
  v_mfma_f32_16x16x32_bf16 v[130:133], a[224:227], v[82:85], v[130:133]
  s_waitcnt vmcnt(7)
  v_mfma_f32_16x16x32_bf16 v[134:137], a[32:35], v[86:89], v[134:137]
  v_mfma_f32_16x16x32_bf16 v[138:141], a[80:83], v[86:89], v[138:141]
  v_mfma_f32_16x16x32_bf16 v[142:145], a[128:131], v[86:89], v[142:145]
  v_mfma_f32_16x16x32_bf16 v[146:149], a[176:179], v[86:89], v[146:149]
  v_mfma_f32_16x16x32_bf16 v[150:153], a[224:227], v[86:89], v[150:153]
  s_waitcnt vmcnt(6)
  v_mfma_f32_16x16x32_bf16 v[114:117], a[36:39], v[90:93], v[114:117]
  v_mfma_f32_16x16x32_bf16 v[118:121], a[84:87], v[90:93], v[118:121]
  v_mfma_f32_16x16x32_bf16 v[122:125], a[132:135], v[90:93], v[122:125]
  v_mfma_f32_16x16x32_bf16 v[126:129], a[180:183], v[90:93], v[126:129]
  v_mfma_f32_16x16x32_bf16 v[130:133], a[228:231], v[90:93], v[130:133]
  s_waitcnt vmcnt(5)
  v_mfma_f32_16x16x32_bf16 v[134:137], a[36:39], v[94:97], v[134:137]
  v_mfma_f32_16x16x32_bf16 v[138:141], a[84:87], v[94:97], v[138:141]
  v_mfma_f32_16x16x32_bf16 v[142:145], a[132:135], v[94:97], v[142:145]
  v_mfma_f32_16x16x32_bf16 v[146:149], a[180:183], v[94:97], v[146:149]
  v_mfma_f32_16x16x32_bf16 v[150:153], a[228:231], v[94:97], v[150:153]
  s_waitcnt vmcnt(4)
  v_mfma_f32_16x16x32_bf16 v[114:117], a[40:43], v[98:101], v[114:117]
  v_mfma_f32_16x16x32_bf16 v[118:121], a[88:91], v[98:101], v[118:121]
  v_mfma_f32_16x16x32_bf16 v[122:125], a[136:139], v[98:101], v[122:125]
  v_mfma_f32_16x16x32_bf16 v[126:129], a[184:187], v[98:101], v[126:129]
  v_mfma_f32_16x16x32_bf16 v[130:133], a[232:235], v[98:101], v[130:133]
  s_waitcnt vmcnt(3)
  v_mfma_f32_16x16x32_bf16 v[134:137], a[40:43], v[102:105], v[134:137]
  v_mfma_f32_16x16x32_bf16 v[138:141], a[88:91], v[102:105], v[138:141]
  v_mfma_f32_16x16x32_bf16 v[142:145], a[136:139], v[102:105], v[142:145]
  v_mfma_f32_16x16x32_bf16 v[146:149], a[184:187], v[102:105], v[146:149]
  v_mfma_f32_16x16x32_bf16 v[150:153], a[232:235], v[102:105], v[150:153]
  s_waitcnt vmcnt(2)
  v_mfma_f32_16x16x32_bf16 v[114:117], a[44:47], v[106:109], v[114:117]
  v_mfma_f32_16x16x32_bf16 v[118:121], a[92:95], v[106:109], v[118:121]
  v_mfma_f32_16x16x32_bf16 v[122:125], a[140:143], v[106:109], v[122:125]
  v_mfma_f32_16x16x32_bf16 v[126:129], a[188:191], v[106:109], v[126:129]
  v_mfma_f32_16x16x32_bf16 v[130:133], a[236:239], v[106:109], v[130:133]
  s_waitcnt vmcnt(1)
  v_mfma_f32_16x16x32_bf16 v[134:137], a[44:47], v[110:113], v[134:137]
  v_mfma_f32_16x16x32_bf16 v[138:141], a[92:95], v[110:113], v[138:141]
  v_mfma_f32_16x16x32_bf16 v[142:145], a[140:143], v[110:113], v[142:145]
  v_mfma_f32_16x16x32_bf16 v[146:149], a[188:191], v[110:113], v[146:149]
  v_mfma_f32_16x16x32_bf16 v[150:153], a[236:239], v[110:113], v[150:153]
  s_add_u32 s34, s34, 393216
  s_add_u32 s44, s34, 4096
  s_add_u32 s35, s34, 6144
  s_add_u32 s45, s34, 10240
  s_add_u32 s36, s34, 12288
  s_add_u32 s46, s34, 16384
  s_add_u32 s37, s34, 18432
  s_add_u32 s47, s34, 22528
  s_cmp_eq_u32 s43, 0
  s_cbranch_scc1 L_o_red0
  buffer_load_dwordx4 v[18:21], v1, s[4:7], s34 offen offset:0 sc1
  buffer_load_dwordx4 v[22:25], v1, s[4:7], s35 offen offset:0 sc1
  buffer_load_dwordx4 v[26:29], v1, s[4:7], s34 offen offset:1024 sc1
  buffer_load_dwordx4 v[30:33], v1, s[4:7], s35 offen offset:1024 sc1
  buffer_load_dwordx4 v[34:37], v1, s[4:7], s34 offen offset:2048 sc1
  buffer_load_dwordx4 v[38:41], v1, s[4:7], s35 offen offset:2048 sc1
  buffer_load_dwordx4 v[42:45], v1, s[4:7], s34 offen offset:3072 sc1
  buffer_load_dwordx4 v[46:49], v1, s[4:7], s35 offen offset:3072 sc1
  buffer_load_dwordx4 v[50:53], v1, s[4:7], s44 offen offset:0 sc1
  buffer_load_dwordx4 v[54:57], v1, s[4:7], s45 offen offset:0 sc1
  buffer_load_dwordx4 v[58:61], v1, s[4:7], s44 offen offset:1024 sc1
  buffer_load_dwordx4 v[62:65], v1, s[4:7], s45 offen offset:1024 sc1
  buffer_load_dwordx4 v[66:69], v1, s[4:7], s36 offen offset:0 sc1
  buffer_load_dwordx4 v[70:73], v1, s[4:7], s37 offen offset:0 sc1
  buffer_load_dwordx4 v[74:77], v1, s[4:7], s36 offen offset:1024 sc1
  buffer_load_dwordx4 v[78:81], v1, s[4:7], s37 offen offset:1024 sc1
  buffer_load_dwordx4 v[82:85], v1, s[4:7], s36 offen offset:2048 sc1
  buffer_load_dwordx4 v[86:89], v1, s[4:7], s37 offen offset:2048 sc1
  buffer_load_dwordx4 v[90:93], v1, s[4:7], s36 offen offset:3072 sc1
  buffer_load_dwordx4 v[94:97], v1, s[4:7], s37 offen offset:3072 sc1
  buffer_load_dwordx4 v[98:101], v1, s[4:7], s46 offen offset:0 sc1
  buffer_load_dwordx4 v[102:105], v1, s[4:7], s47 offen offset:0 sc1
  buffer_load_dwordx4 v[106:109], v1, s[4:7], s46 offen offset:1024 sc1
  buffer_load_dwordx4 v[110:113], v1, s[4:7], s47 offen offset:1024 sc1
  s_add_u32 s34, s34, 393216
  s_add_u32 s44, s34, 4096
  s_add_u32 s35, s34, 6144
  s_add_u32 s45, s34, 10240
  s_add_u32 s36, s34, 12288
  s_add_u32 s46, s34, 16384
  s_add_u32 s37, s34, 18432
  s_add_u32 s47, s34, 22528
  s_branch L_o_red0
L_o_pre0:
  v_cmp_gt_u32 vcc, s41, v7
  s_nop 0
  s_and_b64 vcc, vcc, 0xff
  s_cbranch_scc0 L_o_roll0
  s_mov_b32 s43, 0
  v_mfma_f32_16x16x32_bf16 v[114:117], a[0:3], v[18:21], 0
  v_mfma_f32_16x16x32_bf16 v[118:121], a[48:51], v[18:21], 0
  v_mfma_f32_16x16x32_bf16 v[122:125], a[96:99], v[18:21], 0
  v_mfma_f32_16x16x32_bf16 v[126:129], a[144:147], v[18:21], 0
  v_mfma_f32_16x16x32_bf16 v[130:133], a[192:195], v[18:21], 0
  v_mfma_f32_16x16x32_bf16 v[134:137], a[0:3], v[22:25], 0
  v_mfma_f32_16x16x32_bf16 v[138:141], a[48:51], v[22:25], 0
  v_mfma_f32_16x16x32_bf16 v[142:145], a[96:99], v[22:25], 0
  v_mfma_f32_16x16x32_bf16 v[146:149], a[144:147], v[22:25], 0
  v_mfma_f32_16x16x32_bf16 v[150:153], a[192:195], v[22:25], 0
  v_mfma_f32_16x16x32_bf16 v[114:117], a[4:7], v[26:29], v[114:117]
  v_mfma_f32_16x16x32_bf16 v[118:121], a[52:55], v[26:29], v[118:121]
  v_mfma_f32_16x16x32_bf16 v[122:125], a[100:103], v[26:29], v[122:125]
  v_mfma_f32_16x16x32_bf16 v[126:129], a[148:151], v[26:29], v[126:129]
  v_mfma_f32_16x16x32_bf16 v[130:133], a[196:199], v[26:29], v[130:133]
  v_mfma_f32_16x16x32_bf16 v[134:137], a[4:7], v[30:33], v[134:137]
  v_mfma_f32_16x16x32_bf16 v[138:141], a[52:55], v[30:33], v[138:141]
  v_mfma_f32_16x16x32_bf16 v[142:145], a[100:103], v[30:33], v[142:145]
  v_mfma_f32_16x16x32_bf16 v[146:149], a[148:151], v[30:33], v[146:149]
  v_mfma_f32_16x16x32_bf16 v[150:153], a[196:199], v[30:33], v[150:153]
  v_mfma_f32_16x16x32_bf16 v[114:117], a[8:11], v[34:37], v[114:117]
  v_mfma_f32_16x16x32_bf16 v[118:121], a[56:59], v[34:37], v[118:121]
  v_mfma_f32_16x16x32_bf16 v[122:125], a[104:107], v[34:37], v[122:125]
  v_mfma_f32_16x16x32_bf16 v[126:129], a[152:155], v[34:37], v[126:129]
  v_mfma_f32_16x16x32_bf16 v[130:133], a[200:203], v[34:37], v[130:133]
  v_mfma_f32_16x16x32_bf16 v[134:137], a[8:11], v[38:41], v[134:137]
  v_mfma_f32_16x16x32_bf16 v[138:141], a[56:59], v[38:41], v[138:141]
  v_mfma_f32_16x16x32_bf16 v[142:145], a[104:107], v[38:41], v[142:145]
  v_mfma_f32_16x16x32_bf16 v[146:149], a[152:155], v[38:41], v[146:149]
  v_mfma_f32_16x16x32_bf16 v[150:153], a[200:203], v[38:41], v[150:153]
  v_mfma_f32_16x16x32_bf16 v[114:117], a[12:15], v[42:45], v[114:117]
  v_mfma_f32_16x16x32_bf16 v[118:121], a[60:63], v[42:45], v[118:121]
  v_mfma_f32_16x16x32_bf16 v[122:125], a[108:111], v[42:45], v[122:125]
  v_mfma_f32_16x16x32_bf16 v[126:129], a[156:159], v[42:45], v[126:129]
  v_mfma_f32_16x16x32_bf16 v[130:133], a[204:207], v[42:45], v[130:133]
  v_mfma_f32_16x16x32_bf16 v[134:137], a[12:15], v[46:49], v[134:137]
  v_mfma_f32_16x16x32_bf16 v[138:141], a[60:63], v[46:49], v[138:141]
  v_mfma_f32_16x16x32_bf16 v[142:145], a[108:111], v[46:49], v[142:145]
  v_mfma_f32_16x16x32_bf16 v[146:149], a[156:159], v[46:49], v[146:149]
  v_mfma_f32_16x16x32_bf16 v[150:153], a[204:207], v[46:49], v[150:153]
  v_mfma_f32_16x16x32_bf16 v[114:117], a[16:19], v[50:53], v[114:117]
  v_mfma_f32_16x16x32_bf16 v[118:121], a[64:67], v[50:53], v[118:121]
  v_mfma_f32_16x16x32_bf16 v[122:125], a[112:115], v[50:53], v[122:125]
  v_mfma_f32_16x16x32_bf16 v[126:129], a[160:163], v[50:53], v[126:129]
  v_mfma_f32_16x16x32_bf16 v[130:133], a[208:211], v[50:53], v[130:133]
  v_mfma_f32_16x16x32_bf16 v[134:137], a[16:19], v[54:57], v[134:137]
  v_mfma_f32_16x16x32_bf16 v[138:141], a[64:67], v[54:57], v[138:141]
  v_mfma_f32_16x16x32_bf16 v[142:145], a[112:115], v[54:57], v[142:145]
  v_mfma_f32_16x16x32_bf16 v[146:149], a[160:163], v[54:57], v[146:149]
  v_mfma_f32_16x16x32_bf16 v[150:153], a[208:211], v[54:57], v[150:153]
  v_mfma_f32_16x16x32_bf16 v[114:117], a[20:23], v[58:61], v[114:117]
  v_mfma_f32_16x16x32_bf16 v[118:121], a[68:71], v[58:61], v[118:121]
  v_mfma_f32_16x16x32_bf16 v[122:125], a[116:119], v[58:61], v[122:125]
  v_mfma_f32_16x16x32_bf16 v[126:129], a[164:167], v[58:61], v[126:129]
  v_mfma_f32_16x16x32_bf16 v[130:133], a[212:215], v[58:61], v[130:133]
  v_mfma_f32_16x16x32_bf16 v[134:137], a[20:23], v[62:65], v[134:137]
  v_mfma_f32_16x16x32_bf16 v[138:141], a[68:71], v[62:65], v[138:141]
  v_mfma_f32_16x16x32_bf16 v[142:145], a[116:119], v[62:65], v[142:145]
  v_mfma_f32_16x16x32_bf16 v[146:149], a[164:167], v[62:65], v[146:149]
  v_mfma_f32_16x16x32_bf16 v[150:153], a[212:215], v[62:65], v[150:153]
  s_waitcnt vmcnt(0)
  v_mov_b32 v8, s32
  s_mov_b64 exec, 1
  buffer_store_dword v8, v2, s[4:7], s39 offen sc1
  s_mov_b64 exec, -1
  v_mfma_f32_16x16x32_bf16 v[114:117], a[24:27], v[66:69], v[114:117]
  v_mfma_f32_16x16x32_bf16 v[118:121], a[72:75], v[66:69], v[118:121]
  v_mfma_f32_16x16x32_bf16 v[122:125], a[120:123], v[66:69], v[122:125]
  v_mfma_f32_16x16x32_bf16 v[126:129], a[168:171], v[66:69], v[126:129]
  v_mfma_f32_16x16x32_bf16 v[130:133], a[216:219], v[66:69], v[130:133]
  v_mfma_f32_16x16x32_bf16 v[134:137], a[24:27], v[70:73], v[134:137]
  v_mfma_f32_16x16x32_bf16 v[138:141], a[72:75], v[70:73], v[138:141]
  v_mfma_f32_16x16x32_bf16 v[142:145], a[120:123], v[70:73], v[142:145]
  v_mfma_f32_16x16x32_bf16 v[146:149], a[168:171], v[70:73], v[146:149]
  v_mfma_f32_16x16x32_bf16 v[150:153], a[216:219], v[70:73], v[150:153]
  v_mfma_f32_16x16x32_bf16 v[114:117], a[28:31], v[74:77], v[114:117]
  v_mfma_f32_16x16x32_bf16 v[118:121], a[76:79], v[74:77], v[118:121]
  v_mfma_f32_16x16x32_bf16 v[122:125], a[124:127], v[74:77], v[122:125]
  v_mfma_f32_16x16x32_bf16 v[126:129], a[172:175], v[74:77], v[126:129]
  v_mfma_f32_16x16x32_bf16 v[130:133], a[220:223], v[74:77], v[130:133]
  v_mfma_f32_16x16x32_bf16 v[134:137], a[28:31], v[78:81], v[134:137]
  v_mfma_f32_16x16x32_bf16 v[138:141], a[76:79], v[78:81], v[138:141]
  v_mfma_f32_16x16x32_bf16 v[142:145], a[124:127], v[78:81], v[142:145]
  v_mfma_f32_16x16x32_bf16 v[146:149], a[172:175], v[78:81], v[146:149]
  v_mfma_f32_16x16x32_bf16 v[150:153], a[220:223], v[78:81], v[150:153]
  v_mfma_f32_16x16x32_bf16 v[114:117], a[32:35], v[82:85], v[114:117]
  v_mfma_f32_16x16x32_bf16 v[118:121], a[80:83], v[82:85], v[118:121]
  v_mfma_f32_16x16x32_bf16 v[122:125], a[128:131], v[82:85], v[122:125]
  v_mfma_f32_16x16x32_bf16 v[126:129], a[176:179], v[82:85], v[126:129]
  v_mfma_f32_16x16x32_bf16 v[130:133], a[224:227], v[82:85], v[130:133]
  v_mfma_f32_16x16x32_bf16 v[134:137], a[32:35], v[86:89], v[134:137]
  v_mfma_f32_16x16x32_bf16 v[138:141], a[80:83], v[86:89], v[138:141]
  v_mfma_f32_16x16x32_bf16 v[142:145], a[128:131], v[86:89], v[142:145]
  v_mfma_f32_16x16x32_bf16 v[146:149], a[176:179], v[86:89], v[146:149]
  v_mfma_f32_16x16x32_bf16 v[150:153], a[224:227], v[86:89], v[150:153]
  v_mfma_f32_16x16x32_bf16 v[114:117], a[36:39], v[90:93], v[114:117]
  v_mfma_f32_16x16x32_bf16 v[118:121], a[84:87], v[90:93], v[118:121]
  v_mfma_f32_16x16x32_bf16 v[122:125], a[132:135], v[90:93], v[122:125]
  v_mfma_f32_16x16x32_bf16 v[126:129], a[180:183], v[90:93], v[126:129]
  v_mfma_f32_16x16x32_bf16 v[130:133], a[228:231], v[90:93], v[130:133]
  v_mfma_f32_16x16x32_bf16 v[134:137], a[36:39], v[94:97], v[134:137]
  v_mfma_f32_16x16x32_bf16 v[138:141], a[84:87], v[94:97], v[138:141]
  v_mfma_f32_16x16x32_bf16 v[142:145], a[132:135], v[94:97], v[142:145]
  v_mfma_f32_16x16x32_bf16 v[146:149], a[180:183], v[94:97], v[146:149]
  v_mfma_f32_16x16x32_bf16 v[150:153], a[228:231], v[94:97], v[150:153]
  v_mfma_f32_16x16x32_bf16 v[114:117], a[40:43], v[98:101], v[114:117]
  v_mfma_f32_16x16x32_bf16 v[118:121], a[88:91], v[98:101], v[118:121]
  v_mfma_f32_16x16x32_bf16 v[122:125], a[136:139], v[98:101], v[122:125]
  v_mfma_f32_16x16x32_bf16 v[126:129], a[184:187], v[98:101], v[126:129]
  v_mfma_f32_16x16x32_bf16 v[130:133], a[232:235], v[98:101], v[130:133]
  v_mfma_f32_16x16x32_bf16 v[134:137], a[40:43], v[102:105], v[134:137]
  v_mfma_f32_16x16x32_bf16 v[138:141], a[88:91], v[102:105], v[138:141]
  v_mfma_f32_16x16x32_bf16 v[142:145], a[136:139], v[102:105], v[142:145]
  v_mfma_f32_16x16x32_bf16 v[146:149], a[184:187], v[102:105], v[146:149]
  v_mfma_f32_16x16x32_bf16 v[150:153], a[232:235], v[102:105], v[150:153]
  v_mfma_f32_16x16x32_bf16 v[114:117], a[44:47], v[106:109], v[114:117]
  v_mfma_f32_16x16x32_bf16 v[118:121], a[92:95], v[106:109], v[118:121]
  v_mfma_f32_16x16x32_bf16 v[122:125], a[140:143], v[106:109], v[122:125]
  v_mfma_f32_16x16x32_bf16 v[126:129], a[188:191], v[106:109], v[126:129]
  v_mfma_f32_16x16x32_bf16 v[130:133], a[236:239], v[106:109], v[130:133]
  v_mfma_f32_16x16x32_bf16 v[134:137], a[44:47], v[110:113], v[134:137]
  v_mfma_f32_16x16x32_bf16 v[138:141], a[92:95], v[110:113], v[138:141]
  v_mfma_f32_16x16x32_bf16 v[142:145], a[140:143], v[110:113], v[142:145]
  v_mfma_f32_16x16x32_bf16 v[146:149], a[188:191], v[110:113], v[146:149]
  v_mfma_f32_16x16x32_bf16 v[150:153], a[236:239], v[110:113], v[150:153]
  s_branch L_o_red0
L_o_roll0:
  v_mfma_f32_16x16x32_bf16 v[114:117], a[0:3], v[18:21], 0
  v_mfma_f32_16x16x32_bf16 v[118:121], a[48:51], v[18:21], 0
  v_mfma_f32_16x16x32_bf16 v[122:125], a[96:99], v[18:21], 0
  v_mfma_f32_16x16x32_bf16 v[126:129], a[144:147], v[18:21], 0
  v_mfma_f32_16x16x32_bf16 v[130:133], a[192:195], v[18:21], 0
  buffer_load_dwordx4 v[18:21], v1, s[4:7], s34 offen offset:0 sc1
  v_mfma_f32_16x16x32_bf16 v[134:137], a[0:3], v[22:25], 0
  v_mfma_f32_16x16x32_bf16 v[138:141], a[48:51], v[22:25], 0
  v_mfma_f32_16x16x32_bf16 v[142:145], a[96:99], v[22:25], 0
  v_mfma_f32_16x16x32_bf16 v[146:149], a[144:147], v[22:25], 0
  v_mfma_f32_16x16x32_bf16 v[150:153], a[192:195], v[22:25], 0
  buffer_load_dwordx4 v[22:25], v1, s[4:7], s35 offen offset:0 sc1
  v_mfma_f32_16x16x32_bf16 v[114:117], a[4:7], v[26:29], v[114:117]
  v_mfma_f32_16x16x32_bf16 v[118:121], a[52:55], v[26:29], v[118:121]
  v_mfma_f32_16x16x32_bf16 v[122:125], a[100:103], v[26:29], v[122:125]
  v_mfma_f32_16x16x32_bf16 v[126:129], a[148:151], v[26:29], v[126:129]
  v_mfma_f32_16x16x32_bf16 v[130:133], a[196:199], v[26:29], v[130:133]
  buffer_load_dwordx4 v[26:29], v1, s[4:7], s34 offen offset:1024 sc1
  v_mfma_f32_16x16x32_bf16 v[134:137], a[4:7], v[30:33], v[134:137]
  v_mfma_f32_16x16x32_bf16 v[138:141], a[52:55], v[30:33], v[138:141]
  v_mfma_f32_16x16x32_bf16 v[142:145], a[100:103], v[30:33], v[142:145]
  v_mfma_f32_16x16x32_bf16 v[146:149], a[148:151], v[30:33], v[146:149]
  v_mfma_f32_16x16x32_bf16 v[150:153], a[196:199], v[30:33], v[150:153]
  buffer_load_dwordx4 v[30:33], v1, s[4:7], s35 offen offset:1024 sc1
  v_mfma_f32_16x16x32_bf16 v[114:117], a[8:11], v[34:37], v[114:117]
  v_mfma_f32_16x16x32_bf16 v[118:121], a[56:59], v[34:37], v[118:121]
  v_mfma_f32_16x16x32_bf16 v[122:125], a[104:107], v[34:37], v[122:125]
  v_mfma_f32_16x16x32_bf16 v[126:129], a[152:155], v[34:37], v[126:129]
  v_mfma_f32_16x16x32_bf16 v[130:133], a[200:203], v[34:37], v[130:133]
  buffer_load_dwordx4 v[34:37], v1, s[4:7], s34 offen offset:2048 sc1
  v_mfma_f32_16x16x32_bf16 v[134:137], a[8:11], v[38:41], v[134:137]
  v_mfma_f32_16x16x32_bf16 v[138:141], a[56:59], v[38:41], v[138:141]
  v_mfma_f32_16x16x32_bf16 v[142:145], a[104:107], v[38:41], v[142:145]
  v_mfma_f32_16x16x32_bf16 v[146:149], a[152:155], v[38:41], v[146:149]
  v_mfma_f32_16x16x32_bf16 v[150:153], a[200:203], v[38:41], v[150:153]
  buffer_load_dwordx4 v[38:41], v1, s[4:7], s35 offen offset:2048 sc1
  v_mfma_f32_16x16x32_bf16 v[114:117], a[12:15], v[42:45], v[114:117]
  v_mfma_f32_16x16x32_bf16 v[118:121], a[60:63], v[42:45], v[118:121]
  v_mfma_f32_16x16x32_bf16 v[122:125], a[108:111], v[42:45], v[122:125]
  v_mfma_f32_16x16x32_bf16 v[126:129], a[156:159], v[42:45], v[126:129]
  v_mfma_f32_16x16x32_bf16 v[130:133], a[204:207], v[42:45], v[130:133]
  buffer_load_dwordx4 v[42:45], v1, s[4:7], s34 offen offset:3072 sc1
  v_mfma_f32_16x16x32_bf16 v[134:137], a[12:15], v[46:49], v[134:137]
  v_mfma_f32_16x16x32_bf16 v[138:141], a[60:63], v[46:49], v[138:141]
  v_mfma_f32_16x16x32_bf16 v[142:145], a[108:111], v[46:49], v[142:145]
  v_mfma_f32_16x16x32_bf16 v[146:149], a[156:159], v[46:49], v[146:149]
  v_mfma_f32_16x16x32_bf16 v[150:153], a[204:207], v[46:49], v[150:153]
  buffer_load_dwordx4 v[46:49], v1, s[4:7], s35 offen offset:3072 sc1
  v_mfma_f32_16x16x32_bf16 v[114:117], a[16:19], v[50:53], v[114:117]
  v_mfma_f32_16x16x32_bf16 v[118:121], a[64:67], v[50:53], v[118:121]
  v_mfma_f32_16x16x32_bf16 v[122:125], a[112:115], v[50:53], v[122:125]
  v_mfma_f32_16x16x32_bf16 v[126:129], a[160:163], v[50:53], v[126:129]
  v_mfma_f32_16x16x32_bf16 v[130:133], a[208:211], v[50:53], v[130:133]
  buffer_load_dwordx4 v[50:53], v1, s[4:7], s44 offen offset:0 sc1
  v_mfma_f32_16x16x32_bf16 v[134:137], a[16:19], v[54:57], v[134:137]
  v_mfma_f32_16x16x32_bf16 v[138:141], a[64:67], v[54:57], v[138:141]
  v_mfma_f32_16x16x32_bf16 v[142:145], a[112:115], v[54:57], v[142:145]
  v_mfma_f32_16x16x32_bf16 v[146:149], a[160:163], v[54:57], v[146:149]
  v_mfma_f32_16x16x32_bf16 v[150:153], a[208:211], v[54:57], v[150:153]
  buffer_load_dwordx4 v[54:57], v1, s[4:7], s45 offen offset:0 sc1
  v_mfma_f32_16x16x32_bf16 v[114:117], a[20:23], v[58:61], v[114:117]
  v_mfma_f32_16x16x32_bf16 v[118:121], a[68:71], v[58:61], v[118:121]
  v_mfma_f32_16x16x32_bf16 v[122:125], a[116:119], v[58:61], v[122:125]
  v_mfma_f32_16x16x32_bf16 v[126:129], a[164:167], v[58:61], v[126:129]
  v_mfma_f32_16x16x32_bf16 v[130:133], a[212:215], v[58:61], v[130:133]
  buffer_load_dwordx4 v[58:61], v1, s[4:7], s44 offen offset:1024 sc1
  v_mfma_f32_16x16x32_bf16 v[134:137], a[20:23], v[62:65], v[134:137]
  v_mfma_f32_16x16x32_bf16 v[138:141], a[68:71], v[62:65], v[138:141]
  v_mfma_f32_16x16x32_bf16 v[142:145], a[116:119], v[62:65], v[142:145]
  v_mfma_f32_16x16x32_bf16 v[146:149], a[164:167], v[62:65], v[146:149]
  v_mfma_f32_16x16x32_bf16 v[150:153], a[212:215], v[62:65], v[150:153]
  buffer_load_dwordx4 v[62:65], v1, s[4:7], s45 offen offset:1024 sc1
  s_waitcnt vmcnt(12)
  v_mov_b32 v8, s32
  s_mov_b64 exec, 1
  buffer_store_dword v8, v2, s[4:7], s39 offen sc1
  s_mov_b64 exec, -1
  v_mfma_f32_16x16x32_bf16 v[114:117], a[24:27], v[66:69], v[114:117]
  v_mfma_f32_16x16x32_bf16 v[118:121], a[72:75], v[66:69], v[118:121]
  v_mfma_f32_16x16x32_bf16 v[122:125], a[120:123], v[66:69], v[122:125]
  v_mfma_f32_16x16x32_bf16 v[126:129], a[168:171], v[66:69], v[126:129]
  v_mfma_f32_16x16x32_bf16 v[130:133], a[216:219], v[66:69], v[130:133]
  buffer_load_dwordx4 v[66:69], v1, s[4:7], s36 offen offset:0 sc1
  v_mfma_f32_16x16x32_bf16 v[134:137], a[24:27], v[70:73], v[134:137]
  v_mfma_f32_16x16x32_bf16 v[138:141], a[72:75], v[70:73], v[138:141]
  v_mfma_f32_16x16x32_bf16 v[142:145], a[120:123], v[70:73], v[142:145]
  v_mfma_f32_16x16x32_bf16 v[146:149], a[168:171], v[70:73], v[146:149]
  v_mfma_f32_16x16x32_bf16 v[150:153], a[216:219], v[70:73], v[150:153]
  buffer_load_dwordx4 v[70:73], v1, s[4:7], s37 offen offset:0 sc1
  v_mfma_f32_16x16x32_bf16 v[114:117], a[28:31], v[74:77], v[114:117]
  v_mfma_f32_16x16x32_bf16 v[118:121], a[76:79], v[74:77], v[118:121]
  v_mfma_f32_16x16x32_bf16 v[122:125], a[124:127], v[74:77], v[122:125]
  v_mfma_f32_16x16x32_bf16 v[126:129], a[172:175], v[74:77], v[126:129]
  v_mfma_f32_16x16x32_bf16 v[130:133], a[220:223], v[74:77], v[130:133]
  buffer_load_dwordx4 v[74:77], v1, s[4:7], s36 offen offset:1024 sc1
  v_mfma_f32_16x16x32_bf16 v[134:137], a[28:31], v[78:81], v[134:137]
  v_mfma_f32_16x16x32_bf16 v[138:141], a[76:79], v[78:81], v[138:141]
  v_mfma_f32_16x16x32_bf16 v[142:145], a[124:127], v[78:81], v[142:145]
  v_mfma_f32_16x16x32_bf16 v[146:149], a[172:175], v[78:81], v[146:149]
  v_mfma_f32_16x16x32_bf16 v[150:153], a[220:223], v[78:81], v[150:153]
  buffer_load_dwordx4 v[78:81], v1, s[4:7], s37 offen offset:1024 sc1
  v_mfma_f32_16x16x32_bf16 v[114:117], a[32:35], v[82:85], v[114:117]
  v_mfma_f32_16x16x32_bf16 v[118:121], a[80:83], v[82:85], v[118:121]
  v_mfma_f32_16x16x32_bf16 v[122:125], a[128:131], v[82:85], v[122:125]
  v_mfma_f32_16x16x32_bf16 v[126:129], a[176:179], v[82:85], v[126:129]
  v_mfma_f32_16x16x32_bf16 v[130:133], a[224:227], v[82:85], v[130:133]
  buffer_load_dwordx4 v[82:85], v1, s[4:7], s36 offen offset:2048 sc1
  v_mfma_f32_16x16x32_bf16 v[134:137], a[32:35], v[86:89], v[134:137]
  v_mfma_f32_16x16x32_bf16 v[138:141], a[80:83], v[86:89], v[138:141]
  v_mfma_f32_16x16x32_bf16 v[142:145], a[128:131], v[86:89], v[142:145]
  v_mfma_f32_16x16x32_bf16 v[146:149], a[176:179], v[86:89], v[146:149]
  v_mfma_f32_16x16x32_bf16 v[150:153], a[224:227], v[86:89], v[150:153]
  buffer_load_dwordx4 v[86:89], v1, s[4:7], s37 offen offset:2048 sc1
  v_mfma_f32_16x16x32_bf16 v[114:117], a[36:39], v[90:93], v[114:117]
  v_mfma_f32_16x16x32_bf16 v[118:121], a[84:87], v[90:93], v[118:121]
  v_mfma_f32_16x16x32_bf16 v[122:125], a[132:135], v[90:93], v[122:125]
  v_mfma_f32_16x16x32_bf16 v[126:129], a[180:183], v[90:93], v[126:129]
  v_mfma_f32_16x16x32_bf16 v[130:133], a[228:231], v[90:93], v[130:133]
  buffer_load_dwordx4 v[90:93], v1, s[4:7], s36 offen offset:3072 sc1
  v_mfma_f32_16x16x32_bf16 v[134:137], a[36:39], v[94:97], v[134:137]
  v_mfma_f32_16x16x32_bf16 v[138:141], a[84:87], v[94:97], v[138:141]
  v_mfma_f32_16x16x32_bf16 v[142:145], a[132:135], v[94:97], v[142:145]
  v_mfma_f32_16x16x32_bf16 v[146:149], a[180:183], v[94:97], v[146:149]
  v_mfma_f32_16x16x32_bf16 v[150:153], a[228:231], v[94:97], v[150:153]
  buffer_load_dwordx4 v[94:97], v1, s[4:7], s37 offen offset:3072 sc1
  v_mfma_f32_16x16x32_bf16 v[114:117], a[40:43], v[98:101], v[114:117]
  v_mfma_f32_16x16x32_bf16 v[118:121], a[88:91], v[98:101], v[118:121]
  v_mfma_f32_16x16x32_bf16 v[122:125], a[136:139], v[98:101], v[122:125]
  v_mfma_f32_16x16x32_bf16 v[126:129], a[184:187], v[98:101], v[126:129]
  v_mfma_f32_16x16x32_bf16 v[130:133], a[232:235], v[98:101], v[130:133]
  buffer_load_dwordx4 v[98:101], v1, s[4:7], s46 offen offset:0 sc1
  v_mfma_f32_16x16x32_bf16 v[134:137], a[40:43], v[102:105], v[134:137]
  v_mfma_f32_16x16x32_bf16 v[138:141], a[88:91], v[102:105], v[138:141]
  v_mfma_f32_16x16x32_bf16 v[142:145], a[136:139], v[102:105], v[142:145]
  v_mfma_f32_16x16x32_bf16 v[146:149], a[184:187], v[102:105], v[146:149]
  v_mfma_f32_16x16x32_bf16 v[150:153], a[232:235], v[102:105], v[150:153]
  buffer_load_dwordx4 v[102:105], v1, s[4:7], s47 offen offset:0 sc1
  v_mfma_f32_16x16x32_bf16 v[114:117], a[44:47], v[106:109], v[114:117]
  v_mfma_f32_16x16x32_bf16 v[118:121], a[92:95], v[106:109], v[118:121]
  v_mfma_f32_16x16x32_bf16 v[122:125], a[140:143], v[106:109], v[122:125]
  v_mfma_f32_16x16x32_bf16 v[126:129], a[188:191], v[106:109], v[126:129]
  v_mfma_f32_16x16x32_bf16 v[130:133], a[236:239], v[106:109], v[130:133]
  buffer_load_dwordx4 v[106:109], v1, s[4:7], s46 offen offset:1024 sc1
  v_mfma_f32_16x16x32_bf16 v[134:137], a[44:47], v[110:113], v[134:137]
  v_mfma_f32_16x16x32_bf16 v[138:141], a[92:95], v[110:113], v[138:141]
  v_mfma_f32_16x16x32_bf16 v[142:145], a[140:143], v[110:113], v[142:145]
  v_mfma_f32_16x16x32_bf16 v[146:149], a[188:191], v[110:113], v[146:149]
  v_mfma_f32_16x16x32_bf16 v[150:153], a[236:239], v[110:113], v[150:153]
  buffer_load_dwordx4 v[110:113], v1, s[4:7], s47 offen offset:1024 sc1
  s_add_u32 s34, s34, 393216
  s_add_u32 s44, s34, 4096
  s_add_u32 s35, s34, 6144
  s_add_u32 s45, s34, 10240
  s_add_u32 s36, s34, 12288
  s_add_u32 s46, s34, 16384
  s_add_u32 s37, s34, 18432
  s_add_u32 s47, s34, 22528
L_o_red0:
  s_mov_b64 exec, 0xff
  v_mov_b32 v7, 0
  buffer_atomic_add v7, v3, s[4:7], s40 offen sc0 sc1
  s_mov_b64 exec, -1
  ds_write_b128 v4, v[114:117] offset:0
  ds_write_b128 v4, v[118:121] offset:1024
  ds_write_b128 v4, v[122:125] offset:2048
  ds_write_b128 v4, v[126:129] offset:3072
  ds_write_b128 v4, v[130:133] offset:4096
  ds_write_b128 v4, v[134:137] offset:5120
  ds_write_b128 v4, v[138:141] offset:6144
  ds_write_b128 v4, v[142:145] offset:7168
  ds_write_b128 v4, v[146:149] offset:8192
  ds_write_b128 v4, v[150:153] offset:9216
  s_waitcnt lgkmcnt(0)
  s_barrier
  v_add_u32 v9, 0, v5
  ds_read_b128 v[154:157], v9 offset:0
  ds_read_b128 v[158:161], v9 offset:10240
  ds_read_b128 v[162:165], v9 offset:20480
  ds_read_b128 v[166:169], v9 offset:30720
  ds_read_b128 v[170:173], v9 offset:4096
  ds_read_b128 v[174:177], v9 offset:14336
  ds_read_b128 v[178:181], v9 offset:24576
  ds_read_b128 v[182:185], v9 offset:34816
  ds_read_b128 v[186:189], v9 offset:8192
  ds_read_b128 v[190:193], v9 offset:18432
  ds_read_b128 v[194:197], v9 offset:28672
  ds_read_b128 v[198:201], v9 offset:38912
  s_add_u32 s48, s38, 4096
  s_waitcnt lgkmcnt(8)
  v_pk_add_f32 v[154:155], v[154:155], v[158:159]
  v_pk_add_f32 v[162:163], v[162:163], v[166:167]
  v_pk_add_f32 v[156:157], v[156:157], v[160:161]
  v_pk_add_f32 v[164:165], v[164:165], v[168:169]
  v_pk_add_f32 v[154:155], v[154:155], v[162:163]
  v_pk_add_f32 v[156:157], v[156:157], v[164:165]
  buffer_store_dwordx4 v[154:157], v1, s[4:7], s38 offen sc1
  s_waitcnt lgkmcnt(4)
  v_pk_add_f32 v[170:171], v[170:171], v[174:175]
  v_pk_add_f32 v[178:179], v[178:179], v[182:183]
  v_pk_add_f32 v[172:173], v[172:173], v[176:177]
  v_pk_add_f32 v[180:181], v[180:181], v[184:185]
  v_pk_add_f32 v[170:171], v[170:171], v[178:179]
  v_pk_add_f32 v[172:173], v[172:173], v[180:181]
  buffer_store_dwordx4 v[170:173], v1, s[4:7], s48 offen sc1
  s_waitcnt lgkmcnt(0)
  v_pk_add_f32 v[186:187], v[186:187], v[190:191]
  v_pk_add_f32 v[194:195], v[194:195], v[198:199]
  v_pk_add_f32 v[188:189], v[188:189], v[192:193]
  v_pk_add_f32 v[196:197], v[196:197], v[200:201]
  v_pk_add_f32 v[186:187], v[186:187], v[194:195]
  v_pk_add_f32 v[188:189], v[188:189], v[196:197]
  buffer_store_dwordx4 v[186:189], v6, s[4:7], s38 offen sc1
  s_add_u32 s38, s38, 327680
  s_add_u32 s32, s32, 1
L_o_seg1:
  s_add_u32 s42, s32, 1
  s_add_u32 s41, s32, 2
  s_cmp_lg_u32 s43, 0
  s_waitcnt vmcnt(3)
  s_cbranch_scc1 L_o_pre1
  v_cmp_gt_u32 vcc, s42, v7
  s_nop 0
  s_and_b64 vcc, vcc, 0xff
  s_cbranch_scc0 L_o_go1
  s_waitcnt vmcnt(0)
  v_mov_b32 v8, s32
  s_mov_b64 exec, 1
  buffer_store_dword v8, v2, s[4:7], s39 offen sc1
  s_mov_b64 exec, -1
  s_mov_b64 exec, 0xff
  s_mov_b32 s15, 0
L_o_qa1:
  v_mov_b32 v7, 0
  buffer_atomic_add v7, v3, s[4:7], s40 offen sc0 sc1
  s_waitcnt vmcnt(0)
  v_cmp_gt_u32 vcc, s42, v7
  s_cbranch_vccz L_o_qa1_ok
  s_sleep 2
  s_add_u32 s15, s15, 1
  s_cmp_lt_u32 s15, 262144
  s_cbranch_scc1 L_o_qa1
  s_branch L_fail
L_o_qa1_ok:
  s_mov_b64 exec, -1
L_o_go1:
  buffer_load_dwordx4 v[18:21], v1, s[4:7], s34 offen offset:0 sc1
  buffer_load_dwordx4 v[22:25], v1, s[4:7], s35 offen offset:0 sc1
  buffer_load_dwordx4 v[26:29], v1, s[4:7], s34 offen offset:1024 sc1
  buffer_load_dwordx4 v[30:33], v1, s[4:7], s35 offen offset:1024 sc1
  v_cmp_gt_u32 vcc, s41, v7
  s_nop 0
  s_and_b64 vcc, vcc, 0xff
  s_cselect_b32 s43, 0, 1
  s_nop 15
  s_nop 15
  s_nop 7
  buffer_load_dwordx4 v[34:37], v1, s[4:7], s34 offen offset:2048 sc1
  buffer_load_dwordx4 v[38:41], v1, s[4:7], s35 offen offset:2048 sc1
  buffer_load_dwordx4 v[42:45], v1, s[4:7], s34 offen offset:3072 sc1
  buffer_load_dwordx4 v[46:49], v1, s[4:7], s35 offen offset:3072 sc1
  buffer_load_dwordx4 v[50:53], v1, s[4:7], s44 offen offset:0 sc1
  buffer_load_dwordx4 v[54:57], v1, s[4:7], s45 offen offset:0 sc1
  buffer_load_dwordx4 v[58:61], v1, s[4:7], s44 offen offset:1024 sc1
  buffer_load_dwordx4 v[62:65], v1, s[4:7], s45 offen offset:1024 sc1
  s_waitcnt vmcnt(11)
  v_mfma_f32_16x16x32_bf16 v[114:117], a[0:3], v[18:21], 0
  v_mfma_f32_16x16x32_bf16 v[118:121], a[48:51], v[18:21], 0
  v_mfma_f32_16x16x32_bf16 v[122:125], a[96:99], v[18:21], 0
  v_mfma_f32_16x16x32_bf16 v[126:129], a[144:147], v[18:21], 0
  v_mfma_f32_16x16x32_bf16 v[130:133], a[192:195], v[18:21], 0
  buffer_load_dwordx4 v[66:69], v1, s[4:7], s36 offen offset:0 sc1
  s_waitcnt vmcnt(11)
  v_mfma_f32_16x16x32_bf16 v[134:137], a[0:3], v[22:25], 0
  v_mfma_f32_16x16x32_bf16 v[138:141], a[48:51], v[22:25], 0
  v_mfma_f32_16x16x32_bf16 v[142:145], a[96:99], v[22:25], 0
  v_mfma_f32_16x16x32_bf16 v[146:149], a[144:147], v[22:25], 0
  v_mfma_f32_16x16x32_bf16 v[150:153], a[192:195], v[22:25], 0
  buffer_load_dwordx4 v[70:73], v1, s[4:7], s37 offen offset:0 sc1
  s_waitcnt vmcnt(11)
  v_mfma_f32_16x16x32_bf16 v[114:117], a[4:7], v[26:29], v[114:117]
  v_mfma_f32_16x16x32_bf16 v[118:121], a[52:55], v[26:29], v[118:121]
  v_mfma_f32_16x16x32_bf16 v[122:125], a[100:103], v[26:29], v[122:125]
  v_mfma_f32_16x16x32_bf16 v[126:129], a[148:151], v[26:29], v[126:129]
  v_mfma_f32_16x16x32_bf16 v[130:133], a[196:199], v[26:29], v[130:133]
  buffer_load_dwordx4 v[74:77], v1, s[4:7], s36 offen offset:1024 sc1
  s_waitcnt vmcnt(11)
  v_mfma_f32_16x16x32_bf16 v[134:137], a[4:7], v[30:33], v[134:137]
  v_mfma_f32_16x16x32_bf16 v[138:141], a[52:55], v[30:33], v[138:141]
  v_mfma_f32_16x16x32_bf16 v[142:145], a[100:103], v[30:33], v[142:145]
  v_mfma_f32_16x16x32_bf16 v[146:149], a[148:151], v[30:33], v[146:149]
  v_mfma_f32_16x16x32_bf16 v[150:153], a[196:199], v[30:33], v[150:153]
  buffer_load_dwordx4 v[78:81], v1, s[4:7], s37 offen offset:1024 sc1
  s_waitcnt vmcnt(11)
  v_mfma_f32_16x16x32_bf16 v[114:117], a[8:11], v[34:37], v[114:117]
  v_mfma_f32_16x16x32_bf16 v[118:121], a[56:59], v[34:37], v[118:121]
  v_mfma_f32_16x16x32_bf16 v[122:125], a[104:107], v[34:37], v[122:125]
  v_mfma_f32_16x16x32_bf16 v[126:129], a[152:155], v[34:37], v[126:129]
  v_mfma_f32_16x16x32_bf16 v[130:133], a[200:203], v[34:37], v[130:133]
  buffer_load_dwordx4 v[82:85], v1, s[4:7], s36 offen offset:2048 sc1
  s_waitcnt vmcnt(11)
  v_mfma_f32_16x16x32_bf16 v[134:137], a[8:11], v[38:41], v[134:137]
  v_mfma_f32_16x16x32_bf16 v[138:141], a[56:59], v[38:41], v[138:141]
  v_mfma_f32_16x16x32_bf16 v[142:145], a[104:107], v[38:41], v[142:145]
  v_mfma_f32_16x16x32_bf16 v[146:149], a[152:155], v[38:41], v[146:149]
  v_mfma_f32_16x16x32_bf16 v[150:153], a[200:203], v[38:41], v[150:153]
  buffer_load_dwordx4 v[86:89], v1, s[4:7], s37 offen offset:2048 sc1
  s_waitcnt vmcnt(11)
  v_mfma_f32_16x16x32_bf16 v[114:117], a[12:15], v[42:45], v[114:117]
  v_mfma_f32_16x16x32_bf16 v[118:121], a[60:63], v[42:45], v[118:121]
  v_mfma_f32_16x16x32_bf16 v[122:125], a[108:111], v[42:45], v[122:125]
  v_mfma_f32_16x16x32_bf16 v[126:129], a[156:159], v[42:45], v[126:129]
  v_mfma_f32_16x16x32_bf16 v[130:133], a[204:207], v[42:45], v[130:133]
  buffer_load_dwordx4 v[90:93], v1, s[4:7], s36 offen offset:3072 sc1
  s_waitcnt vmcnt(11)
  v_mfma_f32_16x16x32_bf16 v[134:137], a[12:15], v[46:49], v[134:137]
  v_mfma_f32_16x16x32_bf16 v[138:141], a[60:63], v[46:49], v[138:141]
  v_mfma_f32_16x16x32_bf16 v[142:145], a[108:111], v[46:49], v[142:145]
  v_mfma_f32_16x16x32_bf16 v[146:149], a[156:159], v[46:49], v[146:149]
  v_mfma_f32_16x16x32_bf16 v[150:153], a[204:207], v[46:49], v[150:153]
  buffer_load_dwordx4 v[94:97], v1, s[4:7], s37 offen offset:3072 sc1
  s_waitcnt vmcnt(11)
  v_mfma_f32_16x16x32_bf16 v[114:117], a[16:19], v[50:53], v[114:117]
  v_mfma_f32_16x16x32_bf16 v[118:121], a[64:67], v[50:53], v[118:121]
  v_mfma_f32_16x16x32_bf16 v[122:125], a[112:115], v[50:53], v[122:125]
  v_mfma_f32_16x16x32_bf16 v[126:129], a[160:163], v[50:53], v[126:129]
  v_mfma_f32_16x16x32_bf16 v[130:133], a[208:211], v[50:53], v[130:133]
  buffer_load_dwordx4 v[98:101], v1, s[4:7], s46 offen offset:0 sc1
  s_waitcnt vmcnt(11)
  v_mfma_f32_16x16x32_bf16 v[134:137], a[16:19], v[54:57], v[134:137]
  v_mfma_f32_16x16x32_bf16 v[138:141], a[64:67], v[54:57], v[138:141]
  v_mfma_f32_16x16x32_bf16 v[142:145], a[112:115], v[54:57], v[142:145]
  v_mfma_f32_16x16x32_bf16 v[146:149], a[160:163], v[54:57], v[146:149]
  v_mfma_f32_16x16x32_bf16 v[150:153], a[208:211], v[54:57], v[150:153]
  buffer_load_dwordx4 v[102:105], v1, s[4:7], s47 offen offset:0 sc1
  s_waitcnt vmcnt(11)
  v_mfma_f32_16x16x32_bf16 v[114:117], a[20:23], v[58:61], v[114:117]
  v_mfma_f32_16x16x32_bf16 v[118:121], a[68:71], v[58:61], v[118:121]
  v_mfma_f32_16x16x32_bf16 v[122:125], a[116:119], v[58:61], v[122:125]
  v_mfma_f32_16x16x32_bf16 v[126:129], a[164:167], v[58:61], v[126:129]
  v_mfma_f32_16x16x32_bf16 v[130:133], a[212:215], v[58:61], v[130:133]
  buffer_load_dwordx4 v[106:109], v1, s[4:7], s46 offen offset:1024 sc1
  s_waitcnt vmcnt(11)
  v_mfma_f32_16x16x32_bf16 v[134:137], a[20:23], v[62:65], v[134:137]
  v_mfma_f32_16x16x32_bf16 v[138:141], a[68:71], v[62:65], v[138:141]
  v_mfma_f32_16x16x32_bf16 v[142:145], a[116:119], v[62:65], v[142:145]
  v_mfma_f32_16x16x32_bf16 v[146:149], a[164:167], v[62:65], v[146:149]
  v_mfma_f32_16x16x32_bf16 v[150:153], a[212:215], v[62:65], v[150:153]
  buffer_load_dwordx4 v[110:113], v1, s[4:7], s47 offen offset:1024 sc1
  s_waitcnt vmcnt(11)
  v_mov_b32 v8, s32
  s_mov_b64 exec, 1
  buffer_store_dword v8, v2, s[4:7], s39 offen sc1
  s_mov_b64 exec, -1
  v_mfma_f32_16x16x32_bf16 v[114:117], a[24:27], v[66:69], v[114:117]
  v_mfma_f32_16x16x32_bf16 v[118:121], a[72:75], v[66:69], v[118:121]
  v_mfma_f32_16x16x32_bf16 v[122:125], a[120:123], v[66:69], v[122:125]
  v_mfma_f32_16x16x32_bf16 v[126:129], a[168:171], v[66:69], v[126:129]
  v_mfma_f32_16x16x32_bf16 v[130:133], a[216:219], v[66:69], v[130:133]
  s_waitcnt vmcnt(11)
  v_mfma_f32_16x16x32_bf16 v[134:137], a[24:27], v[70:73], v[134:137]
  v_mfma_f32_16x16x32_bf16 v[138:141], a[72:75], v[70:73], v[138:141]
  v_mfma_f32_16x16x32_bf16 v[142:145], a[120:123], v[70:73], v[142:145]
  v_mfma_f32_16x16x32_bf16 v[146:149], a[168:171], v[70:73], v[146:149]
  v_mfma_f32_16x16x32_bf16 v[150:153], a[216:219], v[70:73], v[150:153]
  s_waitcnt vmcnt(10)
  v_mfma_f32_16x16x32_bf16 v[114:117], a[28:31], v[74:77], v[114:117]
  v_mfma_f32_16x16x32_bf16 v[118:121], a[76:79], v[74:77], v[118:121]
  v_mfma_f32_16x16x32_bf16 v[122:125], a[124:127], v[74:77], v[122:125]
  v_mfma_f32_16x16x32_bf16 v[126:129], a[172:175], v[74:77], v[126:129]
  v_mfma_f32_16x16x32_bf16 v[130:133], a[220:223], v[74:77], v[130:133]
  s_waitcnt vmcnt(9)
  v_mfma_f32_16x16x32_bf16 v[134:137], a[28:31], v[78:81], v[134:137]
  v_mfma_f32_16x16x32_bf16 v[138:141], a[76:79], v[78:81], v[138:141]
  v_mfma_f32_16x16x32_bf16 v[142:145], a[124:127], v[78:81], v[142:145]
  v_mfma_f32_16x16x32_bf16 v[146:149], a[172:175], v[78:81], v[146:149]
  v_mfma_f32_16x16x32_bf16 v[150:153], a[220:223], v[78:81], v[150:153]
  s_waitcnt vmcnt(8)
  v_mfma_f32_16x16x32_bf16 v[114:117], a[32:35], v[82:85], v[114:117]
  v_mfma_f32_16x16x32_bf16 v[118:121], a[80:83], v[82:85], v[118:121]
  v_mfma_f32_16x16x32_bf16 v[122:125], a[128:131], v[82:85], v[122:125]
  v_mfma_f32_16x16x32_bf16 v[126:129], a[176:179], v[82:85], v[126:129]
  v_mfma_f32_16x16x32_bf16 v[130:133], a[224:227], v[82:85], v[130:133]
  s_waitcnt vmcnt(7)
  v_mfma_f32_16x16x32_bf16 v[134:137], a[32:35], v[86:89], v[134:137]
  v_mfma_f32_16x16x32_bf16 v[138:141], a[80:83], v[86:89], v[138:141]
  v_mfma_f32_16x16x32_bf16 v[142:145], a[128:131], v[86:89], v[142:145]
  v_mfma_f32_16x16x32_bf16 v[146:149], a[176:179], v[86:89], v[146:149]
  v_mfma_f32_16x16x32_bf16 v[150:153], a[224:227], v[86:89], v[150:153]
  s_waitcnt vmcnt(6)
  v_mfma_f32_16x16x32_bf16 v[114:117], a[36:39], v[90:93], v[114:117]
  v_mfma_f32_16x16x32_bf16 v[118:121], a[84:87], v[90:93], v[118:121]
  v_mfma_f32_16x16x32_bf16 v[122:125], a[132:135], v[90:93], v[122:125]
  v_mfma_f32_16x16x32_bf16 v[126:129], a[180:183], v[90:93], v[126:129]
  v_mfma_f32_16x16x32_bf16 v[130:133], a[228:231], v[90:93], v[130:133]
  s_waitcnt vmcnt(5)
  v_mfma_f32_16x16x32_bf16 v[134:137], a[36:39], v[94:97], v[134:137]
  v_mfma_f32_16x16x32_bf16 v[138:141], a[84:87], v[94:97], v[138:141]
  v_mfma_f32_16x16x32_bf16 v[142:145], a[132:135], v[94:97], v[142:145]
  v_mfma_f32_16x16x32_bf16 v[146:149], a[180:183], v[94:97], v[146:149]
  v_mfma_f32_16x16x32_bf16 v[150:153], a[228:231], v[94:97], v[150:153]
  s_waitcnt vmcnt(4)
  v_mfma_f32_16x16x32_bf16 v[114:117], a[40:43], v[98:101], v[114:117]
  v_mfma_f32_16x16x32_bf16 v[118:121], a[88:91], v[98:101], v[118:121]
  v_mfma_f32_16x16x32_bf16 v[122:125], a[136:139], v[98:101], v[122:125]
  v_mfma_f32_16x16x32_bf16 v[126:129], a[184:187], v[98:101], v[126:129]
  v_mfma_f32_16x16x32_bf16 v[130:133], a[232:235], v[98:101], v[130:133]
  s_waitcnt vmcnt(3)
  v_mfma_f32_16x16x32_bf16 v[134:137], a[40:43], v[102:105], v[134:137]
  v_mfma_f32_16x16x32_bf16 v[138:141], a[88:91], v[102:105], v[138:141]
  v_mfma_f32_16x16x32_bf16 v[142:145], a[136:139], v[102:105], v[142:145]
  v_mfma_f32_16x16x32_bf16 v[146:149], a[184:187], v[102:105], v[146:149]
  v_mfma_f32_16x16x32_bf16 v[150:153], a[232:235], v[102:105], v[150:153]
  s_waitcnt vmcnt(2)
  v_mfma_f32_16x16x32_bf16 v[114:117], a[44:47], v[106:109], v[114:117]
  v_mfma_f32_16x16x32_bf16 v[118:121], a[92:95], v[106:109], v[118:121]
  v_mfma_f32_16x16x32_bf16 v[122:125], a[140:143], v[106:109], v[122:125]
  v_mfma_f32_16x16x32_bf16 v[126:129], a[188:191], v[106:109], v[126:129]
  v_mfma_f32_16x16x32_bf16 v[130:133], a[236:239], v[106:109], v[130:133]
  s_waitcnt vmcnt(1)
  v_mfma_f32_16x16x32_bf16 v[134:137], a[44:47], v[110:113], v[134:137]
  v_mfma_f32_16x16x32_bf16 v[138:141], a[92:95], v[110:113], v[138:141]
  v_mfma_f32_16x16x32_bf16 v[142:145], a[140:143], v[110:113], v[142:145]
  v_mfma_f32_16x16x32_bf16 v[146:149], a[188:191], v[110:113], v[146:149]
  v_mfma_f32_16x16x32_bf16 v[150:153], a[236:239], v[110:113], v[150:153]
  s_add_u32 s34, s34, 393216
  s_add_u32 s44, s34, 4096
  s_add_u32 s35, s34, 6144
  s_add_u32 s45, s34, 10240
  s_add_u32 s36, s34, 12288
  s_add_u32 s46, s34, 16384
  s_add_u32 s37, s34, 18432
  s_add_u32 s47, s34, 22528
  s_cmp_eq_u32 s43, 0
  s_cbranch_scc1 L_o_red1
  buffer_load_dwordx4 v[18:21], v1, s[4:7], s34 offen offset:0 sc1
  buffer_load_dwordx4 v[22:25], v1, s[4:7], s35 offen offset:0 sc1
  buffer_load_dwordx4 v[26:29], v1, s[4:7], s34 offen offset:1024 sc1
  buffer_load_dwordx4 v[30:33], v1, s[4:7], s35 offen offset:1024 sc1
  buffer_load_dwordx4 v[34:37], v1, s[4:7], s34 offen offset:2048 sc1
  buffer_load_dwordx4 v[38:41], v1, s[4:7], s35 offen offset:2048 sc1
  buffer_load_dwordx4 v[42:45], v1, s[4:7], s34 offen offset:3072 sc1
  buffer_load_dwordx4 v[46:49], v1, s[4:7], s35 offen offset:3072 sc1
  buffer_load_dwordx4 v[50:53], v1, s[4:7], s44 offen offset:0 sc1
  buffer_load_dwordx4 v[54:57], v1, s[4:7], s45 offen offset:0 sc1
  buffer_load_dwordx4 v[58:61], v1, s[4:7], s44 offen offset:1024 sc1
  buffer_load_dwordx4 v[62:65], v1, s[4:7], s45 offen offset:1024 sc1
  buffer_load_dwordx4 v[66:69], v1, s[4:7], s36 offen offset:0 sc1
  buffer_load_dwordx4 v[70:73], v1, s[4:7], s37 offen offset:0 sc1
  buffer_load_dwordx4 v[74:77], v1, s[4:7], s36 offen offset:1024 sc1
  buffer_load_dwordx4 v[78:81], v1, s[4:7], s37 offen offset:1024 sc1
  buffer_load_dwordx4 v[82:85], v1, s[4:7], s36 offen offset:2048 sc1
  buffer_load_dwordx4 v[86:89], v1, s[4:7], s37 offen offset:2048 sc1
  buffer_load_dwordx4 v[90:93], v1, s[4:7], s36 offen offset:3072 sc1
  buffer_load_dwordx4 v[94:97], v1, s[4:7], s37 offen offset:3072 sc1
  buffer_load_dwordx4 v[98:101], v1, s[4:7], s46 offen offset:0 sc1
  buffer_load_dwordx4 v[102:105], v1, s[4:7], s47 offen offset:0 sc1
  buffer_load_dwordx4 v[106:109], v1, s[4:7], s46 offen offset:1024 sc1
  buffer_load_dwordx4 v[110:113], v1, s[4:7], s47 offen offset:1024 sc1
  s_add_u32 s34, s34, 393216
  s_add_u32 s44, s34, 4096
  s_add_u32 s35, s34, 6144
  s_add_u32 s45, s34, 10240
  s_add_u32 s36, s34, 12288
  s_add_u32 s46, s34, 16384
  s_add_u32 s37, s34, 18432
  s_add_u32 s47, s34, 22528
  s_branch L_o_red1
L_o_pre1:
  v_cmp_gt_u32 vcc, s41, v7
  s_nop 0
  s_and_b64 vcc, vcc, 0xff
  s_cbranch_scc0 L_o_roll1
  s_mov_b32 s43, 0
  v_mfma_f32_16x16x32_bf16 v[114:117], a[0:3], v[18:21], 0
  v_mfma_f32_16x16x32_bf16 v[118:121], a[48:51], v[18:21], 0
  v_mfma_f32_16x16x32_bf16 v[122:125], a[96:99], v[18:21], 0
  v_mfma_f32_16x16x32_bf16 v[126:129], a[144:147], v[18:21], 0
  v_mfma_f32_16x16x32_bf16 v[130:133], a[192:195], v[18:21], 0
  v_mfma_f32_16x16x32_bf16 v[134:137], a[0:3], v[22:25], 0
  v_mfma_f32_16x16x32_bf16 v[138:141], a[48:51], v[22:25], 0
  v_mfma_f32_16x16x32_bf16 v[142:145], a[96:99], v[22:25], 0
  v_mfma_f32_16x16x32_bf16 v[146:149], a[144:147], v[22:25], 0
  v_mfma_f32_16x16x32_bf16 v[150:153], a[192:195], v[22:25], 0
  v_mfma_f32_16x16x32_bf16 v[114:117], a[4:7], v[26:29], v[114:117]
  v_mfma_f32_16x16x32_bf16 v[118:121], a[52:55], v[26:29], v[118:121]
  v_mfma_f32_16x16x32_bf16 v[122:125], a[100:103], v[26:29], v[122:125]
  v_mfma_f32_16x16x32_bf16 v[126:129], a[148:151], v[26:29], v[126:129]
  v_mfma_f32_16x16x32_bf16 v[130:133], a[196:199], v[26:29], v[130:133]
  v_mfma_f32_16x16x32_bf16 v[134:137], a[4:7], v[30:33], v[134:137]
  v_mfma_f32_16x16x32_bf16 v[138:141], a[52:55], v[30:33], v[138:141]
  v_mfma_f32_16x16x32_bf16 v[142:145], a[100:103], v[30:33], v[142:145]
  v_mfma_f32_16x16x32_bf16 v[146:149], a[148:151], v[30:33], v[146:149]
  v_mfma_f32_16x16x32_bf16 v[150:153], a[196:199], v[30:33], v[150:153]
  v_mfma_f32_16x16x32_bf16 v[114:117], a[8:11], v[34:37], v[114:117]
  v_mfma_f32_16x16x32_bf16 v[118:121], a[56:59], v[34:37], v[118:121]
  v_mfma_f32_16x16x32_bf16 v[122:125], a[104:107], v[34:37], v[122:125]
  v_mfma_f32_16x16x32_bf16 v[126:129], a[152:155], v[34:37], v[126:129]
  v_mfma_f32_16x16x32_bf16 v[130:133], a[200:203], v[34:37], v[130:133]
  v_mfma_f32_16x16x32_bf16 v[134:137], a[8:11], v[38:41], v[134:137]
  v_mfma_f32_16x16x32_bf16 v[138:141], a[56:59], v[38:41], v[138:141]
  v_mfma_f32_16x16x32_bf16 v[142:145], a[104:107], v[38:41], v[142:145]
  v_mfma_f32_16x16x32_bf16 v[146:149], a[152:155], v[38:41], v[146:149]
  v_mfma_f32_16x16x32_bf16 v[150:153], a[200:203], v[38:41], v[150:153]
  v_mfma_f32_16x16x32_bf16 v[114:117], a[12:15], v[42:45], v[114:117]
  v_mfma_f32_16x16x32_bf16 v[118:121], a[60:63], v[42:45], v[118:121]
  v_mfma_f32_16x16x32_bf16 v[122:125], a[108:111], v[42:45], v[122:125]
  v_mfma_f32_16x16x32_bf16 v[126:129], a[156:159], v[42:45], v[126:129]
  v_mfma_f32_16x16x32_bf16 v[130:133], a[204:207], v[42:45], v[130:133]
  v_mfma_f32_16x16x32_bf16 v[134:137], a[12:15], v[46:49], v[134:137]
  v_mfma_f32_16x16x32_bf16 v[138:141], a[60:63], v[46:49], v[138:141]
  v_mfma_f32_16x16x32_bf16 v[142:145], a[108:111], v[46:49], v[142:145]
  v_mfma_f32_16x16x32_bf16 v[146:149], a[156:159], v[46:49], v[146:149]
  v_mfma_f32_16x16x32_bf16 v[150:153], a[204:207], v[46:49], v[150:153]
  v_mfma_f32_16x16x32_bf16 v[114:117], a[16:19], v[50:53], v[114:117]
  v_mfma_f32_16x16x32_bf16 v[118:121], a[64:67], v[50:53], v[118:121]
  v_mfma_f32_16x16x32_bf16 v[122:125], a[112:115], v[50:53], v[122:125]
  v_mfma_f32_16x16x32_bf16 v[126:129], a[160:163], v[50:53], v[126:129]
  v_mfma_f32_16x16x32_bf16 v[130:133], a[208:211], v[50:53], v[130:133]
  v_mfma_f32_16x16x32_bf16 v[134:137], a[16:19], v[54:57], v[134:137]
  v_mfma_f32_16x16x32_bf16 v[138:141], a[64:67], v[54:57], v[138:141]
  v_mfma_f32_16x16x32_bf16 v[142:145], a[112:115], v[54:57], v[142:145]
  v_mfma_f32_16x16x32_bf16 v[146:149], a[160:163], v[54:57], v[146:149]
  v_mfma_f32_16x16x32_bf16 v[150:153], a[208:211], v[54:57], v[150:153]
  v_mfma_f32_16x16x32_bf16 v[114:117], a[20:23], v[58:61], v[114:117]
  v_mfma_f32_16x16x32_bf16 v[118:121], a[68:71], v[58:61], v[118:121]
  v_mfma_f32_16x16x32_bf16 v[122:125], a[116:119], v[58:61], v[122:125]
  v_mfma_f32_16x16x32_bf16 v[126:129], a[164:167], v[58:61], v[126:129]
  v_mfma_f32_16x16x32_bf16 v[130:133], a[212:215], v[58:61], v[130:133]
  v_mfma_f32_16x16x32_bf16 v[134:137], a[20:23], v[62:65], v[134:137]
  v_mfma_f32_16x16x32_bf16 v[138:141], a[68:71], v[62:65], v[138:141]
  v_mfma_f32_16x16x32_bf16 v[142:145], a[116:119], v[62:65], v[142:145]
  v_mfma_f32_16x16x32_bf16 v[146:149], a[164:167], v[62:65], v[146:149]
  v_mfma_f32_16x16x32_bf16 v[150:153], a[212:215], v[62:65], v[150:153]
  s_waitcnt vmcnt(0)
  v_mov_b32 v8, s32
  s_mov_b64 exec, 1
  buffer_store_dword v8, v2, s[4:7], s39 offen sc1
  s_mov_b64 exec, -1
  v_mfma_f32_16x16x32_bf16 v[114:117], a[24:27], v[66:69], v[114:117]
  v_mfma_f32_16x16x32_bf16 v[118:121], a[72:75], v[66:69], v[118:121]
  v_mfma_f32_16x16x32_bf16 v[122:125], a[120:123], v[66:69], v[122:125]
  v_mfma_f32_16x16x32_bf16 v[126:129], a[168:171], v[66:69], v[126:129]
  v_mfma_f32_16x16x32_bf16 v[130:133], a[216:219], v[66:69], v[130:133]
  v_mfma_f32_16x16x32_bf16 v[134:137], a[24:27], v[70:73], v[134:137]
  v_mfma_f32_16x16x32_bf16 v[138:141], a[72:75], v[70:73], v[138:141]
  v_mfma_f32_16x16x32_bf16 v[142:145], a[120:123], v[70:73], v[142:145]
  v_mfma_f32_16x16x32_bf16 v[146:149], a[168:171], v[70:73], v[146:149]
  v_mfma_f32_16x16x32_bf16 v[150:153], a[216:219], v[70:73], v[150:153]
  v_mfma_f32_16x16x32_bf16 v[114:117], a[28:31], v[74:77], v[114:117]
  v_mfma_f32_16x16x32_bf16 v[118:121], a[76:79], v[74:77], v[118:121]
  v_mfma_f32_16x16x32_bf16 v[122:125], a[124:127], v[74:77], v[122:125]
  v_mfma_f32_16x16x32_bf16 v[126:129], a[172:175], v[74:77], v[126:129]
  v_mfma_f32_16x16x32_bf16 v[130:133], a[220:223], v[74:77], v[130:133]
  v_mfma_f32_16x16x32_bf16 v[134:137], a[28:31], v[78:81], v[134:137]
  v_mfma_f32_16x16x32_bf16 v[138:141], a[76:79], v[78:81], v[138:141]
  v_mfma_f32_16x16x32_bf16 v[142:145], a[124:127], v[78:81], v[142:145]
  v_mfma_f32_16x16x32_bf16 v[146:149], a[172:175], v[78:81], v[146:149]
  v_mfma_f32_16x16x32_bf16 v[150:153], a[220:223], v[78:81], v[150:153]
  v_mfma_f32_16x16x32_bf16 v[114:117], a[32:35], v[82:85], v[114:117]
  v_mfma_f32_16x16x32_bf16 v[118:121], a[80:83], v[82:85], v[118:121]
  v_mfma_f32_16x16x32_bf16 v[122:125], a[128:131], v[82:85], v[122:125]
  v_mfma_f32_16x16x32_bf16 v[126:129], a[176:179], v[82:85], v[126:129]
  v_mfma_f32_16x16x32_bf16 v[130:133], a[224:227], v[82:85], v[130:133]
  v_mfma_f32_16x16x32_bf16 v[134:137], a[32:35], v[86:89], v[134:137]
  v_mfma_f32_16x16x32_bf16 v[138:141], a[80:83], v[86:89], v[138:141]
  v_mfma_f32_16x16x32_bf16 v[142:145], a[128:131], v[86:89], v[142:145]
  v_mfma_f32_16x16x32_bf16 v[146:149], a[176:179], v[86:89], v[146:149]
  v_mfma_f32_16x16x32_bf16 v[150:153], a[224:227], v[86:89], v[150:153]
  v_mfma_f32_16x16x32_bf16 v[114:117], a[36:39], v[90:93], v[114:117]
  v_mfma_f32_16x16x32_bf16 v[118:121], a[84:87], v[90:93], v[118:121]
  v_mfma_f32_16x16x32_bf16 v[122:125], a[132:135], v[90:93], v[122:125]
  v_mfma_f32_16x16x32_bf16 v[126:129], a[180:183], v[90:93], v[126:129]
  v_mfma_f32_16x16x32_bf16 v[130:133], a[228:231], v[90:93], v[130:133]
  v_mfma_f32_16x16x32_bf16 v[134:137], a[36:39], v[94:97], v[134:137]
  v_mfma_f32_16x16x32_bf16 v[138:141], a[84:87], v[94:97], v[138:141]
  v_mfma_f32_16x16x32_bf16 v[142:145], a[132:135], v[94:97], v[142:145]
  v_mfma_f32_16x16x32_bf16 v[146:149], a[180:183], v[94:97], v[146:149]
  v_mfma_f32_16x16x32_bf16 v[150:153], a[228:231], v[94:97], v[150:153]
  v_mfma_f32_16x16x32_bf16 v[114:117], a[40:43], v[98:101], v[114:117]
  v_mfma_f32_16x16x32_bf16 v[118:121], a[88:91], v[98:101], v[118:121]
  v_mfma_f32_16x16x32_bf16 v[122:125], a[136:139], v[98:101], v[122:125]
  v_mfma_f32_16x16x32_bf16 v[126:129], a[184:187], v[98:101], v[126:129]
  v_mfma_f32_16x16x32_bf16 v[130:133], a[232:235], v[98:101], v[130:133]
  v_mfma_f32_16x16x32_bf16 v[134:137], a[40:43], v[102:105], v[134:137]
  v_mfma_f32_16x16x32_bf16 v[138:141], a[88:91], v[102:105], v[138:141]
  v_mfma_f32_16x16x32_bf16 v[142:145], a[136:139], v[102:105], v[142:145]
  v_mfma_f32_16x16x32_bf16 v[146:149], a[184:187], v[102:105], v[146:149]
  v_mfma_f32_16x16x32_bf16 v[150:153], a[232:235], v[102:105], v[150:153]
  v_mfma_f32_16x16x32_bf16 v[114:117], a[44:47], v[106:109], v[114:117]
  v_mfma_f32_16x16x32_bf16 v[118:121], a[92:95], v[106:109], v[118:121]
  v_mfma_f32_16x16x32_bf16 v[122:125], a[140:143], v[106:109], v[122:125]
  v_mfma_f32_16x16x32_bf16 v[126:129], a[188:191], v[106:109], v[126:129]
  v_mfma_f32_16x16x32_bf16 v[130:133], a[236:239], v[106:109], v[130:133]
  v_mfma_f32_16x16x32_bf16 v[134:137], a[44:47], v[110:113], v[134:137]
  v_mfma_f32_16x16x32_bf16 v[138:141], a[92:95], v[110:113], v[138:141]
  v_mfma_f32_16x16x32_bf16 v[142:145], a[140:143], v[110:113], v[142:145]
  v_mfma_f32_16x16x32_bf16 v[146:149], a[188:191], v[110:113], v[146:149]
  v_mfma_f32_16x16x32_bf16 v[150:153], a[236:239], v[110:113], v[150:153]
  s_branch L_o_red1
L_o_roll1:
  v_mfma_f32_16x16x32_bf16 v[114:117], a[0:3], v[18:21], 0
  v_mfma_f32_16x16x32_bf16 v[118:121], a[48:51], v[18:21], 0
  v_mfma_f32_16x16x32_bf16 v[122:125], a[96:99], v[18:21], 0
  v_mfma_f32_16x16x32_bf16 v[126:129], a[144:147], v[18:21], 0
  v_mfma_f32_16x16x32_bf16 v[130:133], a[192:195], v[18:21], 0
  buffer_load_dwordx4 v[18:21], v1, s[4:7], s34 offen offset:0 sc1
  v_mfma_f32_16x16x32_bf16 v[134:137], a[0:3], v[22:25], 0
  v_mfma_f32_16x16x32_bf16 v[138:141], a[48:51], v[22:25], 0
  v_mfma_f32_16x16x32_bf16 v[142:145], a[96:99], v[22:25], 0
  v_mfma_f32_16x16x32_bf16 v[146:149], a[144:147], v[22:25], 0
  v_mfma_f32_16x16x32_bf16 v[150:153], a[192:195], v[22:25], 0
  buffer_load_dwordx4 v[22:25], v1, s[4:7], s35 offen offset:0 sc1
  v_mfma_f32_16x16x32_bf16 v[114:117], a[4:7], v[26:29], v[114:117]
  v_mfma_f32_16x16x32_bf16 v[118:121], a[52:55], v[26:29], v[118:121]
  v_mfma_f32_16x16x32_bf16 v[122:125], a[100:103], v[26:29], v[122:125]
  v_mfma_f32_16x16x32_bf16 v[126:129], a[148:151], v[26:29], v[126:129]
  v_mfma_f32_16x16x32_bf16 v[130:133], a[196:199], v[26:29], v[130:133]
  buffer_load_dwordx4 v[26:29], v1, s[4:7], s34 offen offset:1024 sc1
  v_mfma_f32_16x16x32_bf16 v[134:137], a[4:7], v[30:33], v[134:137]
  v_mfma_f32_16x16x32_bf16 v[138:141], a[52:55], v[30:33], v[138:141]
  v_mfma_f32_16x16x32_bf16 v[142:145], a[100:103], v[30:33], v[142:145]
  v_mfma_f32_16x16x32_bf16 v[146:149], a[148:151], v[30:33], v[146:149]
  v_mfma_f32_16x16x32_bf16 v[150:153], a[196:199], v[30:33], v[150:153]
  buffer_load_dwordx4 v[30:33], v1, s[4:7], s35 offen offset:1024 sc1
  v_mfma_f32_16x16x32_bf16 v[114:117], a[8:11], v[34:37], v[114:117]
  v_mfma_f32_16x16x32_bf16 v[118:121], a[56:59], v[34:37], v[118:121]
  v_mfma_f32_16x16x32_bf16 v[122:125], a[104:107], v[34:37], v[122:125]
  v_mfma_f32_16x16x32_bf16 v[126:129], a[152:155], v[34:37], v[126:129]
  v_mfma_f32_16x16x32_bf16 v[130:133], a[200:203], v[34:37], v[130:133]
  buffer_load_dwordx4 v[34:37], v1, s[4:7], s34 offen offset:2048 sc1
  v_mfma_f32_16x16x32_bf16 v[134:137], a[8:11], v[38:41], v[134:137]
  v_mfma_f32_16x16x32_bf16 v[138:141], a[56:59], v[38:41], v[138:141]
  v_mfma_f32_16x16x32_bf16 v[142:145], a[104:107], v[38:41], v[142:145]
  v_mfma_f32_16x16x32_bf16 v[146:149], a[152:155], v[38:41], v[146:149]
  v_mfma_f32_16x16x32_bf16 v[150:153], a[200:203], v[38:41], v[150:153]
  buffer_load_dwordx4 v[38:41], v1, s[4:7], s35 offen offset:2048 sc1
  v_mfma_f32_16x16x32_bf16 v[114:117], a[12:15], v[42:45], v[114:117]
  v_mfma_f32_16x16x32_bf16 v[118:121], a[60:63], v[42:45], v[118:121]
  v_mfma_f32_16x16x32_bf16 v[122:125], a[108:111], v[42:45], v[122:125]
  v_mfma_f32_16x16x32_bf16 v[126:129], a[156:159], v[42:45], v[126:129]
  v_mfma_f32_16x16x32_bf16 v[130:133], a[204:207], v[42:45], v[130:133]
  buffer_load_dwordx4 v[42:45], v1, s[4:7], s34 offen offset:3072 sc1
  v_mfma_f32_16x16x32_bf16 v[134:137], a[12:15], v[46:49], v[134:137]
  v_mfma_f32_16x16x32_bf16 v[138:141], a[60:63], v[46:49], v[138:141]
  v_mfma_f32_16x16x32_bf16 v[142:145], a[108:111], v[46:49], v[142:145]
  v_mfma_f32_16x16x32_bf16 v[146:149], a[156:159], v[46:49], v[146:149]
  v_mfma_f32_16x16x32_bf16 v[150:153], a[204:207], v[46:49], v[150:153]
  buffer_load_dwordx4 v[46:49], v1, s[4:7], s35 offen offset:3072 sc1
  v_mfma_f32_16x16x32_bf16 v[114:117], a[16:19], v[50:53], v[114:117]
  v_mfma_f32_16x16x32_bf16 v[118:121], a[64:67], v[50:53], v[118:121]
  v_mfma_f32_16x16x32_bf16 v[122:125], a[112:115], v[50:53], v[122:125]
  v_mfma_f32_16x16x32_bf16 v[126:129], a[160:163], v[50:53], v[126:129]
  v_mfma_f32_16x16x32_bf16 v[130:133], a[208:211], v[50:53], v[130:133]
  buffer_load_dwordx4 v[50:53], v1, s[4:7], s44 offen offset:0 sc1
  v_mfma_f32_16x16x32_bf16 v[134:137], a[16:19], v[54:57], v[134:137]
  v_mfma_f32_16x16x32_bf16 v[138:141], a[64:67], v[54:57], v[138:141]
  v_mfma_f32_16x16x32_bf16 v[142:145], a[112:115], v[54:57], v[142:145]
  v_mfma_f32_16x16x32_bf16 v[146:149], a[160:163], v[54:57], v[146:149]
  v_mfma_f32_16x16x32_bf16 v[150:153], a[208:211], v[54:57], v[150:153]
  buffer_load_dwordx4 v[54:57], v1, s[4:7], s45 offen offset:0 sc1
  v_mfma_f32_16x16x32_bf16 v[114:117], a[20:23], v[58:61], v[114:117]
  v_mfma_f32_16x16x32_bf16 v[118:121], a[68:71], v[58:61], v[118:121]
  v_mfma_f32_16x16x32_bf16 v[122:125], a[116:119], v[58:61], v[122:125]
  v_mfma_f32_16x16x32_bf16 v[126:129], a[164:167], v[58:61], v[126:129]
  v_mfma_f32_16x16x32_bf16 v[130:133], a[212:215], v[58:61], v[130:133]
  buffer_load_dwordx4 v[58:61], v1, s[4:7], s44 offen offset:1024 sc1
  v_mfma_f32_16x16x32_bf16 v[134:137], a[20:23], v[62:65], v[134:137]
  v_mfma_f32_16x16x32_bf16 v[138:141], a[68:71], v[62:65], v[138:141]
  v_mfma_f32_16x16x32_bf16 v[142:145], a[116:119], v[62:65], v[142:145]
  v_mfma_f32_16x16x32_bf16 v[146:149], a[164:167], v[62:65], v[146:149]
  v_mfma_f32_16x16x32_bf16 v[150:153], a[212:215], v[62:65], v[150:153]
  buffer_load_dwordx4 v[62:65], v1, s[4:7], s45 offen offset:1024 sc1
  s_waitcnt vmcnt(12)
  v_mov_b32 v8, s32
  s_mov_b64 exec, 1
  buffer_store_dword v8, v2, s[4:7], s39 offen sc1
  s_mov_b64 exec, -1
  v_mfma_f32_16x16x32_bf16 v[114:117], a[24:27], v[66:69], v[114:117]
  v_mfma_f32_16x16x32_bf16 v[118:121], a[72:75], v[66:69], v[118:121]
  v_mfma_f32_16x16x32_bf16 v[122:125], a[120:123], v[66:69], v[122:125]
  v_mfma_f32_16x16x32_bf16 v[126:129], a[168:171], v[66:69], v[126:129]
  v_mfma_f32_16x16x32_bf16 v[130:133], a[216:219], v[66:69], v[130:133]
  buffer_load_dwordx4 v[66:69], v1, s[4:7], s36 offen offset:0 sc1
  v_mfma_f32_16x16x32_bf16 v[134:137], a[24:27], v[70:73], v[134:137]
  v_mfma_f32_16x16x32_bf16 v[138:141], a[72:75], v[70:73], v[138:141]
  v_mfma_f32_16x16x32_bf16 v[142:145], a[120:123], v[70:73], v[142:145]
  v_mfma_f32_16x16x32_bf16 v[146:149], a[168:171], v[70:73], v[146:149]
  v_mfma_f32_16x16x32_bf16 v[150:153], a[216:219], v[70:73], v[150:153]
  buffer_load_dwordx4 v[70:73], v1, s[4:7], s37 offen offset:0 sc1
  v_mfma_f32_16x16x32_bf16 v[114:117], a[28:31], v[74:77], v[114:117]
  v_mfma_f32_16x16x32_bf16 v[118:121], a[76:79], v[74:77], v[118:121]
  v_mfma_f32_16x16x32_bf16 v[122:125], a[124:127], v[74:77], v[122:125]
  v_mfma_f32_16x16x32_bf16 v[126:129], a[172:175], v[74:77], v[126:129]
  v_mfma_f32_16x16x32_bf16 v[130:133], a[220:223], v[74:77], v[130:133]
  buffer_load_dwordx4 v[74:77], v1, s[4:7], s36 offen offset:1024 sc1
  v_mfma_f32_16x16x32_bf16 v[134:137], a[28:31], v[78:81], v[134:137]
  v_mfma_f32_16x16x32_bf16 v[138:141], a[76:79], v[78:81], v[138:141]
  v_mfma_f32_16x16x32_bf16 v[142:145], a[124:127], v[78:81], v[142:145]
  v_mfma_f32_16x16x32_bf16 v[146:149], a[172:175], v[78:81], v[146:149]
  v_mfma_f32_16x16x32_bf16 v[150:153], a[220:223], v[78:81], v[150:153]
  buffer_load_dwordx4 v[78:81], v1, s[4:7], s37 offen offset:1024 sc1
  v_mfma_f32_16x16x32_bf16 v[114:117], a[32:35], v[82:85], v[114:117]
  v_mfma_f32_16x16x32_bf16 v[118:121], a[80:83], v[82:85], v[118:121]
  v_mfma_f32_16x16x32_bf16 v[122:125], a[128:131], v[82:85], v[122:125]
  v_mfma_f32_16x16x32_bf16 v[126:129], a[176:179], v[82:85], v[126:129]
  v_mfma_f32_16x16x32_bf16 v[130:133], a[224:227], v[82:85], v[130:133]
  buffer_load_dwordx4 v[82:85], v1, s[4:7], s36 offen offset:2048 sc1
  v_mfma_f32_16x16x32_bf16 v[134:137], a[32:35], v[86:89], v[134:137]
  v_mfma_f32_16x16x32_bf16 v[138:141], a[80:83], v[86:89], v[138:141]
  v_mfma_f32_16x16x32_bf16 v[142:145], a[128:131], v[86:89], v[142:145]
  v_mfma_f32_16x16x32_bf16 v[146:149], a[176:179], v[86:89], v[146:149]
  v_mfma_f32_16x16x32_bf16 v[150:153], a[224:227], v[86:89], v[150:153]
  buffer_load_dwordx4 v[86:89], v1, s[4:7], s37 offen offset:2048 sc1
  v_mfma_f32_16x16x32_bf16 v[114:117], a[36:39], v[90:93], v[114:117]
  v_mfma_f32_16x16x32_bf16 v[118:121], a[84:87], v[90:93], v[118:121]
  v_mfma_f32_16x16x32_bf16 v[122:125], a[132:135], v[90:93], v[122:125]
  v_mfma_f32_16x16x32_bf16 v[126:129], a[180:183], v[90:93], v[126:129]
  v_mfma_f32_16x16x32_bf16 v[130:133], a[228:231], v[90:93], v[130:133]
  buffer_load_dwordx4 v[90:93], v1, s[4:7], s36 offen offset:3072 sc1
  v_mfma_f32_16x16x32_bf16 v[134:137], a[36:39], v[94:97], v[134:137]
  v_mfma_f32_16x16x32_bf16 v[138:141], a[84:87], v[94:97], v[138:141]
  v_mfma_f32_16x16x32_bf16 v[142:145], a[132:135], v[94:97], v[142:145]
  v_mfma_f32_16x16x32_bf16 v[146:149], a[180:183], v[94:97], v[146:149]
  v_mfma_f32_16x16x32_bf16 v[150:153], a[228:231], v[94:97], v[150:153]
  buffer_load_dwordx4 v[94:97], v1, s[4:7], s37 offen offset:3072 sc1
  v_mfma_f32_16x16x32_bf16 v[114:117], a[40:43], v[98:101], v[114:117]
  v_mfma_f32_16x16x32_bf16 v[118:121], a[88:91], v[98:101], v[118:121]
  v_mfma_f32_16x16x32_bf16 v[122:125], a[136:139], v[98:101], v[122:125]
  v_mfma_f32_16x16x32_bf16 v[126:129], a[184:187], v[98:101], v[126:129]
  v_mfma_f32_16x16x32_bf16 v[130:133], a[232:235], v[98:101], v[130:133]
  buffer_load_dwordx4 v[98:101], v1, s[4:7], s46 offen offset:0 sc1
  v_mfma_f32_16x16x32_bf16 v[134:137], a[40:43], v[102:105], v[134:137]
  v_mfma_f32_16x16x32_bf16 v[138:141], a[88:91], v[102:105], v[138:141]
  v_mfma_f32_16x16x32_bf16 v[142:145], a[136:139], v[102:105], v[142:145]
  v_mfma_f32_16x16x32_bf16 v[146:149], a[184:187], v[102:105], v[146:149]
  v_mfma_f32_16x16x32_bf16 v[150:153], a[232:235], v[102:105], v[150:153]
  buffer_load_dwordx4 v[102:105], v1, s[4:7], s47 offen offset:0 sc1
  v_mfma_f32_16x16x32_bf16 v[114:117], a[44:47], v[106:109], v[114:117]
  v_mfma_f32_16x16x32_bf16 v[118:121], a[92:95], v[106:109], v[118:121]
  v_mfma_f32_16x16x32_bf16 v[122:125], a[140:143], v[106:109], v[122:125]
  v_mfma_f32_16x16x32_bf16 v[126:129], a[188:191], v[106:109], v[126:129]
  v_mfma_f32_16x16x32_bf16 v[130:133], a[236:239], v[106:109], v[130:133]
  buffer_load_dwordx4 v[106:109], v1, s[4:7], s46 offen offset:1024 sc1
  v_mfma_f32_16x16x32_bf16 v[134:137], a[44:47], v[110:113], v[134:137]
  v_mfma_f32_16x16x32_bf16 v[138:141], a[92:95], v[110:113], v[138:141]
  v_mfma_f32_16x16x32_bf16 v[142:145], a[140:143], v[110:113], v[142:145]
  v_mfma_f32_16x16x32_bf16 v[146:149], a[188:191], v[110:113], v[146:149]
  v_mfma_f32_16x16x32_bf16 v[150:153], a[236:239], v[110:113], v[150:153]
  buffer_load_dwordx4 v[110:113], v1, s[4:7], s47 offen offset:1024 sc1
  s_add_u32 s34, s34, 393216
  s_add_u32 s44, s34, 4096
  s_add_u32 s35, s34, 6144
  s_add_u32 s45, s34, 10240
  s_add_u32 s36, s34, 12288
  s_add_u32 s46, s34, 16384
  s_add_u32 s37, s34, 18432
  s_add_u32 s47, s34, 22528
L_o_red1:
  s_mov_b64 exec, 0xff
  v_mov_b32 v7, 0
  buffer_atomic_add v7, v3, s[4:7], s40 offen sc0 sc1
  s_mov_b64 exec, -1
  ds_write_b128 v4, v[114:117] offset:40960
  ds_write_b128 v4, v[118:121] offset:41984
  ds_write_b128 v4, v[122:125] offset:43008
  ds_write_b128 v4, v[126:129] offset:44032
  ds_write_b128 v4, v[130:133] offset:45056
  ds_write_b128 v4, v[134:137] offset:46080
  ds_write_b128 v4, v[138:141] offset:47104
  ds_write_b128 v4, v[142:145] offset:48128
  ds_write_b128 v4, v[146:149] offset:49152
  ds_write_b128 v4, v[150:153] offset:50176
  s_waitcnt lgkmcnt(0)
  s_barrier
  v_add_u32 v9, 40960, v5
  ds_read_b128 v[154:157], v9 offset:0
  ds_read_b128 v[158:161], v9 offset:10240
  ds_read_b128 v[162:165], v9 offset:20480
  ds_read_b128 v[166:169], v9 offset:30720
  ds_read_b128 v[170:173], v9 offset:4096
  ds_read_b128 v[174:177], v9 offset:14336
  ds_read_b128 v[178:181], v9 offset:24576
  ds_read_b128 v[182:185], v9 offset:34816
  ds_read_b128 v[186:189], v9 offset:8192
  ds_read_b128 v[190:193], v9 offset:18432
  ds_read_b128 v[194:197], v9 offset:28672
  ds_read_b128 v[198:201], v9 offset:38912
  s_add_u32 s48, s38, 4096
  s_waitcnt lgkmcnt(8)
  v_pk_add_f32 v[154:155], v[154:155], v[158:159]
  v_pk_add_f32 v[162:163], v[162:163], v[166:167]
  v_pk_add_f32 v[156:157], v[156:157], v[160:161]
  v_pk_add_f32 v[164:165], v[164:165], v[168:169]
  v_pk_add_f32 v[154:155], v[154:155], v[162:163]
  v_pk_add_f32 v[156:157], v[156:157], v[164:165]
  buffer_store_dwordx4 v[154:157], v1, s[4:7], s38 offen sc1
  s_waitcnt lgkmcnt(4)
  v_pk_add_f32 v[170:171], v[170:171], v[174:175]
  v_pk_add_f32 v[178:179], v[178:179], v[182:183]
  v_pk_add_f32 v[172:173], v[172:173], v[176:177]
  v_pk_add_f32 v[180:181], v[180:181], v[184:185]
  v_pk_add_f32 v[170:171], v[170:171], v[178:179]
  v_pk_add_f32 v[172:173], v[172:173], v[180:181]
  buffer_store_dwordx4 v[170:173], v1, s[4:7], s48 offen sc1
  s_waitcnt lgkmcnt(0)
  v_pk_add_f32 v[186:187], v[186:187], v[190:191]
  v_pk_add_f32 v[194:195], v[194:195], v[198:199]
  v_pk_add_f32 v[188:189], v[188:189], v[192:193]
  v_pk_add_f32 v[196:197], v[196:197], v[200:201]
  v_pk_add_f32 v[186:187], v[186:187], v[194:195]
  v_pk_add_f32 v[188:189], v[188:189], v[196:197]
  buffer_store_dwordx4 v[186:189], v6, s[4:7], s38 offen sc1
  s_add_u32 s38, s38, 327680
  s_add_u32 s32, s32, 1
  s_cmp_lt_u32 s32, 64
  s_cbranch_scc1 L_o_seg0
  s_waitcnt vmcnt(0)
  v_mov_b32 v8, s32
  s_mov_b64 exec, 1
  buffer_store_dword v8, v2, s[4:7], s39 offen sc1
  s_mov_b64 exec, -1
  s_waitcnt vmcnt(0)
  s_branch L_exit
L_fail:
  s_mov_b64 exec, -1
  v_mov_b32 v1, 0xdead
  v_mov_b32 v2, 60
  buffer_store_dword v1, v2, s[8:11], 0 offen sc1
  s_waitcnt vmcnt(0)
L_exit:
  s_endpgm
.section .rodata,"a"
.p2align 6
.amdhsa_kernel gated_mix__memory_aug_recurrent_mem_tr__ssm_conv_h3__prompt_kernel
  .amdhsa_next_free_vgpr 512
  .amdhsa_next_free_sgpr 102
  .amdhsa_accum_offset 256
  .amdhsa_group_segment_fixed_size 0
  .amdhsa_kernarg_size 136
  .amdhsa_user_sgpr_count 2
  .amdhsa_user_sgpr_kernarg_segment_ptr 1
  .amdhsa_system_sgpr_workgroup_id_x 1
.end_amdhsa_kernel
```
